```python
import torch

def _softmax(x, axis=-1):
    return torch.softmax(x, dim=axis)

def _gelu(x):
    return torch.nn.functional.gelu(x, approximate='tanh')

def _silu(x):
    return torch.nn.functional.silu(x)

def _sigmoid(x):
    return torch.sigmoid(x)

def _layernorm(x, axis=-1, eps=1e-05):
    m = x.mean(dim=axis, keepdim=True)
    v = x.var(dim=axis, keepdim=True, unbiased=False)
    return (x - m) / torch.sqrt(v + eps)

def _scatter_add(tgt, idx, src, axis=0):
    return tgt.clone().index_add_(axis, idx, src)

def _segment_sum(src, seg, n):
    out = torch.zeros((n,) + src.shape[1:], dtype=src.dtype)
    return out.index_add_(0, seg, src)

def _pad(x, pw):
    flat = tuple((v for pair in reversed(pw) for v in pair))
    return torch.nn.functional.pad(x, flat)
kernel_name = 'interleave_layers__softmax_full_mha__memory_aug_recurrent_mem_tr__prompt'

def setup_inputs():

    _w = lambda a: (lambda t: t.to(torch.bfloat16) if t.is_floating_point() else t)(torch.as_tensor(a))

    def _A_setup():
        B, S, D = (1, 2048, 512)
        return {'x': _w((lambda *s: torch.randn(*s, dtype=torch.bfloat16) * 0.05)(B, S, D)), 'wqkv': _w((lambda *s: torch.randn(*s, dtype=torch.bfloat16) * 0.05)(D, 3 * D)), 'wo': _w((lambda *s: torch.randn(*s, dtype=torch.bfloat16) * 0.05)(D, D))}
    _A_in = _A_setup()

    def _B_setup():
        B, S, Dm = (1, 2048, 512)
        H, Dh = (32, 128)
        M, seg = (8, 32)
        seg = min(seg, S)
        S = S // seg * seg
        return {'x': _w((lambda *s: torch.randn(*s, dtype=torch.bfloat16) * 0.05)(B, S, Dm)), 'mem0': _w((lambda *s: torch.randn(*s, dtype=torch.bfloat16) * 0.8)(B, M, Dm)), 'Wq': _w((lambda *s: torch.randn(*s, dtype=torch.bfloat16) * 1.6)(Dm, H, Dh) * Dm ** (-0.5)), 'Wk': _w((lambda *s: torch.randn(*s, dtype=torch.bfloat16) * 1.6)(Dm, H, Dh) * Dm ** (-0.5)), 'Wv': _w((lambda *s: torch.randn(*s, dtype=torch.bfloat16) * 0.8)(Dm, H, Dh) * Dm ** (-0.5)), 'Wo': _w((lambda *s: torch.randn(*s, dtype=torch.bfloat16) * 0.8)(H, Dh, Dm) * (H * Dh) ** (-0.5)), 'seg_len': seg}
    _B_in = _B_setup()
    return {'A_x': _A_in['x'], 'A_wqkv': _A_in['wqkv'], 'A_wo': _A_in['wo'], 'B_x': _B_in['x'], 'B_mem0': _B_in['mem0'], 'B_Wq': _B_in['Wq'], 'B_Wk': _B_in['Wk'], 'B_Wv': _B_in['Wv'], 'B_Wo': _B_in['Wo'], 'B_seg_len': _B_in['seg_len']}

def reference(A_x, A_wqkv, A_wo, B_x, B_mem0, B_Wq, B_Wk, B_Wv, B_Wo, B_seg_len):

    def _A_ref(x, wqkv, wo):
        B, S, D = x.shape
        H = 32
        Dh = D // H
        qkv = (lambda x, *d: x.permute(*d))((x @ wqkv).reshape(B, S, 3, H, Dh), 2, 0, 3, 1, 4)
        q, k, v = (qkv[0], qkv[1], qkv[2])
        scale = Dh ** (-0.5)
        scores = torch.einsum('bhqd,bhkd->bhqk', q, k) * scale
        p = _softmax(scores, axis=-1)
        o = torch.einsum('bhqk,bhkd->bhqd', p, v)
        return (lambda x, *d: x.permute(*d))(o, 0, 2, 1, 3).reshape(B, S, D) @ wo

    def _B_ref(x, mem0, Wq, Wk, Wv, Wo, seg_len):
        B, S, Dm = x.shape
        H, Dh = (Wq.shape[1], Wq.shape[2])
        M = mem0.shape[1]
        scale = Dh ** (-0.5)
        n_seg = S // seg_len
        L = M + seg_len
        idx = torch.arange(L)
        mask = (idx[:, None] < M) | (idx[:, None] >= idx[None, :])
        mem = mem0
        outs = []
        for s in range(n_seg):
            xs = x[:, s * seg_len:(s + 1) * seg_len, :].clone()
            h = torch.concatenate([mem, xs], axis=1)
            q = torch.einsum('btd,dhe->bhte', h, Wq)
            k = torch.einsum('btd,dhe->bhte', h, Wk)
            v = torch.einsum('btd,dhe->bhte', h, Wv)
            scores = torch.einsum('bhqe,bhke->bhqk', q, k) * scale
            scores = torch.where(mask[None, None], scores, -1000000000.0)
            p = _softmax(scores, axis=-1)
            o = torch.einsum('bhqk,bhke->bhqe', p, v)
            o = torch.einsum('bhte,hed->btd', o, Wo)
            mem = o[:, :M, :].clone()
            outs.append(o[:, M:, :])
        return torch.concatenate(outs, axis=1)
    x = A_x
    x = x + _A_ref(_layernorm(x, axis=-1), A_wqkv, A_wo)
    x = x + _B_ref(_layernorm(x, axis=-1), B_mem0, B_Wq, B_Wk, B_Wv, B_Wo, B_seg_len)
    x = x + _A_ref(_layernorm(x, axis=-1), A_wqkv, A_wo)
    x = x + _B_ref(_layernorm(x, axis=-1), B_mem0, B_Wq, B_Wk, B_Wv, B_Wo, B_seg_len)
    return x
```

```asm
; @launch grid=(256,1,1) block=(256,1,1) lds=163840
.amdgcn_target "amdgcn-amd-amdhsa--gfx950"
.text
.globl interleave_layers__softmax_full_mha__memory_aug_recurrent_mem_tr__prompt_kernel
.p2align 8
.type interleave_layers__softmax_full_mha__memory_aug_recurrent_mem_tr__prompt_kernel,@function
interleave_layers__softmax_full_mha__memory_aug_recurrent_mem_tr__prompt_kernel:
    s_cmp_ge_u32 s2, 256
    s_cbranch_scc1 L_end
    s_load_dwordx16 s[4:19], s[0:1], 0
    s_load_dwordx8 s[20:27], s[0:1], 64
    s_load_dwordx2 s[28:29], s[0:1], 96
    s_getreg_b32 s3, hwreg(HW_REG_XCC_ID, 0, 4)
    s_lshl_b32 s33, s3, 2
    s_lshr_b32 s33, 0x46230715, s33
    s_and_b32 s33, s33, 7
    s_cmp_lt_u32 s3, 8
    s_cselect_b32 s3, s33, s3
    v_lshrrev_b32 v1, 6, v0
    s_mov_b32 s62, 0x40000
    v_readfirstlane_b32 s31, v1
    s_lshl_b32 s33, s3, 2
    s_lshr_b32 s34, 0x32103210, s33
    s_and_b32 s34, s34, 3
    s_lshl_b32 s34, s34, 6
    s_add_u32 s33, s33, s34
    s_add_u32 s33, s33, 28
    s_cmp_eq_u32 s3, 0
    s_cselect_b32 s33, 0, s33
    s_cmp_ge_u32 s3, 8
    s_cselect_b32 s33, 4, s33
    v_mov_b32 v1, s33
    v_mov_b32 v2, 1
    s_waitcnt lgkmcnt(0)
    s_cmp_eq_u32 s31, 0
    s_cbranch_scc1 L_tick
    s_getpc_b64 s[34:35]
L_pc0:
    v_and_b32 v5, 63, v0
    s_bfe_u32 s38, s2, 0x40003
    s_mov_b32 s39, L_code_end-L_pc0-4
    s_cmp_eq_u32 s31, 3
    s_cbranch_scc1 L_touch
    s_mov_b32 s38, s2
    s_mov_b64 s[34:35], s[4:5]
    s_mov_b32 s39, 0x1fff80
    s_cmp_eq_u32 s31, 1
    s_cbranch_scc1 L_touch
    s_mov_b64 s[34:35], s[6:7]
    s_mov_b32 s39, 0x17ff80
L_touch:
    s_lshl_b32 s38, s38, 13
    v_lshl_add_u32 v5, v5, 7, s38
    v_min_u32 v5, s39, v5
    global_load_dword v254, v5, s[34:35]
    s_branch L_tick_wait
L_tick:
    s_mov_b64 exec, 1
    global_atomic_add v3, v1, v2, s[26:27] sc0
    v_mov_b32 v4, 0
    s_waitcnt vmcnt(0)
    ds_write_b32 v4, v3
    s_waitcnt lgkmcnt(0)
    s_mov_b64 exec, -1
L_tick_wait:
    s_barrier
    v_mov_b32 v4, 0
    ds_read_b32 v3, v4
    s_waitcnt lgkmcnt(0)
    v_readfirstlane_b32 s30, v3
    s_barrier
    s_cmp_ge_u32 s3, 8
    s_cbranch_scc1 L_ovf
    s_cmp_ge_u32 s30, 32
    s_cbranch_scc1 L_ovf
L_disp:
    s_cmp_eq_u32 s3, 0
    s_cbranch_scc1 L_head
    s_sub_u32 s32, s3, 3
    s_cmp_lt_u32 s32, 2
    s_cbranch_scc1 L_qkvb
    v_mov_b32 v255, v0
    s_sub_u32 s37, s3, 1
    s_cmp_lt_u32 s3, 3
    s_cbranch_scc1 L_ln0
    s_sub_u32 s37, s3, 5
    s_and_b32 s32, s30, 7
    s_add_u32 s32, s32, 4
    s_lshr_b32 s33, s30, 3
    s_lshl_b32 s80, s37, 2
    s_add_u32 s33, s33, s80
    s_mov_b32 s34, 8
    s_cmp_lg_u32 s3, 7
    s_cbranch_scc1 L_gemm0
    s_cmp_ge_u32 s30, 24
    s_cbranch_scc1 L_proja
    s_cmp_ge_u32 s30, 16
    s_cbranch_scc1 L_qkva0
    s_and_b32 s32, s30, 3
    s_lshr_b32 s33, s30, 2
    s_mov_b32 s34, 4
    s_branch L_gemm0
L_ovf:
    s_cmp_lg_u32 s31, 0
    s_cbranch_scc1 L_ovf_w
    v_mov_b32 v1, 16
    s_mov_b64 exec, 1
    global_atomic_add v3, v1, v2, s[26:27] sc0
    s_waitcnt vmcnt(0)
    ds_write_b32 v4, v3
    s_waitcnt lgkmcnt(0)
    s_mov_b64 exec, -1
L_ovf_w:
    s_barrier
    ds_read_b32 v3, v4
    s_waitcnt lgkmcnt(0)
    v_readfirstlane_b32 s34, v3
    s_barrier
    v_and_b32 v1, 63, v0
    v_lshlrev_b32 v1, 2, v1
L_ovf_poll:
    global_load_dword v3, v1, s[26:27] sc1
    s_waitcnt vmcnt(0)
    v_readlane_b32 s40, v3, 0
    v_readlane_b32 s41, v3, 24
    v_readlane_b32 s42, v3, 41
    v_readlane_b32 s43, v3, 58
    v_readlane_b32 s44, v3, 11
    v_readlane_b32 s45, v3, 28
    v_readlane_b32 s46, v3, 45
    v_readlane_b32 s47, v3, 62
    v_readlane_b32 s48, v3, 1
    s_mov_b32 s33, 0
    s_add_u32 s33, s33, s40
    s_add_u32 s33, s33, s41
    s_add_u32 s33, s33, s42
    s_add_u32 s33, s33, s43
    s_add_u32 s33, s33, s44
    s_add_u32 s33, s33, s45
    s_add_u32 s33, s33, s46
    s_add_u32 s33, s33, s47
    s_add_u32 s33, s33, s48
    s_cmp_ge_u32 s33, 256
    s_cbranch_scc1 L_ovf_go
    s_sleep 4
    s_sub_u32 s62, s62, 1
    s_cbranch_scc0 L_ovf_poll
    s_movk_i32 s63, 20
    s_branch L_fail_far
L_ovf_go:
    s_min_u32 s33, s40, 32
    s_add_u32 s30, s33, s34
    s_mov_b32 s3, 0
    s_cmp_lt_u32 s30, 32
    s_cbranch_scc1 L_disp
    s_sub_u32 s34, s30, 32
    s_min_u32 s33, s41, 32
    s_add_u32 s30, s33, s34
    s_mov_b32 s3, 1
    s_cmp_lt_u32 s30, 32
    s_cbranch_scc1 L_disp
    s_sub_u32 s34, s30, 32
    s_min_u32 s33, s42, 32
    s_add_u32 s30, s33, s34
    s_mov_b32 s3, 2
    s_cmp_lt_u32 s30, 32
    s_cbranch_scc1 L_disp
    s_sub_u32 s34, s30, 32
    s_min_u32 s33, s43, 32
    s_add_u32 s30, s33, s34
    s_mov_b32 s3, 3
    s_cmp_lt_u32 s30, 32
    s_cbranch_scc1 L_disp
    s_sub_u32 s34, s30, 32
    s_min_u32 s33, s44, 32
    s_add_u32 s30, s33, s34
    s_mov_b32 s3, 4
    s_cmp_lt_u32 s30, 32
    s_cbranch_scc1 L_disp
    s_sub_u32 s34, s30, 32
    s_min_u32 s33, s45, 32
    s_add_u32 s30, s33, s34
    s_mov_b32 s3, 5
    s_cmp_lt_u32 s30, 32
    s_cbranch_scc1 L_disp
    s_sub_u32 s34, s30, 32
    s_min_u32 s33, s46, 32
    s_add_u32 s30, s33, s34
    s_mov_b32 s3, 6
    s_cmp_lt_u32 s30, 32
    s_cbranch_scc1 L_disp
    s_sub_u32 s34, s30, 32
    s_min_u32 s33, s47, 32
    s_add_u32 s30, s33, s34
    s_mov_b32 s3, 7
    s_cmp_lt_u32 s30, 32
    s_cbranch_scc1 L_disp
    s_sub_u32 s34, s30, 32
    s_branch L_end
L_fail_far:
    v_mov_b32 v1, 20
    v_mov_b32 v2, s63
    s_mov_b64 exec, 1
    global_store_dword v1, v2, s[26:27] sc1
L_end:
    s_endpgm
L_head:
    v_mov_b32 v127, v0
    s_lshl_b32 s70, s30, 13
    s_lshl_b32 s71, s31, 11
    s_add_u32 s70, s70, s71
    s_add_u32 s70, s70, 0x40000
    s_add_u32 s44, s28, s70
    s_addc_u32 s45, s29, 0
    s_lshl_b32 s70, s31, 16
    s_lshl_b32 s72, s30, 6
    s_add_u32 s70, s70, s72
    s_add_u32 s70, s70, 0x41000
    s_add_u32 s36, s28, s70
    s_addc_u32 s37, s29, 0
    s_add_u32 s71, s71, 0x80000
    s_add_u32 s46, s28, s71
    s_addc_u32 s47, s29, 0
    s_and_b32 s71, s30, 3
    s_mul_i32 s71, s71, 0
    s_add_u32 s40, s46, s71
    s_addc_u32 s41, s47, 0
    v_lshlrev_b32 v1, 4, v0
    v_and_b32 v1, 0x3f0, v1
    v_mov_b32 v4, -1
    v_mov_b32 v5, -1
    v_mov_b32 v6, -1
    v_mov_b32 v7, -1
    global_store_dwordx4 v1, v[4:7], s[44:45] sc1
    global_store_dwordx4 v1, v[4:7], s[44:45] offset:1024 sc1
    v_mov_b32 v1, 0x0
    v_bfe_u32 v94, v127, 0, 1
    v_lshl_add_u32 v1, v94, 4, v1
    v_bfe_u32 v94, v127, 1, 1
    v_lshl_add_u32 v1, v94, 8, v1
    v_bfe_u32 v94, v127, 2, 2
    v_lshl_add_u32 v1, v94, 13, v1
    s_lshr_b32 s70, s30, 3
    s_lshl_b32 s70, s70, 9
    s_and_b32 s71, s30, 7
    s_lshl_b32 s71, s71, 5
    s_add_u32 s38, s70, s71
    s_add_u32 s72, s46, s38
    s_addc_u32 s73, s47, 0
    global_store_dwordx4 v1, v[4:7], s[72:73] sc1
    s_waitcnt vmcnt(0)
    s_barrier
    s_cmp_lg_u32 s31, 0
    s_cbranch_scc1 L_h_noadd
    v_mov_b32 v1, 8
    v_mov_b32 v2, 1
    s_mov_b64 exec, 1
    global_atomic_add v1, v2, s[26:27]
    s_mov_b64 exec, -1
    s_waitcnt vmcnt(0)
L_h_noadd:
    s_lshl_b32 s80, s30, 8
    s_add_u32 s70, s14, s80
    s_addc_u32 s71, s15, 0
    s_add_u32 s72, s16, s80
    s_addc_u32 s73, s17, 0
    s_add_u32 s74, s18, s80
    s_addc_u32 s75, s19, 0
    s_lshl_b32 s80, s30, 17
    s_add_u32 s76, s20, s80
    s_addc_u32 s77, s21, 0
    v_mov_b32 v65, 0x0
    v_bfe_u32 v64, v127, 6, 2
    v_lshl_add_u32 v65, v64, 13, v65
    v_mov_b32 v66, 0x0
    v_bfe_i32 v64, v127, 0, 1
    v_and_b32 v64, 0x10, v64
    v_xor_b32 v66, v66, v64
    v_bfe_i32 v64, v127, 1, 1
    v_and_b32 v64, 0x20, v64
    v_xor_b32 v66, v66, v64
    v_bfe_i32 v64, v127, 2, 1
    v_and_b32 v64, 0x40, v64
    v_xor_b32 v66, v66, v64
    v_bfe_i32 v64, v127, 3, 1
    v_and_b32 v64, 0x80, v64
    v_xor_b32 v66, v66, v64
    v_bfe_i32 v64, v127, 4, 1
    v_and_b32 v64, 0x100, v64
    v_xor_b32 v66, v66, v64
    v_bfe_i32 v64, v127, 5, 1
    v_and_b32 v64, 0x200, v64
    v_xor_b32 v66, v66, v64
    v_bfe_i32 v64, v127, 7, 1
    v_and_b32 v64, 0x80, v64
    v_xor_b32 v66, v66, v64
    v_add_u32 v65, v65, v66
    v_mov_b32 v66, 0x400
    v_bfe_u32 v64, v127, 6, 2
    v_lshl_add_u32 v66, v64, 13, v66
    v_mov_b32 v67, 0x40
    v_bfe_i32 v64, v127, 0, 1
    v_and_b32 v64, 0x10, v64
    v_xor_b32 v67, v67, v64
    v_bfe_i32 v64, v127, 1, 1
    v_and_b32 v64, 0x20, v64
    v_xor_b32 v67, v67, v64
    v_bfe_i32 v64, v127, 2, 1
    v_and_b32 v64, 0x40, v64
    v_xor_b32 v67, v67, v64
    v_bfe_i32 v64, v127, 3, 1
    v_and_b32 v64, 0x80, v64
    v_xor_b32 v67, v67, v64
    v_bfe_i32 v64, v127, 4, 1
    v_and_b32 v64, 0x100, v64
    v_xor_b32 v67, v67, v64
    v_bfe_i32 v64, v127, 5, 1
    v_and_b32 v64, 0x200, v64
    v_xor_b32 v67, v67, v64
    v_bfe_i32 v64, v127, 7, 1
    v_and_b32 v64, 0x80, v64
    v_xor_b32 v67, v67, v64
    v_add_u32 v66, v66, v67
    v_mov_b32 v67, 0x800
    v_bfe_u32 v64, v127, 6, 2
    v_lshl_add_u32 v67, v64, 13, v67
    v_mov_b32 v68, 0x0
    v_bfe_i32 v64, v127, 0, 1
    v_and_b32 v64, 0x10, v64
    v_xor_b32 v68, v68, v64
    v_bfe_i32 v64, v127, 1, 1
    v_and_b32 v64, 0x20, v64
    v_xor_b32 v68, v68, v64
    v_bfe_i32 v64, v127, 2, 1
    v_and_b32 v64, 0x40, v64
    v_xor_b32 v68, v68, v64
    v_bfe_i32 v64, v127, 3, 1
    v_and_b32 v64, 0x80, v64
    v_xor_b32 v68, v68, v64
    v_bfe_i32 v64, v127, 4, 1
    v_and_b32 v64, 0x100, v64
    v_xor_b32 v68, v68, v64
    v_bfe_i32 v64, v127, 5, 1
    v_and_b32 v64, 0x200, v64
    v_xor_b32 v68, v68, v64
    v_bfe_i32 v64, v127, 7, 1
    v_and_b32 v64, 0x80, v64
    v_xor_b32 v68, v68, v64
    v_add_u32 v67, v67, v68
    v_mov_b32 v68, 0xc00
    v_bfe_u32 v64, v127, 6, 2
    v_lshl_add_u32 v68, v64, 13, v68
    v_mov_b32 v69, 0x40
    v_bfe_i32 v64, v127, 0, 1
    v_and_b32 v64, 0x10, v64
    v_xor_b32 v69, v69, v64
    v_bfe_i32 v64, v127, 1, 1
    v_and_b32 v64, 0x20, v64
    v_xor_b32 v69, v69, v64
    v_bfe_i32 v64, v127, 2, 1
    v_and_b32 v64, 0x40, v64
    v_xor_b32 v69, v69, v64
    v_bfe_i32 v64, v127, 3, 1
    v_and_b32 v64, 0x80, v64
    v_xor_b32 v69, v69, v64
    v_bfe_i32 v64, v127, 4, 1
    v_and_b32 v64, 0x100, v64
    v_xor_b32 v69, v69, v64
    v_bfe_i32 v64, v127, 5, 1
    v_and_b32 v64, 0x200, v64
    v_xor_b32 v69, v69, v64
    v_bfe_i32 v64, v127, 7, 1
    v_and_b32 v64, 0x80, v64
    v_xor_b32 v69, v69, v64
    v_add_u32 v68, v68, v69
    v_mov_b32 v69, 0x1000
    v_bfe_u32 v64, v127, 6, 2
    v_lshl_add_u32 v69, v64, 13, v69
    v_mov_b32 v70, 0x0
    v_bfe_i32 v64, v127, 0, 1
    v_and_b32 v64, 0x10, v64
    v_xor_b32 v70, v70, v64
    v_bfe_i32 v64, v127, 1, 1
    v_and_b32 v64, 0x20, v64
    v_xor_b32 v70, v70, v64
    v_bfe_i32 v64, v127, 2, 1
    v_and_b32 v64, 0x40, v64
    v_xor_b32 v70, v70, v64
    v_bfe_i32 v64, v127, 3, 1
    v_and_b32 v64, 0x80, v64
    v_xor_b32 v70, v70, v64
    v_bfe_i32 v64, v127, 4, 1
    v_and_b32 v64, 0x100, v64
    v_xor_b32 v70, v70, v64
    v_bfe_i32 v64, v127, 5, 1
    v_and_b32 v64, 0x200, v64
    v_xor_b32 v70, v70, v64
    v_bfe_i32 v64, v127, 7, 1
    v_and_b32 v64, 0x80, v64
    v_xor_b32 v70, v70, v64
    v_add_u32 v69, v69, v70
    v_mov_b32 v70, 0x1400
    v_bfe_u32 v64, v127, 6, 2
    v_lshl_add_u32 v70, v64, 13, v70
    v_mov_b32 v71, 0x40
    v_bfe_i32 v64, v127, 0, 1
    v_and_b32 v64, 0x10, v64
    v_xor_b32 v71, v71, v64
    v_bfe_i32 v64, v127, 1, 1
    v_and_b32 v64, 0x20, v64
    v_xor_b32 v71, v71, v64
    v_bfe_i32 v64, v127, 2, 1
    v_and_b32 v64, 0x40, v64
    v_xor_b32 v71, v71, v64
    v_bfe_i32 v64, v127, 3, 1
    v_and_b32 v64, 0x80, v64
    v_xor_b32 v71, v71, v64
    v_bfe_i32 v64, v127, 4, 1
    v_and_b32 v64, 0x100, v64
    v_xor_b32 v71, v71, v64
    v_bfe_i32 v64, v127, 5, 1
    v_and_b32 v64, 0x200, v64
    v_xor_b32 v71, v71, v64
    v_bfe_i32 v64, v127, 7, 1
    v_and_b32 v64, 0x80, v64
    v_xor_b32 v71, v71, v64
    v_add_u32 v70, v70, v71
    v_mov_b32 v71, 0x1800
    v_bfe_u32 v64, v127, 6, 2
    v_lshl_add_u32 v71, v64, 13, v71
    v_mov_b32 v72, 0x0
    v_bfe_i32 v64, v127, 0, 1
    v_and_b32 v64, 0x10, v64
    v_xor_b32 v72, v72, v64
    v_bfe_i32 v64, v127, 1, 1
    v_and_b32 v64, 0x20, v64
    v_xor_b32 v72, v72, v64
    v_bfe_i32 v64, v127, 2, 1
    v_and_b32 v64, 0x40, v64
    v_xor_b32 v72, v72, v64
    v_bfe_i32 v64, v127, 3, 1
    v_and_b32 v64, 0x80, v64
    v_xor_b32 v72, v72, v64
    v_bfe_i32 v64, v127, 4, 1
    v_and_b32 v64, 0x100, v64
    v_xor_b32 v72, v72, v64
    v_bfe_i32 v64, v127, 5, 1
    v_and_b32 v64, 0x200, v64
    v_xor_b32 v72, v72, v64
    v_bfe_i32 v64, v127, 7, 1
    v_and_b32 v64, 0x80, v64
    v_xor_b32 v72, v72, v64
    v_add_u32 v71, v71, v72
    v_mov_b32 v72, 0x1c00
    v_bfe_u32 v64, v127, 6, 2
    v_lshl_add_u32 v72, v64, 13, v72
    v_mov_b32 v73, 0x40
    v_bfe_i32 v64, v127, 0, 1
    v_and_b32 v64, 0x10, v64
    v_xor_b32 v73, v73, v64
    v_bfe_i32 v64, v127, 1, 1
    v_and_b32 v64, 0x20, v64
    v_xor_b32 v73, v73, v64
    v_bfe_i32 v64, v127, 2, 1
    v_and_b32 v64, 0x40, v64
    v_xor_b32 v73, v73, v64
    v_bfe_i32 v64, v127, 3, 1
    v_and_b32 v64, 0x80, v64
    v_xor_b32 v73, v73, v64
    v_bfe_i32 v64, v127, 4, 1
    v_and_b32 v64, 0x100, v64
    v_xor_b32 v73, v73, v64
    v_bfe_i32 v64, v127, 5, 1
    v_and_b32 v64, 0x200, v64
    v_xor_b32 v73, v73, v64
    v_bfe_i32 v64, v127, 7, 1
    v_and_b32 v64, 0x80, v64
    v_xor_b32 v73, v73, v64
    v_add_u32 v72, v72, v73
    v_mov_b32 v73, 0x0
    v_bfe_u32 v64, v127, 4, 2
    v_lshl_add_u32 v73, v64, 13, v73
    v_bfe_u32 v64, v127, 6, 2
    v_lshl_add_u32 v73, v64, 18, v73
    v_mov_b32 v74, 0x0
    v_bfe_i32 v64, v127, 0, 1
    v_and_b32 v64, 0x10, v64
    v_xor_b32 v74, v74, v64
    v_bfe_i32 v64, v127, 1, 1
    v_and_b32 v64, 0x20, v64
    v_xor_b32 v74, v74, v64
    v_bfe_i32 v64, v127, 2, 1
    v_and_b32 v64, 0x40, v64
    v_xor_b32 v74, v74, v64
    v_bfe_i32 v64, v127, 3, 1
    v_and_b32 v64, 0x80, v64
    v_xor_b32 v74, v74, v64
    v_bfe_i32 v64, v127, 4, 1
    v_and_b32 v64, 0x20, v64
    v_xor_b32 v74, v74, v64
    v_add_u32 v73, v73, v74
    v_mov_b32 v74, 0x8000
    v_bfe_u32 v64, v127, 4, 2
    v_lshl_add_u32 v74, v64, 13, v74
    v_bfe_u32 v64, v127, 6, 2
    v_lshl_add_u32 v74, v64, 18, v74
    v_mov_b32 v75, 0x40
    v_bfe_i32 v64, v127, 0, 1
    v_and_b32 v64, 0x10, v64
    v_xor_b32 v75, v75, v64
    v_bfe_i32 v64, v127, 1, 1
    v_and_b32 v64, 0x20, v64
    v_xor_b32 v75, v75, v64
    v_bfe_i32 v64, v127, 2, 1
    v_and_b32 v64, 0x40, v64
    v_xor_b32 v75, v75, v64
    v_bfe_i32 v64, v127, 3, 1
    v_and_b32 v64, 0x80, v64
    v_xor_b32 v75, v75, v64
    v_bfe_i32 v64, v127, 4, 1
    v_and_b32 v64, 0x20, v64
    v_xor_b32 v75, v75, v64
    v_add_u32 v74, v74, v75
    v_mov_b32 v75, 0x10000
    v_bfe_u32 v64, v127, 4, 2
    v_lshl_add_u32 v75, v64, 13, v75
    v_bfe_u32 v64, v127, 6, 2
    v_lshl_add_u32 v75, v64, 18, v75
    v_mov_b32 v76, 0x80
    v_bfe_i32 v64, v127, 0, 1
    v_and_b32 v64, 0x10, v64
    v_xor_b32 v76, v76, v64
    v_bfe_i32 v64, v127, 1, 1
    v_and_b32 v64, 0x20, v64
    v_xor_b32 v76, v76, v64
    v_bfe_i32 v64, v127, 2, 1
    v_and_b32 v64, 0x40, v64
    v_xor_b32 v76, v76, v64
    v_bfe_i32 v64, v127, 3, 1
    v_and_b32 v64, 0x80, v64
    v_xor_b32 v76, v76, v64
    v_bfe_i32 v64, v127, 4, 1
    v_and_b32 v64, 0x20, v64
    v_xor_b32 v76, v76, v64
    v_add_u32 v75, v75, v76
    v_mov_b32 v76, 0x18000
    v_bfe_u32 v64, v127, 4, 2
    v_lshl_add_u32 v76, v64, 13, v76
    v_bfe_u32 v64, v127, 6, 2
    v_lshl_add_u32 v76, v64, 18, v76
    v_mov_b32 v77, 0xc0
    v_bfe_i32 v64, v127, 0, 1
    v_and_b32 v64, 0x10, v64
    v_xor_b32 v77, v77, v64
    v_bfe_i32 v64, v127, 1, 1
    v_and_b32 v64, 0x20, v64
    v_xor_b32 v77, v77, v64
    v_bfe_i32 v64, v127, 2, 1
    v_and_b32 v64, 0x40, v64
    v_xor_b32 v77, v77, v64
    v_bfe_i32 v64, v127, 3, 1
    v_and_b32 v64, 0x80, v64
    v_xor_b32 v77, v77, v64
    v_bfe_i32 v64, v127, 4, 1
    v_and_b32 v64, 0x20, v64
    v_xor_b32 v77, v77, v64
    v_add_u32 v76, v76, v77
    v_mov_b32 v77, 0x20000
    v_bfe_u32 v64, v127, 4, 2
    v_lshl_add_u32 v77, v64, 13, v77
    v_bfe_u32 v64, v127, 6, 2
    v_lshl_add_u32 v77, v64, 18, v77
    v_mov_b32 v78, 0x0
    v_bfe_i32 v64, v127, 0, 1
    v_and_b32 v64, 0x10, v64
    v_xor_b32 v78, v78, v64
    v_bfe_i32 v64, v127, 1, 1
    v_and_b32 v64, 0x20, v64
    v_xor_b32 v78, v78, v64
    v_bfe_i32 v64, v127, 2, 1
    v_and_b32 v64, 0x40, v64
    v_xor_b32 v78, v78, v64
    v_bfe_i32 v64, v127, 3, 1
    v_and_b32 v64, 0x80, v64
    v_xor_b32 v78, v78, v64
    v_bfe_i32 v64, v127, 4, 1
    v_and_b32 v64, 0x20, v64
    v_xor_b32 v78, v78, v64
    v_add_u32 v77, v77, v78
    v_mov_b32 v78, 0x28000
    v_bfe_u32 v64, v127, 4, 2
    v_lshl_add_u32 v78, v64, 13, v78
    v_bfe_u32 v64, v127, 6, 2
    v_lshl_add_u32 v78, v64, 18, v78
    v_mov_b32 v79, 0x40
    v_bfe_i32 v64, v127, 0, 1
    v_and_b32 v64, 0x10, v64
    v_xor_b32 v79, v79, v64
    v_bfe_i32 v64, v127, 1, 1
    v_and_b32 v64, 0x20, v64
    v_xor_b32 v79, v79, v64
    v_bfe_i32 v64, v127, 2, 1
    v_and_b32 v64, 0x40, v64
    v_xor_b32 v79, v79, v64
    v_bfe_i32 v64, v127, 3, 1
    v_and_b32 v64, 0x80, v64
    v_xor_b32 v79, v79, v64
    v_bfe_i32 v64, v127, 4, 1
    v_and_b32 v64, 0x20, v64
    v_xor_b32 v79, v79, v64
    v_add_u32 v78, v78, v79
    v_mov_b32 v79, 0x30000
    v_bfe_u32 v64, v127, 4, 2
    v_lshl_add_u32 v79, v64, 13, v79
    v_bfe_u32 v64, v127, 6, 2
    v_lshl_add_u32 v79, v64, 18, v79
    v_mov_b32 v80, 0x80
    v_bfe_i32 v64, v127, 0, 1
    v_and_b32 v64, 0x10, v64
    v_xor_b32 v80, v80, v64
    v_bfe_i32 v64, v127, 1, 1
    v_and_b32 v64, 0x20, v64
    v_xor_b32 v80, v80, v64
    v_bfe_i32 v64, v127, 2, 1
    v_and_b32 v64, 0x40, v64
    v_xor_b32 v80, v80, v64
    v_bfe_i32 v64, v127, 3, 1
    v_and_b32 v64, 0x80, v64
    v_xor_b32 v80, v80, v64
    v_bfe_i32 v64, v127, 4, 1
    v_and_b32 v64, 0x20, v64
    v_xor_b32 v80, v80, v64
    v_add_u32 v79, v79, v80
    v_mov_b32 v80, 0x38000
    v_bfe_u32 v64, v127, 4, 2
    v_lshl_add_u32 v80, v64, 13, v80
    v_bfe_u32 v64, v127, 6, 2
    v_lshl_add_u32 v80, v64, 18, v80
    v_mov_b32 v81, 0xc0
    v_bfe_i32 v64, v127, 0, 1
    v_and_b32 v64, 0x10, v64
    v_xor_b32 v81, v81, v64
    v_bfe_i32 v64, v127, 1, 1
    v_and_b32 v64, 0x20, v64
    v_xor_b32 v81, v81, v64
    v_bfe_i32 v64, v127, 2, 1
    v_and_b32 v64, 0x40, v64
    v_xor_b32 v81, v81, v64
    v_bfe_i32 v64, v127, 3, 1
    v_and_b32 v64, 0x80, v64
    v_xor_b32 v81, v81, v64
    v_bfe_i32 v64, v127, 4, 1
    v_and_b32 v64, 0x20, v64
    v_xor_b32 v81, v81, v64
    v_add_u32 v80, v80, v81
    v_mov_b32 v82, 0x0
    v_bfe_i32 v64, v127, 0, 1
    v_and_b32 v64, 0x8, v64
    v_xor_b32 v82, v82, v64
    v_bfe_i32 v64, v127, 1, 1
    v_and_b32 v64, 0x10, v64
    v_xor_b32 v82, v82, v64
    v_bfe_i32 v64, v127, 2, 1
    v_and_b32 v64, 0x440, v64
    v_xor_b32 v82, v82, v64
    v_bfe_i32 v64, v127, 3, 1
    v_and_b32 v64, 0x20, v64
    v_xor_b32 v82, v82, v64
    v_bfe_i32 v64, v127, 4, 1
    v_and_b32 v64, 0x4080, v64
    v_xor_b32 v82, v82, v64
    v_bfe_i32 v64, v127, 5, 1
    v_and_b32 v64, 0x2000, v64
    v_xor_b32 v82, v82, v64
    v_bfe_i32 v64, v127, 6, 1
    v_and_b32 v64, 0x40, v64
    v_xor_b32 v82, v82, v64
    v_bfe_i32 v64, v127, 7, 1
    v_and_b32 v64, 0x80, v64
    v_xor_b32 v82, v82, v64
    v_mov_b32 v83, 0x0
    v_bfe_i32 v64, v127, 0, 1
    v_and_b32 v64, 0x10, v64
    v_xor_b32 v83, v83, v64
    v_bfe_i32 v64, v127, 1, 1
    v_and_b32 v64, 0x8, v64
    v_xor_b32 v83, v83, v64
    v_bfe_i32 v64, v127, 2, 1
    v_and_b32 v64, 0x120, v64
    v_xor_b32 v83, v83, v64
    v_bfe_i32 v64, v127, 3, 1
    v_and_b32 v64, 0x880, v64
    v_xor_b32 v83, v83, v64
    v_bfe_i32 v64, v127, 4, 1
    v_and_b32 v64, 0x440, v64
    v_xor_b32 v83, v83, v64
    v_bfe_i32 v64, v127, 5, 1
    v_and_b32 v64, 0x1000, v64
    v_xor_b32 v83, v83, v64
    v_bfe_i32 v64, v127, 6, 1
    v_and_b32 v64, 0x40, v64
    v_xor_b32 v83, v83, v64
    v_bfe_i32 v64, v127, 7, 1
    v_and_b32 v64, 0x80, v64
    v_xor_b32 v83, v83, v64
    v_mov_b32 v84, 0x20
    v_bfe_i32 v64, v127, 0, 1
    v_and_b32 v64, 0x10, v64
    v_xor_b32 v84, v84, v64
    v_bfe_i32 v64, v127, 1, 1
    v_and_b32 v64, 0x8, v64
    v_xor_b32 v84, v84, v64
    v_bfe_i32 v64, v127, 2, 1
    v_and_b32 v64, 0x120, v64
    v_xor_b32 v84, v84, v64
    v_bfe_i32 v64, v127, 3, 1
    v_and_b32 v64, 0x880, v64
    v_xor_b32 v84, v84, v64
    v_bfe_i32 v64, v127, 4, 1
    v_and_b32 v64, 0x440, v64
    v_xor_b32 v84, v84, v64
    v_bfe_i32 v64, v127, 5, 1
    v_and_b32 v64, 0x1000, v64
    v_xor_b32 v84, v84, v64
    v_bfe_i32 v64, v127, 6, 1
    v_and_b32 v64, 0x40, v64
    v_xor_b32 v84, v84, v64
    v_bfe_i32 v64, v127, 7, 1
    v_and_b32 v64, 0x80, v64
    v_xor_b32 v84, v84, v64
    v_mov_b32 v85, 0x0
    v_bfe_i32 v64, v127, 0, 1
    v_and_b32 v64, 0x8, v64
    v_xor_b32 v85, v85, v64
    v_bfe_i32 v64, v127, 1, 1
    v_and_b32 v64, 0x10, v64
    v_xor_b32 v85, v85, v64
    v_bfe_i32 v64, v127, 2, 1
    v_and_b32 v64, 0x120, v64
    v_xor_b32 v85, v85, v64
    v_bfe_i32 v64, v127, 3, 1
    v_and_b32 v64, 0x880, v64
    v_xor_b32 v85, v85, v64
    v_bfe_i32 v64, v127, 4, 1
    v_and_b32 v64, 0x440, v64
    v_xor_b32 v85, v85, v64
    v_bfe_i32 v64, v127, 5, 1
    v_and_b32 v64, 0x1000, v64
    v_xor_b32 v85, v85, v64
    v_bfe_i32 v64, v127, 6, 1
    v_and_b32 v64, 0x40, v64
    v_xor_b32 v85, v85, v64
    v_bfe_i32 v64, v127, 7, 1
    v_and_b32 v64, 0x80, v64
    v_xor_b32 v85, v85, v64
    v_mov_b32 v86, 0x20
    v_bfe_i32 v64, v127, 0, 1
    v_and_b32 v64, 0x8, v64
    v_xor_b32 v86, v86, v64
    v_bfe_i32 v64, v127, 1, 1
    v_and_b32 v64, 0x10, v64
    v_xor_b32 v86, v86, v64
    v_bfe_i32 v64, v127, 2, 1
    v_and_b32 v64, 0x120, v64
    v_xor_b32 v86, v86, v64
    v_bfe_i32 v64, v127, 3, 1
    v_and_b32 v64, 0x880, v64
    v_xor_b32 v86, v86, v64
    v_bfe_i32 v64, v127, 4, 1
    v_and_b32 v64, 0x440, v64
    v_xor_b32 v86, v86, v64
    v_bfe_i32 v64, v127, 5, 1
    v_and_b32 v64, 0x1000, v64
    v_xor_b32 v86, v86, v64
    v_bfe_i32 v64, v127, 6, 1
    v_and_b32 v64, 0x40, v64
    v_xor_b32 v86, v86, v64
    v_bfe_i32 v64, v127, 7, 1
    v_and_b32 v64, 0x80, v64
    v_xor_b32 v86, v86, v64
    s_lshl_b32 s64, s31, 13
    s_add_u32 s66, s76, 0x0
    s_addc_u32 s67, s77, 0
    s_add_u32 m0, s64, 0x20000
    s_nop 0
    global_load_lds_dwordx4 v65, s[66:67]
    s_add_u32 m0, s64, 0x20400
    s_nop 0
    global_load_lds_dwordx4 v66, s[66:67]
    s_add_u32 m0, s64, 0x20800
    s_nop 0
    global_load_lds_dwordx4 v67, s[66:67]
    s_add_u32 m0, s64, 0x20c00
    s_nop 0
    global_load_lds_dwordx4 v68, s[66:67]
    s_add_u32 m0, s64, 0x21000
    s_nop 0
    global_load_lds_dwordx4 v69, s[66:67]
    s_add_u32 m0, s64, 0x21400
    s_nop 0
    global_load_lds_dwordx4 v70, s[66:67]
    s_add_u32 m0, s64, 0x21800
    s_nop 0
    global_load_lds_dwordx4 v71, s[66:67]
    s_add_u32 m0, s64, 0x21c00
    s_nop 0
    global_load_lds_dwordx4 v72, s[66:67]
    s_add_u32 s66, s76, 0x8000
    s_addc_u32 s67, s77, 0
    s_add_u32 m0, s64, 0x0
    s_nop 0
    global_load_lds_dwordx4 v65, s[66:67]
    s_add_u32 m0, s64, 0x400
    s_nop 0
    global_load_lds_dwordx4 v66, s[66:67]
    s_add_u32 m0, s64, 0x800
    s_nop 0
    global_load_lds_dwordx4 v67, s[66:67]
    s_add_u32 m0, s64, 0xc00
    s_nop 0
    global_load_lds_dwordx4 v68, s[66:67]
    s_add_u32 m0, s64, 0x1000
    s_nop 0
    global_load_lds_dwordx4 v69, s[66:67]
    s_add_u32 m0, s64, 0x1400
    s_nop 0
    global_load_lds_dwordx4 v70, s[66:67]
    s_add_u32 m0, s64, 0x1800
    s_nop 0
    global_load_lds_dwordx4 v71, s[66:67]
    s_add_u32 m0, s64, 0x1c00
    s_nop 0
    global_load_lds_dwordx4 v72, s[66:67]
    s_add_u32 s66, s76, 0x10000
    s_addc_u32 s67, s77, 0
    s_add_u32 m0, s64, 0x8000
    s_nop 0
    global_load_lds_dwordx4 v65, s[66:67]
    s_add_u32 m0, s64, 0x8400
    s_nop 0
    global_load_lds_dwordx4 v66, s[66:67]
    s_add_u32 m0, s64, 0x8800
    s_nop 0
    global_load_lds_dwordx4 v67, s[66:67]
    s_add_u32 m0, s64, 0x8c00
    s_nop 0
    global_load_lds_dwordx4 v68, s[66:67]
    s_add_u32 m0, s64, 0x9000
    s_nop 0
    global_load_lds_dwordx4 v69, s[66:67]
    s_add_u32 m0, s64, 0x9400
    s_nop 0
    global_load_lds_dwordx4 v70, s[66:67]
    s_add_u32 m0, s64, 0x9800
    s_nop 0
    global_load_lds_dwordx4 v71, s[66:67]
    s_add_u32 m0, s64, 0x9c00
    s_nop 0
    global_load_lds_dwordx4 v72, s[66:67]
    s_add_u32 s66, s76, 0x18000
    s_addc_u32 s67, s77, 0
    s_add_u32 m0, s64, 0x10000
    s_nop 0
    global_load_lds_dwordx4 v65, s[66:67]
    s_add_u32 m0, s64, 0x10400
    s_nop 0
    global_load_lds_dwordx4 v66, s[66:67]
    s_add_u32 m0, s64, 0x10800
    s_nop 0
    global_load_lds_dwordx4 v67, s[66:67]
    s_add_u32 m0, s64, 0x10c00
    s_nop 0
    global_load_lds_dwordx4 v68, s[66:67]
    s_add_u32 m0, s64, 0x11000
    s_nop 0
    global_load_lds_dwordx4 v69, s[66:67]
    s_add_u32 m0, s64, 0x11400
    s_nop 0
    global_load_lds_dwordx4 v70, s[66:67]
    s_add_u32 m0, s64, 0x11800
    s_nop 0
    global_load_lds_dwordx4 v71, s[66:67]
    s_add_u32 m0, s64, 0x11c00
    s_nop 0
    global_load_lds_dwordx4 v72, s[66:67]
    s_waitcnt vmcnt(24)
    s_barrier
    s_add_u32 s66, s74, 0x0
    s_addc_u32 s67, s75, 0
    s_add_u32 m0, s64, 0x18000
    s_nop 0
    global_load_lds_dwordx4 v73, s[66:67]
    s_add_u32 m0, s64, 0x18400
    s_nop 0
    global_load_lds_dwordx4 v74, s[66:67]
    s_add_u32 m0, s64, 0x18800
    s_nop 0
    global_load_lds_dwordx4 v75, s[66:67]
    s_add_u32 m0, s64, 0x18c00
    s_nop 0
    global_load_lds_dwordx4 v76, s[66:67]
    s_add_u32 m0, s64, 0x19000
    s_nop 0
    global_load_lds_dwordx4 v77, s[66:67]
    s_add_u32 m0, s64, 0x19400
    s_nop 0
    global_load_lds_dwordx4 v78, s[66:67]
    s_add_u32 m0, s64, 0x19800
    s_nop 0
    global_load_lds_dwordx4 v79, s[66:67]
    s_add_u32 m0, s64, 0x19c00
    s_nop 0
    global_load_lds_dwordx4 v80, s[66:67]
    v_add_u32 v90, 0x20000, v82
    s_cmp_lg_u32 s31, 0
    s_cbranch_scc1 L_lw_1_0
    ds_read_b64_tr_b16 a[0:1], v90 offset:0
    ds_read_b64_tr_b16 a[2:3], v90 offset:2048
    ds_read_b64_tr_b16 a[4:5], v90 offset:4096
    ds_read_b64_tr_b16 a[6:7], v90 offset:6144
    ds_read_b64_tr_b16 a[32:33], v90 offset:256
    ds_read_b64_tr_b16 a[34:35], v90 offset:2304
    ds_read_b64_tr_b16 a[36:37], v90 offset:4352
    ds_read_b64_tr_b16 a[38:39], v90 offset:6400
    ds_read_b64_tr_b16 a[64:65], v90 offset:512
    ds_read_b64_tr_b16 a[66:67], v90 offset:2560
    ds_read_b64_tr_b16 a[68:69], v90 offset:4608
    ds_read_b64_tr_b16 a[70:71], v90 offset:6656
    ds_read_b64_tr_b16 a[96:97], v90 offset:768
    ds_read_b64_tr_b16 a[98:99], v90 offset:2816
    ds_read_b64_tr_b16 a[100:101], v90 offset:4864
    ds_read_b64_tr_b16 a[102:103], v90 offset:6912
    s_branch L_lw_1
L_lw_1_0:
    s_cmp_lg_u32 s31, 1
    s_cbranch_scc1 L_lw_1_1
    ds_read_b64_tr_b16 a[8:9], v90 offset:0
    ds_read_b64_tr_b16 a[10:11], v90 offset:2048
    ds_read_b64_tr_b16 a[12:13], v90 offset:4096
    ds_read_b64_tr_b16 a[14:15], v90 offset:6144
    ds_read_b64_tr_b16 a[40:41], v90 offset:256
    ds_read_b64_tr_b16 a[42:43], v90 offset:2304
    ds_read_b64_tr_b16 a[44:45], v90 offset:4352
    ds_read_b64_tr_b16 a[46:47], v90 offset:6400
    ds_read_b64_tr_b16 a[72:73], v90 offset:512
    ds_read_b64_tr_b16 a[74:75], v90 offset:2560
    ds_read_b64_tr_b16 a[76:77], v90 offset:4608
    ds_read_b64_tr_b16 a[78:79], v90 offset:6656
    ds_read_b64_tr_b16 a[104:105], v90 offset:768
    ds_read_b64_tr_b16 a[106:107], v90 offset:2816
    ds_read_b64_tr_b16 a[108:109], v90 offset:4864
    ds_read_b64_tr_b16 a[110:111], v90 offset:6912
    s_branch L_lw_1
L_lw_1_1:
    s_cmp_lg_u32 s31, 2
    s_cbranch_scc1 L_lw_1_2
    ds_read_b64_tr_b16 a[16:17], v90 offset:0
    ds_read_b64_tr_b16 a[18:19], v90 offset:2048
    ds_read_b64_tr_b16 a[20:21], v90 offset:4096
    ds_read_b64_tr_b16 a[22:23], v90 offset:6144
    ds_read_b64_tr_b16 a[48:49], v90 offset:256
    ds_read_b64_tr_b16 a[50:51], v90 offset:2304
    ds_read_b64_tr_b16 a[52:53], v90 offset:4352
    ds_read_b64_tr_b16 a[54:55], v90 offset:6400
    ds_read_b64_tr_b16 a[80:81], v90 offset:512
    ds_read_b64_tr_b16 a[82:83], v90 offset:2560
    ds_read_b64_tr_b16 a[84:85], v90 offset:4608
    ds_read_b64_tr_b16 a[86:87], v90 offset:6656
    ds_read_b64_tr_b16 a[112:113], v90 offset:768
    ds_read_b64_tr_b16 a[114:115], v90 offset:2816
    ds_read_b64_tr_b16 a[116:117], v90 offset:4864
    ds_read_b64_tr_b16 a[118:119], v90 offset:6912
    s_branch L_lw_1
L_lw_1_2:
    ds_read_b64_tr_b16 a[24:25], v90 offset:0
    ds_read_b64_tr_b16 a[26:27], v90 offset:2048
    ds_read_b64_tr_b16 a[28:29], v90 offset:4096
    ds_read_b64_tr_b16 a[30:31], v90 offset:6144
    ds_read_b64_tr_b16 a[56:57], v90 offset:256
    ds_read_b64_tr_b16 a[58:59], v90 offset:2304
    ds_read_b64_tr_b16 a[60:61], v90 offset:4352
    ds_read_b64_tr_b16 a[62:63], v90 offset:6400
    ds_read_b64_tr_b16 a[88:89], v90 offset:512
    ds_read_b64_tr_b16 a[90:91], v90 offset:2560
    ds_read_b64_tr_b16 a[92:93], v90 offset:4608
    ds_read_b64_tr_b16 a[94:95], v90 offset:6656
    ds_read_b64_tr_b16 a[120:121], v90 offset:768
    ds_read_b64_tr_b16 a[122:123], v90 offset:2816
    ds_read_b64_tr_b16 a[124:125], v90 offset:4864
    ds_read_b64_tr_b16 a[126:127], v90 offset:6912
L_lw_1:
    s_waitcnt lgkmcnt(0)
    s_waitcnt vmcnt(24)
    s_barrier
    s_add_u32 s66, s74, 0x100000
    s_addc_u32 s67, s75, 0
    s_add_u32 m0, s64, 0x20000
    s_nop 0
    global_load_lds_dwordx4 v73, s[66:67]
    s_add_u32 m0, s64, 0x20400
    s_nop 0
    global_load_lds_dwordx4 v74, s[66:67]
    s_add_u32 m0, s64, 0x20800
    s_nop 0
    global_load_lds_dwordx4 v75, s[66:67]
    s_add_u32 m0, s64, 0x20c00
    s_nop 0
    global_load_lds_dwordx4 v76, s[66:67]
    s_add_u32 m0, s64, 0x21000
    s_nop 0
    global_load_lds_dwordx4 v77, s[66:67]
    s_add_u32 m0, s64, 0x21400
    s_nop 0
    global_load_lds_dwordx4 v78, s[66:67]
    s_add_u32 m0, s64, 0x21800
    s_nop 0
    global_load_lds_dwordx4 v79, s[66:67]
    s_add_u32 m0, s64, 0x21c00
    s_nop 0
    global_load_lds_dwordx4 v80, s[66:67]
    v_add_u32 v90, 0x0, v82
    s_cmp_lg_u32 s31, 1
    s_cbranch_scc1 L_lw_2_0
    ds_read_b64_tr_b16 a[0:1], v90 offset:0
    ds_read_b64_tr_b16 a[2:3], v90 offset:2048
    ds_read_b64_tr_b16 a[4:5], v90 offset:4096
    ds_read_b64_tr_b16 a[6:7], v90 offset:6144
    ds_read_b64_tr_b16 a[32:33], v90 offset:256
    ds_read_b64_tr_b16 a[34:35], v90 offset:2304
    ds_read_b64_tr_b16 a[36:37], v90 offset:4352
    ds_read_b64_tr_b16 a[38:39], v90 offset:6400
    ds_read_b64_tr_b16 a[64:65], v90 offset:512
    ds_read_b64_tr_b16 a[66:67], v90 offset:2560
    ds_read_b64_tr_b16 a[68:69], v90 offset:4608
    ds_read_b64_tr_b16 a[70:71], v90 offset:6656
    ds_read_b64_tr_b16 a[96:97], v90 offset:768
    ds_read_b64_tr_b16 a[98:99], v90 offset:2816
    ds_read_b64_tr_b16 a[100:101], v90 offset:4864
    ds_read_b64_tr_b16 a[102:103], v90 offset:6912
    s_branch L_lw_2
L_lw_2_0:
    s_cmp_lg_u32 s31, 0
    s_cbranch_scc1 L_lw_2_1
    ds_read_b64_tr_b16 a[8:9], v90 offset:0
    ds_read_b64_tr_b16 a[10:11], v90 offset:2048
    ds_read_b64_tr_b16 a[12:13], v90 offset:4096
    ds_read_b64_tr_b16 a[14:15], v90 offset:6144
    ds_read_b64_tr_b16 a[40:41], v90 offset:256
    ds_read_b64_tr_b16 a[42:43], v90 offset:2304
    ds_read_b64_tr_b16 a[44:45], v90 offset:4352
    ds_read_b64_tr_b16 a[46:47], v90 offset:6400
    ds_read_b64_tr_b16 a[72:73], v90 offset:512
    ds_read_b64_tr_b16 a[74:75], v90 offset:2560
    ds_read_b64_tr_b16 a[76:77], v90 offset:4608
    ds_read_b64_tr_b16 a[78:79], v90 offset:6656
    ds_read_b64_tr_b16 a[104:105], v90 offset:768
    ds_read_b64_tr_b16 a[106:107], v90 offset:2816
    ds_read_b64_tr_b16 a[108:109], v90 offset:4864
    ds_read_b64_tr_b16 a[110:111], v90 offset:6912
    s_branch L_lw_2
L_lw_2_1:
    s_cmp_lg_u32 s31, 3
    s_cbranch_scc1 L_lw_2_2
    ds_read_b64_tr_b16 a[16:17], v90 offset:0
    ds_read_b64_tr_b16 a[18:19], v90 offset:2048
    ds_read_b64_tr_b16 a[20:21], v90 offset:4096
    ds_read_b64_tr_b16 a[22:23], v90 offset:6144
    ds_read_b64_tr_b16 a[48:49], v90 offset:256
    ds_read_b64_tr_b16 a[50:51], v90 offset:2304
    ds_read_b64_tr_b16 a[52:53], v90 offset:4352
    ds_read_b64_tr_b16 a[54:55], v90 offset:6400
    ds_read_b64_tr_b16 a[80:81], v90 offset:512
    ds_read_b64_tr_b16 a[82:83], v90 offset:2560
    ds_read_b64_tr_b16 a[84:85], v90 offset:4608
    ds_read_b64_tr_b16 a[86:87], v90 offset:6656
    ds_read_b64_tr_b16 a[112:113], v90 offset:768
    ds_read_b64_tr_b16 a[114:115], v90 offset:2816
    ds_read_b64_tr_b16 a[116:117], v90 offset:4864
    ds_read_b64_tr_b16 a[118:119], v90 offset:6912
    s_branch L_lw_2
L_lw_2_2:
    ds_read_b64_tr_b16 a[24:25], v90 offset:0
    ds_read_b64_tr_b16 a[26:27], v90 offset:2048
    ds_read_b64_tr_b16 a[28:29], v90 offset:4096
    ds_read_b64_tr_b16 a[30:31], v90 offset:6144
    ds_read_b64_tr_b16 a[56:57], v90 offset:256
    ds_read_b64_tr_b16 a[58:59], v90 offset:2304
    ds_read_b64_tr_b16 a[60:61], v90 offset:4352
    ds_read_b64_tr_b16 a[62:63], v90 offset:6400
    ds_read_b64_tr_b16 a[88:89], v90 offset:512
    ds_read_b64_tr_b16 a[90:91], v90 offset:2560
    ds_read_b64_tr_b16 a[92:93], v90 offset:4608
    ds_read_b64_tr_b16 a[94:95], v90 offset:6656
    ds_read_b64_tr_b16 a[120:121], v90 offset:768
    ds_read_b64_tr_b16 a[122:123], v90 offset:2816
    ds_read_b64_tr_b16 a[124:125], v90 offset:4864
    ds_read_b64_tr_b16 a[126:127], v90 offset:6912
L_lw_2:
    s_waitcnt lgkmcnt(0)
    s_waitcnt vmcnt(24)
    s_barrier
    s_add_u32 s66, s74, 0x200000
    s_addc_u32 s67, s75, 0
    s_add_u32 m0, s64, 0x0
    s_nop 0
    global_load_lds_dwordx4 v73, s[66:67]
    s_add_u32 m0, s64, 0x400
    s_nop 0
    global_load_lds_dwordx4 v74, s[66:67]
    s_add_u32 m0, s64, 0x800
    s_nop 0
    global_load_lds_dwordx4 v75, s[66:67]
    s_add_u32 m0, s64, 0xc00
    s_nop 0
    global_load_lds_dwordx4 v76, s[66:67]
    s_add_u32 m0, s64, 0x1000
    s_nop 0
    global_load_lds_dwordx4 v77, s[66:67]
    s_add_u32 m0, s64, 0x1400
    s_nop 0
    global_load_lds_dwordx4 v78, s[66:67]
    s_add_u32 m0, s64, 0x1800
    s_nop 0
    global_load_lds_dwordx4 v79, s[66:67]
    s_add_u32 m0, s64, 0x1c00
    s_nop 0
    global_load_lds_dwordx4 v80, s[66:67]
    v_add_u32 v90, 0x8000, v82
    s_cmp_lg_u32 s31, 2
    s_cbranch_scc1 L_lw_3_0
    ds_read_b64_tr_b16 a[0:1], v90 offset:0
    ds_read_b64_tr_b16 a[2:3], v90 offset:2048
    ds_read_b64_tr_b16 a[4:5], v90 offset:4096
    ds_read_b64_tr_b16 a[6:7], v90 offset:6144
    ds_read_b64_tr_b16 a[32:33], v90 offset:256
    ds_read_b64_tr_b16 a[34:35], v90 offset:2304
    ds_read_b64_tr_b16 a[36:37], v90 offset:4352
    ds_read_b64_tr_b16 a[38:39], v90 offset:6400
    ds_read_b64_tr_b16 a[64:65], v90 offset:512
    ds_read_b64_tr_b16 a[66:67], v90 offset:2560
    ds_read_b64_tr_b16 a[68:69], v90 offset:4608
    ds_read_b64_tr_b16 a[70:71], v90 offset:6656
    ds_read_b64_tr_b16 a[96:97], v90 offset:768
    ds_read_b64_tr_b16 a[98:99], v90 offset:2816
    ds_read_b64_tr_b16 a[100:101], v90 offset:4864
    ds_read_b64_tr_b16 a[102:103], v90 offset:6912
    s_branch L_lw_3
L_lw_3_0:
    s_cmp_lg_u32 s31, 3
    s_cbranch_scc1 L_lw_3_1
    ds_read_b64_tr_b16 a[8:9], v90 offset:0
    ds_read_b64_tr_b16 a[10:11], v90 offset:2048
    ds_read_b64_tr_b16 a[12:13], v90 offset:4096
    ds_read_b64_tr_b16 a[14:15], v90 offset:6144
    ds_read_b64_tr_b16 a[40:41], v90 offset:256
    ds_read_b64_tr_b16 a[42:43], v90 offset:2304
    ds_read_b64_tr_b16 a[44:45], v90 offset:4352
    ds_read_b64_tr_b16 a[46:47], v90 offset:6400
    ds_read_b64_tr_b16 a[72:73], v90 offset:512
    ds_read_b64_tr_b16 a[74:75], v90 offset:2560
    ds_read_b64_tr_b16 a[76:77], v90 offset:4608
    ds_read_b64_tr_b16 a[78:79], v90 offset:6656
    ds_read_b64_tr_b16 a[104:105], v90 offset:768
    ds_read_b64_tr_b16 a[106:107], v90 offset:2816
    ds_read_b64_tr_b16 a[108:109], v90 offset:4864
    ds_read_b64_tr_b16 a[110:111], v90 offset:6912
    s_branch L_lw_3
L_lw_3_1:
    s_cmp_lg_u32 s31, 0
    s_cbranch_scc1 L_lw_3_2
    ds_read_b64_tr_b16 a[16:17], v90 offset:0
    ds_read_b64_tr_b16 a[18:19], v90 offset:2048
    ds_read_b64_tr_b16 a[20:21], v90 offset:4096
    ds_read_b64_tr_b16 a[22:23], v90 offset:6144
    ds_read_b64_tr_b16 a[48:49], v90 offset:256
    ds_read_b64_tr_b16 a[50:51], v90 offset:2304
    ds_read_b64_tr_b16 a[52:53], v90 offset:4352
    ds_read_b64_tr_b16 a[54:55], v90 offset:6400
    ds_read_b64_tr_b16 a[80:81], v90 offset:512
    ds_read_b64_tr_b16 a[82:83], v90 offset:2560
    ds_read_b64_tr_b16 a[84:85], v90 offset:4608
    ds_read_b64_tr_b16 a[86:87], v90 offset:6656
    ds_read_b64_tr_b16 a[112:113], v90 offset:768
    ds_read_b64_tr_b16 a[114:115], v90 offset:2816
    ds_read_b64_tr_b16 a[116:117], v90 offset:4864
    ds_read_b64_tr_b16 a[118:119], v90 offset:6912
    s_branch L_lw_3
L_lw_3_2:
    ds_read_b64_tr_b16 a[24:25], v90 offset:0
    ds_read_b64_tr_b16 a[26:27], v90 offset:2048
    ds_read_b64_tr_b16 a[28:29], v90 offset:4096
    ds_read_b64_tr_b16 a[30:31], v90 offset:6144
    ds_read_b64_tr_b16 a[56:57], v90 offset:256
    ds_read_b64_tr_b16 a[58:59], v90 offset:2304
    ds_read_b64_tr_b16 a[60:61], v90 offset:4352
    ds_read_b64_tr_b16 a[62:63], v90 offset:6400
    ds_read_b64_tr_b16 a[88:89], v90 offset:512
    ds_read_b64_tr_b16 a[90:91], v90 offset:2560
    ds_read_b64_tr_b16 a[92:93], v90 offset:4608
    ds_read_b64_tr_b16 a[94:95], v90 offset:6656
    ds_read_b64_tr_b16 a[120:121], v90 offset:768
    ds_read_b64_tr_b16 a[122:123], v90 offset:2816
    ds_read_b64_tr_b16 a[124:125], v90 offset:4864
    ds_read_b64_tr_b16 a[126:127], v90 offset:6912
L_lw_3:
    s_waitcnt lgkmcnt(0)
    s_waitcnt vmcnt(24)
    s_barrier
    s_add_u32 s66, s74, 0x300000
    s_addc_u32 s67, s75, 0
    s_add_u32 m0, s64, 0x8000
    s_nop 0
    global_load_lds_dwordx4 v73, s[66:67]
    s_add_u32 m0, s64, 0x8400
    s_nop 0
    global_load_lds_dwordx4 v74, s[66:67]
    s_add_u32 m0, s64, 0x8800
    s_nop 0
    global_load_lds_dwordx4 v75, s[66:67]
    s_add_u32 m0, s64, 0x8c00
    s_nop 0
    global_load_lds_dwordx4 v76, s[66:67]
    s_add_u32 m0, s64, 0x9000
    s_nop 0
    global_load_lds_dwordx4 v77, s[66:67]
    s_add_u32 m0, s64, 0x9400
    s_nop 0
    global_load_lds_dwordx4 v78, s[66:67]
    s_add_u32 m0, s64, 0x9800
    s_nop 0
    global_load_lds_dwordx4 v79, s[66:67]
    s_add_u32 m0, s64, 0x9c00
    s_nop 0
    global_load_lds_dwordx4 v80, s[66:67]
    v_add_u32 v90, 0x10000, v82
    s_cmp_lg_u32 s31, 3
    s_cbranch_scc1 L_lw_4_0
    ds_read_b64_tr_b16 a[0:1], v90 offset:0
    ds_read_b64_tr_b16 a[2:3], v90 offset:2048
    ds_read_b64_tr_b16 a[4:5], v90 offset:4096
    ds_read_b64_tr_b16 a[6:7], v90 offset:6144
    ds_read_b64_tr_b16 a[32:33], v90 offset:256
    ds_read_b64_tr_b16 a[34:35], v90 offset:2304
    ds_read_b64_tr_b16 a[36:37], v90 offset:4352
    ds_read_b64_tr_b16 a[38:39], v90 offset:6400
    ds_read_b64_tr_b16 a[64:65], v90 offset:512
    ds_read_b64_tr_b16 a[66:67], v90 offset:2560
    ds_read_b64_tr_b16 a[68:69], v90 offset:4608
    ds_read_b64_tr_b16 a[70:71], v90 offset:6656
    ds_read_b64_tr_b16 a[96:97], v90 offset:768
    ds_read_b64_tr_b16 a[98:99], v90 offset:2816
    ds_read_b64_tr_b16 a[100:101], v90 offset:4864
    ds_read_b64_tr_b16 a[102:103], v90 offset:6912
    s_branch L_lw_4
L_lw_4_0:
    s_cmp_lg_u32 s31, 2
    s_cbranch_scc1 L_lw_4_1
    ds_read_b64_tr_b16 a[8:9], v90 offset:0
    ds_read_b64_tr_b16 a[10:11], v90 offset:2048
    ds_read_b64_tr_b16 a[12:13], v90 offset:4096
    ds_read_b64_tr_b16 a[14:15], v90 offset:6144
    ds_read_b64_tr_b16 a[40:41], v90 offset:256
    ds_read_b64_tr_b16 a[42:43], v90 offset:2304
    ds_read_b64_tr_b16 a[44:45], v90 offset:4352
    ds_read_b64_tr_b16 a[46:47], v90 offset:6400
    ds_read_b64_tr_b16 a[72:73], v90 offset:512
    ds_read_b64_tr_b16 a[74:75], v90 offset:2560
    ds_read_b64_tr_b16 a[76:77], v90 offset:4608
    ds_read_b64_tr_b16 a[78:79], v90 offset:6656
    ds_read_b64_tr_b16 a[104:105], v90 offset:768
    ds_read_b64_tr_b16 a[106:107], v90 offset:2816
    ds_read_b64_tr_b16 a[108:109], v90 offset:4864
    ds_read_b64_tr_b16 a[110:111], v90 offset:6912
    s_branch L_lw_4
L_lw_4_1:
    s_cmp_lg_u32 s31, 1
    s_cbranch_scc1 L_lw_4_2
    ds_read_b64_tr_b16 a[16:17], v90 offset:0
    ds_read_b64_tr_b16 a[18:19], v90 offset:2048
    ds_read_b64_tr_b16 a[20:21], v90 offset:4096
    ds_read_b64_tr_b16 a[22:23], v90 offset:6144
    ds_read_b64_tr_b16 a[48:49], v90 offset:256
    ds_read_b64_tr_b16 a[50:51], v90 offset:2304
    ds_read_b64_tr_b16 a[52:53], v90 offset:4352
    ds_read_b64_tr_b16 a[54:55], v90 offset:6400
    ds_read_b64_tr_b16 a[80:81], v90 offset:512
    ds_read_b64_tr_b16 a[82:83], v90 offset:2560
    ds_read_b64_tr_b16 a[84:85], v90 offset:4608
    ds_read_b64_tr_b16 a[86:87], v90 offset:6656
    ds_read_b64_tr_b16 a[112:113], v90 offset:768
    ds_read_b64_tr_b16 a[114:115], v90 offset:2816
    ds_read_b64_tr_b16 a[116:117], v90 offset:4864
    ds_read_b64_tr_b16 a[118:119], v90 offset:6912
    s_branch L_lw_4
L_lw_4_2:
    ds_read_b64_tr_b16 a[24:25], v90 offset:0
    ds_read_b64_tr_b16 a[26:27], v90 offset:2048
    ds_read_b64_tr_b16 a[28:29], v90 offset:4096
    ds_read_b64_tr_b16 a[30:31], v90 offset:6144
    ds_read_b64_tr_b16 a[56:57], v90 offset:256
    ds_read_b64_tr_b16 a[58:59], v90 offset:2304
    ds_read_b64_tr_b16 a[60:61], v90 offset:4352
    ds_read_b64_tr_b16 a[62:63], v90 offset:6400
    ds_read_b64_tr_b16 a[88:89], v90 offset:512
    ds_read_b64_tr_b16 a[90:91], v90 offset:2560
    ds_read_b64_tr_b16 a[92:93], v90 offset:4608
    ds_read_b64_tr_b16 a[94:95], v90 offset:6656
    ds_read_b64_tr_b16 a[120:121], v90 offset:768
    ds_read_b64_tr_b16 a[122:123], v90 offset:2816
    ds_read_b64_tr_b16 a[124:125], v90 offset:4864
    ds_read_b64_tr_b16 a[126:127], v90 offset:6912
L_lw_4:
    s_waitcnt lgkmcnt(0)
    s_waitcnt vmcnt(24)
    s_barrier
    s_add_u32 s66, s70, 0x0
    s_addc_u32 s67, s71, 0
    s_add_u32 m0, s64, 0x10000
    s_nop 0
    global_load_lds_dwordx4 v73, s[66:67]
    s_add_u32 m0, s64, 0x10400
    s_nop 0
    global_load_lds_dwordx4 v74, s[66:67]
    s_add_u32 m0, s64, 0x10800
    s_nop 0
    global_load_lds_dwordx4 v75, s[66:67]
    s_add_u32 m0, s64, 0x10c00
    s_nop 0
    global_load_lds_dwordx4 v76, s[66:67]
    s_add_u32 m0, s64, 0x11000
    s_nop 0
    global_load_lds_dwordx4 v77, s[66:67]
    s_add_u32 m0, s64, 0x11400
    s_nop 0
    global_load_lds_dwordx4 v78, s[66:67]
    s_add_u32 m0, s64, 0x11800
    s_nop 0
    global_load_lds_dwordx4 v79, s[66:67]
    s_add_u32 m0, s64, 0x11c00
    s_nop 0
    global_load_lds_dwordx4 v80, s[66:67]
    v_add_u32 v90, 0x18000, v83
    v_add_u32 v91, 0x18000, v84
    s_cmp_lg_u32 s31, 0
    s_cbranch_scc1 L_lw_5_0
    ds_read_b64_tr_b16 a[128:129], v90 offset:0
    ds_read_b64_tr_b16 a[130:131], v90 offset:512
    ds_read_b64_tr_b16 a[132:133], v90 offset:8192
    ds_read_b64_tr_b16 a[134:135], v90 offset:8704
    ds_read_b64_tr_b16 a[192:193], v91 offset:0
    ds_read_b64_tr_b16 a[194:195], v91 offset:512
    ds_read_b64_tr_b16 a[196:197], v91 offset:8192
    ds_read_b64_tr_b16 a[198:199], v91 offset:8704
    ds_read_b64_tr_b16 a[136:137], v90 offset:16384
    ds_read_b64_tr_b16 a[138:139], v90 offset:16896
    ds_read_b64_tr_b16 a[140:141], v90 offset:24576
    ds_read_b64_tr_b16 a[142:143], v90 offset:25088
    ds_read_b64_tr_b16 a[200:201], v91 offset:16384
    ds_read_b64_tr_b16 a[202:203], v91 offset:16896
    ds_read_b64_tr_b16 a[204:205], v91 offset:24576
    ds_read_b64_tr_b16 a[206:207], v91 offset:25088
    s_branch L_lw_5
L_lw_5_0:
    s_cmp_lg_u32 s31, 1
    s_cbranch_scc1 L_lw_5_1
    ds_read_b64_tr_b16 a[144:145], v90 offset:0
    ds_read_b64_tr_b16 a[146:147], v90 offset:512
    ds_read_b64_tr_b16 a[148:149], v90 offset:8192
    ds_read_b64_tr_b16 a[150:151], v90 offset:8704
    ds_read_b64_tr_b16 a[208:209], v91 offset:0
    ds_read_b64_tr_b16 a[210:211], v91 offset:512
    ds_read_b64_tr_b16 a[212:213], v91 offset:8192
    ds_read_b64_tr_b16 a[214:215], v91 offset:8704
    ds_read_b64_tr_b16 a[152:153], v90 offset:16384
    ds_read_b64_tr_b16 a[154:155], v90 offset:16896
    ds_read_b64_tr_b16 a[156:157], v90 offset:24576
    ds_read_b64_tr_b16 a[158:159], v90 offset:25088
    ds_read_b64_tr_b16 a[216:217], v91 offset:16384
    ds_read_b64_tr_b16 a[218:219], v91 offset:16896
    ds_read_b64_tr_b16 a[220:221], v91 offset:24576
    ds_read_b64_tr_b16 a[222:223], v91 offset:25088
    s_branch L_lw_5
L_lw_5_1:
    s_cmp_lg_u32 s31, 2
    s_cbranch_scc1 L_lw_5_2
    ds_read_b64_tr_b16 a[160:161], v90 offset:0
    ds_read_b64_tr_b16 a[162:163], v90 offset:512
    ds_read_b64_tr_b16 a[164:165], v90 offset:8192
    ds_read_b64_tr_b16 a[166:167], v90 offset:8704
    ds_read_b64_tr_b16 a[224:225], v91 offset:0
    ds_read_b64_tr_b16 a[226:227], v91 offset:512
    ds_read_b64_tr_b16 a[228:229], v91 offset:8192
    ds_read_b64_tr_b16 a[230:231], v91 offset:8704
    ds_read_b64_tr_b16 a[168:169], v90 offset:16384
    ds_read_b64_tr_b16 a[170:171], v90 offset:16896
    ds_read_b64_tr_b16 a[172:173], v90 offset:24576
    ds_read_b64_tr_b16 a[174:175], v90 offset:25088
    ds_read_b64_tr_b16 a[232:233], v91 offset:16384
    ds_read_b64_tr_b16 a[234:235], v91 offset:16896
    ds_read_b64_tr_b16 a[236:237], v91 offset:24576
    ds_read_b64_tr_b16 a[238:239], v91 offset:25088
    s_branch L_lw_5
L_lw_5_2:
    ds_read_b64_tr_b16 a[176:177], v90 offset:0
    ds_read_b64_tr_b16 a[178:179], v90 offset:512
    ds_read_b64_tr_b16 a[180:181], v90 offset:8192
    ds_read_b64_tr_b16 a[182:183], v90 offset:8704
    ds_read_b64_tr_b16 a[240:241], v91 offset:0
    ds_read_b64_tr_b16 a[242:243], v91 offset:512
    ds_read_b64_tr_b16 a[244:245], v91 offset:8192
    ds_read_b64_tr_b16 a[246:247], v91 offset:8704
    ds_read_b64_tr_b16 a[184:185], v90 offset:16384
    ds_read_b64_tr_b16 a[186:187], v90 offset:16896
    ds_read_b64_tr_b16 a[188:189], v90 offset:24576
    ds_read_b64_tr_b16 a[190:191], v90 offset:25088
    ds_read_b64_tr_b16 a[248:249], v91 offset:16384
    ds_read_b64_tr_b16 a[250:251], v91 offset:16896
    ds_read_b64_tr_b16 a[252:253], v91 offset:24576
    ds_read_b64_tr_b16 a[254:255], v91 offset:25088
L_lw_5:
    s_waitcnt lgkmcnt(0)
    s_waitcnt vmcnt(24)
    s_barrier
    s_add_u32 s66, s70, 0x100000
    s_addc_u32 s67, s71, 0
    s_add_u32 m0, s64, 0x18000
    s_nop 0
    global_load_lds_dwordx4 v73, s[66:67]
    s_add_u32 m0, s64, 0x18400
    s_nop 0
    global_load_lds_dwordx4 v74, s[66:67]
    s_add_u32 m0, s64, 0x18800
    s_nop 0
    global_load_lds_dwordx4 v75, s[66:67]
    s_add_u32 m0, s64, 0x18c00
    s_nop 0
    global_load_lds_dwordx4 v76, s[66:67]
    s_add_u32 m0, s64, 0x19000
    s_nop 0
    global_load_lds_dwordx4 v77, s[66:67]
    s_add_u32 m0, s64, 0x19400
    s_nop 0
    global_load_lds_dwordx4 v78, s[66:67]
    s_add_u32 m0, s64, 0x19800
    s_nop 0
    global_load_lds_dwordx4 v79, s[66:67]
    s_add_u32 m0, s64, 0x19c00
    s_nop 0
    global_load_lds_dwordx4 v80, s[66:67]
    v_add_u32 v90, 0x20000, v83
    v_add_u32 v91, 0x20000, v84
    s_cmp_lg_u32 s31, 1
    s_cbranch_scc1 L_lw_6_0
    ds_read_b64_tr_b16 a[128:129], v90 offset:0
    ds_read_b64_tr_b16 a[130:131], v90 offset:512
    ds_read_b64_tr_b16 a[132:133], v90 offset:8192
    ds_read_b64_tr_b16 a[134:135], v90 offset:8704
    ds_read_b64_tr_b16 a[192:193], v91 offset:0
    ds_read_b64_tr_b16 a[194:195], v91 offset:512
    ds_read_b64_tr_b16 a[196:197], v91 offset:8192
    ds_read_b64_tr_b16 a[198:199], v91 offset:8704
    ds_read_b64_tr_b16 a[136:137], v90 offset:16384
    ds_read_b64_tr_b16 a[138:139], v90 offset:16896
    ds_read_b64_tr_b16 a[140:141], v90 offset:24576
    ds_read_b64_tr_b16 a[142:143], v90 offset:25088
    ds_read_b64_tr_b16 a[200:201], v91 offset:16384
    ds_read_b64_tr_b16 a[202:203], v91 offset:16896
    ds_read_b64_tr_b16 a[204:205], v91 offset:24576
    ds_read_b64_tr_b16 a[206:207], v91 offset:25088
    s_branch L_lw_6
L_lw_6_0:
    s_cmp_lg_u32 s31, 0
    s_cbranch_scc1 L_lw_6_1
    ds_read_b64_tr_b16 a[144:145], v90 offset:0
    ds_read_b64_tr_b16 a[146:147], v90 offset:512
    ds_read_b64_tr_b16 a[148:149], v90 offset:8192
    ds_read_b64_tr_b16 a[150:151], v90 offset:8704
    ds_read_b64_tr_b16 a[208:209], v91 offset:0
    ds_read_b64_tr_b16 a[210:211], v91 offset:512
    ds_read_b64_tr_b16 a[212:213], v91 offset:8192
    ds_read_b64_tr_b16 a[214:215], v91 offset:8704
    ds_read_b64_tr_b16 a[152:153], v90 offset:16384
    ds_read_b64_tr_b16 a[154:155], v90 offset:16896
    ds_read_b64_tr_b16 a[156:157], v90 offset:24576
    ds_read_b64_tr_b16 a[158:159], v90 offset:25088
    ds_read_b64_tr_b16 a[216:217], v91 offset:16384
    ds_read_b64_tr_b16 a[218:219], v91 offset:16896
    ds_read_b64_tr_b16 a[220:221], v91 offset:24576
    ds_read_b64_tr_b16 a[222:223], v91 offset:25088
    s_branch L_lw_6
L_lw_6_1:
    s_cmp_lg_u32 s31, 3
    s_cbranch_scc1 L_lw_6_2
    ds_read_b64_tr_b16 a[160:161], v90 offset:0
    ds_read_b64_tr_b16 a[162:163], v90 offset:512
    ds_read_b64_tr_b16 a[164:165], v90 offset:8192
    ds_read_b64_tr_b16 a[166:167], v90 offset:8704
    ds_read_b64_tr_b16 a[224:225], v91 offset:0
    ds_read_b64_tr_b16 a[226:227], v91 offset:512
    ds_read_b64_tr_b16 a[228:229], v91 offset:8192
    ds_read_b64_tr_b16 a[230:231], v91 offset:8704
    ds_read_b64_tr_b16 a[168:169], v90 offset:16384
    ds_read_b64_tr_b16 a[170:171], v90 offset:16896
    ds_read_b64_tr_b16 a[172:173], v90 offset:24576
    ds_read_b64_tr_b16 a[174:175], v90 offset:25088
    ds_read_b64_tr_b16 a[232:233], v91 offset:16384
    ds_read_b64_tr_b16 a[234:235], v91 offset:16896
    ds_read_b64_tr_b16 a[236:237], v91 offset:24576
    ds_read_b64_tr_b16 a[238:239], v91 offset:25088
    s_branch L_lw_6
L_lw_6_2:
    ds_read_b64_tr_b16 a[176:177], v90 offset:0
    ds_read_b64_tr_b16 a[178:179], v90 offset:512
    ds_read_b64_tr_b16 a[180:181], v90 offset:8192
    ds_read_b64_tr_b16 a[182:183], v90 offset:8704
    ds_read_b64_tr_b16 a[240:241], v91 offset:0
    ds_read_b64_tr_b16 a[242:243], v91 offset:512
    ds_read_b64_tr_b16 a[244:245], v91 offset:8192
    ds_read_b64_tr_b16 a[246:247], v91 offset:8704
    ds_read_b64_tr_b16 a[184:185], v90 offset:16384
    ds_read_b64_tr_b16 a[186:187], v90 offset:16896
    ds_read_b64_tr_b16 a[188:189], v90 offset:24576
    ds_read_b64_tr_b16 a[190:191], v90 offset:25088
    ds_read_b64_tr_b16 a[248:249], v91 offset:16384
    ds_read_b64_tr_b16 a[250:251], v91 offset:16896
    ds_read_b64_tr_b16 a[252:253], v91 offset:24576
    ds_read_b64_tr_b16 a[254:255], v91 offset:25088
L_lw_6:
    s_waitcnt lgkmcnt(0)
    s_waitcnt vmcnt(24)
    s_barrier
    s_add_u32 s66, s70, 0x200000
    s_addc_u32 s67, s71, 0
    s_add_u32 m0, s64, 0x20000
    s_nop 0
    global_load_lds_dwordx4 v73, s[66:67]
    s_add_u32 m0, s64, 0x20400
    s_nop 0
    global_load_lds_dwordx4 v74, s[66:67]
    s_add_u32 m0, s64, 0x20800
    s_nop 0
    global_load_lds_dwordx4 v75, s[66:67]
    s_add_u32 m0, s64, 0x20c00
    s_nop 0
    global_load_lds_dwordx4 v76, s[66:67]
    s_add_u32 m0, s64, 0x21000
    s_nop 0
    global_load_lds_dwordx4 v77, s[66:67]
    s_add_u32 m0, s64, 0x21400
    s_nop 0
    global_load_lds_dwordx4 v78, s[66:67]
    s_add_u32 m0, s64, 0x21800
    s_nop 0
    global_load_lds_dwordx4 v79, s[66:67]
    s_add_u32 m0, s64, 0x21c00
    s_nop 0
    global_load_lds_dwordx4 v80, s[66:67]
    v_add_u32 v90, 0x0, v83
    v_add_u32 v91, 0x0, v84
    s_cmp_lg_u32 s31, 2
    s_cbranch_scc1 L_lw_7_0
    ds_read_b64_tr_b16 a[128:129], v90 offset:0
    ds_read_b64_tr_b16 a[130:131], v90 offset:512
    ds_read_b64_tr_b16 a[132:133], v90 offset:8192
    ds_read_b64_tr_b16 a[134:135], v90 offset:8704
    ds_read_b64_tr_b16 a[192:193], v91 offset:0
    ds_read_b64_tr_b16 a[194:195], v91 offset:512
    ds_read_b64_tr_b16 a[196:197], v91 offset:8192
    ds_read_b64_tr_b16 a[198:199], v91 offset:8704
    ds_read_b64_tr_b16 a[136:137], v90 offset:16384
    ds_read_b64_tr_b16 a[138:139], v90 offset:16896
    ds_read_b64_tr_b16 a[140:141], v90 offset:24576
    ds_read_b64_tr_b16 a[142:143], v90 offset:25088
    ds_read_b64_tr_b16 a[200:201], v91 offset:16384
    ds_read_b64_tr_b16 a[202:203], v91 offset:16896
    ds_read_b64_tr_b16 a[204:205], v91 offset:24576
    ds_read_b64_tr_b16 a[206:207], v91 offset:25088
    s_branch L_lw_7
L_lw_7_0:
    s_cmp_lg_u32 s31, 3
    s_cbranch_scc1 L_lw_7_1
    ds_read_b64_tr_b16 a[144:145], v90 offset:0
    ds_read_b64_tr_b16 a[146:147], v90 offset:512
    ds_read_b64_tr_b16 a[148:149], v90 offset:8192
    ds_read_b64_tr_b16 a[150:151], v90 offset:8704
    ds_read_b64_tr_b16 a[208:209], v91 offset:0
    ds_read_b64_tr_b16 a[210:211], v91 offset:512
    ds_read_b64_tr_b16 a[212:213], v91 offset:8192
    ds_read_b64_tr_b16 a[214:215], v91 offset:8704
    ds_read_b64_tr_b16 a[152:153], v90 offset:16384
    ds_read_b64_tr_b16 a[154:155], v90 offset:16896
    ds_read_b64_tr_b16 a[156:157], v90 offset:24576
    ds_read_b64_tr_b16 a[158:159], v90 offset:25088
    ds_read_b64_tr_b16 a[216:217], v91 offset:16384
    ds_read_b64_tr_b16 a[218:219], v91 offset:16896
    ds_read_b64_tr_b16 a[220:221], v91 offset:24576
    ds_read_b64_tr_b16 a[222:223], v91 offset:25088
    s_branch L_lw_7
L_lw_7_1:
    s_cmp_lg_u32 s31, 0
    s_cbranch_scc1 L_lw_7_2
    ds_read_b64_tr_b16 a[160:161], v90 offset:0
    ds_read_b64_tr_b16 a[162:163], v90 offset:512
    ds_read_b64_tr_b16 a[164:165], v90 offset:8192
    ds_read_b64_tr_b16 a[166:167], v90 offset:8704
    ds_read_b64_tr_b16 a[224:225], v91 offset:0
    ds_read_b64_tr_b16 a[226:227], v91 offset:512
    ds_read_b64_tr_b16 a[228:229], v91 offset:8192
    ds_read_b64_tr_b16 a[230:231], v91 offset:8704
    ds_read_b64_tr_b16 a[168:169], v90 offset:16384
    ds_read_b64_tr_b16 a[170:171], v90 offset:16896
    ds_read_b64_tr_b16 a[172:173], v90 offset:24576
    ds_read_b64_tr_b16 a[174:175], v90 offset:25088
    ds_read_b64_tr_b16 a[232:233], v91 offset:16384
    ds_read_b64_tr_b16 a[234:235], v91 offset:16896
    ds_read_b64_tr_b16 a[236:237], v91 offset:24576
    ds_read_b64_tr_b16 a[238:239], v91 offset:25088
    s_branch L_lw_7
L_lw_7_2:
    ds_read_b64_tr_b16 a[176:177], v90 offset:0
    ds_read_b64_tr_b16 a[178:179], v90 offset:512
    ds_read_b64_tr_b16 a[180:181], v90 offset:8192
    ds_read_b64_tr_b16 a[182:183], v90 offset:8704
    ds_read_b64_tr_b16 a[240:241], v91 offset:0
    ds_read_b64_tr_b16 a[242:243], v91 offset:512
    ds_read_b64_tr_b16 a[244:245], v91 offset:8192
    ds_read_b64_tr_b16 a[246:247], v91 offset:8704
    ds_read_b64_tr_b16 a[184:185], v90 offset:16384
    ds_read_b64_tr_b16 a[186:187], v90 offset:16896
    ds_read_b64_tr_b16 a[188:189], v90 offset:24576
    ds_read_b64_tr_b16 a[190:191], v90 offset:25088
    ds_read_b64_tr_b16 a[248:249], v91 offset:16384
    ds_read_b64_tr_b16 a[250:251], v91 offset:16896
    ds_read_b64_tr_b16 a[252:253], v91 offset:24576
    ds_read_b64_tr_b16 a[254:255], v91 offset:25088
L_lw_7:
    s_waitcnt lgkmcnt(0)
    s_waitcnt vmcnt(24)
    s_barrier
    s_add_u32 s66, s70, 0x300000
    s_addc_u32 s67, s71, 0
    s_add_u32 m0, s64, 0x0
    s_nop 0
    global_load_lds_dwordx4 v73, s[66:67]
    s_add_u32 m0, s64, 0x400
    s_nop 0
    global_load_lds_dwordx4 v74, s[66:67]
    s_add_u32 m0, s64, 0x800
    s_nop 0
    global_load_lds_dwordx4 v75, s[66:67]
    s_add_u32 m0, s64, 0xc00
    s_nop 0
    global_load_lds_dwordx4 v76, s[66:67]
    s_add_u32 m0, s64, 0x1000
    s_nop 0
    global_load_lds_dwordx4 v77, s[66:67]
    s_add_u32 m0, s64, 0x1400
    s_nop 0
    global_load_lds_dwordx4 v78, s[66:67]
    s_add_u32 m0, s64, 0x1800
    s_nop 0
    global_load_lds_dwordx4 v79, s[66:67]
    s_add_u32 m0, s64, 0x1c00
    s_nop 0
    global_load_lds_dwordx4 v80, s[66:67]
    v_add_u32 v90, 0x8000, v83
    v_add_u32 v91, 0x8000, v84
    s_cmp_lg_u32 s31, 3
    s_cbranch_scc1 L_lw_8_0
    ds_read_b64_tr_b16 a[128:129], v90 offset:0
    ds_read_b64_tr_b16 a[130:131], v90 offset:512
    ds_read_b64_tr_b16 a[132:133], v90 offset:8192
    ds_read_b64_tr_b16 a[134:135], v90 offset:8704
    ds_read_b64_tr_b16 a[192:193], v91 offset:0
    ds_read_b64_tr_b16 a[194:195], v91 offset:512
    ds_read_b64_tr_b16 a[196:197], v91 offset:8192
    ds_read_b64_tr_b16 a[198:199], v91 offset:8704
    ds_read_b64_tr_b16 a[136:137], v90 offset:16384
    ds_read_b64_tr_b16 a[138:139], v90 offset:16896
    ds_read_b64_tr_b16 a[140:141], v90 offset:24576
    ds_read_b64_tr_b16 a[142:143], v90 offset:25088
    ds_read_b64_tr_b16 a[200:201], v91 offset:16384
    ds_read_b64_tr_b16 a[202:203], v91 offset:16896
    ds_read_b64_tr_b16 a[204:205], v91 offset:24576
    ds_read_b64_tr_b16 a[206:207], v91 offset:25088
    s_branch L_lw_8
L_lw_8_0:
    s_cmp_lg_u32 s31, 2
    s_cbranch_scc1 L_lw_8_1
    ds_read_b64_tr_b16 a[144:145], v90 offset:0
    ds_read_b64_tr_b16 a[146:147], v90 offset:512
    ds_read_b64_tr_b16 a[148:149], v90 offset:8192
    ds_read_b64_tr_b16 a[150:151], v90 offset:8704
    ds_read_b64_tr_b16 a[208:209], v91 offset:0
    ds_read_b64_tr_b16 a[210:211], v91 offset:512
    ds_read_b64_tr_b16 a[212:213], v91 offset:8192
    ds_read_b64_tr_b16 a[214:215], v91 offset:8704
    ds_read_b64_tr_b16 a[152:153], v90 offset:16384
    ds_read_b64_tr_b16 a[154:155], v90 offset:16896
    ds_read_b64_tr_b16 a[156:157], v90 offset:24576
    ds_read_b64_tr_b16 a[158:159], v90 offset:25088
    ds_read_b64_tr_b16 a[216:217], v91 offset:16384
    ds_read_b64_tr_b16 a[218:219], v91 offset:16896
    ds_read_b64_tr_b16 a[220:221], v91 offset:24576
    ds_read_b64_tr_b16 a[222:223], v91 offset:25088
    s_branch L_lw_8
L_lw_8_1:
    s_cmp_lg_u32 s31, 1
    s_cbranch_scc1 L_lw_8_2
    ds_read_b64_tr_b16 a[160:161], v90 offset:0
    ds_read_b64_tr_b16 a[162:163], v90 offset:512
    ds_read_b64_tr_b16 a[164:165], v90 offset:8192
    ds_read_b64_tr_b16 a[166:167], v90 offset:8704
    ds_read_b64_tr_b16 a[224:225], v91 offset:0
    ds_read_b64_tr_b16 a[226:227], v91 offset:512
    ds_read_b64_tr_b16 a[228:229], v91 offset:8192
    ds_read_b64_tr_b16 a[230:231], v91 offset:8704
    ds_read_b64_tr_b16 a[168:169], v90 offset:16384
    ds_read_b64_tr_b16 a[170:171], v90 offset:16896
    ds_read_b64_tr_b16 a[172:173], v90 offset:24576
    ds_read_b64_tr_b16 a[174:175], v90 offset:25088
    ds_read_b64_tr_b16 a[232:233], v91 offset:16384
    ds_read_b64_tr_b16 a[234:235], v91 offset:16896
    ds_read_b64_tr_b16 a[236:237], v91 offset:24576
    ds_read_b64_tr_b16 a[238:239], v91 offset:25088
    s_branch L_lw_8
L_lw_8_2:
    ds_read_b64_tr_b16 a[176:177], v90 offset:0
    ds_read_b64_tr_b16 a[178:179], v90 offset:512
    ds_read_b64_tr_b16 a[180:181], v90 offset:8192
    ds_read_b64_tr_b16 a[182:183], v90 offset:8704
    ds_read_b64_tr_b16 a[240:241], v91 offset:0
    ds_read_b64_tr_b16 a[242:243], v91 offset:512
    ds_read_b64_tr_b16 a[244:245], v91 offset:8192
    ds_read_b64_tr_b16 a[246:247], v91 offset:8704
    ds_read_b64_tr_b16 a[184:185], v90 offset:16384
    ds_read_b64_tr_b16 a[186:187], v90 offset:16896
    ds_read_b64_tr_b16 a[188:189], v90 offset:24576
    ds_read_b64_tr_b16 a[190:191], v90 offset:25088
    ds_read_b64_tr_b16 a[248:249], v91 offset:16384
    ds_read_b64_tr_b16 a[250:251], v91 offset:16896
    ds_read_b64_tr_b16 a[252:253], v91 offset:24576
    ds_read_b64_tr_b16 a[254:255], v91 offset:25088
L_lw_8:
    s_waitcnt lgkmcnt(0)
    s_waitcnt vmcnt(24)
    s_barrier
    s_add_u32 s66, s72, 0x0
    s_addc_u32 s67, s73, 0
    s_add_u32 m0, s64, 0x8000
    s_nop 0
    global_load_lds_dwordx4 v73, s[66:67]
    s_add_u32 m0, s64, 0x8400
    s_nop 0
    global_load_lds_dwordx4 v74, s[66:67]
    s_add_u32 m0, s64, 0x8800
    s_nop 0
    global_load_lds_dwordx4 v75, s[66:67]
    s_add_u32 m0, s64, 0x8c00
    s_nop 0
    global_load_lds_dwordx4 v76, s[66:67]
    s_add_u32 m0, s64, 0x9000
    s_nop 0
    global_load_lds_dwordx4 v77, s[66:67]
    s_add_u32 m0, s64, 0x9400
    s_nop 0
    global_load_lds_dwordx4 v78, s[66:67]
    s_add_u32 m0, s64, 0x9800
    s_nop 0
    global_load_lds_dwordx4 v79, s[66:67]
    s_add_u32 m0, s64, 0x9c00
    s_nop 0
    global_load_lds_dwordx4 v80, s[66:67]
    v_add_u32 v90, 0x10000, v85
    v_add_u32 v91, 0x10000, v86
    s_cmp_lg_u32 s31, 0
    s_cbranch_scc1 L_lw_9_0
    ds_read_b64_tr_b16 v[0:1], v90 offset:0
    ds_read_b64_tr_b16 v[2:3], v90 offset:512
    ds_read_b64_tr_b16 v[4:5], v90 offset:8192
    ds_read_b64_tr_b16 v[6:7], v90 offset:8704
    ds_read_b64_tr_b16 v[8:9], v91 offset:0
    ds_read_b64_tr_b16 v[10:11], v91 offset:512
    ds_read_b64_tr_b16 v[12:13], v91 offset:8192
    ds_read_b64_tr_b16 v[14:15], v91 offset:8704
    ds_read_b64_tr_b16 v[16:17], v90 offset:16384
    ds_read_b64_tr_b16 v[18:19], v90 offset:16896
    ds_read_b64_tr_b16 v[20:21], v90 offset:24576
    ds_read_b64_tr_b16 v[22:23], v90 offset:25088
    ds_read_b64_tr_b16 v[24:25], v91 offset:16384
    ds_read_b64_tr_b16 v[26:27], v91 offset:16896
    ds_read_b64_tr_b16 v[28:29], v91 offset:24576
    ds_read_b64_tr_b16 v[30:31], v91 offset:25088
    s_branch L_lw_9
L_lw_9_0:
    s_cmp_lg_u32 s31, 1
    s_cbranch_scc1 L_lw_9_1
    ds_read_b64_tr_b16 v[32:33], v90 offset:0
    ds_read_b64_tr_b16 v[34:35], v90 offset:512
    ds_read_b64_tr_b16 v[36:37], v90 offset:8192
    ds_read_b64_tr_b16 v[38:39], v90 offset:8704
    ds_read_b64_tr_b16 v[40:41], v91 offset:0
    ds_read_b64_tr_b16 v[42:43], v91 offset:512
    ds_read_b64_tr_b16 v[44:45], v91 offset:8192
    ds_read_b64_tr_b16 v[46:47], v91 offset:8704
    ds_read_b64_tr_b16 v[48:49], v90 offset:16384
    ds_read_b64_tr_b16 v[50:51], v90 offset:16896
    ds_read_b64_tr_b16 v[52:53], v90 offset:24576
    ds_read_b64_tr_b16 v[54:55], v90 offset:25088
    ds_read_b64_tr_b16 v[56:57], v91 offset:16384
    ds_read_b64_tr_b16 v[58:59], v91 offset:16896
    ds_read_b64_tr_b16 v[60:61], v91 offset:24576
    ds_read_b64_tr_b16 v[62:63], v91 offset:25088
    s_branch L_lw_9
L_lw_9_1:
    s_cmp_lg_u32 s31, 2
    s_cbranch_scc1 L_lw_9_2
    ds_read_b64_tr_b16 v[128:129], v90 offset:0
    ds_read_b64_tr_b16 v[130:131], v90 offset:512
    ds_read_b64_tr_b16 v[132:133], v90 offset:8192
    ds_read_b64_tr_b16 v[134:135], v90 offset:8704
    ds_read_b64_tr_b16 v[192:193], v91 offset:0
    ds_read_b64_tr_b16 v[194:195], v91 offset:512
    ds_read_b64_tr_b16 v[196:197], v91 offset:8192
    ds_read_b64_tr_b16 v[198:199], v91 offset:8704
    ds_read_b64_tr_b16 v[136:137], v90 offset:16384
    ds_read_b64_tr_b16 v[138:139], v90 offset:16896
    ds_read_b64_tr_b16 v[140:141], v90 offset:24576
    ds_read_b64_tr_b16 v[142:143], v90 offset:25088
    ds_read_b64_tr_b16 v[200:201], v91 offset:16384
    ds_read_b64_tr_b16 v[202:203], v91 offset:16896
    ds_read_b64_tr_b16 v[204:205], v91 offset:24576
    ds_read_b64_tr_b16 v[206:207], v91 offset:25088
    s_branch L_lw_9
L_lw_9_2:
    ds_read_b64_tr_b16 v[144:145], v90 offset:0
    ds_read_b64_tr_b16 v[146:147], v90 offset:512
    ds_read_b64_tr_b16 v[148:149], v90 offset:8192
    ds_read_b64_tr_b16 v[150:151], v90 offset:8704
    ds_read_b64_tr_b16 v[208:209], v91 offset:0
    ds_read_b64_tr_b16 v[210:211], v91 offset:512
    ds_read_b64_tr_b16 v[212:213], v91 offset:8192
    ds_read_b64_tr_b16 v[214:215], v91 offset:8704
    ds_read_b64_tr_b16 v[152:153], v90 offset:16384
    ds_read_b64_tr_b16 v[154:155], v90 offset:16896
    ds_read_b64_tr_b16 v[156:157], v90 offset:24576
    ds_read_b64_tr_b16 v[158:159], v90 offset:25088
    ds_read_b64_tr_b16 v[216:217], v91 offset:16384
    ds_read_b64_tr_b16 v[218:219], v91 offset:16896
    ds_read_b64_tr_b16 v[220:221], v91 offset:24576
    ds_read_b64_tr_b16 v[222:223], v91 offset:25088
L_lw_9:
    s_waitcnt lgkmcnt(0)
    s_waitcnt vmcnt(24)
    s_barrier
    s_add_u32 s66, s72, 0x100000
    s_addc_u32 s67, s73, 0
    s_add_u32 m0, s64, 0x10000
    s_nop 0
    global_load_lds_dwordx4 v73, s[66:67]
    s_add_u32 m0, s64, 0x10400
    s_nop 0
    global_load_lds_dwordx4 v74, s[66:67]
    s_add_u32 m0, s64, 0x10800
    s_nop 0
    global_load_lds_dwordx4 v75, s[66:67]
    s_add_u32 m0, s64, 0x10c00
    s_nop 0
    global_load_lds_dwordx4 v76, s[66:67]
    s_add_u32 m0, s64, 0x11000
    s_nop 0
    global_load_lds_dwordx4 v77, s[66:67]
    s_add_u32 m0, s64, 0x11400
    s_nop 0
    global_load_lds_dwordx4 v78, s[66:67]
    s_add_u32 m0, s64, 0x11800
    s_nop 0
    global_load_lds_dwordx4 v79, s[66:67]
    s_add_u32 m0, s64, 0x11c00
    s_nop 0
    global_load_lds_dwordx4 v80, s[66:67]
    v_add_u32 v90, 0x18000, v85
    v_add_u32 v91, 0x18000, v86
    s_cmp_lg_u32 s31, 1
    s_cbranch_scc1 L_lw_10_0
    ds_read_b64_tr_b16 v[0:1], v90 offset:0
    ds_read_b64_tr_b16 v[2:3], v90 offset:512
    ds_read_b64_tr_b16 v[4:5], v90 offset:8192
    ds_read_b64_tr_b16 v[6:7], v90 offset:8704
    ds_read_b64_tr_b16 v[8:9], v91 offset:0
    ds_read_b64_tr_b16 v[10:11], v91 offset:512
    ds_read_b64_tr_b16 v[12:13], v91 offset:8192
    ds_read_b64_tr_b16 v[14:15], v91 offset:8704
    ds_read_b64_tr_b16 v[16:17], v90 offset:16384
    ds_read_b64_tr_b16 v[18:19], v90 offset:16896
    ds_read_b64_tr_b16 v[20:21], v90 offset:24576
    ds_read_b64_tr_b16 v[22:23], v90 offset:25088
    ds_read_b64_tr_b16 v[24:25], v91 offset:16384
    ds_read_b64_tr_b16 v[26:27], v91 offset:16896
    ds_read_b64_tr_b16 v[28:29], v91 offset:24576
    ds_read_b64_tr_b16 v[30:31], v91 offset:25088
    s_branch L_lw_10
L_lw_10_0:
    s_cmp_lg_u32 s31, 0
    s_cbranch_scc1 L_lw_10_1
    ds_read_b64_tr_b16 v[32:33], v90 offset:0
    ds_read_b64_tr_b16 v[34:35], v90 offset:512
    ds_read_b64_tr_b16 v[36:37], v90 offset:8192
    ds_read_b64_tr_b16 v[38:39], v90 offset:8704
    ds_read_b64_tr_b16 v[40:41], v91 offset:0
    ds_read_b64_tr_b16 v[42:43], v91 offset:512
    ds_read_b64_tr_b16 v[44:45], v91 offset:8192
    ds_read_b64_tr_b16 v[46:47], v91 offset:8704
    ds_read_b64_tr_b16 v[48:49], v90 offset:16384
    ds_read_b64_tr_b16 v[50:51], v90 offset:16896
    ds_read_b64_tr_b16 v[52:53], v90 offset:24576
    ds_read_b64_tr_b16 v[54:55], v90 offset:25088
    ds_read_b64_tr_b16 v[56:57], v91 offset:16384
    ds_read_b64_tr_b16 v[58:59], v91 offset:16896
    ds_read_b64_tr_b16 v[60:61], v91 offset:24576
    ds_read_b64_tr_b16 v[62:63], v91 offset:25088
    s_branch L_lw_10
L_lw_10_1:
    s_cmp_lg_u32 s31, 3
    s_cbranch_scc1 L_lw_10_2
    ds_read_b64_tr_b16 v[128:129], v90 offset:0
    ds_read_b64_tr_b16 v[130:131], v90 offset:512
    ds_read_b64_tr_b16 v[132:133], v90 offset:8192
    ds_read_b64_tr_b16 v[134:135], v90 offset:8704
    ds_read_b64_tr_b16 v[192:193], v91 offset:0
    ds_read_b64_tr_b16 v[194:195], v91 offset:512
    ds_read_b64_tr_b16 v[196:197], v91 offset:8192
    ds_read_b64_tr_b16 v[198:199], v91 offset:8704
    ds_read_b64_tr_b16 v[136:137], v90 offset:16384
    ds_read_b64_tr_b16 v[138:139], v90 offset:16896
    ds_read_b64_tr_b16 v[140:141], v90 offset:24576
    ds_read_b64_tr_b16 v[142:143], v90 offset:25088
    ds_read_b64_tr_b16 v[200:201], v91 offset:16384
    ds_read_b64_tr_b16 v[202:203], v91 offset:16896
    ds_read_b64_tr_b16 v[204:205], v91 offset:24576
    ds_read_b64_tr_b16 v[206:207], v91 offset:25088
    s_branch L_lw_10
L_lw_10_2:
    ds_read_b64_tr_b16 v[144:145], v90 offset:0
    ds_read_b64_tr_b16 v[146:147], v90 offset:512
    ds_read_b64_tr_b16 v[148:149], v90 offset:8192
    ds_read_b64_tr_b16 v[150:151], v90 offset:8704
    ds_read_b64_tr_b16 v[208:209], v91 offset:0
    ds_read_b64_tr_b16 v[210:211], v91 offset:512
    ds_read_b64_tr_b16 v[212:213], v91 offset:8192
    ds_read_b64_tr_b16 v[214:215], v91 offset:8704
    ds_read_b64_tr_b16 v[152:153], v90 offset:16384
    ds_read_b64_tr_b16 v[154:155], v90 offset:16896
    ds_read_b64_tr_b16 v[156:157], v90 offset:24576
    ds_read_b64_tr_b16 v[158:159], v90 offset:25088
    ds_read_b64_tr_b16 v[216:217], v91 offset:16384
    ds_read_b64_tr_b16 v[218:219], v91 offset:16896
    ds_read_b64_tr_b16 v[220:221], v91 offset:24576
    ds_read_b64_tr_b16 v[222:223], v91 offset:25088
L_lw_10:
    s_waitcnt lgkmcnt(0)
    s_waitcnt vmcnt(24)
    s_barrier
    s_add_u32 s66, s72, 0x200000
    s_addc_u32 s67, s73, 0
    s_add_u32 m0, s64, 0x18000
    s_nop 0
    global_load_lds_dwordx4 v73, s[66:67]
    s_add_u32 m0, s64, 0x18400
    s_nop 0
    global_load_lds_dwordx4 v74, s[66:67]
    s_add_u32 m0, s64, 0x18800
    s_nop 0
    global_load_lds_dwordx4 v75, s[66:67]
    s_add_u32 m0, s64, 0x18c00
    s_nop 0
    global_load_lds_dwordx4 v76, s[66:67]
    s_add_u32 m0, s64, 0x19000
    s_nop 0
    global_load_lds_dwordx4 v77, s[66:67]
    s_add_u32 m0, s64, 0x19400
    s_nop 0
    global_load_lds_dwordx4 v78, s[66:67]
    s_add_u32 m0, s64, 0x19800
    s_nop 0
    global_load_lds_dwordx4 v79, s[66:67]
    s_add_u32 m0, s64, 0x19c00
    s_nop 0
    global_load_lds_dwordx4 v80, s[66:67]
    v_add_u32 v90, 0x20000, v85
    v_add_u32 v91, 0x20000, v86
    s_cmp_lg_u32 s31, 2
    s_cbranch_scc1 L_lw_11_0
    ds_read_b64_tr_b16 v[0:1], v90 offset:0
    ds_read_b64_tr_b16 v[2:3], v90 offset:512
    ds_read_b64_tr_b16 v[4:5], v90 offset:8192
    ds_read_b64_tr_b16 v[6:7], v90 offset:8704
    ds_read_b64_tr_b16 v[8:9], v91 offset:0
    ds_read_b64_tr_b16 v[10:11], v91 offset:512
    ds_read_b64_tr_b16 v[12:13], v91 offset:8192
    ds_read_b64_tr_b16 v[14:15], v91 offset:8704
    ds_read_b64_tr_b16 v[16:17], v90 offset:16384
    ds_read_b64_tr_b16 v[18:19], v90 offset:16896
    ds_read_b64_tr_b16 v[20:21], v90 offset:24576
    ds_read_b64_tr_b16 v[22:23], v90 offset:25088
    ds_read_b64_tr_b16 v[24:25], v91 offset:16384
    ds_read_b64_tr_b16 v[26:27], v91 offset:16896
    ds_read_b64_tr_b16 v[28:29], v91 offset:24576
    ds_read_b64_tr_b16 v[30:31], v91 offset:25088
    s_branch L_lw_11
L_lw_11_0:
    s_cmp_lg_u32 s31, 3
    s_cbranch_scc1 L_lw_11_1
    ds_read_b64_tr_b16 v[32:33], v90 offset:0
    ds_read_b64_tr_b16 v[34:35], v90 offset:512
    ds_read_b64_tr_b16 v[36:37], v90 offset:8192
    ds_read_b64_tr_b16 v[38:39], v90 offset:8704
    ds_read_b64_tr_b16 v[40:41], v91 offset:0
    ds_read_b64_tr_b16 v[42:43], v91 offset:512
    ds_read_b64_tr_b16 v[44:45], v91 offset:8192
    ds_read_b64_tr_b16 v[46:47], v91 offset:8704
    ds_read_b64_tr_b16 v[48:49], v90 offset:16384
    ds_read_b64_tr_b16 v[50:51], v90 offset:16896
    ds_read_b64_tr_b16 v[52:53], v90 offset:24576
    ds_read_b64_tr_b16 v[54:55], v90 offset:25088
    ds_read_b64_tr_b16 v[56:57], v91 offset:16384
    ds_read_b64_tr_b16 v[58:59], v91 offset:16896
    ds_read_b64_tr_b16 v[60:61], v91 offset:24576
    ds_read_b64_tr_b16 v[62:63], v91 offset:25088
    s_branch L_lw_11
L_lw_11_1:
    s_cmp_lg_u32 s31, 0
    s_cbranch_scc1 L_lw_11_2
    ds_read_b64_tr_b16 v[128:129], v90 offset:0
    ds_read_b64_tr_b16 v[130:131], v90 offset:512
    ds_read_b64_tr_b16 v[132:133], v90 offset:8192
    ds_read_b64_tr_b16 v[134:135], v90 offset:8704
    ds_read_b64_tr_b16 v[192:193], v91 offset:0
    ds_read_b64_tr_b16 v[194:195], v91 offset:512
    ds_read_b64_tr_b16 v[196:197], v91 offset:8192
    ds_read_b64_tr_b16 v[198:199], v91 offset:8704
    ds_read_b64_tr_b16 v[136:137], v90 offset:16384
    ds_read_b64_tr_b16 v[138:139], v90 offset:16896
    ds_read_b64_tr_b16 v[140:141], v90 offset:24576
    ds_read_b64_tr_b16 v[142:143], v90 offset:25088
    ds_read_b64_tr_b16 v[200:201], v91 offset:16384
    ds_read_b64_tr_b16 v[202:203], v91 offset:16896
    ds_read_b64_tr_b16 v[204:205], v91 offset:24576
    ds_read_b64_tr_b16 v[206:207], v91 offset:25088
    s_branch L_lw_11
L_lw_11_2:
    ds_read_b64_tr_b16 v[144:145], v90 offset:0
    ds_read_b64_tr_b16 v[146:147], v90 offset:512
    ds_read_b64_tr_b16 v[148:149], v90 offset:8192
    ds_read_b64_tr_b16 v[150:151], v90 offset:8704
    ds_read_b64_tr_b16 v[208:209], v91 offset:0
    ds_read_b64_tr_b16 v[210:211], v91 offset:512
    ds_read_b64_tr_b16 v[212:213], v91 offset:8192
    ds_read_b64_tr_b16 v[214:215], v91 offset:8704
    ds_read_b64_tr_b16 v[152:153], v90 offset:16384
    ds_read_b64_tr_b16 v[154:155], v90 offset:16896
    ds_read_b64_tr_b16 v[156:157], v90 offset:24576
    ds_read_b64_tr_b16 v[158:159], v90 offset:25088
    ds_read_b64_tr_b16 v[216:217], v91 offset:16384
    ds_read_b64_tr_b16 v[218:219], v91 offset:16896
    ds_read_b64_tr_b16 v[220:221], v91 offset:24576
    ds_read_b64_tr_b16 v[222:223], v91 offset:25088
L_lw_11:
    s_waitcnt lgkmcnt(0)
    s_waitcnt vmcnt(24)
    s_barrier
    s_add_u32 s66, s72, 0x300000
    s_addc_u32 s67, s73, 0
    s_add_u32 m0, s64, 0x20000
    s_nop 0
    global_load_lds_dwordx4 v73, s[66:67]
    s_add_u32 m0, s64, 0x20400
    s_nop 0
    global_load_lds_dwordx4 v74, s[66:67]
    s_add_u32 m0, s64, 0x20800
    s_nop 0
    global_load_lds_dwordx4 v75, s[66:67]
    s_add_u32 m0, s64, 0x20c00
    s_nop 0
    global_load_lds_dwordx4 v76, s[66:67]
    s_add_u32 m0, s64, 0x21000
    s_nop 0
    global_load_lds_dwordx4 v77, s[66:67]
    s_add_u32 m0, s64, 0x21400
    s_nop 0
    global_load_lds_dwordx4 v78, s[66:67]
    s_add_u32 m0, s64, 0x21800
    s_nop 0
    global_load_lds_dwordx4 v79, s[66:67]
    s_add_u32 m0, s64, 0x21c00
    s_nop 0
    global_load_lds_dwordx4 v80, s[66:67]
    v_add_u32 v90, 0x0, v85
    v_add_u32 v91, 0x0, v86
    s_cmp_lg_u32 s31, 3
    s_cbranch_scc1 L_lw_12_0
    ds_read_b64_tr_b16 v[0:1], v90 offset:0
    ds_read_b64_tr_b16 v[2:3], v90 offset:512
    ds_read_b64_tr_b16 v[4:5], v90 offset:8192
    ds_read_b64_tr_b16 v[6:7], v90 offset:8704
    ds_read_b64_tr_b16 v[8:9], v91 offset:0
    ds_read_b64_tr_b16 v[10:11], v91 offset:512
    ds_read_b64_tr_b16 v[12:13], v91 offset:8192
    ds_read_b64_tr_b16 v[14:15], v91 offset:8704
    ds_read_b64_tr_b16 v[16:17], v90 offset:16384
    ds_read_b64_tr_b16 v[18:19], v90 offset:16896
    ds_read_b64_tr_b16 v[20:21], v90 offset:24576
    ds_read_b64_tr_b16 v[22:23], v90 offset:25088
    ds_read_b64_tr_b16 v[24:25], v91 offset:16384
    ds_read_b64_tr_b16 v[26:27], v91 offset:16896
    ds_read_b64_tr_b16 v[28:29], v91 offset:24576
    ds_read_b64_tr_b16 v[30:31], v91 offset:25088
    s_branch L_lw_12
L_lw_12_0:
    s_cmp_lg_u32 s31, 2
    s_cbranch_scc1 L_lw_12_1
    ds_read_b64_tr_b16 v[32:33], v90 offset:0
    ds_read_b64_tr_b16 v[34:35], v90 offset:512
    ds_read_b64_tr_b16 v[36:37], v90 offset:8192
    ds_read_b64_tr_b16 v[38:39], v90 offset:8704
    ds_read_b64_tr_b16 v[40:41], v91 offset:0
    ds_read_b64_tr_b16 v[42:43], v91 offset:512
    ds_read_b64_tr_b16 v[44:45], v91 offset:8192
    ds_read_b64_tr_b16 v[46:47], v91 offset:8704
    ds_read_b64_tr_b16 v[48:49], v90 offset:16384
    ds_read_b64_tr_b16 v[50:51], v90 offset:16896
    ds_read_b64_tr_b16 v[52:53], v90 offset:24576
    ds_read_b64_tr_b16 v[54:55], v90 offset:25088
    ds_read_b64_tr_b16 v[56:57], v91 offset:16384
    ds_read_b64_tr_b16 v[58:59], v91 offset:16896
    ds_read_b64_tr_b16 v[60:61], v91 offset:24576
    ds_read_b64_tr_b16 v[62:63], v91 offset:25088
    s_branch L_lw_12
L_lw_12_1:
    s_cmp_lg_u32 s31, 1
    s_cbranch_scc1 L_lw_12_2
    ds_read_b64_tr_b16 v[128:129], v90 offset:0
    ds_read_b64_tr_b16 v[130:131], v90 offset:512
    ds_read_b64_tr_b16 v[132:133], v90 offset:8192
    ds_read_b64_tr_b16 v[134:135], v90 offset:8704
    ds_read_b64_tr_b16 v[192:193], v91 offset:0
    ds_read_b64_tr_b16 v[194:195], v91 offset:512
    ds_read_b64_tr_b16 v[196:197], v91 offset:8192
    ds_read_b64_tr_b16 v[198:199], v91 offset:8704
    ds_read_b64_tr_b16 v[136:137], v90 offset:16384
    ds_read_b64_tr_b16 v[138:139], v90 offset:16896
    ds_read_b64_tr_b16 v[140:141], v90 offset:24576
    ds_read_b64_tr_b16 v[142:143], v90 offset:25088
    ds_read_b64_tr_b16 v[200:201], v91 offset:16384
    ds_read_b64_tr_b16 v[202:203], v91 offset:16896
    ds_read_b64_tr_b16 v[204:205], v91 offset:24576
    ds_read_b64_tr_b16 v[206:207], v91 offset:25088
    s_branch L_lw_12
L_lw_12_2:
    ds_read_b64_tr_b16 v[144:145], v90 offset:0
    ds_read_b64_tr_b16 v[146:147], v90 offset:512
    ds_read_b64_tr_b16 v[148:149], v90 offset:8192
    ds_read_b64_tr_b16 v[150:151], v90 offset:8704
    ds_read_b64_tr_b16 v[208:209], v91 offset:0
    ds_read_b64_tr_b16 v[210:211], v91 offset:512
    ds_read_b64_tr_b16 v[212:213], v91 offset:8192
    ds_read_b64_tr_b16 v[214:215], v91 offset:8704
    ds_read_b64_tr_b16 v[152:153], v90 offset:16384
    ds_read_b64_tr_b16 v[154:155], v90 offset:16896
    ds_read_b64_tr_b16 v[156:157], v90 offset:24576
    ds_read_b64_tr_b16 v[158:159], v90 offset:25088
    ds_read_b64_tr_b16 v[216:217], v91 offset:16384
    ds_read_b64_tr_b16 v[218:219], v91 offset:16896
    ds_read_b64_tr_b16 v[220:221], v91 offset:24576
    ds_read_b64_tr_b16 v[222:223], v91 offset:25088
L_lw_12:
    s_waitcnt lgkmcnt(0)
    s_waitcnt vmcnt(24)
    s_barrier
    v_add_u32 v90, 0x8000, v85
    v_add_u32 v91, 0x8000, v86
    s_cmp_lg_u32 s31, 0
    s_cbranch_scc1 L_lw_13_0
    ds_read_b64_tr_b16 v[92:93], v90 offset:0
    ds_read_b64_tr_b16 v[94:95], v90 offset:512
    ds_read_b64_tr_b16 v[96:97], v90 offset:8192
    ds_read_b64_tr_b16 v[98:99], v90 offset:8704
    ds_read_b64_tr_b16 v[100:101], v91 offset:0
    ds_read_b64_tr_b16 v[102:103], v91 offset:512
    ds_read_b64_tr_b16 v[104:105], v91 offset:8192
    ds_read_b64_tr_b16 v[106:107], v91 offset:8704
    ds_read_b64_tr_b16 v[108:109], v90 offset:16384
    ds_read_b64_tr_b16 v[110:111], v90 offset:16896
    ds_read_b64_tr_b16 v[112:113], v90 offset:24576
    ds_read_b64_tr_b16 v[114:115], v90 offset:25088
    ds_read_b64_tr_b16 v[116:117], v91 offset:16384
    ds_read_b64_tr_b16 v[118:119], v91 offset:16896
    ds_read_b64_tr_b16 v[120:121], v91 offset:24576
    ds_read_b64_tr_b16 v[122:123], v91 offset:25088
    s_branch L_lw_13
L_lw_13_0:
    s_cmp_lg_u32 s31, 1
    s_cbranch_scc1 L_lw_13_1
    ds_read_b64_tr_b16 v[92:93], v90 offset:0
    ds_read_b64_tr_b16 v[94:95], v90 offset:512
    ds_read_b64_tr_b16 v[96:97], v90 offset:8192
    ds_read_b64_tr_b16 v[98:99], v90 offset:8704
    ds_read_b64_tr_b16 v[100:101], v91 offset:0
    ds_read_b64_tr_b16 v[102:103], v91 offset:512
    ds_read_b64_tr_b16 v[104:105], v91 offset:8192
    ds_read_b64_tr_b16 v[106:107], v91 offset:8704
    ds_read_b64_tr_b16 v[108:109], v90 offset:16384
    ds_read_b64_tr_b16 v[110:111], v90 offset:16896
    ds_read_b64_tr_b16 v[112:113], v90 offset:24576
    ds_read_b64_tr_b16 v[114:115], v90 offset:25088
    ds_read_b64_tr_b16 v[116:117], v91 offset:16384
    ds_read_b64_tr_b16 v[118:119], v91 offset:16896
    ds_read_b64_tr_b16 v[120:121], v91 offset:24576
    ds_read_b64_tr_b16 v[122:123], v91 offset:25088
    s_branch L_lw_13
L_lw_13_1:
    s_cmp_lg_u32 s31, 2
    s_cbranch_scc1 L_lw_13_2
    ds_read_b64_tr_b16 v[160:161], v90 offset:0
    ds_read_b64_tr_b16 v[162:163], v90 offset:512
    ds_read_b64_tr_b16 v[164:165], v90 offset:8192
    ds_read_b64_tr_b16 v[166:167], v90 offset:8704
    ds_read_b64_tr_b16 v[224:225], v91 offset:0
    ds_read_b64_tr_b16 v[226:227], v91 offset:512
    ds_read_b64_tr_b16 v[228:229], v91 offset:8192
    ds_read_b64_tr_b16 v[230:231], v91 offset:8704
    ds_read_b64_tr_b16 v[168:169], v90 offset:16384
    ds_read_b64_tr_b16 v[170:171], v90 offset:16896
    ds_read_b64_tr_b16 v[172:173], v90 offset:24576
    ds_read_b64_tr_b16 v[174:175], v90 offset:25088
    ds_read_b64_tr_b16 v[232:233], v91 offset:16384
    ds_read_b64_tr_b16 v[234:235], v91 offset:16896
    ds_read_b64_tr_b16 v[236:237], v91 offset:24576
    ds_read_b64_tr_b16 v[238:239], v91 offset:25088
    s_branch L_lw_13
L_lw_13_2:
    ds_read_b64_tr_b16 v[176:177], v90 offset:0
    ds_read_b64_tr_b16 v[178:179], v90 offset:512
    ds_read_b64_tr_b16 v[180:181], v90 offset:8192
    ds_read_b64_tr_b16 v[182:183], v90 offset:8704
    ds_read_b64_tr_b16 v[240:241], v91 offset:0
    ds_read_b64_tr_b16 v[242:243], v91 offset:512
    ds_read_b64_tr_b16 v[244:245], v91 offset:8192
    ds_read_b64_tr_b16 v[246:247], v91 offset:8704
    ds_read_b64_tr_b16 v[184:185], v90 offset:16384
    ds_read_b64_tr_b16 v[186:187], v90 offset:16896
    ds_read_b64_tr_b16 v[188:189], v90 offset:24576
    ds_read_b64_tr_b16 v[190:191], v90 offset:25088
    ds_read_b64_tr_b16 v[248:249], v91 offset:16384
    ds_read_b64_tr_b16 v[250:251], v91 offset:16896
    ds_read_b64_tr_b16 v[252:253], v91 offset:24576
    ds_read_b64_tr_b16 v[254:255], v91 offset:25088
L_lw_13:
    s_waitcnt lgkmcnt(0)
    s_barrier
    v_mov_b32 v125, 0x8000
    v_bfe_u32 v126, v127, 0, 6
    v_lshl_add_u32 v125, v126, 4, v125
    s_cmp_lg_u32 s31, 0
    s_cbranch_scc1 L_hw_14
    ds_write_b128 v125, v[0:3] offset:0
    ds_write_b128 v125, v[4:7] offset:1024
    ds_write_b128 v125, v[92:95] offset:2048
    ds_write_b128 v125, v[96:99] offset:3072
    ds_write_b128 v125, v[8:11] offset:4096
    ds_write_b128 v125, v[12:15] offset:5120
    ds_write_b128 v125, v[100:103] offset:6144
    ds_write_b128 v125, v[104:107] offset:7168
    ds_write_b128 v125, v[16:19] offset:8192
    ds_write_b128 v125, v[20:23] offset:9216
    ds_write_b128 v125, v[108:111] offset:10240
    ds_write_b128 v125, v[112:115] offset:11264
    ds_write_b128 v125, v[24:27] offset:12288
    ds_write_b128 v125, v[28:31] offset:13312
    ds_write_b128 v125, v[116:119] offset:14336
    ds_write_b128 v125, v[120:123] offset:15360
L_hw_14:
    s_cmp_lg_u32 s31, 1
    s_cbranch_scc1 L_hw_15
    ds_write_b128 v125, v[32:35] offset:16384
    ds_write_b128 v125, v[36:39] offset:17408
    ds_write_b128 v125, v[92:95] offset:18432
    ds_write_b128 v125, v[96:99] offset:19456
    ds_write_b128 v125, v[40:43] offset:20480
    ds_write_b128 v125, v[44:47] offset:21504
    ds_write_b128 v125, v[100:103] offset:22528
    ds_write_b128 v125, v[104:107] offset:23552
    ds_write_b128 v125, v[48:51] offset:24576
    ds_write_b128 v125, v[52:55] offset:25600
    ds_write_b128 v125, v[108:111] offset:26624
    ds_write_b128 v125, v[112:115] offset:27648
    ds_write_b128 v125, v[56:59] offset:28672
    ds_write_b128 v125, v[60:63] offset:29696
    ds_write_b128 v125, v[116:119] offset:30720
    ds_write_b128 v125, v[120:123] offset:31744
L_hw_15:
    s_waitcnt lgkmcnt(0)
    s_waitcnt vmcnt(16)
    s_barrier
    v_add_u32 v90, 0x10000, v85
    v_add_u32 v91, 0x10000, v86
    s_cmp_lg_u32 s31, 1
    s_cbranch_scc1 L_lw_16_0
    ds_read_b64_tr_b16 v[92:93], v90 offset:0
    ds_read_b64_tr_b16 v[94:95], v90 offset:512
    ds_read_b64_tr_b16 v[96:97], v90 offset:8192
    ds_read_b64_tr_b16 v[98:99], v90 offset:8704
    ds_read_b64_tr_b16 v[100:101], v91 offset:0
    ds_read_b64_tr_b16 v[102:103], v91 offset:512
    ds_read_b64_tr_b16 v[104:105], v91 offset:8192
    ds_read_b64_tr_b16 v[106:107], v91 offset:8704
    ds_read_b64_tr_b16 v[108:109], v90 offset:16384
    ds_read_b64_tr_b16 v[110:111], v90 offset:16896
    ds_read_b64_tr_b16 v[112:113], v90 offset:24576
    ds_read_b64_tr_b16 v[114:115], v90 offset:25088
    ds_read_b64_tr_b16 v[116:117], v91 offset:16384
    ds_read_b64_tr_b16 v[118:119], v91 offset:16896
    ds_read_b64_tr_b16 v[120:121], v91 offset:24576
    ds_read_b64_tr_b16 v[122:123], v91 offset:25088
    s_branch L_lw_16
L_lw_16_0:
    s_cmp_lg_u32 s31, 0
    s_cbranch_scc1 L_lw_16_1
    ds_read_b64_tr_b16 v[92:93], v90 offset:0
    ds_read_b64_tr_b16 v[94:95], v90 offset:512
    ds_read_b64_tr_b16 v[96:97], v90 offset:8192
    ds_read_b64_tr_b16 v[98:99], v90 offset:8704
    ds_read_b64_tr_b16 v[100:101], v91 offset:0
    ds_read_b64_tr_b16 v[102:103], v91 offset:512
    ds_read_b64_tr_b16 v[104:105], v91 offset:8192
    ds_read_b64_tr_b16 v[106:107], v91 offset:8704
    ds_read_b64_tr_b16 v[108:109], v90 offset:16384
    ds_read_b64_tr_b16 v[110:111], v90 offset:16896
    ds_read_b64_tr_b16 v[112:113], v90 offset:24576
    ds_read_b64_tr_b16 v[114:115], v90 offset:25088
    ds_read_b64_tr_b16 v[116:117], v91 offset:16384
    ds_read_b64_tr_b16 v[118:119], v91 offset:16896
    ds_read_b64_tr_b16 v[120:121], v91 offset:24576
    ds_read_b64_tr_b16 v[122:123], v91 offset:25088
    s_branch L_lw_16
L_lw_16_1:
    s_cmp_lg_u32 s31, 3
    s_cbranch_scc1 L_lw_16_2
    ds_read_b64_tr_b16 v[160:161], v90 offset:0
    ds_read_b64_tr_b16 v[162:163], v90 offset:512
    ds_read_b64_tr_b16 v[164:165], v90 offset:8192
    ds_read_b64_tr_b16 v[166:167], v90 offset:8704
    ds_read_b64_tr_b16 v[224:225], v91 offset:0
    ds_read_b64_tr_b16 v[226:227], v91 offset:512
    ds_read_b64_tr_b16 v[228:229], v91 offset:8192
    ds_read_b64_tr_b16 v[230:231], v91 offset:8704
    ds_read_b64_tr_b16 v[168:169], v90 offset:16384
    ds_read_b64_tr_b16 v[170:171], v90 offset:16896
    ds_read_b64_tr_b16 v[172:173], v90 offset:24576
    ds_read_b64_tr_b16 v[174:175], v90 offset:25088
    ds_read_b64_tr_b16 v[232:233], v91 offset:16384
    ds_read_b64_tr_b16 v[234:235], v91 offset:16896
    ds_read_b64_tr_b16 v[236:237], v91 offset:24576
    ds_read_b64_tr_b16 v[238:239], v91 offset:25088
    s_branch L_lw_16
L_lw_16_2:
    ds_read_b64_tr_b16 v[176:177], v90 offset:0
    ds_read_b64_tr_b16 v[178:179], v90 offset:512
    ds_read_b64_tr_b16 v[180:181], v90 offset:8192
    ds_read_b64_tr_b16 v[182:183], v90 offset:8704
    ds_read_b64_tr_b16 v[240:241], v91 offset:0
    ds_read_b64_tr_b16 v[242:243], v91 offset:512
    ds_read_b64_tr_b16 v[244:245], v91 offset:8192
    ds_read_b64_tr_b16 v[246:247], v91 offset:8704
    ds_read_b64_tr_b16 v[184:185], v90 offset:16384
    ds_read_b64_tr_b16 v[186:187], v90 offset:16896
    ds_read_b64_tr_b16 v[188:189], v90 offset:24576
    ds_read_b64_tr_b16 v[190:191], v90 offset:25088
    ds_read_b64_tr_b16 v[248:249], v91 offset:16384
    ds_read_b64_tr_b16 v[250:251], v91 offset:16896
    ds_read_b64_tr_b16 v[252:253], v91 offset:24576
    ds_read_b64_tr_b16 v[254:255], v91 offset:25088
L_lw_16:
    s_waitcnt lgkmcnt(0)
    s_barrier
    v_mov_b32 v125, 0x10000
    v_bfe_u32 v126, v127, 0, 6
    v_lshl_add_u32 v125, v126, 4, v125
    s_cmp_lg_u32 s31, 1
    s_cbranch_scc1 L_hw_17
    ds_write_b128 v125, v[0:3] offset:0
    ds_write_b128 v125, v[4:7] offset:1024
    ds_write_b128 v125, v[92:95] offset:2048
    ds_write_b128 v125, v[96:99] offset:3072
    ds_write_b128 v125, v[8:11] offset:4096
    ds_write_b128 v125, v[12:15] offset:5120
    ds_write_b128 v125, v[100:103] offset:6144
    ds_write_b128 v125, v[104:107] offset:7168
    ds_write_b128 v125, v[16:19] offset:8192
    ds_write_b128 v125, v[20:23] offset:9216
    ds_write_b128 v125, v[108:111] offset:10240
    ds_write_b128 v125, v[112:115] offset:11264
    ds_write_b128 v125, v[24:27] offset:12288
    ds_write_b128 v125, v[28:31] offset:13312
    ds_write_b128 v125, v[116:119] offset:14336
    ds_write_b128 v125, v[120:123] offset:15360
L_hw_17:
    s_cmp_lg_u32 s31, 0
    s_cbranch_scc1 L_hw_18
    ds_write_b128 v125, v[32:35] offset:16384
    ds_write_b128 v125, v[36:39] offset:17408
    ds_write_b128 v125, v[92:95] offset:18432
    ds_write_b128 v125, v[96:99] offset:19456
    ds_write_b128 v125, v[40:43] offset:20480
    ds_write_b128 v125, v[44:47] offset:21504
    ds_write_b128 v125, v[100:103] offset:22528
    ds_write_b128 v125, v[104:107] offset:23552
    ds_write_b128 v125, v[48:51] offset:24576
    ds_write_b128 v125, v[52:55] offset:25600
    ds_write_b128 v125, v[108:111] offset:26624
    ds_write_b128 v125, v[112:115] offset:27648
    ds_write_b128 v125, v[56:59] offset:28672
    ds_write_b128 v125, v[60:63] offset:29696
    ds_write_b128 v125, v[116:119] offset:30720
    ds_write_b128 v125, v[120:123] offset:31744
L_hw_18:
    s_waitcnt lgkmcnt(0)
    s_waitcnt vmcnt(8)
    s_barrier
    v_add_u32 v90, 0x18000, v85
    v_add_u32 v91, 0x18000, v86
    s_cmp_lg_u32 s31, 2
    s_cbranch_scc1 L_lw_19_0
    ds_read_b64_tr_b16 v[92:93], v90 offset:0
    ds_read_b64_tr_b16 v[94:95], v90 offset:512
    ds_read_b64_tr_b16 v[96:97], v90 offset:8192
    ds_read_b64_tr_b16 v[98:99], v90 offset:8704
    ds_read_b64_tr_b16 v[100:101], v91 offset:0
    ds_read_b64_tr_b16 v[102:103], v91 offset:512
    ds_read_b64_tr_b16 v[104:105], v91 offset:8192
    ds_read_b64_tr_b16 v[106:107], v91 offset:8704
    ds_read_b64_tr_b16 v[108:109], v90 offset:16384
    ds_read_b64_tr_b16 v[110:111], v90 offset:16896
    ds_read_b64_tr_b16 v[112:113], v90 offset:24576
    ds_read_b64_tr_b16 v[114:115], v90 offset:25088
    ds_read_b64_tr_b16 v[116:117], v91 offset:16384
    ds_read_b64_tr_b16 v[118:119], v91 offset:16896
    ds_read_b64_tr_b16 v[120:121], v91 offset:24576
    ds_read_b64_tr_b16 v[122:123], v91 offset:25088
    s_branch L_lw_19
L_lw_19_0:
    s_cmp_lg_u32 s31, 3
    s_cbranch_scc1 L_lw_19_1
    ds_read_b64_tr_b16 v[92:93], v90 offset:0
    ds_read_b64_tr_b16 v[94:95], v90 offset:512
    ds_read_b64_tr_b16 v[96:97], v90 offset:8192
    ds_read_b64_tr_b16 v[98:99], v90 offset:8704
    ds_read_b64_tr_b16 v[100:101], v91 offset:0
    ds_read_b64_tr_b16 v[102:103], v91 offset:512
    ds_read_b64_tr_b16 v[104:105], v91 offset:8192
    ds_read_b64_tr_b16 v[106:107], v91 offset:8704
    ds_read_b64_tr_b16 v[108:109], v90 offset:16384
    ds_read_b64_tr_b16 v[110:111], v90 offset:16896
    ds_read_b64_tr_b16 v[112:113], v90 offset:24576
    ds_read_b64_tr_b16 v[114:115], v90 offset:25088
    ds_read_b64_tr_b16 v[116:117], v91 offset:16384
    ds_read_b64_tr_b16 v[118:119], v91 offset:16896
    ds_read_b64_tr_b16 v[120:121], v91 offset:24576
    ds_read_b64_tr_b16 v[122:123], v91 offset:25088
    s_branch L_lw_19
L_lw_19_1:
    s_cmp_lg_u32 s31, 0
    s_cbranch_scc1 L_lw_19_2
    ds_read_b64_tr_b16 v[160:161], v90 offset:0
    ds_read_b64_tr_b16 v[162:163], v90 offset:512
    ds_read_b64_tr_b16 v[164:165], v90 offset:8192
    ds_read_b64_tr_b16 v[166:167], v90 offset:8704
    ds_read_b64_tr_b16 v[224:225], v91 offset:0
    ds_read_b64_tr_b16 v[226:227], v91 offset:512
    ds_read_b64_tr_b16 v[228:229], v91 offset:8192
    ds_read_b64_tr_b16 v[230:231], v91 offset:8704
    ds_read_b64_tr_b16 v[168:169], v90 offset:16384
    ds_read_b64_tr_b16 v[170:171], v90 offset:16896
    ds_read_b64_tr_b16 v[172:173], v90 offset:24576
    ds_read_b64_tr_b16 v[174:175], v90 offset:25088
    ds_read_b64_tr_b16 v[232:233], v91 offset:16384
    ds_read_b64_tr_b16 v[234:235], v91 offset:16896
    ds_read_b64_tr_b16 v[236:237], v91 offset:24576
    ds_read_b64_tr_b16 v[238:239], v91 offset:25088
    s_branch L_lw_19
L_lw_19_2:
    ds_read_b64_tr_b16 v[176:177], v90 offset:0
    ds_read_b64_tr_b16 v[178:179], v90 offset:512
    ds_read_b64_tr_b16 v[180:181], v90 offset:8192
    ds_read_b64_tr_b16 v[182:183], v90 offset:8704
    ds_read_b64_tr_b16 v[240:241], v91 offset:0
    ds_read_b64_tr_b16 v[242:243], v91 offset:512
    ds_read_b64_tr_b16 v[244:245], v91 offset:8192
    ds_read_b64_tr_b16 v[246:247], v91 offset:8704
    ds_read_b64_tr_b16 v[184:185], v90 offset:16384
    ds_read_b64_tr_b16 v[186:187], v90 offset:16896
    ds_read_b64_tr_b16 v[188:189], v90 offset:24576
    ds_read_b64_tr_b16 v[190:191], v90 offset:25088
    ds_read_b64_tr_b16 v[248:249], v91 offset:16384
    ds_read_b64_tr_b16 v[250:251], v91 offset:16896
    ds_read_b64_tr_b16 v[252:253], v91 offset:24576
    ds_read_b64_tr_b16 v[254:255], v91 offset:25088
L_lw_19:
    s_waitcnt lgkmcnt(0)
    s_barrier
    v_mov_b32 v125, 0x18000
    v_bfe_u32 v126, v127, 0, 6
    v_lshl_add_u32 v125, v126, 4, v125
    s_cmp_lg_u32 s31, 2
    s_cbranch_scc1 L_hw_20
    ds_write_b128 v125, v[0:3] offset:0
    ds_write_b128 v125, v[4:7] offset:1024
    ds_write_b128 v125, v[92:95] offset:2048
    ds_write_b128 v125, v[96:99] offset:3072
    ds_write_b128 v125, v[8:11] offset:4096
    ds_write_b128 v125, v[12:15] offset:5120
    ds_write_b128 v125, v[100:103] offset:6144
    ds_write_b128 v125, v[104:107] offset:7168
    ds_write_b128 v125, v[16:19] offset:8192
    ds_write_b128 v125, v[20:23] offset:9216
    ds_write_b128 v125, v[108:111] offset:10240
    ds_write_b128 v125, v[112:115] offset:11264
    ds_write_b128 v125, v[24:27] offset:12288
    ds_write_b128 v125, v[28:31] offset:13312
    ds_write_b128 v125, v[116:119] offset:14336
    ds_write_b128 v125, v[120:123] offset:15360
L_hw_20:
    s_cmp_lg_u32 s31, 3
    s_cbranch_scc1 L_hw_21
    ds_write_b128 v125, v[32:35] offset:16384
    ds_write_b128 v125, v[36:39] offset:17408
    ds_write_b128 v125, v[92:95] offset:18432
    ds_write_b128 v125, v[96:99] offset:19456
    ds_write_b128 v125, v[40:43] offset:20480
    ds_write_b128 v125, v[44:47] offset:21504
    ds_write_b128 v125, v[100:103] offset:22528
    ds_write_b128 v125, v[104:107] offset:23552
    ds_write_b128 v125, v[48:51] offset:24576
    ds_write_b128 v125, v[52:55] offset:25600
    ds_write_b128 v125, v[108:111] offset:26624
    ds_write_b128 v125, v[112:115] offset:27648
    ds_write_b128 v125, v[56:59] offset:28672
    ds_write_b128 v125, v[60:63] offset:29696
    ds_write_b128 v125, v[116:119] offset:30720
    ds_write_b128 v125, v[120:123] offset:31744
L_hw_21:
    s_waitcnt lgkmcnt(0)
    s_waitcnt vmcnt(0)
    s_barrier
    v_add_u32 v90, 0x20000, v85
    v_add_u32 v91, 0x20000, v86
    s_cmp_lg_u32 s31, 3
    s_cbranch_scc1 L_lw_22_0
    ds_read_b64_tr_b16 v[92:93], v90 offset:0
    ds_read_b64_tr_b16 v[94:95], v90 offset:512
    ds_read_b64_tr_b16 v[96:97], v90 offset:8192
    ds_read_b64_tr_b16 v[98:99], v90 offset:8704
    ds_read_b64_tr_b16 v[100:101], v91 offset:0
    ds_read_b64_tr_b16 v[102:103], v91 offset:512
    ds_read_b64_tr_b16 v[104:105], v91 offset:8192
    ds_read_b64_tr_b16 v[106:107], v91 offset:8704
    ds_read_b64_tr_b16 v[108:109], v90 offset:16384
    ds_read_b64_tr_b16 v[110:111], v90 offset:16896
    ds_read_b64_tr_b16 v[112:113], v90 offset:24576
    ds_read_b64_tr_b16 v[114:115], v90 offset:25088
    ds_read_b64_tr_b16 v[116:117], v91 offset:16384
    ds_read_b64_tr_b16 v[118:119], v91 offset:16896
    ds_read_b64_tr_b16 v[120:121], v91 offset:24576
    ds_read_b64_tr_b16 v[122:123], v91 offset:25088
    s_branch L_lw_22
L_lw_22_0:
    s_cmp_lg_u32 s31, 2
    s_cbranch_scc1 L_lw_22_1
    ds_read_b64_tr_b16 v[92:93], v90 offset:0
    ds_read_b64_tr_b16 v[94:95], v90 offset:512
    ds_read_b64_tr_b16 v[96:97], v90 offset:8192
    ds_read_b64_tr_b16 v[98:99], v90 offset:8704
    ds_read_b64_tr_b16 v[100:101], v91 offset:0
    ds_read_b64_tr_b16 v[102:103], v91 offset:512
    ds_read_b64_tr_b16 v[104:105], v91 offset:8192
    ds_read_b64_tr_b16 v[106:107], v91 offset:8704
    ds_read_b64_tr_b16 v[108:109], v90 offset:16384
    ds_read_b64_tr_b16 v[110:111], v90 offset:16896
    ds_read_b64_tr_b16 v[112:113], v90 offset:24576
    ds_read_b64_tr_b16 v[114:115], v90 offset:25088
    ds_read_b64_tr_b16 v[116:117], v91 offset:16384
    ds_read_b64_tr_b16 v[118:119], v91 offset:16896
    ds_read_b64_tr_b16 v[120:121], v91 offset:24576
    ds_read_b64_tr_b16 v[122:123], v91 offset:25088
    s_branch L_lw_22
L_lw_22_1:
    s_cmp_lg_u32 s31, 1
    s_cbranch_scc1 L_lw_22_2
    ds_read_b64_tr_b16 v[160:161], v90 offset:0
    ds_read_b64_tr_b16 v[162:163], v90 offset:512
    ds_read_b64_tr_b16 v[164:165], v90 offset:8192
    ds_read_b64_tr_b16 v[166:167], v90 offset:8704
    ds_read_b64_tr_b16 v[224:225], v91 offset:0
    ds_read_b64_tr_b16 v[226:227], v91 offset:512
    ds_read_b64_tr_b16 v[228:229], v91 offset:8192
    ds_read_b64_tr_b16 v[230:231], v91 offset:8704
    ds_read_b64_tr_b16 v[168:169], v90 offset:16384
    ds_read_b64_tr_b16 v[170:171], v90 offset:16896
    ds_read_b64_tr_b16 v[172:173], v90 offset:24576
    ds_read_b64_tr_b16 v[174:175], v90 offset:25088
    ds_read_b64_tr_b16 v[232:233], v91 offset:16384
    ds_read_b64_tr_b16 v[234:235], v91 offset:16896
    ds_read_b64_tr_b16 v[236:237], v91 offset:24576
    ds_read_b64_tr_b16 v[238:239], v91 offset:25088
    s_branch L_lw_22
L_lw_22_2:
    ds_read_b64_tr_b16 v[176:177], v90 offset:0
    ds_read_b64_tr_b16 v[178:179], v90 offset:512
    ds_read_b64_tr_b16 v[180:181], v90 offset:8192
    ds_read_b64_tr_b16 v[182:183], v90 offset:8704
    ds_read_b64_tr_b16 v[240:241], v91 offset:0
    ds_read_b64_tr_b16 v[242:243], v91 offset:512
    ds_read_b64_tr_b16 v[244:245], v91 offset:8192
    ds_read_b64_tr_b16 v[246:247], v91 offset:8704
    ds_read_b64_tr_b16 v[184:185], v90 offset:16384
    ds_read_b64_tr_b16 v[186:187], v90 offset:16896
    ds_read_b64_tr_b16 v[188:189], v90 offset:24576
    ds_read_b64_tr_b16 v[190:191], v90 offset:25088
    ds_read_b64_tr_b16 v[248:249], v91 offset:16384
    ds_read_b64_tr_b16 v[250:251], v91 offset:16896
    ds_read_b64_tr_b16 v[252:253], v91 offset:24576
    ds_read_b64_tr_b16 v[254:255], v91 offset:25088
L_lw_22:
    s_waitcnt lgkmcnt(0)
    s_barrier
    v_mov_b32 v125, 0x20000
    v_bfe_u32 v126, v127, 0, 6
    v_lshl_add_u32 v125, v126, 4, v125
    s_cmp_lg_u32 s31, 3
    s_cbranch_scc1 L_hw_23
    ds_write_b128 v125, v[0:3] offset:0
    ds_write_b128 v125, v[4:7] offset:1024
    ds_write_b128 v125, v[92:95] offset:2048
    ds_write_b128 v125, v[96:99] offset:3072
    ds_write_b128 v125, v[8:11] offset:4096
    ds_write_b128 v125, v[12:15] offset:5120
    ds_write_b128 v125, v[100:103] offset:6144
    ds_write_b128 v125, v[104:107] offset:7168
    ds_write_b128 v125, v[16:19] offset:8192
    ds_write_b128 v125, v[20:23] offset:9216
    ds_write_b128 v125, v[108:111] offset:10240
    ds_write_b128 v125, v[112:115] offset:11264
    ds_write_b128 v125, v[24:27] offset:12288
    ds_write_b128 v125, v[28:31] offset:13312
    ds_write_b128 v125, v[116:119] offset:14336
    ds_write_b128 v125, v[120:123] offset:15360
L_hw_23:
    s_cmp_lg_u32 s31, 2
    s_cbranch_scc1 L_hw_24
    ds_write_b128 v125, v[32:35] offset:16384
    ds_write_b128 v125, v[36:39] offset:17408
    ds_write_b128 v125, v[92:95] offset:18432
    ds_write_b128 v125, v[96:99] offset:19456
    ds_write_b128 v125, v[40:43] offset:20480
    ds_write_b128 v125, v[44:47] offset:21504
    ds_write_b128 v125, v[100:103] offset:22528
    ds_write_b128 v125, v[104:107] offset:23552
    ds_write_b128 v125, v[48:51] offset:24576
    ds_write_b128 v125, v[52:55] offset:25600
    ds_write_b128 v125, v[108:111] offset:26624
    ds_write_b128 v125, v[112:115] offset:27648
    ds_write_b128 v125, v[56:59] offset:28672
    ds_write_b128 v125, v[60:63] offset:29696
    ds_write_b128 v125, v[116:119] offset:30720
    ds_write_b128 v125, v[120:123] offset:31744
L_hw_24:
    s_waitcnt lgkmcnt(0)
    v_mov_b32 v95, v127
    v_mov_b32 v112, 0x0
    v_bfe_u32 v94, v95, 0, 6
    v_lshl_add_u32 v112, v94, 4, v112
    v_mov_b32 v113, 0x0
    v_bfe_u32 v94, v95, 0, 3
    v_lshl_add_u32 v113, v94, 2, v113
    v_bfe_u32 v94, v95, 4, 1
    v_lshl_add_u32 v113, v94, 8, v113
    v_mov_b32 v114, 0x0
    v_bfe_u32 v94, v95, 0, 6
    v_lshl_add_u32 v114, v94, 4, v114
    v_bfe_u32 v94, v95, 6, 2
    v_lshl_add_u32 v114, v94, 11, v114
    v_mov_b32 v115, 0x0
    v_bfe_i32 v94, v95, 0, 1
    v_and_b32 v94, 0x20, v94
    v_xor_b32 v115, v115, v94
    v_bfe_i32 v94, v95, 1, 1
    v_and_b32 v94, 0x40, v94
    v_xor_b32 v115, v115, v94
    v_bfe_i32 v94, v95, 2, 1
    v_and_b32 v94, 0x80, v94
    v_xor_b32 v115, v115, v94
    v_bfe_i32 v94, v95, 3, 1
    v_and_b32 v94, 0x180, v94
    v_xor_b32 v115, v115, v94
    v_bfe_i32 v94, v95, 4, 1
    v_and_b32 v94, 0x8, v94
    v_xor_b32 v115, v115, v94
    v_bfe_i32 v94, v95, 5, 1
    v_and_b32 v94, 0x10, v94
    v_xor_b32 v115, v115, v94
    v_bfe_i32 v94, v95, 6, 1
    v_and_b32 v94, 0x400, v94
    v_xor_b32 v115, v115, v94
    v_bfe_i32 v94, v95, 7, 1
    v_and_b32 v94, 0x800, v94
    v_xor_b32 v115, v115, v94
    v_mov_b32 v116, 0x0
    v_bfe_u32 v94, v95, 0, 4
    v_lshl_add_u32 v116, v94, 3, v116
    v_bfe_u32 v94, v95, 4, 1
    v_mul_u32_u24 v94, 0x180, v94
    v_add_u32 v116, v116, v94
    v_bfe_u32 v94, v95, 5, 1
    v_lshl_add_u32 v116, v94, 9, v116
    v_xor_b32 v117, 0x80, v116
    v_mov_b32 v118, 0x0
    v_bfe_u32 v94, v95, 0, 3
    v_lshl_add_u32 v118, v94, 4, v118
    v_bfe_u32 v94, v95, 3, 3
    v_lshl_add_u32 v118, v94, 8, v118
    v_mov_b32 v119, 0x2000
    v_bfe_u32 v94, v95, 0, 4
    v_lshl_add_u32 v119, v94, 4, v119
    v_bfe_u32 v94, v95, 4, 2
    v_lshl_add_u32 v119, v94, 9, v119
    s_lshl_b32 s67, s31, 11
    s_lshl_b32 s66, s31, 10
    v_mov_b32 v120, 0x0
    v_bfe_u32 v94, v95, 0, 1
    v_lshl_add_u32 v120, v94, 4, v120
    v_bfe_u32 v94, v95, 2, 6
    v_lshl_add_u32 v120, v94, 5, v120
    v_mov_b32 v125, 0x2000
    v_bfe_u32 v94, v95, 0, 6
    v_lshl_add_u32 v125, v94, 4, v125
    v_mov_b32 v122, 0x0
    v_bfe_u32 v94, v95, 0, 6
    v_lshl_add_u32 v122, v94, 4, v122
    v_bfe_u32 v94, v95, 6, 2
    v_lshl_add_u32 v122, v94, 15, v122
    v_xor_b32 v121, 0xc000, v122
    v_mov_b32 v123, 0x0
    v_bfe_u32 v94, v95, 0, 3
    v_lshl_add_u32 v123, v94, 3, v123
    v_bfe_u32 v94, v95, 3, 3
    v_lshl_add_u32 v123, v94, 13, v123
    v_mov_b32 v124, 0x4444
    v_bfe_u32 v94, v95, 1, 1
    v_mul_u32_u24 v94, 0xaaaa, v94
    v_add_u32 v124, v124, v94
    v_mov_b32 v0, 0x0
    v_bfe_u32 v94, v95, 0, 1
    v_lshl_add_u32 v0, v94, 2, v0
    v_bfe_u32 v94, v95, 1, 2
    v_lshl_add_u32 v0, v94, 0, v0
    v_lshrrev_b32 v1, 1, v0
    v_and_b32 v2, 1, v0
    v_lshlrev_b32 v2, 4, v2
    v_mov_b32 v3, 0x3f80
    v_lshlrev_b32 v3, v2, v3
    v_cmp_eq_u32 vcc, 0, v1
    s_nop 1
    v_cndmask_b32 v4, 0, v3, vcc
    v_cmp_eq_u32 vcc, 1, v1
    s_nop 1
    v_cndmask_b32 v5, 0, v3, vcc
    v_cmp_eq_u32 vcc, 2, v1
    s_nop 1
    v_cndmask_b32 v6, 0, v3, vcc
    v_cmp_eq_u32 vcc, 3, v1
    s_nop 1
    v_cndmask_b32 v7, 0, v3, vcc
    ds_write_b128 v112, v[4:7] offset:28672
    s_mov_b32 s64, 0x3e0293ee
    s_mov_b32 s65, s64
    s_movk_i32 s79, 8192
    s_mov_b32 s94, 0
    s_mov_b32 s95, 0x3f003f00
    s_mov_b32 s70, 0x3f803f80
    s_mov_b32 s71, 0x3f803f80
    s_mov_b32 s76, 0xcccccccc
    s_mov_b32 s77, 0xcccccccc
    s_mov_b32 s78, 0x01010101
    s_mov_b32 s33, 0
    s_mov_b32 s73, s67
    s_mov_b32 s74, 8192
    s_mov_b32 s34, 0
    v_mov_b32 v1, 0
L_h_wait0:
    global_load_dwordx2 v[2:3], v1, s[26:27] offset:8 sc1
    s_waitcnt vmcnt(0)
    v_readfirstlane_b32 s80, v2
    v_readfirstlane_b32 s81, v3
    s_cmp_ge_u32 s80, 32
    s_cselect_b32 s80, 1, 0
    s_cmp_ge_u32 s81, 32
    s_cselect_b32 s80, s80, 0
    s_cmp_lg_u32 s80, 0
    s_cbranch_scc1 L_h_go
    s_sub_u32 s62, s62, 1
    s_cbranch_scc0 L_h_wait0
    s_movk_i32 s63, 1
    s_branch L_fail_far
L_h_go:
    v_mov_b32 v2, 64
L_h_arm:
    global_load_dword v3, v2, s[26:27] sc1
    s_waitcnt vmcnt(0)
    v_readfirstlane_b32 s80, v3
    s_cmp_ge_u32 s80, 32
    s_cbranch_scc1 L_h_arm_ok
    s_sleep 4
    s_sub_u32 s62, s62, 1
    s_cbranch_scc0 L_h_arm
    s_movk_i32 s63, 10
    s_branch L_fail_far
L_h_arm_ok:
    global_load_dword v2, v1, s[26:27] sc1
    s_waitcnt vmcnt(0)
    v_readfirstlane_b32 s80, v2
    s_cmp_lt_u32 s80, 32
    s_cbranch_scc1 L_hs_layer
L_hf_layer:
    s_mul_i32 s80, s34, 0x5200000
    s_lshl_b32 s81, s30, 14
    s_add_u32 s81, s81, s80
    s_add_u32 s81, s81, 0x3300000
    s_add_u32 s81, s81, s67
    s_add_u32 s42, s28, s81
    s_addc_u32 s43, s29, 0
    s_add_u32 s54, s28, 0x40000
    s_addc_u32 s55, s29, 0
    s_lshl_b32 s81, s30, 13
    s_add_u32 s81, s81, s80
    s_add_u32 s81, s81, 0x1300000
    s_add_u32 s82, s81, s66
    s_add_u32 s56, s28, s82
    s_addc_u32 s57, s29, 0
    s_lshl_b32 s80, s34, 17
    s_lshl_b32 s81, s30, 10
    s_add_u32 s80, s80, s81
    s_add_u32 s81, s80, 0xc000
    s_add_u32 s58, s28, s81
    s_addc_u32 s59, s29, 0
    s_add_u32 s81, s80, 0x14000
    s_add_u32 s81, s81, s31
    s_add_u32 s68, s28, s81
    s_addc_u32 s69, s29, 0
    s_mov_b32 s32, 0
    s_mov_b32 s72, 0
    s_mov_b64 s[60:61], 0
    v_lshrrev_b32 v8, 4, v112
    v_mov_b32 v126, 0x0
    v_bfe_u32 v127, v8, 0, 1
    v_lshl_add_u32 v126, v127, 10, v126
    v_bfe_u32 v127, v8, 1, 1
    v_lshl_add_u32 v126, v127, 4, v126
    v_bfe_u32 v127, v8, 2, 2
    v_lshl_add_u32 v126, v127, 11, v126
    v_bfe_u32 v127, v8, 4, 2
    v_lshl_add_u32 v126, v127, 5, v126
    s_lshl_b32 s81, s31, 8
    v_add_u32 v126, s81, v126
    global_load_dwordx4 v[0:3], v126, s[12:13] offset:0
    global_load_dwordx4 v[4:7], v126, s[12:13] offset:128
    ds_read_b128 v[80:83], v122 offset:32768
    ds_read_b128 v[84:87], v122 offset:33792
    ds_read_b128 v[88:91], v122 offset:34816
    ds_read_b128 v[92:95], v122 offset:35840
    ds_read_b128 v[32:35], v122 offset:36864
    ds_read_b128 v[36:39], v122 offset:37888
    ds_read_b128 v[40:43], v122 offset:38912
    ds_read_b128 v[44:47], v122 offset:39936
    ds_read_b128 v[48:51], v122 offset:40960
    ds_read_b128 v[52:55], v122 offset:41984
    ds_read_b128 v[56:59], v122 offset:43008
    ds_read_b128 v[60:63], v122 offset:44032
    v_mov_b64 v[96:97], 0
    v_mov_b64 v[98:99], 0
    v_mov_b64 v[100:101], 0
    v_mov_b64 v[102:103], 0
    v_mov_b64 v[104:105], 0
    v_mov_b64 v[106:107], 0
    v_mov_b64 v[108:109], 0
    v_mov_b64 v[110:111], 0
    v_xor_b32 v29, 0x800, v114
    v_xor_b32 v30, 0x1000, v114
    v_xor_b32 v31, 0x1800, v114
    v_mov_b64 v[72:73], 0
    v_mov_b64 v[74:75], 0
    v_mov_b64 v[76:77], 0
    v_mov_b64 v[78:79], 0
    s_waitcnt vmcnt(0) lgkmcnt(0)
    s_branch L_hf_top
.p2align 6
    s_nop 0
    s_nop 0
    s_nop 0
    s_nop 0
    s_nop 0
    s_nop 0
    s_nop 0
    s_nop 0
    s_nop 0
    s_nop 0
    s_nop 0
    s_nop 0
    s_nop 0
L_hf_w0comm:
    ds_read_b128 v[96:99], v112 offset:28672
    s_add_u32 s32, s32, 1
    s_and_b32 s80, s33, 3
    s_lshl_b32 s80, s80, 13
    s_add_u32 s82, s38, s80
    s_add_u32 s50, s46, s82
    s_addc_u32 s51, s47, 0
    s_xor_b32 s82, s82, 0x4000
    s_add_u32 s52, s46, s82
    s_addc_u32 s53, s47, 0
    s_waitcnt vmcnt(2)
    global_load_dwordx4 v[8:11], v112, s[44:45] offset:0 sc1
    global_load_dwordx4 v[12:15], v112, s[44:45] offset:1024 sc1
    ds_read_b128 v[80:83], v122 offset:32768
    ds_read_b128 v[84:87], v122 offset:33792
    ds_read_b128 v[88:91], v122 offset:34816
    v_mov_b64 v[108:109], 0
    v_mov_b64 v[110:111], 0
    v_xor_b32 v29, 0x800, v114
    v_xor_b32 v30, 0x1000, v114
    v_xor_b32 v31, 0x1800, v114
    v_mov_b64 v[72:73], 0
    v_mov_b64 v[74:75], 0
    v_mov_b64 v[76:77], 0
    v_mov_b64 v[78:79], 0
    s_waitcnt lgkmcnt(0)
L_hf_w0pa0:
    s_waitcnt vmcnt(1)
    v_mfma_f32_16x16x32_bf16 v[100:103], v[96:99], v[8:11], 0
    v_bitop3_b32 v104, v8, v10, s35 bitop3:0x7e
    s_waitcnt vmcnt(0)
    v_mfma_f32_16x16x32_bf16 v[100:103], v[96:99], v[12:15], v[100:103]
    v_bitop3_b32 v105, v12, v14, s35 bitop3:0x7e
    v_bitop3_b32 v104, v104, v105, 1 bitop3:0xa8
    v_cmp_ne_u32 vcc, 0, v104
    s_cbranch_vccnz L_hf_w0pa_fail
L_hf_w0pa_ok:
    s_nop 3
    v_add_f32_dpp v100, v100, v100 row_ror:4 row_mask:0xf bank_mask:0xf
    v_add_f32_dpp v101, v101, v101 row_ror:4 row_mask:0xf bank_mask:0xf
    v_add_f32_dpp v102, v102, v102 row_ror:4 row_mask:0xf bank_mask:0xf
    v_add_f32_dpp v103, v103, v103 row_ror:4 row_mask:0xf bank_mask:0xf
    v_add_f32_dpp v106, v100, v100 row_ror:8 row_mask:0xf bank_mask:0x5
    v_add_f32_dpp v107, v101, v101 row_ror:8 row_mask:0xf bank_mask:0x5
    v_mov_b32 v104, -1
    v_add_f32_dpp v106, v102, v102 row_ror:8 row_mask:0xf bank_mask:0xa
    v_add_f32_dpp v107, v103, v103 row_ror:8 row_mask:0xf bank_mask:0xa
    v_cvt_pk_bf16_f32 v106, v106, v107
    v_min_u32 v106, -2, v106
    global_store_dword v113, v106, s[50:51]
    global_store_dword v113, v104, s[52:53]
    v_and_b32 v127, v126, v127
    v_cmp_eq_u32 vcc, s78, v127
    s_or_b64 s[60:61], s[60:61], vcc
    s_add_u32 s82, s32, 1
    s_bitcmp1_b64 s[60:61], s82
    s_cselect_b32 s72, 0x80000, 0
    s_add_u32 s48, s40, s80
    s_addc_u32 s49, s41, 0
    ds_read_b128 v[92:95], v122 offset:35840
    ds_read_b128 v[32:35], v122 offset:36864
    ds_read_b128 v[36:39], v122 offset:37888
    global_load_dwordx4 v[0:3], v112, s[48:49] offset:0 sc1
    global_load_dwordx4 v[4:7], v112, s[48:49] offset:1024 sc1
    s_cmp_ge_u32 s32, 63
    s_cselect_b32 s72, 0, s72
    s_xor_b32 s73, s73, 0x2000
    v_xor_b32 v125, 0x2000, v125
    s_add_u32 s33, s33, 1
    s_add_u32 s56, s56, 0x40000
    s_addc_u32 s57, s57, 0
    s_add_u32 s68, s68, 8
    s_addc_u32 s69, s69, 0
    v_mov_b64 v[96:97], 0
    v_mov_b64 v[98:99], 0
    v_mov_b64 v[100:101], 0
    v_mov_b64 v[102:103], 0
    v_mov_b64 v[104:105], 0
    v_mov_b64 v[106:107], 0
    ds_read_b128 v[40:43], v122 offset:38912
    ds_read_b128 v[44:47], v122 offset:39936
    ds_read_b128 v[48:51], v122 offset:40960
    ds_read_b128 v[52:55], v122 offset:41984
    ds_read_b128 v[56:59], v122 offset:43008
    ds_read_b128 v[60:63], v122 offset:44032
    s_waitcnt lgkmcnt(0)
    global_load_dwordx4 v[0:3], v112, s[48:49] offset:0 sc1
    global_load_dwordx4 v[4:7], v112, s[48:49] offset:1024 sc1
L_hf_w0pb:
    s_waitcnt vmcnt(3)
    v_max3_u32 v127, v0, v1, v2
    s_waitcnt vmcnt(2)
    v_max3_u32 v126, v3, v4, v5
    v_max3_u32 v127, v127, v6, v7
    v_max_u32 v127, v127, v126
    v_cmp_eq_u32 vcc, -1, v127
    s_cbranch_vccnz L_hf_w0pb_fail
    s_branch L_hf_top0
.p2align 6
    s_nop 0
    s_nop 0
    s_nop 0
    s_nop 0
    s_nop 0
    s_nop 0
    s_nop 0
    s_nop 0
    s_nop 0
    s_nop 0
    s_nop 0
    s_nop 0
    s_nop 0
L_hf_w1comm:
    ds_read_b128 v[96:99], v112 offset:28672
    s_add_u32 s32, s32, 1
    s_and_b32 s80, s33, 3
    s_lshl_b32 s80, s80, 13
    s_add_u32 s82, s38, s80
    s_add_u32 s50, s46, s82
    s_addc_u32 s51, s47, 0
    s_xor_b32 s82, s82, 0x4000
    s_add_u32 s52, s46, s82
    s_addc_u32 s53, s47, 0
    s_waitcnt vmcnt(2)
    global_load_dwordx4 v[8:11], v112, s[44:45] offset:0 sc1
    global_load_dwordx4 v[12:15], v112, s[44:45] offset:1024 sc1
    ds_read_b128 v[80:83], v122 offset:32768
    ds_read_b128 v[84:87], v122 offset:33792
    ds_read_b128 v[88:91], v122 offset:34816
    v_mov_b64 v[108:109], 0
    v_mov_b64 v[110:111], 0
    v_xor_b32 v29, 0x800, v114
    v_xor_b32 v30, 0x1000, v114
    v_xor_b32 v31, 0x1800, v114
    v_mov_b64 v[72:73], 0
    v_mov_b64 v[74:75], 0
    v_mov_b64 v[76:77], 0
    v_mov_b64 v[78:79], 0
    s_waitcnt lgkmcnt(0)
L_hf_w1pa0:
    s_waitcnt vmcnt(1)
    v_mfma_f32_16x16x32_bf16 v[100:103], v[96:99], v[8:11], 0
    v_bitop3_b32 v104, v8, v10, s35 bitop3:0x7e
    s_waitcnt vmcnt(0)
    v_mfma_f32_16x16x32_bf16 v[100:103], v[96:99], v[12:15], v[100:103]
    v_bitop3_b32 v105, v12, v14, s35 bitop3:0x7e
    v_bitop3_b32 v104, v104, v105, 1 bitop3:0xa8
    v_cmp_ne_u32 vcc, 0, v104
    s_cbranch_vccnz L_hf_w1pa_fail
L_hf_w1pa_ok:
    s_nop 3
    v_add_f32_dpp v100, v100, v100 row_ror:4 row_mask:0xf bank_mask:0xf
    v_add_f32_dpp v101, v101, v101 row_ror:4 row_mask:0xf bank_mask:0xf
    v_add_f32_dpp v102, v102, v102 row_ror:4 row_mask:0xf bank_mask:0xf
    v_add_f32_dpp v103, v103, v103 row_ror:4 row_mask:0xf bank_mask:0xf
    v_add_f32_dpp v106, v100, v100 row_ror:8 row_mask:0xf bank_mask:0x5
    v_add_f32_dpp v107, v101, v101 row_ror:8 row_mask:0xf bank_mask:0x5
    v_mov_b32 v104, -1
    v_add_f32_dpp v106, v102, v102 row_ror:8 row_mask:0xf bank_mask:0xa
    v_add_f32_dpp v107, v103, v103 row_ror:8 row_mask:0xf bank_mask:0xa
    v_cvt_pk_bf16_f32 v106, v106, v107
    v_min_u32 v106, -2, v106
    global_store_dword v113, v106, s[50:51]
    global_store_dword v113, v104, s[52:53]
    v_and_b32 v127, v126, v127
    v_cmp_eq_u32 vcc, s78, v127
    s_or_b64 s[60:61], s[60:61], vcc
    s_add_u32 s82, s32, 1
    s_bitcmp1_b64 s[60:61], s82
    s_cselect_b32 s72, 0x80000, 0
    s_add_u32 s48, s40, s80
    s_addc_u32 s49, s41, 0
    s_cmp_ge_u32 s32, 63
    s_cselect_b32 s72, 0, s72
    s_xor_b32 s73, s73, 0x2000
    v_xor_b32 v125, 0x2000, v125
    s_add_u32 s33, s33, 1
    s_add_u32 s56, s56, 0x40000
    s_addc_u32 s57, s57, 0
    s_add_u32 s68, s68, 8
    s_addc_u32 s69, s69, 0
    v_mov_b64 v[96:97], 0
    v_mov_b64 v[98:99], 0
    v_mov_b64 v[100:101], 0
    v_mov_b64 v[102:103], 0
    v_mov_b64 v[104:105], 0
    v_mov_b64 v[106:107], 0
    global_load_dwordx4 v[0:3], v112, s[48:49] offset:0 sc1
    global_load_dwordx4 v[4:7], v112, s[48:49] offset:1024 sc1
    ds_read_b128 v[92:95], v122 offset:35840
    ds_read_b128 v[32:35], v122 offset:36864
    ds_read_b128 v[36:39], v122 offset:37888
    ds_read_b128 v[40:43], v122 offset:38912
    ds_read_b128 v[44:47], v122 offset:39936
    ds_read_b128 v[48:51], v122 offset:40960
    ds_read_b128 v[52:55], v122 offset:41984
    ds_read_b128 v[56:59], v122 offset:43008
    ds_read_b128 v[60:63], v122 offset:44032
    s_waitcnt lgkmcnt(0)
    global_load_dwordx4 v[0:3], v112, s[48:49] offset:0 sc1
    global_load_dwordx4 v[4:7], v112, s[48:49] offset:1024 sc1
L_hf_w1pb:
    s_waitcnt vmcnt(3)
    v_max3_u32 v127, v0, v1, v2
    s_waitcnt vmcnt(2)
    v_max3_u32 v126, v3, v4, v5
    v_max3_u32 v127, v127, v6, v7
    v_max_u32 v127, v127, v126
    v_cmp_eq_u32 vcc, -1, v127
    s_cbranch_vccnz L_hf_w1pb_fail
    s_branch L_hf_top0
.p2align 6
    s_nop 0
    s_nop 0
    s_nop 0
    s_nop 0
    s_nop 0
    s_nop 0
    s_nop 0
    s_nop 0
    s_nop 0
    s_nop 0
    s_nop 0
    s_nop 0
    s_nop 0
L_hf_w2comm:
    ds_read_b128 v[96:99], v112 offset:28672
    s_add_u32 s32, s32, 1
    s_and_b32 s80, s33, 3
    s_lshl_b32 s80, s80, 13
    s_add_u32 s82, s38, s80
    s_add_u32 s50, s46, s82
    s_addc_u32 s51, s47, 0
    s_xor_b32 s82, s82, 0x4000
    s_add_u32 s52, s46, s82
    s_addc_u32 s53, s47, 0
    s_waitcnt vmcnt(1)
    global_load_dwordx4 v[8:11], v112, s[44:45] offset:0 sc1
    global_load_dwordx4 v[12:15], v112, s[44:45] offset:1024 sc1
    ds_read_b128 v[80:83], v122 offset:32768
    ds_read_b128 v[84:87], v122 offset:33792
    v_mov_b64 v[108:109], 0
    v_mov_b64 v[110:111], 0
    v_xor_b32 v29, 0x800, v114
    v_xor_b32 v30, 0x1000, v114
    v_xor_b32 v31, 0x1800, v114
    v_mov_b64 v[72:73], 0
    v_mov_b64 v[74:75], 0
    v_mov_b64 v[76:77], 0
    v_mov_b64 v[78:79], 0
    s_waitcnt lgkmcnt(0)
L_hf_w2pa0:
    s_waitcnt vmcnt(1)
    v_mfma_f32_16x16x32_bf16 v[100:103], v[96:99], v[8:11], 0
    v_bitop3_b32 v104, v8, v10, s35 bitop3:0x7e
    s_waitcnt vmcnt(0)
    v_mfma_f32_16x16x32_bf16 v[100:103], v[96:99], v[12:15], v[100:103]
    v_bitop3_b32 v105, v12, v14, s35 bitop3:0x7e
    v_bitop3_b32 v104, v104, v105, 1 bitop3:0xa8
    v_cmp_ne_u32 vcc, 0, v104
    s_cbranch_vccnz L_hf_w2pa_fail
L_hf_w2pa_ok:
    s_nop 3
    v_add_f32_dpp v100, v100, v100 row_ror:4 row_mask:0xf bank_mask:0xf
    v_add_f32_dpp v101, v101, v101 row_ror:4 row_mask:0xf bank_mask:0xf
    v_add_f32_dpp v102, v102, v102 row_ror:4 row_mask:0xf bank_mask:0xf
    v_add_f32_dpp v103, v103, v103 row_ror:4 row_mask:0xf bank_mask:0xf
    v_add_f32_dpp v106, v100, v100 row_ror:8 row_mask:0xf bank_mask:0x5
    v_add_f32_dpp v107, v101, v101 row_ror:8 row_mask:0xf bank_mask:0x5
    v_mov_b32 v104, -1
    v_add_f32_dpp v106, v102, v102 row_ror:8 row_mask:0xf bank_mask:0xa
    v_add_f32_dpp v107, v103, v103 row_ror:8 row_mask:0xf bank_mask:0xa
    v_cvt_pk_bf16_f32 v106, v106, v107
    v_min_u32 v106, -2, v106
    global_store_dword v113, v106, s[50:51]
    global_store_dword v113, v104, s[52:53]
    v_and_b32 v127, v126, v127
    v_cmp_eq_u32 vcc, s78, v127
    s_or_b64 s[60:61], s[60:61], vcc
    s_add_u32 s82, s32, 1
    s_bitcmp1_b64 s[60:61], s82
    s_cselect_b32 s72, 0x80000, 0
    s_add_u32 s48, s40, s80
    s_addc_u32 s49, s41, 0
    s_cmp_ge_u32 s32, 63
    s_cselect_b32 s72, 0, s72
    s_xor_b32 s73, s73, 0x2000
    v_xor_b32 v125, 0x2000, v125
    s_add_u32 s33, s33, 1
    s_add_u32 s56, s56, 0x40000
    s_addc_u32 s57, s57, 0
    s_add_u32 s68, s68, 8
    s_addc_u32 s69, s69, 0
    v_mov_b64 v[96:97], 0
    v_mov_b64 v[98:99], 0
    v_mov_b64 v[100:101], 0
    v_mov_b64 v[102:103], 0
    v_mov_b64 v[104:105], 0
    v_mov_b64 v[106:107], 0
    global_load_dwordx4 v[0:3], v112, s[48:49] offset:0 sc1
    global_load_dwordx4 v[4:7], v112, s[48:49] offset:1024 sc1
    ds_read_b128 v[88:91], v122 offset:34816
    ds_read_b128 v[92:95], v122 offset:35840
    ds_read_b128 v[32:35], v122 offset:36864
    ds_read_b128 v[36:39], v122 offset:37888
    ds_read_b128 v[40:43], v122 offset:38912
    ds_read_b128 v[44:47], v122 offset:39936
    ds_read_b128 v[48:51], v122 offset:40960
    ds_read_b128 v[52:55], v122 offset:41984
    ds_read_b128 v[56:59], v122 offset:43008
    ds_read_b128 v[60:63], v122 offset:44032
    s_waitcnt lgkmcnt(0)
    global_load_dwordx4 v[0:3], v112, s[48:49] offset:0 sc1
    global_load_dwordx4 v[4:7], v112, s[48:49] offset:1024 sc1
L_hf_w2pb:
    s_waitcnt vmcnt(3)
    v_max3_u32 v127, v0, v1, v2
    s_waitcnt vmcnt(2)
    v_max3_u32 v126, v3, v4, v5
    v_max3_u32 v127, v127, v6, v7
    v_max_u32 v127, v127, v126
    v_cmp_eq_u32 vcc, -1, v127
    s_cbranch_vccnz L_hf_w2pb_fail
    s_branch L_hf_top0
.p2align 6
    s_nop 0
    s_nop 0
    s_nop 0
    s_nop 0
    s_nop 0
    s_nop 0
    s_nop 0
    s_nop 0
    s_nop 0
    s_nop 0
    s_nop 0
    s_nop 0
L_hf_w3comm:
    ds_read_b128 v[96:99], v112 offset:28672
    s_add_u32 s32, s32, 1
    s_and_b32 s80, s33, 3
    s_lshl_b32 s80, s80, 13
    s_add_u32 s82, s38, s80
    s_add_u32 s50, s46, s82
    s_addc_u32 s51, s47, 0
    s_xor_b32 s82, s82, 0x4000
    s_add_u32 s52, s46, s82
    s_addc_u32 s53, s47, 0
    s_waitcnt vmcnt(0)
    global_load_dwordx4 v[8:11], v112, s[44:45] offset:0 sc1
    global_load_dwordx4 v[12:15], v112, s[44:45] offset:1024 sc1
    v_mov_b64 v[108:109], 0
    v_mov_b64 v[110:111], 0
    v_xor_b32 v29, 0x800, v114
    v_xor_b32 v30, 0x1000, v114
    v_xor_b32 v31, 0x1800, v114
    v_mov_b64 v[72:73], 0
    v_mov_b64 v[74:75], 0
    v_mov_b64 v[76:77], 0
    v_mov_b64 v[78:79], 0
    s_waitcnt lgkmcnt(0)
    global_load_dwordx4 v[16:19], v112, s[44:45] offset:0 sc1
    global_load_dwordx4 v[20:23], v112, s[44:45] offset:1024 sc1
    s_waitcnt lgkmcnt(0)
L_hf_w3pa0:
    s_waitcnt vmcnt(3)
    v_mfma_f32_16x16x32_bf16 v[100:103], v[96:99], v[8:11], 0
    v_bitop3_b32 v104, v8, v10, s35 bitop3:0x7e
    s_waitcnt vmcnt(2)
    v_mfma_f32_16x16x32_bf16 v[100:103], v[96:99], v[12:15], v[100:103]
    v_bitop3_b32 v105, v12, v14, s35 bitop3:0x7e
    v_bitop3_b32 v104, v104, v105, 1 bitop3:0xa8
    v_cmp_ne_u32 vcc, 0, v104
    s_cbranch_vccnz L_hf_w3pa_fail
L_hf_w3pa_ok:
    s_nop 3
    v_add_f32_dpp v100, v100, v100 row_ror:4 row_mask:0xf bank_mask:0xf
    v_add_f32_dpp v101, v101, v101 row_ror:4 row_mask:0xf bank_mask:0xf
    v_add_f32_dpp v102, v102, v102 row_ror:4 row_mask:0xf bank_mask:0xf
    v_add_f32_dpp v103, v103, v103 row_ror:4 row_mask:0xf bank_mask:0xf
    v_add_f32_dpp v106, v100, v100 row_ror:8 row_mask:0xf bank_mask:0x5
    v_add_f32_dpp v107, v101, v101 row_ror:8 row_mask:0xf bank_mask:0x5
    v_mov_b32 v104, -1
    v_add_f32_dpp v106, v102, v102 row_ror:8 row_mask:0xf bank_mask:0xa
    v_add_f32_dpp v107, v103, v103 row_ror:8 row_mask:0xf bank_mask:0xa
    v_cvt_pk_bf16_f32 v106, v106, v107
    v_min_u32 v106, -2, v106
    global_store_dword v113, v106, s[50:51]
    global_store_dword v113, v104, s[52:53]
    v_and_b32 v127, v126, v127
    v_cmp_eq_u32 vcc, s78, v127
    s_or_b64 s[60:61], s[60:61], vcc
    s_add_u32 s82, s32, 1
    s_bitcmp1_b64 s[60:61], s82
    s_cselect_b32 s72, 0x80000, 0
    s_add_u32 s48, s40, s80
    s_addc_u32 s49, s41, 0
    s_cmp_ge_u32 s32, 63
    s_cselect_b32 s72, 0, s72
    s_xor_b32 s73, s73, 0x2000
    v_xor_b32 v125, 0x2000, v125
    s_add_u32 s33, s33, 1
    s_add_u32 s56, s56, 0x40000
    s_addc_u32 s57, s57, 0
    s_add_u32 s68, s68, 8
    s_addc_u32 s69, s69, 0
    v_mov_b64 v[96:97], 0
    v_mov_b64 v[98:99], 0
    v_mov_b64 v[100:101], 0
    v_mov_b64 v[102:103], 0
    v_mov_b64 v[104:105], 0
    v_mov_b64 v[106:107], 0
    ds_read_b128 v[80:83], v122 offset:32768
    ds_read_b128 v[84:87], v122 offset:33792
    ds_read_b128 v[88:91], v122 offset:34816
    ds_read_b128 v[92:95], v122 offset:35840
    global_load_dwordx4 v[0:3], v112, s[48:49] offset:0 sc1
    global_load_dwordx4 v[4:7], v112, s[48:49] offset:1024 sc1
    ds_read_b128 v[32:35], v122 offset:36864
    ds_read_b128 v[36:39], v122 offset:37888
    ds_read_b128 v[40:43], v122 offset:38912
    ds_read_b128 v[44:47], v122 offset:39936
    ds_read_b128 v[48:51], v122 offset:40960
    ds_read_b128 v[52:55], v122 offset:41984
    ds_read_b128 v[56:59], v122 offset:43008
    ds_read_b128 v[60:63], v122 offset:44032
    s_waitcnt lgkmcnt(0)
    global_load_dwordx4 v[0:3], v112, s[48:49] offset:0 sc1
    global_load_dwordx4 v[4:7], v112, s[48:49] offset:1024 sc1
L_hf_w3pb:
    s_waitcnt vmcnt(3)
    v_max3_u32 v127, v0, v1, v2
    s_waitcnt vmcnt(2)
    v_max3_u32 v126, v3, v4, v5
    v_max3_u32 v127, v127, v6, v7
    v_max_u32 v127, v127, v126
    v_cmp_eq_u32 vcc, -1, v127
    s_cbranch_vccnz L_hf_w3pb_fail
L_hf_top0:
L_hf_top:
    ds_write_b128 v114, v[0:3] offset:16384
    v_smfmac_f32_16x16x64_bf16 v[96:99], v[0:3], v[80:87], v124
    ds_write_b128 v114, v[4:7] offset:17408
    v_smfmac_f32_16x16x64_bf16 v[100:103], v[0:3], v[88:95], v124
    ds_read_b128 v[80:83], v122 offset:45056
    v_smfmac_f32_16x16x64_bf16 v[104:107], v[0:3], v[32:39], v124
    ds_read_b128 v[32:35], v121 offset:32768
    v_smfmac_f32_16x16x64_bf16 v[108:111], v[0:3], v[40:47], v124
    ds_read_b128 v[36:39], v121 offset:33792
    v_smfmac_f32_16x16x64_bf16 v[96:99], v[4:7], v[48:55], v124
    ds_read_b128 v[40:43], v121 offset:34816
    v_smfmac_f32_16x16x64_bf16 v[100:103], v[4:7], v[56:63], v124
    ds_read_b128 v[44:47], v121 offset:35840
    global_load_dwordx4 v[64:67], v119, s[54:55] offset:0 sc1
    v_smfmac_f32_16x16x64_bf16 v[72:75], v[0:3], a[128:135], v124
    ds_read_b128 v[48:51], v121 offset:40960
    s_waitcnt lgkmcnt(6)
    s_barrier
    ds_read_b128 v[16:19], v30 offset:16384
    v_smfmac_f32_16x16x64_bf16 v[76:79], v[0:3], a[192:199], v124
    ds_read_b128 v[20:23], v30 offset:17408
    global_load_dwordx4 v[68:71], v119, s[54:55] offset:256 sc1
    v_smfmac_f32_16x16x64_bf16 v[72:75], v[4:7], a[136:143], v124
    ds_read_b128 v[8:11], v29 offset:16384
    s_add_u32 s54, s54, s72
    v_smfmac_f32_16x16x64_bf16 v[76:79], v[4:7], a[200:207], v124
    ds_read_b128 v[12:15], v29 offset:17408
    s_addc_u32 s55, s55, 0
    s_waitcnt lgkmcnt(3)
    v_smfmac_f32_16x16x64_bf16 v[96:99], v[16:19], v[128:135], v124
    ds_read_b128 v[52:55], v121 offset:41984
    s_mov_b32 m0, s73
    v_smfmac_f32_16x16x64_bf16 v[100:103], v[16:19], v[160:167], v124
    ds_read_b128 v[56:59], v121 offset:43008
    global_load_lds_dwordx4 v118, s[54:55] sc1
    s_waitcnt lgkmcnt(4)
    v_smfmac_f32_16x16x64_bf16 v[96:99], v[20:23], v[136:143], v124
    ds_read_b128 v[60:63], v121 offset:44032
    s_add_u32 m0, s73, 896
    v_smfmac_f32_16x16x64_bf16 v[100:103], v[20:23], v[168:175], v124
    ds_read_b128 v[24:27], v31 offset:16384
    global_load_lds_dwordx4 v118, s[54:55] offset:128 sc1
    v_smfmac_f32_16x16x64_bf16 v[104:107], v[16:19], v[192:199], v124
    ds_read_b128 v[28:31], v31 offset:17408
    v_smfmac_f32_16x16x64_bf16 v[104:107], v[20:23], v[200:207], v124
    ds_read_b128 v[84:87], v122 offset:46080
    s_waitcnt lgkmcnt(7)
    v_smfmac_f32_16x16x64_bf16 v[96:99], v[8:11], v[32:39], v124
    ds_read_b128 v[88:91], v122 offset:47104
    v_smfmac_f32_16x16x64_bf16 v[100:103], v[8:11], v[40:47], v124
    ds_read_b128 v[92:95], v122 offset:48128
    s_waitcnt lgkmcnt(7)
    v_smfmac_f32_16x16x64_bf16 v[96:99], v[12:15], v[48:55], v124
    ds_read_b128 v[48:51], v121 offset:45056
    v_smfmac_f32_16x16x64_bf16 v[108:111], v[16:19], v[224:231], v124
    ds_read_b128 v[52:55], v121 offset:46080
    s_waitcnt lgkmcnt(7)
    v_smfmac_f32_16x16x64_bf16 v[100:103], v[12:15], v[56:63], v124
    ds_read_b128 v[56:59], v121 offset:47104
    s_waitcnt lgkmcnt(7)
    v_smfmac_f32_16x16x64_bf16 v[96:99], v[24:27], v[144:151], v124
    ds_read_b128 v[60:63], v121 offset:48128
    v_smfmac_f32_16x16x64_bf16 v[100:103], v[24:27], v[176:183], v124
    ds_read_b128 v[32:35], v125 offset:0
    s_waitcnt lgkmcnt(7)
    v_smfmac_f32_16x16x64_bf16 v[96:99], v[28:31], v[152:159], v124
    ds_read_b128 v[36:39], v125 offset:1024
    v_smfmac_f32_16x16x64_bf16 v[100:103], v[28:31], v[184:191], v124
    ds_read_b128 v[40:43], v125 offset:2048
    s_nop 0
    v_smfmac_f32_16x16x64_bf16 v[104:107], v[4:7], v[80:87], v124
    ds_read_b128 v[80:83], v121 offset:36864
    s_nop 0
    s_waitcnt lgkmcnt(7)
    v_smfmac_f32_16x16x64_bf16 v[108:111], v[4:7], v[88:95], v124
    ds_read_b128 v[84:87], v121 offset:37888
    s_nop 0
    s_waitcnt lgkmcnt(7)
    v_smfmac_f32_16x16x64_bf16 v[104:107], v[12:15], v[48:55], v124
    ds_read_b128 v[88:91], v121 offset:38912
    v_add_f32 v96, v96, v98
    v_smfmac_f32_16x16x64_bf16 v[104:107], v[24:27], v[208:215], v124
    ds_read_b128 v[92:95], v121 offset:39936
    v_add_f32 v97, v97, v99
    s_waitcnt lgkmcnt(7)
    v_smfmac_f32_16x16x64_bf16 v[108:111], v[12:15], v[56:63], v124
    ds_read_b128 v[44:47], v125 offset:3072
    v_add_f32 v100, v100, v102
    v_smfmac_f32_16x16x64_bf16 v[104:107], v[28:31], v[216:223], v124
    ds_read_b128 v[48:51], v125 offset:4096
    v_add_f32 v101, v101, v103
    v_smfmac_f32_16x16x64_bf16 v[108:111], v[20:23], v[232:239], v124
    ds_read_b128 v[52:55], v125 offset:5120
    v_cvt_pk_bf16_f32 v99, v96, v97
    v_smfmac_f32_16x16x64_bf16 v[108:111], v[24:27], v[240:247], v124
    ds_read_b128 v[56:59], v125 offset:6144
    v_cvt_pk_bf16_f32 v98, v100, v101
    v_smfmac_f32_16x16x64_bf16 v[108:111], v[28:31], v[248:255], v124
    ds_read_b128 v[60:63], v125 offset:7168
    ds_write_b64 v115, v[98:99] offset:24576
    s_waitcnt lgkmcnt(8)
    v_smfmac_f32_16x16x64_bf16 v[104:107], v[8:11], v[80:87], v124
    s_nop 1
    v_smfmac_f32_16x16x64_bf16 v[72:75], v[16:19], a[160:167], v124
    s_nop 1
    s_waitcnt lgkmcnt(6)
    v_smfmac_f32_16x16x64_bf16 v[108:111], v[8:11], v[88:95], v124
    s_nop 0
    v_add_f32 v104, v104, v106
    v_add_u32 v126, s66, v116
    v_add_u32 v95, s66, v117
    v_add_f32 v105, v105, v107
    v_cvt_pk_bf16_f32 v107, v104, v105
    s_nop 1
    v_pk_add_f32 v[108:109], v[108:109], v[110:111]
    v_cvt_pk_bf16_f32 v106, v108, v109
    ds_write_b64 v115, v[106:107] offset:25088
    v_smfmac_f32_16x16x64_bf16 v[76:79], v[16:19], a[224:231], v124
    v_smfmac_f32_16x16x64_bf16 v[72:75], v[20:23], a[168:175], v124
    v_smfmac_f32_16x16x64_bf16 v[76:79], v[20:23], a[232:239], v124
    s_cmp_eq_u32 s32, 0
    v_smfmac_f32_16x16x64_bf16 v[72:75], v[8:11], a[144:151], v124
    s_mov_b64 exec, 1
    global_store_byte v112, v124, s[68:69] sc1
    s_mov_b64 exec, -1
    v_smfmac_f32_16x16x64_bf16 v[76:79], v[8:11], a[208:215], v124
    v_smfmac_f32_16x16x64_bf16 v[72:75], v[12:15], a[152:159], v124
    v_smfmac_f32_16x16x64_bf16 v[76:79], v[12:15], a[216:223], v124
    v_smfmac_f32_16x16x64_bf16 v[72:75], v[24:27], a[176:183], v124
    s_cbranch_scc1 L_hf_k0
L_hf_k0_ok:
    s_waitcnt lgkmcnt(0)
    s_barrier
    ds_read_b64_tr_b16 v[96:97], v116 offset:24576
    ds_read_b64_tr_b16 v[98:99], v117 offset:24576
    v_smfmac_f32_16x16x64_bf16 v[76:79], v[24:27], a[240:247], v124
    ds_read_b64_tr_b16 v[100:101], v116 offset:25600
    ds_read_b64_tr_b16 v[102:103], v117 offset:25600
    v_smfmac_f32_16x16x64_bf16 v[72:75], v[28:31], a[184:191], v124
    ds_read_b64_tr_b16 v[104:105], v116 offset:26624
    ds_read_b64_tr_b16 v[106:107], v117 offset:26624
    v_smfmac_f32_16x16x64_bf16 v[76:79], v[28:31], a[248:255], v124
    ds_read_b64_tr_b16 v[108:109], v116 offset:27648
    ds_read_b64_tr_b16 v[110:111], v117 offset:27648
    s_waitcnt lgkmcnt(6)
    v_mfma_f32_16x16x32_bf16 v[80:83], v[32:35], v[96:99], 0
    ds_read_b64_tr_b16 v[8:9], v126 offset:24576
    v_mov_b64 v[12:13], s[94:95]
    v_mov_b64 v[14:15], s[70:71]
    v_mfma_f32_16x16x32_bf16 v[84:87], v[36:39], v[96:99], 0
    ds_read_b64_tr_b16 v[10:11], v95 offset:24576
    v_mov_b64 v[16:17], 0
    v_mov_b64 v[18:19], 0
    v_mfma_f32_16x16x32_bf16 v[88:91], v[96:99], v[96:99], 0
    v_add_f32 v72, v72, v74
    v_add_f32 v73, v73, v75
    s_waitcnt lgkmcnt(6)
    v_mfma_f32_16x16x32_bf16 v[80:83], v[40:43], v[100:103], v[80:83]
    s_not_b64 vcc, s[76:77]
    v_add_f32 v76, v76, v78
    v_add_f32 v77, v77, v79
    v_mfma_f32_16x16x32_bf16 v[84:87], v[44:47], v[100:103], v[84:87]
    v_cvt_pk_bf16_f32 v75, v72, v73
    v_cvt_pk_bf16_f32 v79, v76, v77
    s_waitcnt lgkmcnt(4)
    v_mfma_f32_16x16x32_bf16 v[80:83], v[48:51], v[104:107], v[80:83]
    global_load_dwordx2 v[126:127], v112, s[58:59] sc1
    v_mov_b32 v74, 0
    v_mov_b32 v78, 0
    s_waitcnt lgkmcnt(0)
    v_mfma_f32_16x16x32_bf16 v[84:87], v[52:55], v[104:107], v[84:87]
    v_cndmask_b32 v8, v75, v8, vcc
    v_cndmask_b32 v9, v79, v9, vcc
    v_mfma_f32_16x16x32_bf16 v[80:83], v[56:59], v[108:111], v[80:83]
    v_cndmask_b32_dpp v10, v75, v10, vcc quad_perm:[2,3,0,1] row_mask:0xf bank_mask:0xf
    v_cndmask_b32_dpp v11, v79, v11, vcc quad_perm:[2,3,0,1] row_mask:0xf bank_mask:0xf
    v_mfma_f32_16x16x32_bf16 v[84:87], v[60:63], v[108:111], v[84:87]
    global_store_dwordx4 v112, v[8:11], s[56:57] sc1
    s_nop 1
    v_mfma_f32_16x16x32_bf16 v[88:91], v[100:103], v[100:103], v[88:91]
    s_mov_b64 vcc, s[76:77]
    s_nop 1
    v_mfma_f32_16x16x32_bf16 v[88:91], v[104:107], v[104:107], v[88:91]
    s_and_b32 s35, s33, 1
    s_nop 1
    v_mfma_f32_16x16x32_bf16 v[88:91], v[108:111], v[108:111], v[88:91]
    s_cmp_eq_u32 s32, 63
    v_cndmask_b32_dpp v80, v84, v80, vcc quad_perm:[2,3,0,1] row_mask:0xf bank_mask:0xf
    v_cndmask_b32_dpp v81, v85, v81, vcc quad_perm:[2,3,0,1] row_mask:0xf bank_mask:0xf
    s_cbranch_scc1 L_hf_last
    v_cndmask_b32_dpp v82, v86, v82, vcc quad_perm:[2,3,0,1] row_mask:0xf bank_mask:0xf
    v_cndmask_b32_dpp v83, v87, v83, vcc quad_perm:[2,3,0,1] row_mask:0xf bank_mask:0xf
    v_max3_f32 v94, v80, v81, v82
    s_nop 0
    v_cndmask_b32_dpp v88, v89, v88, vcc quad_perm:[2,3,0,1] row_mask:0xf bank_mask:0xf
    v_max3_f32 v92, v94, v83, v88
    v_max3_f32 v93, v94, v83, v88
    v_mov_b64 v[20:21], 0
    v_mov_b64 v[22:23], 0
    v_permlane32_swap_b32 v92, v93
    v_max_f32 v94, v92, v93
    v_max_f32 v95, v92, v93
    v_mov_b64 v[24:25], 0
    v_mov_b64 v[26:27], 0
    v_permlane16_swap_b32 v94, v95
    v_max_f32 v92, v94, v95
    v_mov_b64 v[28:29], 0
    v_mov_b64 v[30:31], 0
    v_max_f32_dpp v93, v92, v92 quad_perm:[2,3,0,1] row_mask:0xf bank_mask:0xf
    v_mul_f32 v92, s64, v93
    v_fma_f32 v88, v88, s64, -v92
    v_pk_fma_f32 v[80:81], v[80:81], s[64:65], v[92:93] op_sel_hi:[1,1,0] neg_lo:[0,0,1] neg_hi:[0,0,1]
    v_pk_fma_f32 v[82:83], v[82:83], s[64:65], v[92:93] op_sel_hi:[1,1,0] neg_lo:[0,0,1] neg_hi:[0,0,1]
    v_exp_f32 v88, v88
    v_exp_f32 v80, v80
    v_exp_f32 v81, v81
    v_mov_b32_dpp v89, v88 quad_perm:[2,3,0,1] row_mask:0xf bank_mask:0xf
    v_cvt_pk_bf16_f32 v33, v88, v89
    v_exp_f32 v82, v82
    v_cvt_pk_bf16_f32 v34, v80, v81
    v_mfma_f32_16x16x16_bf16 v[40:43], v[74:75], v[32:33], 0
    v_exp_f32 v83, v83
    v_mfma_f32_16x16x16_bf16 v[44:47], v[78:79], v[32:33], 0
    v_cvt_pk_bf16_f32 v35, v82, v83
    v_mov_b32_dpp v36, v34 quad_perm:[2,3,0,1] row_mask:0xf bank_mask:0xf
    s_waitcnt vmcnt(5)
    v_mfma_f32_16x16x32_bf16 v[48:51], v[12:15], v[32:35], 0
    v_mov_b32_dpp v37, v35 quad_perm:[2,3,0,1] row_mask:0xf bank_mask:0xf
    v_xor_b32 v100, 0x200, v120
    v_xor_b32 v104, 0x400, v120
    v_mfma_f32_16x16x32_bf16 v[40:43], v[64:67], v[34:37], v[40:43]
    s_nop 1
    v_xor_b32 v108, 0x600, v120
    v_mfma_f32_16x16x32_bf16 v[44:47], v[68:71], v[34:37], v[44:47]
    v_add_f32_dpp v48, v48, v48 quad_perm:[2,3,0,1] row_mask:0xf bank_mask:0xf
    s_mov_b64 exec, vcc
    v_rcp_f32 v92, v48
    s_nop 0
    v_mul_f32 v40, v40, v92
    v_mul_f32 v41, v41, v92
    v_mul_f32 v42, v42, v92
    v_mul_f32 v43, v43, v92
    v_cvt_pk_bf16_f32 v96, v40, v41
    v_cvt_pk_bf16_f32 v97, v42, v43
    ds_write_b64 v120, v[96:97] offset:29696
    v_pk_mul_f32 v[44:45], v[44:45], v[92:93] op_sel_hi:[1,0]
    v_pk_mul_f32 v[46:47], v[46:47], v[92:93] op_sel_hi:[1,0]
    v_cvt_pk_bf16_f32 v98, v44, v45
    v_cvt_pk_bf16_f32 v99, v46, v47
    ds_write_b64 v120, v[98:99] offset:29704
    s_mov_b64 exec, -1
    v_cndmask_b32_dpp v96, v96, v96, vcc quad_perm:[2,3,0,1] row_mask:0xf bank_mask:0xf
    v_cndmask_b32_dpp v97, v97, v97, vcc quad_perm:[2,3,0,1] row_mask:0xf bank_mask:0xf
    v_cndmask_b32_dpp v98, v98, v98, vcc quad_perm:[2,3,0,1] row_mask:0xf bank_mask:0xf
    v_cndmask_b32_dpp v99, v99, v99, vcc quad_perm:[2,3,0,1] row_mask:0xf bank_mask:0xf
    s_nop 1
    v_smfmac_f32_16x16x64_bf16 v[16:19], v[96:99], a[0:7], v124
    s_cmp_eq_u32 s72, 0
    s_cbranch_scc1 L_hf_k1
L_hf_k1_ok:
    v_smfmac_f32_16x16x64_bf16 v[20:23], v[96:99], a[32:39], v124
    s_waitcnt lgkmcnt(0)
    s_barrier
    ds_read_b128 v[100:103], v100 offset:29696
    ds_read_b128 v[104:107], v104 offset:29696
    ds_read_b128 v[108:111], v108 offset:29696
    v_smfmac_f32_16x16x64_bf16 v[24:27], v[96:99], a[64:71], v124
    v_smfmac_f32_16x16x64_bf16 v[28:31], v[96:99], a[96:103], v124
    s_waitcnt lgkmcnt(2)
    v_smfmac_f32_16x16x64_bf16 v[16:19], v[100:103], a[8:15], v124
    s_waitcnt lgkmcnt(1)
    v_smfmac_f32_16x16x64_bf16 v[16:19], v[104:107], a[16:23], v124
    s_waitcnt lgkmcnt(0)
    v_smfmac_f32_16x16x64_bf16 v[16:19], v[108:111], a[24:31], v124
    s_nop 2
    v_smfmac_f32_16x16x64_bf16 v[20:23], v[100:103], a[40:47], v124
    s_nop 3
    v_cvt_pk_bf16_f32 v16, v16, v17
    v_cvt_pk_bf16_f32 v17, v18, v19
    v_and_or_b32 v16, v16, -2, s35
    global_store_dwordx2 v123, v[16:17], s[36:37] offset:-4096
    v_smfmac_f32_16x16x64_bf16 v[20:23], v[104:107], a[48:55], v124
    s_nop 2
    v_smfmac_f32_16x16x64_bf16 v[20:23], v[108:111], a[56:63], v124
    s_nop 2
    v_smfmac_f32_16x16x64_bf16 v[24:27], v[100:103], a[72:79], v124
    s_nop 3
    v_cvt_pk_bf16_f32 v20, v20, v21
    v_cvt_pk_bf16_f32 v21, v22, v23
    v_and_or_b32 v20, v20, -2, s35
    global_store_dwordx2 v123, v[20:21], s[36:37] offset:-2048
    v_smfmac_f32_16x16x64_bf16 v[24:27], v[104:107], a[80:87], v124
    s_nop 2
    v_smfmac_f32_16x16x64_bf16 v[24:27], v[108:111], a[88:95], v124
    s_nop 2
    v_smfmac_f32_16x16x64_bf16 v[28:31], v[100:103], a[104:111], v124
    s_nop 3
    v_cvt_pk_bf16_f32 v24, v24, v25
    v_cvt_pk_bf16_f32 v25, v26, v27
    v_and_or_b32 v24, v24, -2, s35
    global_store_dwordx2 v123, v[24:25], s[36:37] offset:0
    v_smfmac_f32_16x16x64_bf16 v[28:31], v[104:107], a[112:119], v124
    s_nop 2
    v_smfmac_f32_16x16x64_bf16 v[28:31], v[108:111], a[120:127], v124
    s_nop 2
    s_cmp_eq_u32 s31, 0
    s_nop 3
    v_cvt_pk_bf16_f32 v28, v28, v29
    v_cvt_pk_bf16_f32 v29, v30, v31
    v_and_or_b32 v28, v28, -2, s35
    global_store_dwordx2 v123, v[28:29], s[36:37] offset:2048
    s_cbranch_scc1 L_hf_w0comm
    s_cmp_eq_u32 s31, 1
    s_cbranch_scc1 L_hf_w1comm
    s_cmp_eq_u32 s31, 2
    s_cbranch_scc1 L_hf_w2comm
    s_branch L_hf_w3comm
L_hf_w0pa_fail:
    s_mov_b64 exec, vcc
    global_load_dwordx4 v[8:11], v112, s[44:45] offset:0 sc1
    global_load_dwordx4 v[12:15], v112, s[44:45] offset:1024 sc1
    s_mov_b64 exec, -1
    s_sub_u32 s62, s62, 1
    s_cbranch_scc0 L_hf_w0pa0
    s_movk_i32 s63, 3
    s_branch L_fail_far
L_hf_w0pb_fail:
    s_mov_b64 exec, vcc
    global_load_dwordx4 v[0:3], v112, s[48:49] offset:0 sc1
    global_load_dwordx4 v[4:7], v112, s[48:49] offset:1024 sc1
    s_mov_b64 exec, -1
    s_sub_u32 s62, s62, 1
    s_cbranch_scc0 L_hf_w0pb
    s_movk_i32 s63, 4
    s_branch L_fail_far
L_hf_w1pa_fail:
    s_mov_b64 exec, vcc
    global_load_dwordx4 v[8:11], v112, s[44:45] offset:0 sc1
    global_load_dwordx4 v[12:15], v112, s[44:45] offset:1024 sc1
    s_mov_b64 exec, -1
    s_sub_u32 s62, s62, 1
    s_cbranch_scc0 L_hf_w1pa0
    s_movk_i32 s63, 3
    s_branch L_fail_far
L_hf_w1pb_fail:
    s_mov_b64 exec, vcc
    global_load_dwordx4 v[0:3], v112, s[48:49] offset:0 sc1
    global_load_dwordx4 v[4:7], v112, s[48:49] offset:1024 sc1
    s_mov_b64 exec, -1
    s_sub_u32 s62, s62, 1
    s_cbranch_scc0 L_hf_w1pb
    s_movk_i32 s63, 4
    s_branch L_fail_far
L_hf_w2pa_fail:
    s_mov_b64 exec, vcc
    global_load_dwordx4 v[8:11], v112, s[44:45] offset:0 sc1
    global_load_dwordx4 v[12:15], v112, s[44:45] offset:1024 sc1
    s_mov_b64 exec, -1
    s_sub_u32 s62, s62, 1
    s_cbranch_scc0 L_hf_w2pa0
    s_movk_i32 s63, 3
    s_branch L_fail_far
L_hf_w2pb_fail:
    s_mov_b64 exec, vcc
    global_load_dwordx4 v[0:3], v112, s[48:49] offset:0 sc1
    global_load_dwordx4 v[4:7], v112, s[48:49] offset:1024 sc1
    s_mov_b64 exec, -1
    s_sub_u32 s62, s62, 1
    s_cbranch_scc0 L_hf_w2pb
    s_movk_i32 s63, 4
    s_branch L_fail_far
L_hf_w3pa_fail:
    s_mov_b64 exec, vcc
    global_load_dwordx4 v[8:11], v112, s[44:45] offset:0 sc1
    global_load_dwordx4 v[12:15], v112, s[44:45] offset:1024 sc1
    s_mov_b64 exec, -1
    s_waitcnt vmcnt(3)
    v_mfma_f32_16x16x32_bf16 v[100:103], v[96:99], v[16:19], 0
    v_bitop3_b32 v104, v16, v18, s35 bitop3:0x7e
    s_waitcnt vmcnt(2)
    v_mfma_f32_16x16x32_bf16 v[100:103], v[96:99], v[20:23], v[100:103]
    v_bitop3_b32 v105, v20, v22, s35 bitop3:0x7e
    v_bitop3_b32 v104, v104, v105, 1 bitop3:0xa8
    v_cmp_ne_u32 vcc, 0, v104
    s_cbranch_vccz L_hf_w3pa_ok
    s_mov_b64 exec, vcc
    global_load_dwordx4 v[16:19], v112, s[44:45] offset:0 sc1
    global_load_dwordx4 v[20:23], v112, s[44:45] offset:1024 sc1
    s_mov_b64 exec, -1
    s_sub_u32 s62, s62, 1
    s_cbranch_scc0 L_hf_w3pa0
    s_movk_i32 s63, 3
    s_branch L_fail_far
L_hf_w3pb_fail:
    s_mov_b64 exec, vcc
    global_load_dwordx4 v[0:3], v112, s[48:49] offset:0 sc1
    global_load_dwordx4 v[4:7], v112, s[48:49] offset:1024 sc1
    s_mov_b64 exec, -1
    s_sub_u32 s62, s62, 1
    s_cbranch_scc0 L_hf_w3pb
    s_movk_i32 s63, 4
    s_branch L_fail_far
L_hf_k1:
    s_cmp_eq_u32 s32, 0
    s_cbranch_scc1 L_hf_k1d
    s_add_u32 s82, s32, 1
    s_waitcnt vmcnt(1)
    v_and_b32 v127, v126, v127
    v_cmp_eq_u32 s[60:61], s78, v127
L_hf_fw2:
    s_bitcmp1_b64 s[60:61], s82
    s_cbranch_scc1 L_hf_fw2_ok
    global_load_dwordx2 v[126:127], v112, s[58:59] sc1
    s_waitcnt vmcnt(0)
    v_and_b32 v127, v126, v127
    v_cmp_eq_u32 s[60:61], s78, v127
    s_sub_u32 s62, s62, 1
    s_cbranch_scc0 L_hf_fw2
    s_movk_i32 s63, 2
    s_branch L_fail_far
L_hf_fw2_ok:
    s_add_u32 s54, s54, 0x80000
    s_addc_u32 s55, s55, 0
    s_mov_b32 m0, s73
    s_nop 0
    global_load_lds_dwordx4 v118, s[54:55] sc1
    s_add_u32 m0, s73, 896
    s_nop 0
    global_load_lds_dwordx4 v118, s[54:55] offset:128 sc1
    s_branch L_hf_k1_ok
L_hf_k1d:
    s_add_u32 s54, s54, 0x80000
    s_addc_u32 s55, s55, 0
L_hf_k1_poll:
    global_load_dwordx4 v[32:35], v118, s[54:55] offset:0 sc1
    global_load_dwordx4 v[36:39], v118, s[54:55] offset:128 sc1
    global_load_dwordx4 v[64:67], v119, s[54:55] offset:0 sc1
    global_load_dwordx4 v[68:71], v119, s[54:55] offset:256 sc1
    s_waitcnt vmcnt(0)
    v_max_u32 v92, v32, v33
    v_max3_u32 v92, v92, v34, v35
    v_max3_u32 v92, v92, v36, v37
    v_max3_u32 v92, v92, v38, v39
    v_max3_u32 v92, v92, v64, v65
    v_max3_u32 v92, v92, v66, v67
    v_max3_u32 v92, v92, v68, v69
    v_max3_u32 v92, v92, v70, v71
    v_cmp_eq_u32 vcc, -1, v92
    s_cbranch_vccz L_hf_k1_got
    s_sub_u32 s62, s62, 1
    s_cbranch_scc0 L_hf_k1_poll
    s_movk_i32 s63, 7
    s_branch L_fail_far
L_hf_k1_got:
    v_add_u32 v92, s73, v112
    ds_write_b128 v92, v[32:35] offset:0
    ds_write_b128 v92, v[36:39] offset:1024
    s_waitcnt lgkmcnt(0)
    s_branch L_hf_k1_ok
L_hf_k0:
    v_mov_b32 v94, v126
    s_mov_b64 s[54:55], s[42:43]
    s_waitcnt lgkmcnt(0)
L_hf_k0_poll:
    global_load_dwordx4 v[32:35], v118, s[54:55] offset:0 sc1
    global_load_dwordx4 v[36:39], v118, s[54:55] offset:128 sc1
    global_load_dwordx4 v[64:67], v119, s[54:55] offset:0 sc1
    global_load_dwordx4 v[68:71], v119, s[54:55] offset:256 sc1
    s_waitcnt vmcnt(0)
    v_max_u32 v127, v32, v33
    v_max3_u32 v127, v127, v34, v35
    v_max3_u32 v127, v127, v36, v37
    v_max3_u32 v127, v127, v38, v39
    v_max3_u32 v127, v127, v64, v65
    v_max3_u32 v127, v127, v66, v67
    v_max3_u32 v127, v127, v68, v69
    v_max3_u32 v127, v127, v70, v71
    v_cmp_eq_u32 vcc, -1, v127
    s_cbranch_vccz L_hf_k0_got
    s_sub_u32 s62, s62, 1
    s_cbranch_scc0 L_hf_k0_poll
    s_movk_i32 s63, 6
    s_branch L_fail_far
L_hf_k0_got:
    v_add_u32 v127, s67, v125
    ds_write_b128 v127, v[32:35] offset:0
    ds_write_b128 v127, v[36:39] offset:1024
    s_waitcnt lgkmcnt(0)
    s_barrier
    ds_read_b128 v[32:35], v125 offset:0
    ds_read_b128 v[36:39], v125 offset:1024
    ds_read_b128 v[40:43], v125 offset:2048
    ds_read_b128 v[44:47], v125 offset:3072
    ds_read_b128 v[48:51], v125 offset:4096
    ds_read_b128 v[52:55], v125 offset:5120
    ds_read_b128 v[56:59], v125 offset:6144
    ds_read_b128 v[60:63], v125 offset:7168
    v_mov_b32 v126, v94
    s_branch L_hf_k0_ok
L_hf_last:
    v_min_u32 v8, -2, v8
    v_min_u32 v9, -2, v9
    v_min_u32 v10, -2, v10
    v_min_u32 v11, -2, v11
    global_store_dwordx4 v112, v[8:11], s[56:57] sc1
    s_waitcnt vmcnt(0)
    s_barrier
    s_add_u32 s34, s34, 1
    s_cmp_lt_u32 s34, 2
    s_cbranch_scc1 L_hf_layer
    s_endpgm
L_hs_layer:
    s_mul_i32 s80, s34, 0x5200000
    s_lshl_b32 s81, s30, 14
    s_add_u32 s81, s81, s80
    s_add_u32 s81, s81, 0x3300000
    s_add_u32 s81, s81, s67
    s_add_u32 s42, s28, s81
    s_addc_u32 s43, s29, 0
    s_add_u32 s54, s28, 0x40000
    s_addc_u32 s55, s29, 0
    s_lshl_b32 s81, s30, 13
    s_add_u32 s81, s81, s80
    s_add_u32 s81, s81, 0x1300000
    s_add_u32 s82, s81, s66
    s_add_u32 s56, s28, s82
    s_addc_u32 s57, s29, 0
    s_lshl_b32 s80, s34, 17
    s_lshl_b32 s81, s30, 10
    s_add_u32 s80, s80, s81
    s_add_u32 s81, s80, 0xc000
    s_add_u32 s58, s28, s81
    s_addc_u32 s59, s29, 0
    s_add_u32 s81, s80, 0x14000
    s_add_u32 s81, s81, s31
    s_add_u32 s68, s28, s81
    s_addc_u32 s69, s29, 0
    s_mov_b32 s32, 0
    s_mov_b32 s72, 0
    s_mov_b64 s[60:61], 0
    v_lshrrev_b32 v8, 4, v112
    v_mov_b32 v126, 0x0
    v_bfe_u32 v127, v8, 0, 1
    v_lshl_add_u32 v126, v127, 10, v126
    v_bfe_u32 v127, v8, 1, 1
    v_lshl_add_u32 v126, v127, 4, v126
    v_bfe_u32 v127, v8, 2, 2
    v_lshl_add_u32 v126, v127, 11, v126
    v_bfe_u32 v127, v8, 4, 2
    v_lshl_add_u32 v126, v127, 5, v126
    s_lshl_b32 s81, s31, 8
    v_add_u32 v126, s81, v126
    global_load_dwordx4 v[0:3], v126, s[12:13] offset:0
    global_load_dwordx4 v[4:7], v126, s[12:13] offset:128
    ds_read_b128 v[80:83], v122 offset:32768
    ds_read_b128 v[84:87], v122 offset:33792
    ds_read_b128 v[88:91], v122 offset:34816
    ds_read_b128 v[92:95], v122 offset:35840
    ds_read_b128 v[32:35], v122 offset:36864
    ds_read_b128 v[36:39], v122 offset:37888
    ds_read_b128 v[40:43], v122 offset:38912
    ds_read_b128 v[44:47], v122 offset:39936
    ds_read_b128 v[48:51], v122 offset:40960
    ds_read_b128 v[52:55], v122 offset:41984
    ds_read_b128 v[56:59], v122 offset:43008
    ds_read_b128 v[60:63], v122 offset:44032
    v_mov_b64 v[96:97], 0
    v_mov_b64 v[98:99], 0
    v_mov_b64 v[100:101], 0
    v_mov_b64 v[102:103], 0
    v_mov_b64 v[104:105], 0
    v_mov_b64 v[106:107], 0
    v_mov_b64 v[108:109], 0
    v_mov_b64 v[110:111], 0
    v_xor_b32 v29, 0x800, v114
    v_xor_b32 v30, 0x1000, v114
    v_xor_b32 v31, 0x1800, v114
    v_mov_b64 v[72:73], 0
    v_mov_b64 v[74:75], 0
    v_mov_b64 v[76:77], 0
    v_mov_b64 v[78:79], 0
    s_waitcnt vmcnt(0) lgkmcnt(0)
    s_branch L_hs_top
.p2align 6
    s_nop 0
    s_nop 0
    s_nop 0
    s_nop 0
    s_nop 0
    s_nop 0
    s_nop 0
    s_nop 0
    s_nop 0
    s_nop 0
    s_nop 0
    s_nop 0
    s_nop 0
L_hs_w0comm:
    ds_read_b128 v[96:99], v112 offset:28672
    s_add_u32 s32, s32, 1
    s_and_b32 s80, s33, 3
    s_lshl_b32 s80, s80, 13
    s_add_u32 s82, s38, s80
    s_add_u32 s50, s46, s82
    s_addc_u32 s51, s47, 0
    s_xor_b32 s82, s82, 0x4000
    s_add_u32 s52, s46, s82
    s_addc_u32 s53, s47, 0
    s_waitcnt vmcnt(2)
    global_load_dwordx4 v[8:11], v112, s[44:45] offset:0 sc1
    global_load_dwordx4 v[12:15], v112, s[44:45] offset:1024 sc1
    ds_read_b128 v[80:83], v122 offset:32768
    ds_read_b128 v[84:87], v122 offset:33792
    ds_read_b128 v[88:91], v122 offset:34816
    v_mov_b64 v[108:109], 0
    v_mov_b64 v[110:111], 0
    v_xor_b32 v29, 0x800, v114
    v_xor_b32 v30, 0x1000, v114
    v_xor_b32 v31, 0x1800, v114
    v_mov_b64 v[72:73], 0
    v_mov_b64 v[74:75], 0
    v_mov_b64 v[76:77], 0
    v_mov_b64 v[78:79], 0
    s_waitcnt lgkmcnt(0)
L_hs_w0pa0:
    s_waitcnt vmcnt(1)
    v_mfma_f32_16x16x32_bf16 v[100:103], v[96:99], v[8:11], 0
    v_bitop3_b32 v104, v8, v10, s35 bitop3:0x7e
    s_waitcnt vmcnt(0)
    v_mfma_f32_16x16x32_bf16 v[100:103], v[96:99], v[12:15], v[100:103]
    v_bitop3_b32 v105, v12, v14, s35 bitop3:0x7e
    v_bitop3_b32 v104, v104, v105, 1 bitop3:0xa8
    v_cmp_ne_u32 vcc, 0, v104
    s_cbranch_vccnz L_hs_w0pa_fail
L_hs_w0pa_ok:
    s_nop 3
    v_add_f32_dpp v100, v100, v100 row_ror:4 row_mask:0xf bank_mask:0xf
    v_add_f32_dpp v101, v101, v101 row_ror:4 row_mask:0xf bank_mask:0xf
    v_add_f32_dpp v102, v102, v102 row_ror:4 row_mask:0xf bank_mask:0xf
    v_add_f32_dpp v103, v103, v103 row_ror:4 row_mask:0xf bank_mask:0xf
    v_add_f32_dpp v106, v100, v100 row_ror:8 row_mask:0xf bank_mask:0x5
    v_add_f32_dpp v107, v101, v101 row_ror:8 row_mask:0xf bank_mask:0x5
    v_mov_b32 v104, -1
    v_add_f32_dpp v106, v102, v102 row_ror:8 row_mask:0xf bank_mask:0xa
    v_add_f32_dpp v107, v103, v103 row_ror:8 row_mask:0xf bank_mask:0xa
    v_cvt_pk_bf16_f32 v106, v106, v107
    v_min_u32 v106, -2, v106
    global_store_dword v113, v106, s[50:51] sc1
    global_store_dword v113, v104, s[52:53] sc1
    v_and_b32 v127, v126, v127
    v_cmp_eq_u32 vcc, s78, v127
    s_or_b64 s[60:61], s[60:61], vcc
    s_add_u32 s82, s32, 1
    s_bitcmp1_b64 s[60:61], s82
    s_cselect_b32 s72, 0x80000, 0
    s_add_u32 s48, s40, s80
    s_addc_u32 s49, s41, 0
    ds_read_b128 v[92:95], v122 offset:35840
    ds_read_b128 v[32:35], v122 offset:36864
    ds_read_b128 v[36:39], v122 offset:37888
    global_load_dwordx4 v[0:3], v112, s[48:49] offset:0 sc1
    global_load_dwordx4 v[4:7], v112, s[48:49] offset:1024 sc1
    s_cmp_ge_u32 s32, 63
    s_cselect_b32 s72, 0, s72
    s_xor_b32 s73, s73, 0x2000
    v_xor_b32 v125, 0x2000, v125
    s_add_u32 s33, s33, 1
    s_add_u32 s56, s56, 0x40000
    s_addc_u32 s57, s57, 0
    s_add_u32 s68, s68, 8
    s_addc_u32 s69, s69, 0
    v_mov_b64 v[96:97], 0
    v_mov_b64 v[98:99], 0
    v_mov_b64 v[100:101], 0
    v_mov_b64 v[102:103], 0
    v_mov_b64 v[104:105], 0
    v_mov_b64 v[106:107], 0
    ds_read_b128 v[40:43], v122 offset:38912
    ds_read_b128 v[44:47], v122 offset:39936
    ds_read_b128 v[48:51], v122 offset:40960
    ds_read_b128 v[52:55], v122 offset:41984
    ds_read_b128 v[56:59], v122 offset:43008
    ds_read_b128 v[60:63], v122 offset:44032
    s_waitcnt lgkmcnt(0)
    global_load_dwordx4 v[0:3], v112, s[48:49] offset:0 sc1
    global_load_dwordx4 v[4:7], v112, s[48:49] offset:1024 sc1
L_hs_w0pb:
    s_waitcnt vmcnt(3)
    v_max3_u32 v127, v0, v1, v2
    s_waitcnt vmcnt(2)
    v_max3_u32 v126, v3, v4, v5
    v_max3_u32 v127, v127, v6, v7
    v_max_u32 v127, v127, v126
    v_cmp_eq_u32 vcc, -1, v127
    s_cbranch_vccnz L_hs_w0pb_fail
    s_branch L_hs_top0
.p2align 6
    s_nop 0
    s_nop 0
    s_nop 0
    s_nop 0
    s_nop 0
    s_nop 0
    s_nop 0
    s_nop 0
    s_nop 0
    s_nop 0
    s_nop 0
    s_nop 0
    s_nop 0
L_hs_w1comm:
    ds_read_b128 v[96:99], v112 offset:28672
    s_add_u32 s32, s32, 1
    s_and_b32 s80, s33, 3
    s_lshl_b32 s80, s80, 13
    s_add_u32 s82, s38, s80
    s_add_u32 s50, s46, s82
    s_addc_u32 s51, s47, 0
    s_xor_b32 s82, s82, 0x4000
    s_add_u32 s52, s46, s82
    s_addc_u32 s53, s47, 0
    s_waitcnt vmcnt(2)
    global_load_dwordx4 v[8:11], v112, s[44:45] offset:0 sc1
    global_load_dwordx4 v[12:15], v112, s[44:45] offset:1024 sc1
    ds_read_b128 v[80:83], v122 offset:32768
    ds_read_b128 v[84:87], v122 offset:33792
    ds_read_b128 v[88:91], v122 offset:34816
    v_mov_b64 v[108:109], 0
    v_mov_b64 v[110:111], 0
    v_xor_b32 v29, 0x800, v114
    v_xor_b32 v30, 0x1000, v114
    v_xor_b32 v31, 0x1800, v114
    v_mov_b64 v[72:73], 0
    v_mov_b64 v[74:75], 0
    v_mov_b64 v[76:77], 0
    v_mov_b64 v[78:79], 0
    s_waitcnt lgkmcnt(0)
L_hs_w1pa0:
    s_waitcnt vmcnt(1)
    v_mfma_f32_16x16x32_bf16 v[100:103], v[96:99], v[8:11], 0
    v_bitop3_b32 v104, v8, v10, s35 bitop3:0x7e
    s_waitcnt vmcnt(0)
    v_mfma_f32_16x16x32_bf16 v[100:103], v[96:99], v[12:15], v[100:103]
    v_bitop3_b32 v105, v12, v14, s35 bitop3:0x7e
    v_bitop3_b32 v104, v104, v105, 1 bitop3:0xa8
    v_cmp_ne_u32 vcc, 0, v104
    s_cbranch_vccnz L_hs_w1pa_fail
L_hs_w1pa_ok:
    s_nop 3
    v_add_f32_dpp v100, v100, v100 row_ror:4 row_mask:0xf bank_mask:0xf
    v_add_f32_dpp v101, v101, v101 row_ror:4 row_mask:0xf bank_mask:0xf
    v_add_f32_dpp v102, v102, v102 row_ror:4 row_mask:0xf bank_mask:0xf
    v_add_f32_dpp v103, v103, v103 row_ror:4 row_mask:0xf bank_mask:0xf
    v_add_f32_dpp v106, v100, v100 row_ror:8 row_mask:0xf bank_mask:0x5
    v_add_f32_dpp v107, v101, v101 row_ror:8 row_mask:0xf bank_mask:0x5
    v_mov_b32 v104, -1
    v_add_f32_dpp v106, v102, v102 row_ror:8 row_mask:0xf bank_mask:0xa
    v_add_f32_dpp v107, v103, v103 row_ror:8 row_mask:0xf bank_mask:0xa
    v_cvt_pk_bf16_f32 v106, v106, v107
    v_min_u32 v106, -2, v106
    global_store_dword v113, v106, s[50:51] sc1
    global_store_dword v113, v104, s[52:53] sc1
    v_and_b32 v127, v126, v127
    v_cmp_eq_u32 vcc, s78, v127
    s_or_b64 s[60:61], s[60:61], vcc
    s_add_u32 s82, s32, 1
    s_bitcmp1_b64 s[60:61], s82
    s_cselect_b32 s72, 0x80000, 0
    s_add_u32 s48, s40, s80
    s_addc_u32 s49, s41, 0
    s_cmp_ge_u32 s32, 63
    s_cselect_b32 s72, 0, s72
    s_xor_b32 s73, s73, 0x2000
    v_xor_b32 v125, 0x2000, v125
    s_add_u32 s33, s33, 1
    s_add_u32 s56, s56, 0x40000
    s_addc_u32 s57, s57, 0
    s_add_u32 s68, s68, 8
    s_addc_u32 s69, s69, 0
    v_mov_b64 v[96:97], 0
    v_mov_b64 v[98:99], 0
    v_mov_b64 v[100:101], 0
    v_mov_b64 v[102:103], 0
    v_mov_b64 v[104:105], 0
    v_mov_b64 v[106:107], 0
    global_load_dwordx4 v[0:3], v112, s[48:49] offset:0 sc1
    global_load_dwordx4 v[4:7], v112, s[48:49] offset:1024 sc1
    ds_read_b128 v[92:95], v122 offset:35840
    ds_read_b128 v[32:35], v122 offset:36864
    ds_read_b128 v[36:39], v122 offset:37888
    ds_read_b128 v[40:43], v122 offset:38912
    ds_read_b128 v[44:47], v122 offset:39936
    ds_read_b128 v[48:51], v122 offset:40960
    ds_read_b128 v[52:55], v122 offset:41984
    ds_read_b128 v[56:59], v122 offset:43008
    ds_read_b128 v[60:63], v122 offset:44032
    s_waitcnt lgkmcnt(0)
    global_load_dwordx4 v[0:3], v112, s[48:49] offset:0 sc1
    global_load_dwordx4 v[4:7], v112, s[48:49] offset:1024 sc1
L_hs_w1pb:
    s_waitcnt vmcnt(3)
    v_max3_u32 v127, v0, v1, v2
    s_waitcnt vmcnt(2)
    v_max3_u32 v126, v3, v4, v5
    v_max3_u32 v127, v127, v6, v7
    v_max_u32 v127, v127, v126
    v_cmp_eq_u32 vcc, -1, v127
    s_cbranch_vccnz L_hs_w1pb_fail
    s_branch L_hs_top0
.p2align 6
    s_nop 0
    s_nop 0
    s_nop 0
    s_nop 0
    s_nop 0
    s_nop 0
    s_nop 0
    s_nop 0
    s_nop 0
    s_nop 0
    s_nop 0
    s_nop 0
    s_nop 0
L_hs_w2comm:
    ds_read_b128 v[96:99], v112 offset:28672
    s_add_u32 s32, s32, 1
    s_and_b32 s80, s33, 3
    s_lshl_b32 s80, s80, 13
    s_add_u32 s82, s38, s80
    s_add_u32 s50, s46, s82
    s_addc_u32 s51, s47, 0
    s_xor_b32 s82, s82, 0x4000
    s_add_u32 s52, s46, s82
    s_addc_u32 s53, s47, 0
    s_waitcnt vmcnt(1)
    global_load_dwordx4 v[8:11], v112, s[44:45] offset:0 sc1
    global_load_dwordx4 v[12:15], v112, s[44:45] offset:1024 sc1
    ds_read_b128 v[80:83], v122 offset:32768
    ds_read_b128 v[84:87], v122 offset:33792
    v_mov_b64 v[108:109], 0
    v_mov_b64 v[110:111], 0
    v_xor_b32 v29, 0x800, v114
    v_xor_b32 v30, 0x1000, v114
    v_xor_b32 v31, 0x1800, v114
    v_mov_b64 v[72:73], 0
    v_mov_b64 v[74:75], 0
    v_mov_b64 v[76:77], 0
    v_mov_b64 v[78:79], 0
    s_waitcnt lgkmcnt(0)
L_hs_w2pa0:
    s_waitcnt vmcnt(1)
    v_mfma_f32_16x16x32_bf16 v[100:103], v[96:99], v[8:11], 0
    v_bitop3_b32 v104, v8, v10, s35 bitop3:0x7e
    s_waitcnt vmcnt(0)
    v_mfma_f32_16x16x32_bf16 v[100:103], v[96:99], v[12:15], v[100:103]
    v_bitop3_b32 v105, v12, v14, s35 bitop3:0x7e
    v_bitop3_b32 v104, v104, v105, 1 bitop3:0xa8
    v_cmp_ne_u32 vcc, 0, v104
    s_cbranch_vccnz L_hs_w2pa_fail
L_hs_w2pa_ok:
    s_nop 3
    v_add_f32_dpp v100, v100, v100 row_ror:4 row_mask:0xf bank_mask:0xf
    v_add_f32_dpp v101, v101, v101 row_ror:4 row_mask:0xf bank_mask:0xf
    v_add_f32_dpp v102, v102, v102 row_ror:4 row_mask:0xf bank_mask:0xf
    v_add_f32_dpp v103, v103, v103 row_ror:4 row_mask:0xf bank_mask:0xf
    v_add_f32_dpp v106, v100, v100 row_ror:8 row_mask:0xf bank_mask:0x5
    v_add_f32_dpp v107, v101, v101 row_ror:8 row_mask:0xf bank_mask:0x5
    v_mov_b32 v104, -1
    v_add_f32_dpp v106, v102, v102 row_ror:8 row_mask:0xf bank_mask:0xa
    v_add_f32_dpp v107, v103, v103 row_ror:8 row_mask:0xf bank_mask:0xa
    v_cvt_pk_bf16_f32 v106, v106, v107
    v_min_u32 v106, -2, v106
    global_store_dword v113, v106, s[50:51] sc1
    global_store_dword v113, v104, s[52:53] sc1
    v_and_b32 v127, v126, v127
    v_cmp_eq_u32 vcc, s78, v127
    s_or_b64 s[60:61], s[60:61], vcc
    s_add_u32 s82, s32, 1
    s_bitcmp1_b64 s[60:61], s82
    s_cselect_b32 s72, 0x80000, 0
    s_add_u32 s48, s40, s80
    s_addc_u32 s49, s41, 0
    s_cmp_ge_u32 s32, 63
    s_cselect_b32 s72, 0, s72
    s_xor_b32 s73, s73, 0x2000
    v_xor_b32 v125, 0x2000, v125
    s_add_u32 s33, s33, 1
    s_add_u32 s56, s56, 0x40000
    s_addc_u32 s57, s57, 0
    s_add_u32 s68, s68, 8
    s_addc_u32 s69, s69, 0
    v_mov_b64 v[96:97], 0
    v_mov_b64 v[98:99], 0
    v_mov_b64 v[100:101], 0
    v_mov_b64 v[102:103], 0
    v_mov_b64 v[104:105], 0
    v_mov_b64 v[106:107], 0
    global_load_dwordx4 v[0:3], v112, s[48:49] offset:0 sc1
    global_load_dwordx4 v[4:7], v112, s[48:49] offset:1024 sc1
    ds_read_b128 v[88:91], v122 offset:34816
    ds_read_b128 v[92:95], v122 offset:35840
    ds_read_b128 v[32:35], v122 offset:36864
    ds_read_b128 v[36:39], v122 offset:37888
    ds_read_b128 v[40:43], v122 offset:38912
    ds_read_b128 v[44:47], v122 offset:39936
    ds_read_b128 v[48:51], v122 offset:40960
    ds_read_b128 v[52:55], v122 offset:41984
    ds_read_b128 v[56:59], v122 offset:43008
    ds_read_b128 v[60:63], v122 offset:44032
    s_waitcnt lgkmcnt(0)
    global_load_dwordx4 v[0:3], v112, s[48:49] offset:0 sc1
    global_load_dwordx4 v[4:7], v112, s[48:49] offset:1024 sc1
L_hs_w2pb:
    s_waitcnt vmcnt(3)
    v_max3_u32 v127, v0, v1, v2
    s_waitcnt vmcnt(2)
    v_max3_u32 v126, v3, v4, v5
    v_max3_u32 v127, v127, v6, v7
    v_max_u32 v127, v127, v126
    v_cmp_eq_u32 vcc, -1, v127
    s_cbranch_vccnz L_hs_w2pb_fail
    s_branch L_hs_top0
.p2align 6
    s_nop 0
    s_nop 0
    s_nop 0
    s_nop 0
    s_nop 0
    s_nop 0
    s_nop 0
    s_nop 0
    s_nop 0
    s_nop 0
    s_nop 0
    s_nop 0
L_hs_w3comm:
    ds_read_b128 v[96:99], v112 offset:28672
    s_add_u32 s32, s32, 1
    s_and_b32 s80, s33, 3
    s_lshl_b32 s80, s80, 13
    s_add_u32 s82, s38, s80
    s_add_u32 s50, s46, s82
    s_addc_u32 s51, s47, 0
    s_xor_b32 s82, s82, 0x4000
    s_add_u32 s52, s46, s82
    s_addc_u32 s53, s47, 0
    s_waitcnt vmcnt(0)
    global_load_dwordx4 v[8:11], v112, s[44:45] offset:0 sc1
    global_load_dwordx4 v[12:15], v112, s[44:45] offset:1024 sc1
    v_mov_b64 v[108:109], 0
    v_mov_b64 v[110:111], 0
    v_xor_b32 v29, 0x800, v114
    v_xor_b32 v30, 0x1000, v114
    v_xor_b32 v31, 0x1800, v114
    v_mov_b64 v[72:73], 0
    v_mov_b64 v[74:75], 0
    v_mov_b64 v[76:77], 0
    v_mov_b64 v[78:79], 0
    s_waitcnt lgkmcnt(0)
    global_load_dwordx4 v[16:19], v112, s[44:45] offset:0 sc1
    global_load_dwordx4 v[20:23], v112, s[44:45] offset:1024 sc1
    s_waitcnt lgkmcnt(0)
L_hs_w3pa0:
    s_waitcnt vmcnt(3)
    v_mfma_f32_16x16x32_bf16 v[100:103], v[96:99], v[8:11], 0
    v_bitop3_b32 v104, v8, v10, s35 bitop3:0x7e
    s_waitcnt vmcnt(2)
    v_mfma_f32_16x16x32_bf16 v[100:103], v[96:99], v[12:15], v[100:103]
    v_bitop3_b32 v105, v12, v14, s35 bitop3:0x7e
    v_bitop3_b32 v104, v104, v105, 1 bitop3:0xa8
    v_cmp_ne_u32 vcc, 0, v104
    s_cbranch_vccnz L_hs_w3pa_fail
L_hs_w3pa_ok:
    s_nop 3
    v_add_f32_dpp v100, v100, v100 row_ror:4 row_mask:0xf bank_mask:0xf
    v_add_f32_dpp v101, v101, v101 row_ror:4 row_mask:0xf bank_mask:0xf
    v_add_f32_dpp v102, v102, v102 row_ror:4 row_mask:0xf bank_mask:0xf
    v_add_f32_dpp v103, v103, v103 row_ror:4 row_mask:0xf bank_mask:0xf
    v_add_f32_dpp v106, v100, v100 row_ror:8 row_mask:0xf bank_mask:0x5
    v_add_f32_dpp v107, v101, v101 row_ror:8 row_mask:0xf bank_mask:0x5
    v_mov_b32 v104, -1
    v_add_f32_dpp v106, v102, v102 row_ror:8 row_mask:0xf bank_mask:0xa
    v_add_f32_dpp v107, v103, v103 row_ror:8 row_mask:0xf bank_mask:0xa
    v_cvt_pk_bf16_f32 v106, v106, v107
    v_min_u32 v106, -2, v106
    global_store_dword v113, v106, s[50:51] sc1
    global_store_dword v113, v104, s[52:53] sc1
    v_and_b32 v127, v126, v127
    v_cmp_eq_u32 vcc, s78, v127
    s_or_b64 s[60:61], s[60:61], vcc
    s_add_u32 s82, s32, 1
    s_bitcmp1_b64 s[60:61], s82
    s_cselect_b32 s72, 0x80000, 0
    s_add_u32 s48, s40, s80
    s_addc_u32 s49, s41, 0
    s_cmp_ge_u32 s32, 63
    s_cselect_b32 s72, 0, s72
    s_xor_b32 s73, s73, 0x2000
    v_xor_b32 v125, 0x2000, v125
    s_add_u32 s33, s33, 1
    s_add_u32 s56, s56, 0x40000
    s_addc_u32 s57, s57, 0
    s_add_u32 s68, s68, 8
    s_addc_u32 s69, s69, 0
    v_mov_b64 v[96:97], 0
    v_mov_b64 v[98:99], 0
    v_mov_b64 v[100:101], 0
    v_mov_b64 v[102:103], 0
    v_mov_b64 v[104:105], 0
    v_mov_b64 v[106:107], 0
    ds_read_b128 v[80:83], v122 offset:32768
    ds_read_b128 v[84:87], v122 offset:33792
    ds_read_b128 v[88:91], v122 offset:34816
    ds_read_b128 v[92:95], v122 offset:35840
    global_load_dwordx4 v[0:3], v112, s[48:49] offset:0 sc1
    global_load_dwordx4 v[4:7], v112, s[48:49] offset:1024 sc1
    ds_read_b128 v[32:35], v122 offset:36864
    ds_read_b128 v[36:39], v122 offset:37888
    ds_read_b128 v[40:43], v122 offset:38912
    ds_read_b128 v[44:47], v122 offset:39936
    ds_read_b128 v[48:51], v122 offset:40960
    ds_read_b128 v[52:55], v122 offset:41984
    ds_read_b128 v[56:59], v122 offset:43008
    ds_read_b128 v[60:63], v122 offset:44032
    s_waitcnt lgkmcnt(0)
    global_load_dwordx4 v[0:3], v112, s[48:49] offset:0 sc1
    global_load_dwordx4 v[4:7], v112, s[48:49] offset:1024 sc1
L_hs_w3pb:
    s_waitcnt vmcnt(3)
    v_max3_u32 v127, v0, v1, v2
    s_waitcnt vmcnt(2)
    v_max3_u32 v126, v3, v4, v5
    v_max3_u32 v127, v127, v6, v7
    v_max_u32 v127, v127, v126
    v_cmp_eq_u32 vcc, -1, v127
    s_cbranch_vccnz L_hs_w3pb_fail
L_hs_top0:
L_hs_top:
    ds_write_b128 v114, v[0:3] offset:16384
    v_smfmac_f32_16x16x64_bf16 v[96:99], v[0:3], v[80:87], v124
    ds_write_b128 v114, v[4:7] offset:17408
    v_smfmac_f32_16x16x64_bf16 v[100:103], v[0:3], v[88:95], v124
    ds_read_b128 v[80:83], v122 offset:45056
    v_smfmac_f32_16x16x64_bf16 v[104:107], v[0:3], v[32:39], v124
    ds_read_b128 v[32:35], v121 offset:32768
    v_smfmac_f32_16x16x64_bf16 v[108:111], v[0:3], v[40:47], v124
    ds_read_b128 v[36:39], v121 offset:33792
    v_smfmac_f32_16x16x64_bf16 v[96:99], v[4:7], v[48:55], v124
    ds_read_b128 v[40:43], v121 offset:34816
    v_smfmac_f32_16x16x64_bf16 v[100:103], v[4:7], v[56:63], v124
    ds_read_b128 v[44:47], v121 offset:35840
    global_load_dwordx4 v[64:67], v119, s[54:55] offset:0 sc1
    v_smfmac_f32_16x16x64_bf16 v[72:75], v[0:3], a[128:135], v124
    ds_read_b128 v[48:51], v121 offset:40960
    s_waitcnt lgkmcnt(6)
    s_barrier
    ds_read_b128 v[16:19], v30 offset:16384
    v_smfmac_f32_16x16x64_bf16 v[76:79], v[0:3], a[192:199], v124
    ds_read_b128 v[20:23], v30 offset:17408
    global_load_dwordx4 v[68:71], v119, s[54:55] offset:256 sc1
    v_smfmac_f32_16x16x64_bf16 v[72:75], v[4:7], a[136:143], v124
    ds_read_b128 v[8:11], v29 offset:16384
    s_add_u32 s54, s54, s72
    v_smfmac_f32_16x16x64_bf16 v[76:79], v[4:7], a[200:207], v124
    ds_read_b128 v[12:15], v29 offset:17408
    s_addc_u32 s55, s55, 0
    s_waitcnt lgkmcnt(3)
    v_smfmac_f32_16x16x64_bf16 v[96:99], v[16:19], v[128:135], v124
    ds_read_b128 v[52:55], v121 offset:41984
    s_mov_b32 m0, s73
    v_smfmac_f32_16x16x64_bf16 v[100:103], v[16:19], v[160:167], v124
    ds_read_b128 v[56:59], v121 offset:43008
    global_load_lds_dwordx4 v118, s[54:55] sc1
    s_waitcnt lgkmcnt(4)
    v_smfmac_f32_16x16x64_bf16 v[96:99], v[20:23], v[136:143], v124
    ds_read_b128 v[60:63], v121 offset:44032
    s_add_u32 m0, s73, 896
    v_smfmac_f32_16x16x64_bf16 v[100:103], v[20:23], v[168:175], v124
    ds_read_b128 v[24:27], v31 offset:16384
    global_load_lds_dwordx4 v118, s[54:55] offset:128 sc1
    v_smfmac_f32_16x16x64_bf16 v[104:107], v[16:19], v[192:199], v124
    ds_read_b128 v[28:31], v31 offset:17408
    v_smfmac_f32_16x16x64_bf16 v[104:107], v[20:23], v[200:207], v124
    ds_read_b128 v[84:87], v122 offset:46080
    s_waitcnt lgkmcnt(7)
    v_smfmac_f32_16x16x64_bf16 v[96:99], v[8:11], v[32:39], v124
    ds_read_b128 v[88:91], v122 offset:47104
    v_smfmac_f32_16x16x64_bf16 v[100:103], v[8:11], v[40:47], v124
    ds_read_b128 v[92:95], v122 offset:48128
    s_waitcnt lgkmcnt(7)
    v_smfmac_f32_16x16x64_bf16 v[96:99], v[12:15], v[48:55], v124
    ds_read_b128 v[48:51], v121 offset:45056
    v_smfmac_f32_16x16x64_bf16 v[108:111], v[16:19], v[224:231], v124
    ds_read_b128 v[52:55], v121 offset:46080
    s_waitcnt lgkmcnt(7)
    v_smfmac_f32_16x16x64_bf16 v[100:103], v[12:15], v[56:63], v124
    ds_read_b128 v[56:59], v121 offset:47104
    s_waitcnt lgkmcnt(7)
    v_smfmac_f32_16x16x64_bf16 v[96:99], v[24:27], v[144:151], v124
    ds_read_b128 v[60:63], v121 offset:48128
    v_smfmac_f32_16x16x64_bf16 v[100:103], v[24:27], v[176:183], v124
    ds_read_b128 v[32:35], v125 offset:0
    s_waitcnt lgkmcnt(7)
    v_smfmac_f32_16x16x64_bf16 v[96:99], v[28:31], v[152:159], v124
    ds_read_b128 v[36:39], v125 offset:1024
    v_smfmac_f32_16x16x64_bf16 v[100:103], v[28:31], v[184:191], v124
    ds_read_b128 v[40:43], v125 offset:2048
    s_nop 0
    v_smfmac_f32_16x16x64_bf16 v[104:107], v[4:7], v[80:87], v124
    ds_read_b128 v[80:83], v121 offset:36864
    s_nop 0
    s_waitcnt lgkmcnt(7)
    v_smfmac_f32_16x16x64_bf16 v[108:111], v[4:7], v[88:95], v124
    ds_read_b128 v[84:87], v121 offset:37888
    s_nop 0
    s_waitcnt lgkmcnt(7)
    v_smfmac_f32_16x16x64_bf16 v[104:107], v[12:15], v[48:55], v124
    ds_read_b128 v[88:91], v121 offset:38912
    v_add_f32 v96, v96, v98
    v_smfmac_f32_16x16x64_bf16 v[104:107], v[24:27], v[208:215], v124
    ds_read_b128 v[92:95], v121 offset:39936
    v_add_f32 v97, v97, v99
    s_waitcnt lgkmcnt(7)
    v_smfmac_f32_16x16x64_bf16 v[108:111], v[12:15], v[56:63], v124
    ds_read_b128 v[44:47], v125 offset:3072
    v_add_f32 v100, v100, v102
    v_smfmac_f32_16x16x64_bf16 v[104:107], v[28:31], v[216:223], v124
    ds_read_b128 v[48:51], v125 offset:4096
    v_add_f32 v101, v101, v103
    v_smfmac_f32_16x16x64_bf16 v[108:111], v[20:23], v[232:239], v124
    ds_read_b128 v[52:55], v125 offset:5120
    v_cvt_pk_bf16_f32 v99, v96, v97
    v_smfmac_f32_16x16x64_bf16 v[108:111], v[24:27], v[240:247], v124
    ds_read_b128 v[56:59], v125 offset:6144
    v_cvt_pk_bf16_f32 v98, v100, v101
    v_smfmac_f32_16x16x64_bf16 v[108:111], v[28:31], v[248:255], v124
    ds_read_b128 v[60:63], v125 offset:7168
    ds_write_b64 v115, v[98:99] offset:24576
    s_waitcnt lgkmcnt(8)
    v_smfmac_f32_16x16x64_bf16 v[104:107], v[8:11], v[80:87], v124
    s_nop 1
    v_smfmac_f32_16x16x64_bf16 v[72:75], v[16:19], a[160:167], v124
    s_nop 1
    s_waitcnt lgkmcnt(6)
    v_smfmac_f32_16x16x64_bf16 v[108:111], v[8:11], v[88:95], v124
    s_nop 0
    v_add_f32 v104, v104, v106
    v_add_u32 v126, s66, v116
    v_add_u32 v95, s66, v117
    v_add_f32 v105, v105, v107
    v_cvt_pk_bf16_f32 v107, v104, v105
    s_nop 1
    v_pk_add_f32 v[108:109], v[108:109], v[110:111]
    v_cvt_pk_bf16_f32 v106, v108, v109
    ds_write_b64 v115, v[106:107] offset:25088
    v_smfmac_f32_16x16x64_bf16 v[76:79], v[16:19], a[224:231], v124
    v_smfmac_f32_16x16x64_bf16 v[72:75], v[20:23], a[168:175], v124
    v_smfmac_f32_16x16x64_bf16 v[76:79], v[20:23], a[232:239], v124
    s_cmp_eq_u32 s32, 0
    v_smfmac_f32_16x16x64_bf16 v[72:75], v[8:11], a[144:151], v124
    s_mov_b64 exec, 1
    global_store_byte v112, v124, s[68:69] sc1
    s_mov_b64 exec, -1
    v_smfmac_f32_16x16x64_bf16 v[76:79], v[8:11], a[208:215], v124
    v_smfmac_f32_16x16x64_bf16 v[72:75], v[12:15], a[152:159], v124
    v_smfmac_f32_16x16x64_bf16 v[76:79], v[12:15], a[216:223], v124
    v_smfmac_f32_16x16x64_bf16 v[72:75], v[24:27], a[176:183], v124
    s_cbranch_scc1 L_hs_k0
L_hs_k0_ok:
    s_waitcnt lgkmcnt(0)
    s_barrier
    ds_read_b64_tr_b16 v[96:97], v116 offset:24576
    ds_read_b64_tr_b16 v[98:99], v117 offset:24576
    v_smfmac_f32_16x16x64_bf16 v[76:79], v[24:27], a[240:247], v124
    ds_read_b64_tr_b16 v[100:101], v116 offset:25600
    ds_read_b64_tr_b16 v[102:103], v117 offset:25600
    v_smfmac_f32_16x16x64_bf16 v[72:75], v[28:31], a[184:191], v124
    ds_read_b64_tr_b16 v[104:105], v116 offset:26624
    ds_read_b64_tr_b16 v[106:107], v117 offset:26624
    v_smfmac_f32_16x16x64_bf16 v[76:79], v[28:31], a[248:255], v124
    ds_read_b64_tr_b16 v[108:109], v116 offset:27648
    ds_read_b64_tr_b16 v[110:111], v117 offset:27648
    s_waitcnt lgkmcnt(6)
    v_mfma_f32_16x16x32_bf16 v[80:83], v[32:35], v[96:99], 0
    ds_read_b64_tr_b16 v[8:9], v126 offset:24576
    v_mov_b64 v[12:13], s[94:95]
    v_mov_b64 v[14:15], s[70:71]
    v_mfma_f32_16x16x32_bf16 v[84:87], v[36:39], v[96:99], 0
    ds_read_b64_tr_b16 v[10:11], v95 offset:24576
    v_mov_b64 v[16:17], 0
    v_mov_b64 v[18:19], 0
    v_mfma_f32_16x16x32_bf16 v[88:91], v[96:99], v[96:99], 0
    v_add_f32 v72, v72, v74
    v_add_f32 v73, v73, v75
    s_waitcnt lgkmcnt(6)
    v_mfma_f32_16x16x32_bf16 v[80:83], v[40:43], v[100:103], v[80:83]
    s_not_b64 vcc, s[76:77]
    v_add_f32 v76, v76, v78
    v_add_f32 v77, v77, v79
    v_mfma_f32_16x16x32_bf16 v[84:87], v[44:47], v[100:103], v[84:87]
    v_cvt_pk_bf16_f32 v75, v72, v73
    v_cvt_pk_bf16_f32 v79, v76, v77
    s_waitcnt lgkmcnt(4)
    v_mfma_f32_16x16x32_bf16 v[80:83], v[48:51], v[104:107], v[80:83]
    global_load_dwordx2 v[126:127], v112, s[58:59] sc1
    v_mov_b32 v74, 0
    v_mov_b32 v78, 0
    s_waitcnt lgkmcnt(0)
    v_mfma_f32_16x16x32_bf16 v[84:87], v[52:55], v[104:107], v[84:87]
    v_cndmask_b32 v8, v75, v8, vcc
    v_cndmask_b32 v9, v79, v9, vcc
    v_mfma_f32_16x16x32_bf16 v[80:83], v[56:59], v[108:111], v[80:83]
    v_cndmask_b32_dpp v10, v75, v10, vcc quad_perm:[2,3,0,1] row_mask:0xf bank_mask:0xf
    v_cndmask_b32_dpp v11, v79, v11, vcc quad_perm:[2,3,0,1] row_mask:0xf bank_mask:0xf
    v_mfma_f32_16x16x32_bf16 v[84:87], v[60:63], v[108:111], v[84:87]
    global_store_dwordx4 v112, v[8:11], s[56:57] sc1
    s_nop 1
    v_mfma_f32_16x16x32_bf16 v[88:91], v[100:103], v[100:103], v[88:91]
    s_mov_b64 vcc, s[76:77]
    s_nop 1
    v_mfma_f32_16x16x32_bf16 v[88:91], v[104:107], v[104:107], v[88:91]
    s_and_b32 s35, s33, 1
    s_nop 1
    v_mfma_f32_16x16x32_bf16 v[88:91], v[108:111], v[108:111], v[88:91]
    s_cmp_eq_u32 s32, 63
    v_cndmask_b32_dpp v80, v84, v80, vcc quad_perm:[2,3,0,1] row_mask:0xf bank_mask:0xf
    v_cndmask_b32_dpp v81, v85, v81, vcc quad_perm:[2,3,0,1] row_mask:0xf bank_mask:0xf
    s_cbranch_scc1 L_hs_last
    v_cndmask_b32_dpp v82, v86, v82, vcc quad_perm:[2,3,0,1] row_mask:0xf bank_mask:0xf
    v_cndmask_b32_dpp v83, v87, v83, vcc quad_perm:[2,3,0,1] row_mask:0xf bank_mask:0xf
    v_max3_f32 v94, v80, v81, v82
    s_nop 0
    v_cndmask_b32_dpp v88, v89, v88, vcc quad_perm:[2,3,0,1] row_mask:0xf bank_mask:0xf
    v_max3_f32 v92, v94, v83, v88
    v_max3_f32 v93, v94, v83, v88
    v_mov_b64 v[20:21], 0
    v_mov_b64 v[22:23], 0
    v_permlane32_swap_b32 v92, v93
    v_max_f32 v94, v92, v93
    v_max_f32 v95, v92, v93
    v_mov_b64 v[24:25], 0
    v_mov_b64 v[26:27], 0
    v_permlane16_swap_b32 v94, v95
    v_max_f32 v92, v94, v95
    v_mov_b64 v[28:29], 0
    v_mov_b64 v[30:31], 0
    v_max_f32_dpp v93, v92, v92 quad_perm:[2,3,0,1] row_mask:0xf bank_mask:0xf
    v_mul_f32 v92, s64, v93
    v_fma_f32 v88, v88, s64, -v92
    v_pk_fma_f32 v[80:81], v[80:81], s[64:65], v[92:93] op_sel_hi:[1,1,0] neg_lo:[0,0,1] neg_hi:[0,0,1]
    v_pk_fma_f32 v[82:83], v[82:83], s[64:65], v[92:93] op_sel_hi:[1,1,0] neg_lo:[0,0,1] neg_hi:[0,0,1]
    v_exp_f32 v88, v88
    v_exp_f32 v80, v80
    v_exp_f32 v81, v81
    v_mov_b32_dpp v89, v88 quad_perm:[2,3,0,1] row_mask:0xf bank_mask:0xf
    v_cvt_pk_bf16_f32 v33, v88, v89
    v_exp_f32 v82, v82
    v_cvt_pk_bf16_f32 v34, v80, v81
    v_mfma_f32_16x16x16_bf16 v[40:43], v[74:75], v[32:33], 0
    v_exp_f32 v83, v83
    v_mfma_f32_16x16x16_bf16 v[44:47], v[78:79], v[32:33], 0
    v_cvt_pk_bf16_f32 v35, v82, v83
    v_mov_b32_dpp v36, v34 quad_perm:[2,3,0,1] row_mask:0xf bank_mask:0xf
    s_waitcnt vmcnt(5)
    v_mfma_f32_16x16x32_bf16 v[48:51], v[12:15], v[32:35], 0
    v_mov_b32_dpp v37, v35 quad_perm:[2,3,0,1] row_mask:0xf bank_mask:0xf
    v_xor_b32 v100, 0x200, v120
    v_xor_b32 v104, 0x400, v120
    v_mfma_f32_16x16x32_bf16 v[40:43], v[64:67], v[34:37], v[40:43]
    s_nop 1
    v_xor_b32 v108, 0x600, v120
    v_mfma_f32_16x16x32_bf16 v[44:47], v[68:71], v[34:37], v[44:47]
    v_add_f32_dpp v48, v48, v48 quad_perm:[2,3,0,1] row_mask:0xf bank_mask:0xf
    s_mov_b64 exec, vcc
    v_rcp_f32 v92, v48
    s_nop 0
    v_mul_f32 v40, v40, v92
    v_mul_f32 v41, v41, v92
    v_mul_f32 v42, v42, v92
    v_mul_f32 v43, v43, v92
    v_cvt_pk_bf16_f32 v96, v40, v41
    v_cvt_pk_bf16_f32 v97, v42, v43
    ds_write_b64 v120, v[96:97] offset:29696
    v_pk_mul_f32 v[44:45], v[44:45], v[92:93] op_sel_hi:[1,0]
    v_pk_mul_f32 v[46:47], v[46:47], v[92:93] op_sel_hi:[1,0]
    v_cvt_pk_bf16_f32 v98, v44, v45
    v_cvt_pk_bf16_f32 v99, v46, v47
    ds_write_b64 v120, v[98:99] offset:29704
    s_mov_b64 exec, -1
    v_cndmask_b32_dpp v96, v96, v96, vcc quad_perm:[2,3,0,1] row_mask:0xf bank_mask:0xf
    v_cndmask_b32_dpp v97, v97, v97, vcc quad_perm:[2,3,0,1] row_mask:0xf bank_mask:0xf
    v_cndmask_b32_dpp v98, v98, v98, vcc quad_perm:[2,3,0,1] row_mask:0xf bank_mask:0xf
    v_cndmask_b32_dpp v99, v99, v99, vcc quad_perm:[2,3,0,1] row_mask:0xf bank_mask:0xf
    s_nop 1
    v_smfmac_f32_16x16x64_bf16 v[16:19], v[96:99], a[0:7], v124
    s_cmp_eq_u32 s72, 0
    s_cbranch_scc1 L_hs_k1
L_hs_k1_ok:
    v_smfmac_f32_16x16x64_bf16 v[20:23], v[96:99], a[32:39], v124
    s_waitcnt lgkmcnt(0)
    s_barrier
    ds_read_b128 v[100:103], v100 offset:29696
    ds_read_b128 v[104:107], v104 offset:29696
    ds_read_b128 v[108:111], v108 offset:29696
    v_smfmac_f32_16x16x64_bf16 v[24:27], v[96:99], a[64:71], v124
    v_smfmac_f32_16x16x64_bf16 v[28:31], v[96:99], a[96:103], v124
    s_waitcnt lgkmcnt(2)
    v_smfmac_f32_16x16x64_bf16 v[16:19], v[100:103], a[8:15], v124
    s_waitcnt lgkmcnt(1)
    v_smfmac_f32_16x16x64_bf16 v[16:19], v[104:107], a[16:23], v124
    s_waitcnt lgkmcnt(0)
    v_smfmac_f32_16x16x64_bf16 v[16:19], v[108:111], a[24:31], v124
    s_nop 2
    v_smfmac_f32_16x16x64_bf16 v[20:23], v[100:103], a[40:47], v124
    s_nop 3
    v_cvt_pk_bf16_f32 v16, v16, v17
    v_cvt_pk_bf16_f32 v17, v18, v19
    v_and_or_b32 v16, v16, -2, s35
    global_store_dwordx2 v123, v[16:17], s[36:37] offset:-4096 sc1
    v_smfmac_f32_16x16x64_bf16 v[20:23], v[104:107], a[48:55], v124
    s_nop 2
    v_smfmac_f32_16x16x64_bf16 v[20:23], v[108:111], a[56:63], v124
    s_nop 2
    v_smfmac_f32_16x16x64_bf16 v[24:27], v[100:103], a[72:79], v124
    s_nop 3
    v_cvt_pk_bf16_f32 v20, v20, v21
    v_cvt_pk_bf16_f32 v21, v22, v23
    v_and_or_b32 v20, v20, -2, s35
    global_store_dwordx2 v123, v[20:21], s[36:37] offset:-2048 sc1
    v_smfmac_f32_16x16x64_bf16 v[24:27], v[104:107], a[80:87], v124
    s_nop 2
    v_smfmac_f32_16x16x64_bf16 v[24:27], v[108:111], a[88:95], v124
    s_nop 2
    v_smfmac_f32_16x16x64_bf16 v[28:31], v[100:103], a[104:111], v124
    s_nop 3
    v_cvt_pk_bf16_f32 v24, v24, v25
    v_cvt_pk_bf16_f32 v25, v26, v27
    v_and_or_b32 v24, v24, -2, s35
    global_store_dwordx2 v123, v[24:25], s[36:37] offset:0 sc1
    v_smfmac_f32_16x16x64_bf16 v[28:31], v[104:107], a[112:119], v124
    s_nop 2
    v_smfmac_f32_16x16x64_bf16 v[28:31], v[108:111], a[120:127], v124
    s_nop 2
    s_cmp_eq_u32 s31, 0
    s_nop 3
    v_cvt_pk_bf16_f32 v28, v28, v29
    v_cvt_pk_bf16_f32 v29, v30, v31
    v_and_or_b32 v28, v28, -2, s35
    global_store_dwordx2 v123, v[28:29], s[36:37] offset:2048 sc1
    s_cbranch_scc1 L_hs_w0comm
    s_cmp_eq_u32 s31, 1
    s_cbranch_scc1 L_hs_w1comm
    s_cmp_eq_u32 s31, 2
    s_cbranch_scc1 L_hs_w2comm
    s_branch L_hs_w3comm
L_hs_w0pa_fail:
    s_mov_b64 exec, vcc
    global_load_dwordx4 v[8:11], v112, s[44:45] offset:0 sc1
    global_load_dwordx4 v[12:15], v112, s[44:45] offset:1024 sc1
    s_mov_b64 exec, -1
    s_sub_u32 s62, s62, 1
    s_cbranch_scc0 L_hs_w0pa0
    s_movk_i32 s63, 3
    s_branch L_fail_far
L_hs_w0pb_fail:
    s_mov_b64 exec, vcc
    global_load_dwordx4 v[0:3], v112, s[48:49] offset:0 sc1
    global_load_dwordx4 v[4:7], v112, s[48:49] offset:1024 sc1
    s_mov_b64 exec, -1
    s_sub_u32 s62, s62, 1
    s_cbranch_scc0 L_hs_w0pb
    s_movk_i32 s63, 4
    s_branch L_fail_far
L_hs_w1pa_fail:
    s_mov_b64 exec, vcc
    global_load_dwordx4 v[8:11], v112, s[44:45] offset:0 sc1
    global_load_dwordx4 v[12:15], v112, s[44:45] offset:1024 sc1
    s_mov_b64 exec, -1
    s_sub_u32 s62, s62, 1
    s_cbranch_scc0 L_hs_w1pa0
    s_movk_i32 s63, 3
    s_branch L_fail_far
L_hs_w1pb_fail:
    s_mov_b64 exec, vcc
    global_load_dwordx4 v[0:3], v112, s[48:49] offset:0 sc1
    global_load_dwordx4 v[4:7], v112, s[48:49] offset:1024 sc1
    s_mov_b64 exec, -1
    s_sub_u32 s62, s62, 1
    s_cbranch_scc0 L_hs_w1pb
    s_movk_i32 s63, 4
    s_branch L_fail_far
L_hs_w2pa_fail:
    s_mov_b64 exec, vcc
    global_load_dwordx4 v[8:11], v112, s[44:45] offset:0 sc1
    global_load_dwordx4 v[12:15], v112, s[44:45] offset:1024 sc1
    s_mov_b64 exec, -1
    s_sub_u32 s62, s62, 1
    s_cbranch_scc0 L_hs_w2pa0
    s_movk_i32 s63, 3
    s_branch L_fail_far
L_hs_w2pb_fail:
    s_mov_b64 exec, vcc
    global_load_dwordx4 v[0:3], v112, s[48:49] offset:0 sc1
    global_load_dwordx4 v[4:7], v112, s[48:49] offset:1024 sc1
    s_mov_b64 exec, -1
    s_sub_u32 s62, s62, 1
    s_cbranch_scc0 L_hs_w2pb
    s_movk_i32 s63, 4
    s_branch L_fail_far
L_hs_w3pa_fail:
    s_mov_b64 exec, vcc
    global_load_dwordx4 v[8:11], v112, s[44:45] offset:0 sc1
    global_load_dwordx4 v[12:15], v112, s[44:45] offset:1024 sc1
    s_mov_b64 exec, -1
    s_waitcnt vmcnt(3)
    v_mfma_f32_16x16x32_bf16 v[100:103], v[96:99], v[16:19], 0
    v_bitop3_b32 v104, v16, v18, s35 bitop3:0x7e
    s_waitcnt vmcnt(2)
    v_mfma_f32_16x16x32_bf16 v[100:103], v[96:99], v[20:23], v[100:103]
    v_bitop3_b32 v105, v20, v22, s35 bitop3:0x7e
    v_bitop3_b32 v104, v104, v105, 1 bitop3:0xa8
    v_cmp_ne_u32 vcc, 0, v104
    s_cbranch_vccz L_hs_w3pa_ok
    s_mov_b64 exec, vcc
    global_load_dwordx4 v[16:19], v112, s[44:45] offset:0 sc1
    global_load_dwordx4 v[20:23], v112, s[44:45] offset:1024 sc1
    s_mov_b64 exec, -1
    s_sub_u32 s62, s62, 1
    s_cbranch_scc0 L_hs_w3pa0
    s_movk_i32 s63, 3
    s_branch L_fail_far
L_hs_w3pb_fail:
    s_mov_b64 exec, vcc
    global_load_dwordx4 v[0:3], v112, s[48:49] offset:0 sc1
    global_load_dwordx4 v[4:7], v112, s[48:49] offset:1024 sc1
    s_mov_b64 exec, -1
    s_sub_u32 s62, s62, 1
    s_cbranch_scc0 L_hs_w3pb
    s_movk_i32 s63, 4
    s_branch L_fail_far
L_hs_k1:
    s_cmp_eq_u32 s32, 0
    s_cbranch_scc1 L_hs_k1d
    s_add_u32 s82, s32, 1
    s_waitcnt vmcnt(1)
    v_and_b32 v127, v126, v127
    v_cmp_eq_u32 s[60:61], s78, v127
L_hs_fw2:
    s_bitcmp1_b64 s[60:61], s82
    s_cbranch_scc1 L_hs_fw2_ok
    global_load_dwordx2 v[126:127], v112, s[58:59] sc1
    s_waitcnt vmcnt(0)
    v_and_b32 v127, v126, v127
    v_cmp_eq_u32 s[60:61], s78, v127
    s_sub_u32 s62, s62, 1
    s_cbranch_scc0 L_hs_fw2
    s_movk_i32 s63, 2
    s_branch L_fail_far
L_hs_fw2_ok:
    s_add_u32 s54, s54, 0x80000
    s_addc_u32 s55, s55, 0
    s_mov_b32 m0, s73
    s_nop 0
    global_load_lds_dwordx4 v118, s[54:55] sc1
    s_add_u32 m0, s73, 896
    s_nop 0
    global_load_lds_dwordx4 v118, s[54:55] offset:128 sc1
    s_branch L_hs_k1_ok
L_hs_k1d:
    s_add_u32 s54, s54, 0x80000
    s_addc_u32 s55, s55, 0
L_hs_k1_poll:
    global_load_dwordx4 v[32:35], v118, s[54:55] offset:0 sc1
    global_load_dwordx4 v[36:39], v118, s[54:55] offset:128 sc1
    global_load_dwordx4 v[64:67], v119, s[54:55] offset:0 sc1
    global_load_dwordx4 v[68:71], v119, s[54:55] offset:256 sc1
    s_waitcnt vmcnt(0)
    v_max_u32 v92, v32, v33
    v_max3_u32 v92, v92, v34, v35
    v_max3_u32 v92, v92, v36, v37
    v_max3_u32 v92, v92, v38, v39
    v_max3_u32 v92, v92, v64, v65
    v_max3_u32 v92, v92, v66, v67
    v_max3_u32 v92, v92, v68, v69
    v_max3_u32 v92, v92, v70, v71
    v_cmp_eq_u32 vcc, -1, v92
    s_cbranch_vccz L_hs_k1_got
    s_sub_u32 s62, s62, 1
    s_cbranch_scc0 L_hs_k1_poll
    s_movk_i32 s63, 7
    s_branch L_fail_far
L_hs_k1_got:
    v_add_u32 v92, s73, v112
    ds_write_b128 v92, v[32:35] offset:0
    ds_write_b128 v92, v[36:39] offset:1024
    s_waitcnt lgkmcnt(0)
    s_branch L_hs_k1_ok
L_hs_k0:
    v_mov_b32 v94, v126
    s_mov_b64 s[54:55], s[42:43]
    s_waitcnt lgkmcnt(0)
L_hs_k0_poll:
    global_load_dwordx4 v[32:35], v118, s[54:55] offset:0 sc1
    global_load_dwordx4 v[36:39], v118, s[54:55] offset:128 sc1
    global_load_dwordx4 v[64:67], v119, s[54:55] offset:0 sc1
    global_load_dwordx4 v[68:71], v119, s[54:55] offset:256 sc1
    s_waitcnt vmcnt(0)
    v_max_u32 v127, v32, v33
    v_max3_u32 v127, v127, v34, v35
    v_max3_u32 v127, v127, v36, v37
    v_max3_u32 v127, v127, v38, v39
    v_max3_u32 v127, v127, v64, v65
    v_max3_u32 v127, v127, v66, v67
    v_max3_u32 v127, v127, v68, v69
    v_max3_u32 v127, v127, v70, v71
    v_cmp_eq_u32 vcc, -1, v127
    s_cbranch_vccz L_hs_k0_got
    s_sub_u32 s62, s62, 1
    s_cbranch_scc0 L_hs_k0_poll
    s_movk_i32 s63, 6
    s_branch L_fail_far
L_hs_k0_got:
    v_add_u32 v127, s67, v125
    ds_write_b128 v127, v[32:35] offset:0
    ds_write_b128 v127, v[36:39] offset:1024
    s_waitcnt lgkmcnt(0)
    s_barrier
    ds_read_b128 v[32:35], v125 offset:0
    ds_read_b128 v[36:39], v125 offset:1024
    ds_read_b128 v[40:43], v125 offset:2048
    ds_read_b128 v[44:47], v125 offset:3072
    ds_read_b128 v[48:51], v125 offset:4096
    ds_read_b128 v[52:55], v125 offset:5120
    ds_read_b128 v[56:59], v125 offset:6144
    ds_read_b128 v[60:63], v125 offset:7168
    v_mov_b32 v126, v94
    s_branch L_hs_k0_ok
L_hs_last:
    v_min_u32 v8, -2, v8
    v_min_u32 v9, -2, v9
    v_min_u32 v10, -2, v10
    v_min_u32 v11, -2, v11
    global_store_dwordx4 v112, v[8:11], s[56:57] sc1
    s_waitcnt vmcnt(0)
    s_barrier
    s_add_u32 s34, s34, 1
    s_cmp_lt_u32 s34, 2
    s_cbranch_scc1 L_hs_layer
    s_endpgm
L_ln0:
    v_mov_b32 v152, 0x0
    v_bfe_i32 v150, v255, 0, 1
    v_and_b32 v150, 0x10, v150
    v_xor_b32 v152, v152, v150
    v_bfe_i32 v150, v255, 1, 1
    v_and_b32 v150, 0x20, v150
    v_xor_b32 v152, v152, v150
    v_bfe_i32 v150, v255, 2, 1
    v_and_b32 v150, 0x40, v150
    v_xor_b32 v152, v152, v150
    v_bfe_i32 v150, v255, 3, 1
    v_and_b32 v150, 0x80, v150
    v_xor_b32 v152, v152, v150
    v_bfe_i32 v150, v255, 4, 1
    v_and_b32 v150, 0x100, v150
    v_xor_b32 v152, v152, v150
    v_bfe_i32 v150, v255, 5, 1
    v_and_b32 v150, 0x200, v150
    v_xor_b32 v152, v152, v150
    v_bfe_i32 v150, v255, 6, 1
    v_and_b32 v150, 0x2080, v150
    v_xor_b32 v152, v152, v150
    v_bfe_i32 v150, v255, 7, 1
    v_and_b32 v150, 0x4000, v150
    v_xor_b32 v152, v152, v150
    s_lshl_b32 s81, s37, 5
    s_add_u32 s81, s81, s30
    s_lshl_b32 s81, s81, 15
    s_add_u32 s38, s4, s81
    s_addc_u32 s39, s5, 0
    s_lshl_b32 s82, s31, 13
    v_xor_b32 v0, 0x0, v152
    s_add_u32 m0, s82, 0
    s_nop 0
    global_load_lds_dwordx4 v0, s[38:39]
    v_xor_b32 v1, 0x410, v152
    s_add_u32 m0, s82, 1024
    s_nop 0
    global_load_lds_dwordx4 v1, s[38:39]
    v_xor_b32 v2, 0x820, v152
    s_add_u32 m0, s82, 2048
    s_nop 0
    global_load_lds_dwordx4 v2, s[38:39]
    v_xor_b32 v3, 0xc30, v152
    s_add_u32 m0, s82, 3072
    s_nop 0
    global_load_lds_dwordx4 v3, s[38:39]
    v_xor_b32 v4, 0x1040, v152
    s_add_u32 m0, s82, 4096
    s_nop 0
    global_load_lds_dwordx4 v4, s[38:39]
    v_xor_b32 v5, 0x1450, v152
    s_add_u32 m0, s82, 5120
    s_nop 0
    global_load_lds_dwordx4 v5, s[38:39]
    v_xor_b32 v6, 0x1860, v152
    s_add_u32 m0, s82, 6144
    s_nop 0
    global_load_lds_dwordx4 v6, s[38:39]
    v_xor_b32 v7, 0x1c70, v152
    s_add_u32 m0, s82, 7168
    s_nop 0
    global_load_lds_dwordx4 v7, s[38:39]
    v_mov_b32 v151, 0x0
    v_bfe_u32 v150, v255, 0, 6
    v_lshl_add_u32 v151, v150, 4, v151
    v_mov_b32 v153, 0x8000
    v_bfe_u32 v150, v255, 0, 5
    v_lshl_add_u32 v153, v150, 6, v153
    v_bfe_u32 v150, v255, 5, 3
    v_lshl_add_u32 v153, v150, 3, v153
    v_mov_b32 v154, 0x8000
    v_bfe_u32 v150, v255, 0, 5
    v_lshl_add_u32 v154, v150, 6, v154
    v_mov_b32 v152, 0x0
    v_bfe_i32 v150, v255, 0, 1
    v_and_b32 v150, 0x410, v150
    v_xor_b32 v152, v152, v150
    v_bfe_i32 v150, v255, 1, 1
    v_and_b32 v150, 0x820, v150
    v_xor_b32 v152, v152, v150
    v_bfe_i32 v150, v255, 2, 1
    v_and_b32 v150, 0x1040, v150
    v_xor_b32 v152, v152, v150
    v_bfe_i32 v150, v255, 3, 1
    v_and_b32 v150, 0x2080, v150
    v_xor_b32 v152, v152, v150
    v_bfe_i32 v150, v255, 4, 1
    v_and_b32 v150, 0x4000, v150
    v_xor_b32 v152, v152, v150
    v_bfe_i32 v150, v255, 5, 1
    v_and_b32 v150, 0x10, v150
    v_xor_b32 v152, v152, v150
    v_bfe_i32 v150, v255, 6, 1
    v_and_b32 v150, 0x100, v150
    v_xor_b32 v152, v152, v150
    v_bfe_i32 v150, v255, 7, 1
    v_and_b32 v150, 0x200, v150
    v_xor_b32 v152, v152, v150
    s_mov_b32 s90, 0x00003f80
    s_mov_b32 s91, 0x3f800000
    s_mov_b32 s92, 0x3f803f80
    s_add_u32 s81, s81, s82
    s_add_u32 s82, s81, 0xc801000
    s_add_u32 s40, s28, s82
    s_addc_u32 s41, s29, 0
    v_xor_b32 v0, 0x0, v152
    v_xor_b32 v1, 0x20, v152
    v_xor_b32 v2, 0x40, v152
    v_xor_b32 v3, 0x60, v152
    v_xor_b32 v4, 0x80, v152
    v_xor_b32 v5, 0xa0, v152
    v_xor_b32 v6, 0xc0, v152
    v_xor_b32 v7, 0xe0, v152
    s_waitcnt vmcnt(0)
    s_barrier
    ds_read_b128 v[64:67], v0
    ds_read_b128 v[68:71], v1
    ds_read_b128 v[72:75], v2
    ds_read_b128 v[76:79], v3
    ds_read_b128 v[80:83], v4
    ds_read_b128 v[84:87], v5
    ds_read_b128 v[88:91], v6
    ds_read_b128 v[92:95], v7
    s_waitcnt lgkmcnt(7)
    v_dot2_f32_bf16 v144, v64, s92, 0
    v_dot2_f32_bf16 v145, v64, v64, 0
    v_dot2_f32_bf16 v144, v65, s92, v144
    v_dot2_f32_bf16 v145, v65, v65, v145
    v_dot2_f32_bf16 v144, v66, s92, v144
    v_dot2_f32_bf16 v145, v66, v66, v145
    v_dot2_f32_bf16 v144, v67, s92, v144
    v_dot2_f32_bf16 v145, v67, v67, v145
    s_waitcnt lgkmcnt(6)
    v_dot2_f32_bf16 v144, v68, s92, v144
    v_dot2_f32_bf16 v145, v68, v68, v145
    v_dot2_f32_bf16 v144, v69, s92, v144
    v_dot2_f32_bf16 v145, v69, v69, v145
    v_dot2_f32_bf16 v144, v70, s92, v144
    v_dot2_f32_bf16 v145, v70, v70, v145
    v_dot2_f32_bf16 v144, v71, s92, v144
    v_dot2_f32_bf16 v145, v71, v71, v145
    s_waitcnt lgkmcnt(5)
    v_dot2_f32_bf16 v144, v72, s92, v144
    v_dot2_f32_bf16 v145, v72, v72, v145
    v_dot2_f32_bf16 v144, v73, s92, v144
    v_dot2_f32_bf16 v145, v73, v73, v145
    v_dot2_f32_bf16 v144, v74, s92, v144
    v_dot2_f32_bf16 v145, v74, v74, v145
    v_dot2_f32_bf16 v144, v75, s92, v144
    v_dot2_f32_bf16 v145, v75, v75, v145
    s_waitcnt lgkmcnt(4)
    v_dot2_f32_bf16 v144, v76, s92, v144
    v_dot2_f32_bf16 v145, v76, v76, v145
    v_dot2_f32_bf16 v144, v77, s92, v144
    v_dot2_f32_bf16 v145, v77, v77, v145
    v_dot2_f32_bf16 v144, v78, s92, v144
    v_dot2_f32_bf16 v145, v78, v78, v145
    v_dot2_f32_bf16 v144, v79, s92, v144
    v_dot2_f32_bf16 v145, v79, v79, v145
    s_waitcnt lgkmcnt(3)
    v_dot2_f32_bf16 v144, v80, s92, v144
    v_dot2_f32_bf16 v145, v80, v80, v145
    v_dot2_f32_bf16 v144, v81, s92, v144
    v_dot2_f32_bf16 v145, v81, v81, v145
    v_dot2_f32_bf16 v144, v82, s92, v144
    v_dot2_f32_bf16 v145, v82, v82, v145
    v_dot2_f32_bf16 v144, v83, s92, v144
    v_dot2_f32_bf16 v145, v83, v83, v145
    s_waitcnt lgkmcnt(2)
    v_dot2_f32_bf16 v144, v84, s92, v144
    v_dot2_f32_bf16 v145, v84, v84, v145
    v_dot2_f32_bf16 v144, v85, s92, v144
    v_dot2_f32_bf16 v145, v85, v85, v145
    v_dot2_f32_bf16 v144, v86, s92, v144
    v_dot2_f32_bf16 v145, v86, v86, v145
    v_dot2_f32_bf16 v144, v87, s92, v144
    v_dot2_f32_bf16 v145, v87, v87, v145
    s_waitcnt lgkmcnt(1)
    v_dot2_f32_bf16 v144, v88, s92, v144
    v_dot2_f32_bf16 v145, v88, v88, v145
    v_dot2_f32_bf16 v144, v89, s92, v144
    v_dot2_f32_bf16 v145, v89, v89, v145
    v_dot2_f32_bf16 v144, v90, s92, v144
    v_dot2_f32_bf16 v145, v90, v90, v145
    v_dot2_f32_bf16 v144, v91, s92, v144
    v_dot2_f32_bf16 v145, v91, v91, v145
    s_waitcnt lgkmcnt(0)
    v_dot2_f32_bf16 v144, v92, s92, v144
    v_dot2_f32_bf16 v145, v92, v92, v145
    v_dot2_f32_bf16 v144, v93, s92, v144
    v_dot2_f32_bf16 v145, v93, v93, v145
    v_dot2_f32_bf16 v144, v94, s92, v144
    v_dot2_f32_bf16 v145, v94, v94, v145
    v_dot2_f32_bf16 v144, v95, s92, v144
    v_dot2_f32_bf16 v145, v95, v95, v145
    s_nop 2
    ds_write_b64 v153, v[144:145]
    s_waitcnt lgkmcnt(0)
    s_barrier
    ds_read_b128 v[128:131], v154 offset:0
    ds_read_b128 v[132:135], v154 offset:16
    ds_read_b128 v[136:139], v154 offset:32
    ds_read_b128 v[140:143], v154 offset:48
    s_waitcnt lgkmcnt(0)
    v_pk_add_f32 v[128:129], v[128:129], v[130:131]
    v_pk_add_f32 v[132:133], v[132:133], v[134:135]
    v_pk_add_f32 v[136:137], v[136:137], v[138:139]
    v_pk_add_f32 v[140:141], v[140:141], v[142:143]
    v_pk_add_f32 v[128:129], v[128:129], v[132:133]
    v_pk_add_f32 v[136:137], v[136:137], v[140:141]
    v_pk_add_f32 v[144:145], v[128:129], v[136:137]
    v_mul_f32 v144, 0x3b000000, v144
    v_mul_f32 v145, 0x3b000000, v145
    v_fma_f32 v145, -v144, v144, v145
    v_max_f32 v145, 0, v145
    v_cvt_pk_bf16_f32 v144, v144, v144
    v_and_b32 v144, 0xffff0000, v144
    v_cvt_pk_bf16_f32 v145, v145, v145
    v_and_b32 v145, 0xffff0000, v145
    v_add_f32 v145, 0x3727c5ac, v145
    v_cvt_pk_bf16_f32 v145, v145, v145
    v_and_b32 v145, 0xffff0000, v145
    v_sqrt_f32 v145, v145
    s_nop 0
    v_cvt_pk_bf16_f32 v145, v145, v145
    v_and_b32 v145, 0xffff0000, v145
    v_rcp_f32 v145, v145
    v_sub_f32 v144, 0, v144
    v_dot2_f32_bf16 v0, v64, s90, v144
    v_dot2_f32_bf16 v1, v64, s91, v144
    v_dot2_f32_bf16 v2, v65, s90, v144
    v_dot2_f32_bf16 v3, v65, s91, v144
    v_dot2_f32_bf16 v4, v66, s90, v144
    v_dot2_f32_bf16 v5, v66, s91, v144
    v_dot2_f32_bf16 v6, v67, s90, v144
    v_dot2_f32_bf16 v7, v67, s91, v144
    v_dot2_f32_bf16 v8, v68, s90, v144
    v_dot2_f32_bf16 v9, v68, s91, v144
    v_dot2_f32_bf16 v10, v69, s90, v144
    v_dot2_f32_bf16 v11, v69, s91, v144
    v_dot2_f32_bf16 v12, v70, s90, v144
    v_dot2_f32_bf16 v13, v70, s91, v144
    v_dot2_f32_bf16 v14, v71, s90, v144
    v_dot2_f32_bf16 v15, v71, s91, v144
    v_cvt_pk_bf16_f32 v64, v0, v1
    v_cvt_pk_bf16_f32 v65, v2, v3
    v_cvt_pk_bf16_f32 v66, v4, v5
    v_cvt_pk_bf16_f32 v67, v6, v7
    v_cvt_pk_bf16_f32 v68, v8, v9
    v_cvt_pk_bf16_f32 v69, v10, v11
    v_cvt_pk_bf16_f32 v70, v12, v13
    v_cvt_pk_bf16_f32 v71, v14, v15
    v_lshlrev_b32 v0, 16, v64
    v_and_b32 v1, 0xffff0000, v64
    v_lshlrev_b32 v2, 16, v65
    v_and_b32 v3, 0xffff0000, v65
    v_lshlrev_b32 v4, 16, v66
    v_and_b32 v5, 0xffff0000, v66
    v_lshlrev_b32 v6, 16, v67
    v_and_b32 v7, 0xffff0000, v67
    v_lshlrev_b32 v8, 16, v68
    v_and_b32 v9, 0xffff0000, v68
    v_lshlrev_b32 v10, 16, v69
    v_and_b32 v11, 0xffff0000, v69
    v_lshlrev_b32 v12, 16, v70
    v_and_b32 v13, 0xffff0000, v70
    v_lshlrev_b32 v14, 16, v71
    v_and_b32 v15, 0xffff0000, v71
    v_pk_mul_f32 v[0:1], v[0:1], v[144:145] op_sel:[0,1] op_sel_hi:[1,1]
    v_pk_mul_f32 v[2:3], v[2:3], v[144:145] op_sel:[0,1] op_sel_hi:[1,1]
    v_pk_mul_f32 v[4:5], v[4:5], v[144:145] op_sel:[0,1] op_sel_hi:[1,1]
    v_pk_mul_f32 v[6:7], v[6:7], v[144:145] op_sel:[0,1] op_sel_hi:[1,1]
    v_pk_mul_f32 v[8:9], v[8:9], v[144:145] op_sel:[0,1] op_sel_hi:[1,1]
    v_pk_mul_f32 v[10:11], v[10:11], v[144:145] op_sel:[0,1] op_sel_hi:[1,1]
    v_pk_mul_f32 v[12:13], v[12:13], v[144:145] op_sel:[0,1] op_sel_hi:[1,1]
    v_pk_mul_f32 v[14:15], v[14:15], v[144:145] op_sel:[0,1] op_sel_hi:[1,1]
    v_cvt_pk_bf16_f32 v64, v0, v1
    v_cvt_pk_bf16_f32 v65, v2, v3
    v_cvt_pk_bf16_f32 v66, v4, v5
    v_cvt_pk_bf16_f32 v67, v6, v7
    v_cvt_pk_bf16_f32 v68, v8, v9
    v_cvt_pk_bf16_f32 v69, v10, v11
    v_cvt_pk_bf16_f32 v70, v12, v13
    v_cvt_pk_bf16_f32 v71, v14, v15
    global_store_dwordx4 v151, v[64:67], s[40:41] offset:-4096 sc1
    global_store_dwordx4 v151, v[68:71], s[40:41] offset:-3072 sc1
    v_dot2_f32_bf16 v0, v72, s90, v144
    v_dot2_f32_bf16 v1, v72, s91, v144
    v_dot2_f32_bf16 v2, v73, s90, v144
    v_dot2_f32_bf16 v3, v73, s91, v144
    v_dot2_f32_bf16 v4, v74, s90, v144
    v_dot2_f32_bf16 v5, v74, s91, v144
    v_dot2_f32_bf16 v6, v75, s90, v144
    v_dot2_f32_bf16 v7, v75, s91, v144
    v_dot2_f32_bf16 v8, v76, s90, v144
    v_dot2_f32_bf16 v9, v76, s91, v144
    v_dot2_f32_bf16 v10, v77, s90, v144
    v_dot2_f32_bf16 v11, v77, s91, v144
    v_dot2_f32_bf16 v12, v78, s90, v144
    v_dot2_f32_bf16 v13, v78, s91, v144
    v_dot2_f32_bf16 v14, v79, s90, v144
    v_dot2_f32_bf16 v15, v79, s91, v144
    v_cvt_pk_bf16_f32 v72, v0, v1
    v_cvt_pk_bf16_f32 v73, v2, v3
    v_cvt_pk_bf16_f32 v74, v4, v5
    v_cvt_pk_bf16_f32 v75, v6, v7
    v_cvt_pk_bf16_f32 v76, v8, v9
    v_cvt_pk_bf16_f32 v77, v10, v11
    v_cvt_pk_bf16_f32 v78, v12, v13
    v_cvt_pk_bf16_f32 v79, v14, v15
    v_lshlrev_b32 v0, 16, v72
    v_and_b32 v1, 0xffff0000, v72
    v_lshlrev_b32 v2, 16, v73
    v_and_b32 v3, 0xffff0000, v73
    v_lshlrev_b32 v4, 16, v74
    v_and_b32 v5, 0xffff0000, v74
    v_lshlrev_b32 v6, 16, v75
    v_and_b32 v7, 0xffff0000, v75
    v_lshlrev_b32 v8, 16, v76
    v_and_b32 v9, 0xffff0000, v76
    v_lshlrev_b32 v10, 16, v77
    v_and_b32 v11, 0xffff0000, v77
    v_lshlrev_b32 v12, 16, v78
    v_and_b32 v13, 0xffff0000, v78
    v_lshlrev_b32 v14, 16, v79
    v_and_b32 v15, 0xffff0000, v79
    v_pk_mul_f32 v[0:1], v[0:1], v[144:145] op_sel:[0,1] op_sel_hi:[1,1]
    v_pk_mul_f32 v[2:3], v[2:3], v[144:145] op_sel:[0,1] op_sel_hi:[1,1]
    v_pk_mul_f32 v[4:5], v[4:5], v[144:145] op_sel:[0,1] op_sel_hi:[1,1]
    v_pk_mul_f32 v[6:7], v[6:7], v[144:145] op_sel:[0,1] op_sel_hi:[1,1]
    v_pk_mul_f32 v[8:9], v[8:9], v[144:145] op_sel:[0,1] op_sel_hi:[1,1]
    v_pk_mul_f32 v[10:11], v[10:11], v[144:145] op_sel:[0,1] op_sel_hi:[1,1]
    v_pk_mul_f32 v[12:13], v[12:13], v[144:145] op_sel:[0,1] op_sel_hi:[1,1]
    v_pk_mul_f32 v[14:15], v[14:15], v[144:145] op_sel:[0,1] op_sel_hi:[1,1]
    v_cvt_pk_bf16_f32 v72, v0, v1
    v_cvt_pk_bf16_f32 v73, v2, v3
    v_cvt_pk_bf16_f32 v74, v4, v5
    v_cvt_pk_bf16_f32 v75, v6, v7
    v_cvt_pk_bf16_f32 v76, v8, v9
    v_cvt_pk_bf16_f32 v77, v10, v11
    v_cvt_pk_bf16_f32 v78, v12, v13
    v_cvt_pk_bf16_f32 v79, v14, v15
    global_store_dwordx4 v151, v[72:75], s[40:41] offset:-2048 sc1
    global_store_dwordx4 v151, v[76:79], s[40:41] offset:-1024 sc1
    v_dot2_f32_bf16 v0, v80, s90, v144
    v_dot2_f32_bf16 v1, v80, s91, v144
    v_dot2_f32_bf16 v2, v81, s90, v144
    v_dot2_f32_bf16 v3, v81, s91, v144
    v_dot2_f32_bf16 v4, v82, s90, v144
    v_dot2_f32_bf16 v5, v82, s91, v144
    v_dot2_f32_bf16 v6, v83, s90, v144
    v_dot2_f32_bf16 v7, v83, s91, v144
    v_dot2_f32_bf16 v8, v84, s90, v144
    v_dot2_f32_bf16 v9, v84, s91, v144
    v_dot2_f32_bf16 v10, v85, s90, v144
    v_dot2_f32_bf16 v11, v85, s91, v144
    v_dot2_f32_bf16 v12, v86, s90, v144
    v_dot2_f32_bf16 v13, v86, s91, v144
    v_dot2_f32_bf16 v14, v87, s90, v144
    v_dot2_f32_bf16 v15, v87, s91, v144
    v_cvt_pk_bf16_f32 v80, v0, v1
    v_cvt_pk_bf16_f32 v81, v2, v3
    v_cvt_pk_bf16_f32 v82, v4, v5
    v_cvt_pk_bf16_f32 v83, v6, v7
    v_cvt_pk_bf16_f32 v84, v8, v9
    v_cvt_pk_bf16_f32 v85, v10, v11
    v_cvt_pk_bf16_f32 v86, v12, v13
    v_cvt_pk_bf16_f32 v87, v14, v15
    v_lshlrev_b32 v0, 16, v80
    v_and_b32 v1, 0xffff0000, v80
    v_lshlrev_b32 v2, 16, v81
    v_and_b32 v3, 0xffff0000, v81
    v_lshlrev_b32 v4, 16, v82
    v_and_b32 v5, 0xffff0000, v82
    v_lshlrev_b32 v6, 16, v83
    v_and_b32 v7, 0xffff0000, v83
    v_lshlrev_b32 v8, 16, v84
    v_and_b32 v9, 0xffff0000, v84
    v_lshlrev_b32 v10, 16, v85
    v_and_b32 v11, 0xffff0000, v85
    v_lshlrev_b32 v12, 16, v86
    v_and_b32 v13, 0xffff0000, v86
    v_lshlrev_b32 v14, 16, v87
    v_and_b32 v15, 0xffff0000, v87
    v_pk_mul_f32 v[0:1], v[0:1], v[144:145] op_sel:[0,1] op_sel_hi:[1,1]
    v_pk_mul_f32 v[2:3], v[2:3], v[144:145] op_sel:[0,1] op_sel_hi:[1,1]
    v_pk_mul_f32 v[4:5], v[4:5], v[144:145] op_sel:[0,1] op_sel_hi:[1,1]
    v_pk_mul_f32 v[6:7], v[6:7], v[144:145] op_sel:[0,1] op_sel_hi:[1,1]
    v_pk_mul_f32 v[8:9], v[8:9], v[144:145] op_sel:[0,1] op_sel_hi:[1,1]
    v_pk_mul_f32 v[10:11], v[10:11], v[144:145] op_sel:[0,1] op_sel_hi:[1,1]
    v_pk_mul_f32 v[12:13], v[12:13], v[144:145] op_sel:[0,1] op_sel_hi:[1,1]
    v_pk_mul_f32 v[14:15], v[14:15], v[144:145] op_sel:[0,1] op_sel_hi:[1,1]
    v_cvt_pk_bf16_f32 v80, v0, v1
    v_cvt_pk_bf16_f32 v81, v2, v3
    v_cvt_pk_bf16_f32 v82, v4, v5
    v_cvt_pk_bf16_f32 v83, v6, v7
    v_cvt_pk_bf16_f32 v84, v8, v9
    v_cvt_pk_bf16_f32 v85, v10, v11
    v_cvt_pk_bf16_f32 v86, v12, v13
    v_cvt_pk_bf16_f32 v87, v14, v15
    global_store_dwordx4 v151, v[80:83], s[40:41] offset:0 sc1
    global_store_dwordx4 v151, v[84:87], s[40:41] offset:1024 sc1
    v_dot2_f32_bf16 v0, v88, s90, v144
    v_dot2_f32_bf16 v1, v88, s91, v144
    v_dot2_f32_bf16 v2, v89, s90, v144
    v_dot2_f32_bf16 v3, v89, s91, v144
    v_dot2_f32_bf16 v4, v90, s90, v144
    v_dot2_f32_bf16 v5, v90, s91, v144
    v_dot2_f32_bf16 v6, v91, s90, v144
    v_dot2_f32_bf16 v7, v91, s91, v144
    v_dot2_f32_bf16 v8, v92, s90, v144
    v_dot2_f32_bf16 v9, v92, s91, v144
    v_dot2_f32_bf16 v10, v93, s90, v144
    v_dot2_f32_bf16 v11, v93, s91, v144
    v_dot2_f32_bf16 v12, v94, s90, v144
    v_dot2_f32_bf16 v13, v94, s91, v144
    v_dot2_f32_bf16 v14, v95, s90, v144
    v_dot2_f32_bf16 v15, v95, s91, v144
    v_cvt_pk_bf16_f32 v88, v0, v1
    v_cvt_pk_bf16_f32 v89, v2, v3
    v_cvt_pk_bf16_f32 v90, v4, v5
    v_cvt_pk_bf16_f32 v91, v6, v7
    v_cvt_pk_bf16_f32 v92, v8, v9
    v_cvt_pk_bf16_f32 v93, v10, v11
    v_cvt_pk_bf16_f32 v94, v12, v13
    v_cvt_pk_bf16_f32 v95, v14, v15
    v_lshlrev_b32 v0, 16, v88
    v_and_b32 v1, 0xffff0000, v88
    v_lshlrev_b32 v2, 16, v89
    v_and_b32 v3, 0xffff0000, v89
    v_lshlrev_b32 v4, 16, v90
    v_and_b32 v5, 0xffff0000, v90
    v_lshlrev_b32 v6, 16, v91
    v_and_b32 v7, 0xffff0000, v91
    v_lshlrev_b32 v8, 16, v92
    v_and_b32 v9, 0xffff0000, v92
    v_lshlrev_b32 v10, 16, v93
    v_and_b32 v11, 0xffff0000, v93
    v_lshlrev_b32 v12, 16, v94
    v_and_b32 v13, 0xffff0000, v94
    v_lshlrev_b32 v14, 16, v95
    v_and_b32 v15, 0xffff0000, v95
    v_pk_mul_f32 v[0:1], v[0:1], v[144:145] op_sel:[0,1] op_sel_hi:[1,1]
    v_pk_mul_f32 v[2:3], v[2:3], v[144:145] op_sel:[0,1] op_sel_hi:[1,1]
    v_pk_mul_f32 v[4:5], v[4:5], v[144:145] op_sel:[0,1] op_sel_hi:[1,1]
    v_pk_mul_f32 v[6:7], v[6:7], v[144:145] op_sel:[0,1] op_sel_hi:[1,1]
    v_pk_mul_f32 v[8:9], v[8:9], v[144:145] op_sel:[0,1] op_sel_hi:[1,1]
    v_pk_mul_f32 v[10:11], v[10:11], v[144:145] op_sel:[0,1] op_sel_hi:[1,1]
    v_pk_mul_f32 v[12:13], v[12:13], v[144:145] op_sel:[0,1] op_sel_hi:[1,1]
    v_pk_mul_f32 v[14:15], v[14:15], v[144:145] op_sel:[0,1] op_sel_hi:[1,1]
    v_cvt_pk_bf16_f32 v88, v0, v1
    v_cvt_pk_bf16_f32 v89, v2, v3
    v_cvt_pk_bf16_f32 v90, v4, v5
    v_cvt_pk_bf16_f32 v91, v6, v7
    v_cvt_pk_bf16_f32 v92, v8, v9
    v_cvt_pk_bf16_f32 v93, v10, v11
    v_cvt_pk_bf16_f32 v94, v12, v13
    v_cvt_pk_bf16_f32 v95, v14, v15
    global_store_dwordx4 v151, v[88:91], s[40:41] offset:2048 sc1
    global_store_dwordx4 v151, v[92:95], s[40:41] offset:3072 sc1
    s_cmp_lg_u32 s31, 0
    s_cbranch_scc1 L_l0_init_ok
    v_mov_b32 v148, 12
L_l0_init:
    global_load_dword v149, v148, s[26:27] sc1
    s_waitcnt vmcnt(0)
    v_readfirstlane_b32 s80, v149
    s_cmp_ge_u32 s80, 32
    s_cbranch_scc1 L_l0_init_ok
    s_sleep 4
    s_sub_u32 s62, s62, 1
    s_cbranch_scc0 L_l0_init
    s_movk_i32 s63, 10
    s_branch L_fail_far
L_l0_init_ok:
    s_lshl_b32 s81, s37, 5
    s_add_u32 s81, s81, s30
    s_lshl_b32 s81, s81, 7
    s_add_u32 s81, s81, 0x1c000
    s_add_u32 s38, s28, s81
    s_addc_u32 s39, s29, 0
    s_mov_b32 s81, 1
    v_mov_b32 v148, 0
    s_waitcnt vmcnt(0)
    s_barrier
    s_cmp_lg_u32 s31, 0
    s_cbranch_scc1 L_l0_na
    v_mov_b32 v149, s81
    s_mov_b64 exec, 1
    global_store_dword v148, v149, s[38:39] sc1
    s_mov_b64 exec, -1
L_l0_na:
    s_cmp_lg_u32 s31, 0
    s_cbranch_scc1 L_l0_init2_ok
    v_mov_b32 v148, 64
L_l0_init2:
    global_load_dword v149, v148, s[26:27] sc1
    s_waitcnt vmcnt(0)
    v_readfirstlane_b32 s80, v149
    s_cmp_ge_u32 s80, 32
    s_cbranch_scc1 L_l0_init2_ok
    s_sleep 4
    s_sub_u32 s62, s62, 1
    s_cbranch_scc0 L_l0_init2
    s_movk_i32 s63, 10
    s_branch L_fail_far
L_l0_init2_ok:
    s_mov_b32 s60, 0
    s_branch L_attn
L_gemm0:
    v_mov_b32 v1, 0x0
    v_bfe_u32 v2, v255, 0, 1
    v_lshl_add_u32 v1, v2, 7, v1
    v_bfe_u32 v2, v255, 1, 7
    v_mul_u32_u24 v2, 0xc00, v2
    v_add_u32 v1, v1, v2
    s_and_b32 s80, s33, 3
    s_mul_i32 s80, s80, 393216
    s_lshl_b32 s81, s32, 8
    s_add_u32 s80, s80, s81
    v_add_u32 v1, s80, v1
    global_load_dword v254, v1, s[6:7]
    s_lshl_b32 s80, s32, 8
    s_add_u32 s70, s6, s80
    s_addc_u32 s71, s7, 0
    v_mov_b32 v161, 0x0
    v_bfe_u32 v160, v255, 4, 2
    v_mul_u32_u24 v160, 0xc00, v160
    v_add_u32 v161, v161, v160
    v_bfe_u32 v160, v255, 6, 2
    v_mul_u32_u24 v160, 0x18000, v160
    v_add_u32 v161, v161, v160
    v_mov_b32 v162, 0x0
    v_bfe_i32 v160, v255, 0, 1
    v_and_b32 v160, 0x10, v160
    v_xor_b32 v162, v162, v160
    v_bfe_i32 v160, v255, 1, 1
    v_and_b32 v160, 0x20, v160
    v_xor_b32 v162, v162, v160
    v_bfe_i32 v160, v255, 2, 1
    v_and_b32 v160, 0x40, v160
    v_xor_b32 v162, v162, v160
    v_bfe_i32 v160, v255, 3, 1
    v_and_b32 v160, 0x80, v160
    v_xor_b32 v162, v162, v160
    v_bfe_i32 v160, v255, 4, 1
    v_and_b32 v160, 0x40, v160
    v_xor_b32 v162, v162, v160
    v_bfe_i32 v160, v255, 5, 1
    v_and_b32 v160, 0x80, v160
    v_xor_b32 v162, v162, v160
    v_add_u32 v161, v161, v162
    v_mov_b32 v162, 0x3000
    v_bfe_u32 v160, v255, 4, 2
    v_mul_u32_u24 v160, 0xc00, v160
    v_add_u32 v162, v162, v160
    v_bfe_u32 v160, v255, 6, 2
    v_mul_u32_u24 v160, 0x18000, v160
    v_add_u32 v162, v162, v160
    v_mov_b32 v163, 0x0
    v_bfe_i32 v160, v255, 0, 1
    v_and_b32 v160, 0x10, v160
    v_xor_b32 v163, v163, v160
    v_bfe_i32 v160, v255, 1, 1
    v_and_b32 v160, 0x20, v160
    v_xor_b32 v163, v163, v160
    v_bfe_i32 v160, v255, 2, 1
    v_and_b32 v160, 0x40, v160
    v_xor_b32 v163, v163, v160
    v_bfe_i32 v160, v255, 3, 1
    v_and_b32 v160, 0x80, v160
    v_xor_b32 v163, v163, v160
    v_bfe_i32 v160, v255, 4, 1
    v_and_b32 v160, 0x40, v160
    v_xor_b32 v163, v163, v160
    v_bfe_i32 v160, v255, 5, 1
    v_and_b32 v160, 0x80, v160
    v_xor_b32 v163, v163, v160
    v_add_u32 v162, v162, v163
    v_mov_b32 v163, 0x6000
    v_bfe_u32 v160, v255, 4, 2
    v_mul_u32_u24 v160, 0xc00, v160
    v_add_u32 v163, v163, v160
    v_bfe_u32 v160, v255, 6, 2
    v_mul_u32_u24 v160, 0x18000, v160
    v_add_u32 v163, v163, v160
    v_mov_b32 v164, 0x0
    v_bfe_i32 v160, v255, 0, 1
    v_and_b32 v160, 0x10, v160
    v_xor_b32 v164, v164, v160
    v_bfe_i32 v160, v255, 1, 1
    v_and_b32 v160, 0x20, v160
    v_xor_b32 v164, v164, v160
    v_bfe_i32 v160, v255, 2, 1
    v_and_b32 v160, 0x40, v160
    v_xor_b32 v164, v164, v160
    v_bfe_i32 v160, v255, 3, 1
    v_and_b32 v160, 0x80, v160
    v_xor_b32 v164, v164, v160
    v_bfe_i32 v160, v255, 4, 1
    v_and_b32 v160, 0x40, v160
    v_xor_b32 v164, v164, v160
    v_bfe_i32 v160, v255, 5, 1
    v_and_b32 v160, 0x80, v160
    v_xor_b32 v164, v164, v160
    v_add_u32 v163, v163, v164
    v_mov_b32 v164, 0x9000
    v_bfe_u32 v160, v255, 4, 2
    v_mul_u32_u24 v160, 0xc00, v160
    v_add_u32 v164, v164, v160
    v_bfe_u32 v160, v255, 6, 2
    v_mul_u32_u24 v160, 0x18000, v160
    v_add_u32 v164, v164, v160
    v_mov_b32 v165, 0x0
    v_bfe_i32 v160, v255, 0, 1
    v_and_b32 v160, 0x10, v160
    v_xor_b32 v165, v165, v160
    v_bfe_i32 v160, v255, 1, 1
    v_and_b32 v160, 0x20, v160
    v_xor_b32 v165, v165, v160
    v_bfe_i32 v160, v255, 2, 1
    v_and_b32 v160, 0x40, v160
    v_xor_b32 v165, v165, v160
    v_bfe_i32 v160, v255, 3, 1
    v_and_b32 v160, 0x80, v160
    v_xor_b32 v165, v165, v160
    v_bfe_i32 v160, v255, 4, 1
    v_and_b32 v160, 0x40, v160
    v_xor_b32 v165, v165, v160
    v_bfe_i32 v160, v255, 5, 1
    v_and_b32 v160, 0x80, v160
    v_xor_b32 v165, v165, v160
    v_add_u32 v164, v164, v165
    v_mov_b32 v165, 0xc000
    v_bfe_u32 v160, v255, 4, 2
    v_mul_u32_u24 v160, 0xc00, v160
    v_add_u32 v165, v165, v160
    v_bfe_u32 v160, v255, 6, 2
    v_mul_u32_u24 v160, 0x18000, v160
    v_add_u32 v165, v165, v160
    v_mov_b32 v166, 0x0
    v_bfe_i32 v160, v255, 0, 1
    v_and_b32 v160, 0x10, v160
    v_xor_b32 v166, v166, v160
    v_bfe_i32 v160, v255, 1, 1
    v_and_b32 v160, 0x20, v160
    v_xor_b32 v166, v166, v160
    v_bfe_i32 v160, v255, 2, 1
    v_and_b32 v160, 0x40, v160
    v_xor_b32 v166, v166, v160
    v_bfe_i32 v160, v255, 3, 1
    v_and_b32 v160, 0x80, v160
    v_xor_b32 v166, v166, v160
    v_bfe_i32 v160, v255, 4, 1
    v_and_b32 v160, 0x40, v160
    v_xor_b32 v166, v166, v160
    v_bfe_i32 v160, v255, 5, 1
    v_and_b32 v160, 0x80, v160
    v_xor_b32 v166, v166, v160
    v_add_u32 v165, v165, v166
    v_mov_b32 v166, 0xf000
    v_bfe_u32 v160, v255, 4, 2
    v_mul_u32_u24 v160, 0xc00, v160
    v_add_u32 v166, v166, v160
    v_bfe_u32 v160, v255, 6, 2
    v_mul_u32_u24 v160, 0x18000, v160
    v_add_u32 v166, v166, v160
    v_mov_b32 v167, 0x0
    v_bfe_i32 v160, v255, 0, 1
    v_and_b32 v160, 0x10, v160
    v_xor_b32 v167, v167, v160
    v_bfe_i32 v160, v255, 1, 1
    v_and_b32 v160, 0x20, v160
    v_xor_b32 v167, v167, v160
    v_bfe_i32 v160, v255, 2, 1
    v_and_b32 v160, 0x40, v160
    v_xor_b32 v167, v167, v160
    v_bfe_i32 v160, v255, 3, 1
    v_and_b32 v160, 0x80, v160
    v_xor_b32 v167, v167, v160
    v_bfe_i32 v160, v255, 4, 1
    v_and_b32 v160, 0x40, v160
    v_xor_b32 v167, v167, v160
    v_bfe_i32 v160, v255, 5, 1
    v_and_b32 v160, 0x80, v160
    v_xor_b32 v167, v167, v160
    v_add_u32 v166, v166, v167
    v_mov_b32 v167, 0x12000
    v_bfe_u32 v160, v255, 4, 2
    v_mul_u32_u24 v160, 0xc00, v160
    v_add_u32 v167, v167, v160
    v_bfe_u32 v160, v255, 6, 2
    v_mul_u32_u24 v160, 0x18000, v160
    v_add_u32 v167, v167, v160
    v_mov_b32 v168, 0x0
    v_bfe_i32 v160, v255, 0, 1
    v_and_b32 v160, 0x10, v160
    v_xor_b32 v168, v168, v160
    v_bfe_i32 v160, v255, 1, 1
    v_and_b32 v160, 0x20, v160
    v_xor_b32 v168, v168, v160
    v_bfe_i32 v160, v255, 2, 1
    v_and_b32 v160, 0x40, v160
    v_xor_b32 v168, v168, v160
    v_bfe_i32 v160, v255, 3, 1
    v_and_b32 v160, 0x80, v160
    v_xor_b32 v168, v168, v160
    v_bfe_i32 v160, v255, 4, 1
    v_and_b32 v160, 0x40, v160
    v_xor_b32 v168, v168, v160
    v_bfe_i32 v160, v255, 5, 1
    v_and_b32 v160, 0x80, v160
    v_xor_b32 v168, v168, v160
    v_add_u32 v167, v167, v168
    v_mov_b32 v168, 0x15000
    v_bfe_u32 v160, v255, 4, 2
    v_mul_u32_u24 v160, 0xc00, v160
    v_add_u32 v168, v168, v160
    v_bfe_u32 v160, v255, 6, 2
    v_mul_u32_u24 v160, 0x18000, v160
    v_add_u32 v168, v168, v160
    v_mov_b32 v169, 0x0
    v_bfe_i32 v160, v255, 0, 1
    v_and_b32 v160, 0x10, v160
    v_xor_b32 v169, v169, v160
    v_bfe_i32 v160, v255, 1, 1
    v_and_b32 v160, 0x20, v160
    v_xor_b32 v169, v169, v160
    v_bfe_i32 v160, v255, 2, 1
    v_and_b32 v160, 0x40, v160
    v_xor_b32 v169, v169, v160
    v_bfe_i32 v160, v255, 3, 1
    v_and_b32 v160, 0x80, v160
    v_xor_b32 v169, v169, v160
    v_bfe_i32 v160, v255, 4, 1
    v_and_b32 v160, 0x40, v160
    v_xor_b32 v169, v169, v160
    v_bfe_i32 v160, v255, 5, 1
    v_and_b32 v160, 0x80, v160
    v_xor_b32 v169, v169, v160
    v_add_u32 v168, v168, v169
    v_mov_b32 v170, 0x0
    v_bfe_i32 v160, v255, 0, 1
    v_and_b32 v160, 0x10, v160
    v_xor_b32 v170, v170, v160
    v_bfe_i32 v160, v255, 1, 1
    v_and_b32 v160, 0x8, v160
    v_xor_b32 v170, v170, v160
    v_bfe_i32 v160, v255, 2, 1
    v_and_b32 v160, 0x140, v160
    v_xor_b32 v170, v170, v160
    v_bfe_i32 v160, v255, 3, 1
    v_and_b32 v160, 0x280, v160
    v_xor_b32 v170, v170, v160
    v_bfe_i32 v160, v255, 4, 1
    v_and_b32 v160, 0x20, v160
    v_xor_b32 v170, v170, v160
    v_bfe_i32 v160, v255, 5, 1
    v_and_b32 v160, 0x800, v160
    v_xor_b32 v170, v170, v160
    v_bfe_i32 v160, v255, 6, 1
    v_and_b32 v160, 0x40, v160
    v_xor_b32 v170, v170, v160
    v_bfe_i32 v160, v255, 7, 1
    v_and_b32 v160, 0x80, v160
    v_xor_b32 v170, v170, v160
    s_lshl_b32 s64, s31, 13
    s_add_u32 s66, s70, 0x0
    s_addc_u32 s67, s71, 0
    s_add_u32 m0, s64, 0x0
    s_nop 0
    global_load_lds_dwordx4 v161, s[66:67]
    s_add_u32 m0, s64, 0x400
    s_nop 0
    global_load_lds_dwordx4 v162, s[66:67]
    s_add_u32 m0, s64, 0x800
    s_nop 0
    global_load_lds_dwordx4 v163, s[66:67]
    s_add_u32 m0, s64, 0xc00
    s_nop 0
    global_load_lds_dwordx4 v164, s[66:67]
    s_add_u32 m0, s64, 0x1000
    s_nop 0
    global_load_lds_dwordx4 v165, s[66:67]
    s_add_u32 m0, s64, 0x1400
    s_nop 0
    global_load_lds_dwordx4 v166, s[66:67]
    s_add_u32 m0, s64, 0x1800
    s_nop 0
    global_load_lds_dwordx4 v167, s[66:67]
    s_add_u32 m0, s64, 0x1c00
    s_nop 0
    global_load_lds_dwordx4 v168, s[66:67]
    s_add_u32 s66, s70, 0x60000
    s_addc_u32 s67, s71, 0
    s_add_u32 m0, s64, 0x8000
    s_nop 0
    global_load_lds_dwordx4 v161, s[66:67]
    s_add_u32 m0, s64, 0x8400
    s_nop 0
    global_load_lds_dwordx4 v162, s[66:67]
    s_add_u32 m0, s64, 0x8800
    s_nop 0
    global_load_lds_dwordx4 v163, s[66:67]
    s_add_u32 m0, s64, 0x8c00
    s_nop 0
    global_load_lds_dwordx4 v164, s[66:67]
    s_add_u32 m0, s64, 0x9000
    s_nop 0
    global_load_lds_dwordx4 v165, s[66:67]
    s_add_u32 m0, s64, 0x9400
    s_nop 0
    global_load_lds_dwordx4 v166, s[66:67]
    s_add_u32 m0, s64, 0x9800
    s_nop 0
    global_load_lds_dwordx4 v167, s[66:67]
    s_add_u32 m0, s64, 0x9c00
    s_nop 0
    global_load_lds_dwordx4 v168, s[66:67]
    s_add_u32 s66, s70, 0xc0000
    s_addc_u32 s67, s71, 0
    s_add_u32 m0, s64, 0x10000
    s_nop 0
    global_load_lds_dwordx4 v161, s[66:67]
    s_add_u32 m0, s64, 0x10400
    s_nop 0
    global_load_lds_dwordx4 v162, s[66:67]
    s_add_u32 m0, s64, 0x10800
    s_nop 0
    global_load_lds_dwordx4 v163, s[66:67]
    s_add_u32 m0, s64, 0x10c00
    s_nop 0
    global_load_lds_dwordx4 v164, s[66:67]
    s_add_u32 m0, s64, 0x11000
    s_nop 0
    global_load_lds_dwordx4 v165, s[66:67]
    s_add_u32 m0, s64, 0x11400
    s_nop 0
    global_load_lds_dwordx4 v166, s[66:67]
    s_add_u32 m0, s64, 0x11800
    s_nop 0
    global_load_lds_dwordx4 v167, s[66:67]
    s_add_u32 m0, s64, 0x11c00
    s_nop 0
    global_load_lds_dwordx4 v168, s[66:67]
    s_add_u32 s66, s70, 0x120000
    s_addc_u32 s67, s71, 0
    s_add_u32 m0, s64, 0x18000
    s_nop 0
    global_load_lds_dwordx4 v161, s[66:67]
    s_add_u32 m0, s64, 0x18400
    s_nop 0
    global_load_lds_dwordx4 v162, s[66:67]
    s_add_u32 m0, s64, 0x18800
    s_nop 0
    global_load_lds_dwordx4 v163, s[66:67]
    s_add_u32 m0, s64, 0x18c00
    s_nop 0
    global_load_lds_dwordx4 v164, s[66:67]
    s_add_u32 m0, s64, 0x19000
    s_nop 0
    global_load_lds_dwordx4 v165, s[66:67]
    s_add_u32 m0, s64, 0x19400
    s_nop 0
    global_load_lds_dwordx4 v166, s[66:67]
    s_add_u32 m0, s64, 0x19800
    s_nop 0
    global_load_lds_dwordx4 v167, s[66:67]
    s_add_u32 m0, s64, 0x19c00
    s_nop 0
    global_load_lds_dwordx4 v168, s[66:67]
    s_waitcnt vmcnt(24)
    s_barrier
    v_add_u32 v186, 0x0, v170
    ds_read_b64_tr_b16 a[0:1], v186 offset:0
    ds_read_b64_tr_b16 a[2:3], v186 offset:1024
    ds_read_b64_tr_b16 a[4:5], v186 offset:4096
    ds_read_b64_tr_b16 a[6:7], v186 offset:5120
    ds_read_b64_tr_b16 a[8:9], v186 offset:8192
    ds_read_b64_tr_b16 a[10:11], v186 offset:9216
    ds_read_b64_tr_b16 a[12:13], v186 offset:12288
    ds_read_b64_tr_b16 a[14:15], v186 offset:13312
    ds_read_b64_tr_b16 a[16:17], v186 offset:16384
    ds_read_b64_tr_b16 a[18:19], v186 offset:17408
    ds_read_b64_tr_b16 a[20:21], v186 offset:20480
    ds_read_b64_tr_b16 a[22:23], v186 offset:21504
    ds_read_b64_tr_b16 a[24:25], v186 offset:24576
    ds_read_b64_tr_b16 a[26:27], v186 offset:25600
    ds_read_b64_tr_b16 a[28:29], v186 offset:28672
    ds_read_b64_tr_b16 a[30:31], v186 offset:29696
L_lw_25:
    s_waitcnt lgkmcnt(0)
    s_waitcnt vmcnt(16)
    s_barrier
    v_add_u32 v186, 0x8000, v170
    ds_read_b64_tr_b16 a[32:33], v186 offset:0
    ds_read_b64_tr_b16 a[34:35], v186 offset:1024
    ds_read_b64_tr_b16 a[36:37], v186 offset:4096
    ds_read_b64_tr_b16 a[38:39], v186 offset:5120
    ds_read_b64_tr_b16 a[40:41], v186 offset:8192
    ds_read_b64_tr_b16 a[42:43], v186 offset:9216
    ds_read_b64_tr_b16 a[44:45], v186 offset:12288
    ds_read_b64_tr_b16 a[46:47], v186 offset:13312
    ds_read_b64_tr_b16 a[48:49], v186 offset:16384
    ds_read_b64_tr_b16 a[50:51], v186 offset:17408
    ds_read_b64_tr_b16 a[52:53], v186 offset:20480
    ds_read_b64_tr_b16 a[54:55], v186 offset:21504
    ds_read_b64_tr_b16 a[56:57], v186 offset:24576
    ds_read_b64_tr_b16 a[58:59], v186 offset:25600
    ds_read_b64_tr_b16 a[60:61], v186 offset:28672
    ds_read_b64_tr_b16 a[62:63], v186 offset:29696
L_lw_26:
    s_waitcnt lgkmcnt(0)
    s_waitcnt vmcnt(8)
    s_barrier
    v_add_u32 v186, 0x10000, v170
    ds_read_b64_tr_b16 a[64:65], v186 offset:0
    ds_read_b64_tr_b16 a[66:67], v186 offset:1024
    ds_read_b64_tr_b16 a[68:69], v186 offset:4096
    ds_read_b64_tr_b16 a[70:71], v186 offset:5120
    ds_read_b64_tr_b16 a[72:73], v186 offset:8192
    ds_read_b64_tr_b16 a[74:75], v186 offset:9216
    ds_read_b64_tr_b16 a[76:77], v186 offset:12288
    ds_read_b64_tr_b16 a[78:79], v186 offset:13312
    ds_read_b64_tr_b16 a[80:81], v186 offset:16384
    ds_read_b64_tr_b16 a[82:83], v186 offset:17408
    ds_read_b64_tr_b16 a[84:85], v186 offset:20480
    ds_read_b64_tr_b16 a[86:87], v186 offset:21504
    ds_read_b64_tr_b16 a[88:89], v186 offset:24576
    ds_read_b64_tr_b16 a[90:91], v186 offset:25600
    ds_read_b64_tr_b16 a[92:93], v186 offset:28672
    ds_read_b64_tr_b16 a[94:95], v186 offset:29696
L_lw_27:
    s_waitcnt lgkmcnt(0)
    s_waitcnt vmcnt(0)
    s_barrier
    v_add_u32 v186, 0x18000, v170
    ds_read_b64_tr_b16 a[96:97], v186 offset:0
    ds_read_b64_tr_b16 a[98:99], v186 offset:1024
    ds_read_b64_tr_b16 a[100:101], v186 offset:4096
    ds_read_b64_tr_b16 a[102:103], v186 offset:5120
    ds_read_b64_tr_b16 a[104:105], v186 offset:8192
    ds_read_b64_tr_b16 a[106:107], v186 offset:9216
    ds_read_b64_tr_b16 a[108:109], v186 offset:12288
    ds_read_b64_tr_b16 a[110:111], v186 offset:13312
    ds_read_b64_tr_b16 a[112:113], v186 offset:16384
    ds_read_b64_tr_b16 a[114:115], v186 offset:17408
    ds_read_b64_tr_b16 a[116:117], v186 offset:20480
    ds_read_b64_tr_b16 a[118:119], v186 offset:21504
    ds_read_b64_tr_b16 a[120:121], v186 offset:24576
    ds_read_b64_tr_b16 a[122:123], v186 offset:25600
    ds_read_b64_tr_b16 a[124:125], v186 offset:28672
    ds_read_b64_tr_b16 a[126:127], v186 offset:29696
L_lw_28:
    s_waitcnt lgkmcnt(0)
    s_cmp_lt_u32 s32, 4
    s_cselect_b32 s50, 0x3eb8aa3b, 1.0
    s_mov_b32 s51, s50
    v_mov_b32 v150, 0x0
    v_bfe_u32 v160, v255, 0, 6
    v_lshl_add_u32 v150, v160, 4, v150
    v_mov_b32 v152, 0
    v_mov_b32 v153, 0x0101
    v_add_u32 v151, 0x10000, v150
    s_lshl_b32 s82, s33, 15
    s_lshr_b32 s84, s32, 2
    s_lshl_b32 s84, s84, 21
    s_add_u32 s84, s84, s82
    s_and_b32 s85, s32, 3
    s_lshl_b32 s85, s85, 2
    s_add_u32 s85, s85, s31
    s_lshl_b32 s85, s85, 11
    s_add_u32 s84, s84, s85
    s_add_u32 s84, s84, 0x300000
    s_add_u32 s42, s28, s84
    s_addc_u32 s43, s29, 0
    s_lshl_b32 s84, s32, 2
    s_add_u32 s84, s84, s31
    s_lshl_b32 s84, s84, 6
    s_add_u32 s84, s84, s33
    s_lshl_b32 s84, s84, 2
    s_add_u32 s84, s84, 0x4000
    s_add_u32 s46, s28, s84
    s_addc_u32 s47, s29, 0
    s_lshl_b32 s54, s34, 15
    s_sub_u32 s53, s54, 4096
    s_lshl_b32 s55, s34, 2
    s_add_u32 s82, s82, 0xc800000
    s_and_b32 s83, s32, 7
    s_mul_i32 s83, s83, s54
    s_add_u32 s83, s83, s82
    v_lshl_add_u32 v154, v255, 7, s83
    s_lshl_b32 s52, s31, 13
    s_add_u32 s82, s82, s52
    s_add_u32 s38, s28, s82
    s_addc_u32 s39, s29, 0
    s_cmp_lg_u32 s31, 0
    s_cbranch_scc1 L_g0_init_ok
    v_mov_b32 v158, 12
L_g0_init:
    global_load_dword v159, v158, s[26:27] sc1
    s_waitcnt vmcnt(0)
    v_readfirstlane_b32 s80, v159
    s_cmp_ge_u32 s80, 32
    s_cbranch_scc1 L_g0_init_ok
    s_sleep 4
    s_sub_u32 s62, s62, 1
    s_cbranch_scc0 L_g0_init
    s_movk_i32 s63, 10
    s_branch L_fail_far
L_g0_init_ok:
    v_and_b32 v157, 15, v255
    v_mul_u32_u24 v157, s34, v157
    v_add_u32 v157, s33, v157
    v_and_b32 v157, 63, v157
    v_lshlrev_b32 v157, 7, v157
    s_add_u32 s40, s28, 0x1c000
    s_addc_u32 s41, s29, 0
    s_mov_b32 s81, 1
    s_cmp_lg_u32 s31, 0
    s_cbranch_scc1 L_g0_wy_ok
L_g0_wy:
    global_load_dword v158, v157, s[40:41] sc1
    s_waitcnt vmcnt(0)
    v_cmp_gt_u32 vcc, s81, v158
    s_cbranch_vccz L_g0_wy_ok
    s_sub_u32 s62, s62, 1
    s_cbranch_scc0 L_g0_wy
    s_movk_i32 s63, 18
    s_branch L_fail_far
L_g0_wy_ok:
    s_barrier
    s_add_u32 m0, s52, 0
    s_nop 0
    global_load_lds_dwordx4 v150, s[38:39] offset:0 sc1
    global_load_lds_dwordx4 v150, s[38:39] offset:1024 sc1
    global_load_lds_dwordx4 v150, s[38:39] offset:2048 sc1
    global_load_lds_dwordx4 v150, s[38:39] offset:3072 sc1
    s_add_u32 s38, s38, 4096
    s_addc_u32 s39, s39, 0
    s_add_u32 m0, s52, 4096
    s_nop 0
    global_load_lds_dwordx4 v150, s[38:39] offset:0 sc1
    global_load_lds_dwordx4 v150, s[38:39] offset:1024 sc1
    global_load_lds_dwordx4 v150, s[38:39] offset:2048 sc1
    global_load_lds_dwordx4 v150, s[38:39] offset:3072 sc1
    s_add_u32 s38, s38, s53
    s_addc_u32 s39, s39, 0
    global_load_dword v154, v154, s[28:29] sc1
L_g0_pass:
    s_add_u32 m0, s52, 32768
    s_nop 0
    global_load_lds_dwordx4 v150, s[38:39] offset:0 sc1
    global_load_lds_dwordx4 v150, s[38:39] offset:1024 sc1
    global_load_lds_dwordx4 v150, s[38:39] offset:2048 sc1
    global_load_lds_dwordx4 v150, s[38:39] offset:3072 sc1
    s_add_u32 s38, s38, 4096
    s_addc_u32 s39, s39, 0
    s_add_u32 m0, s52, 36864
    s_nop 0
    global_load_lds_dwordx4 v150, s[38:39] offset:0 sc1
    global_load_lds_dwordx4 v150, s[38:39] offset:1024 sc1
    global_load_lds_dwordx4 v150, s[38:39] offset:2048 sc1
    global_load_lds_dwordx4 v150, s[38:39] offset:3072 sc1
    s_add_u32 s38, s38, s53
    s_addc_u32 s39, s39, 0
    s_add_u32 m0, s52, 65536
    s_nop 0
    global_load_lds_dwordx4 v150, s[38:39] offset:0 sc1
    global_load_lds_dwordx4 v150, s[38:39] offset:1024 sc1
    global_load_lds_dwordx4 v150, s[38:39] offset:2048 sc1
    global_load_lds_dwordx4 v150, s[38:39] offset:3072 sc1
    s_add_u32 s38, s38, 4096
    s_addc_u32 s39, s39, 0
    s_add_u32 m0, s52, 69632
    s_nop 0
    global_load_lds_dwordx4 v150, s[38:39] offset:0 sc1
    global_load_lds_dwordx4 v150, s[38:39] offset:1024 sc1
    global_load_lds_dwordx4 v150, s[38:39] offset:2048 sc1
    global_load_lds_dwordx4 v150, s[38:39] offset:3072 sc1
    s_add_u32 s38, s38, s53
    s_addc_u32 s39, s39, 0
    s_cmp_ge_u32 s32, 8
    s_cbranch_scc1 L_g0_gv
    s_cmp_lt_u32 s32, 4
    s_cbranch_scc1 L_g0_gq
    s_waitcnt vmcnt(16)
    s_barrier
    ds_read_b128 v[32:35], v150 offset:0
    ds_read_b128 v[36:39], v150 offset:1024
    ds_read_b128 v[40:43], v150 offset:2048
    ds_read_b128 v[44:47], v150 offset:3072
    ds_read_b128 v[48:51], v150 offset:4096
    ds_read_b128 v[52:55], v150 offset:5120
    ds_read_b128 v[56:59], v150 offset:6144
    ds_read_b128 v[60:63], v150 offset:7168
    s_waitcnt lgkmcnt(6)
    v_mfma_f32_32x32x16_bf16 v[0:15], a[0:3], v[32:35], 0
    ds_read_b128 v[32:35], v150 offset:8192
    v_mfma_f32_32x32x16_bf16 v[0:15], a[4:7], v[36:39], v[0:15]
    ds_read_b128 v[36:39], v150 offset:9216
    s_waitcnt lgkmcnt(6)
    v_mfma_f32_32x32x16_bf16 v[0:15], a[8:11], v[40:43], v[0:15]
    ds_read_b128 v[40:43], v150 offset:10240
    v_mfma_f32_32x32x16_bf16 v[0:15], a[12:15], v[44:47], v[0:15]
    ds_read_b128 v[44:47], v150 offset:11264
    s_waitcnt lgkmcnt(6)
    v_mfma_f32_32x32x16_bf16 v[0:15], a[16:19], v[48:51], v[0:15]
    ds_read_b128 v[48:51], v150 offset:12288
    v_mfma_f32_32x32x16_bf16 v[0:15], a[20:23], v[52:55], v[0:15]
    ds_read_b128 v[52:55], v150 offset:13312
    s_waitcnt lgkmcnt(6)
    v_mfma_f32_32x32x16_bf16 v[0:15], a[24:27], v[56:59], v[0:15]
    ds_read_b128 v[56:59], v150 offset:14336
    v_mfma_f32_32x32x16_bf16 v[0:15], a[28:31], v[60:63], v[0:15]
    ds_read_b128 v[60:63], v150 offset:15360
    s_waitcnt lgkmcnt(6)
    v_mfma_f32_32x32x16_bf16 v[0:15], a[32:35], v[32:35], v[0:15]
    ds_read_b128 v[32:35], v150 offset:16384
    v_mfma_f32_32x32x16_bf16 v[0:15], a[36:39], v[36:39], v[0:15]
    ds_read_b128 v[36:39], v150 offset:17408
    s_waitcnt lgkmcnt(6)
    v_mfma_f32_32x32x16_bf16 v[0:15], a[40:43], v[40:43], v[0:15]
    ds_read_b128 v[40:43], v150 offset:18432
    v_mfma_f32_32x32x16_bf16 v[0:15], a[44:47], v[44:47], v[0:15]
    ds_read_b128 v[44:47], v150 offset:19456
    s_waitcnt lgkmcnt(6)
    v_mfma_f32_32x32x16_bf16 v[0:15], a[48:51], v[48:51], v[0:15]
    ds_read_b128 v[48:51], v150 offset:20480
    v_mfma_f32_32x32x16_bf16 v[0:15], a[52:55], v[52:55], v[0:15]
    ds_read_b128 v[52:55], v150 offset:21504
    s_waitcnt lgkmcnt(6)
    v_mfma_f32_32x32x16_bf16 v[0:15], a[56:59], v[56:59], v[0:15]
    ds_read_b128 v[56:59], v150 offset:22528
    v_mfma_f32_32x32x16_bf16 v[0:15], a[60:63], v[60:63], v[0:15]
    ds_read_b128 v[60:63], v150 offset:23552
    s_waitcnt lgkmcnt(6)
    v_mfma_f32_32x32x16_bf16 v[0:15], a[64:67], v[32:35], v[0:15]
    ds_read_b128 v[32:35], v150 offset:24576
    v_mfma_f32_32x32x16_bf16 v[0:15], a[68:71], v[36:39], v[0:15]
    ds_read_b128 v[36:39], v150 offset:25600
    s_waitcnt lgkmcnt(6)
    v_mfma_f32_32x32x16_bf16 v[0:15], a[72:75], v[40:43], v[0:15]
    ds_read_b128 v[40:43], v150 offset:26624
    v_mfma_f32_32x32x16_bf16 v[0:15], a[76:79], v[44:47], v[0:15]
    ds_read_b128 v[44:47], v150 offset:27648
    s_waitcnt vmcnt(8)
    s_barrier
    s_waitcnt lgkmcnt(6)
    v_mfma_f32_32x32x16_bf16 v[0:15], a[80:83], v[48:51], v[0:15]
    ds_read_b128 v[48:51], v150 offset:28672
    v_mfma_f32_32x32x16_bf16 v[0:15], a[84:87], v[52:55], v[0:15]
    ds_read_b128 v[52:55], v150 offset:29696
    s_add_u32 m0, s52, 98304
    s_waitcnt lgkmcnt(6)
    v_mfma_f32_32x32x16_bf16 v[0:15], a[88:91], v[56:59], v[0:15]
    ds_read_b128 v[56:59], v150 offset:30720
    global_load_lds_dwordx4 v150, s[38:39] offset:0 sc1
    v_mfma_f32_32x32x16_bf16 v[0:15], a[92:95], v[60:63], v[0:15]
    ds_read_b128 v[60:63], v150 offset:31744
    global_load_lds_dwordx4 v150, s[38:39] offset:1024 sc1
    s_waitcnt lgkmcnt(6)
    v_mfma_f32_32x32x16_bf16 v[0:15], a[96:99], v[32:35], v[0:15]
    ds_read_b128 v[32:35], v150 offset:32768
    global_load_lds_dwordx4 v150, s[38:39] offset:2048 sc1
    v_mfma_f32_32x32x16_bf16 v[0:15], a[100:103], v[36:39], v[0:15]
    ds_read_b128 v[36:39], v150 offset:33792
    global_load_lds_dwordx4 v150, s[38:39] offset:3072 sc1
    s_add_u32 s38, s38, 4096
    s_addc_u32 s39, s39, 0
    s_waitcnt lgkmcnt(6)
    v_mfma_f32_32x32x16_bf16 v[0:15], a[104:107], v[40:43], v[0:15]
    ds_read_b128 v[40:43], v150 offset:34816
    s_add_u32 m0, s52, 102400
    v_mfma_f32_32x32x16_bf16 v[0:15], a[108:111], v[44:47], v[0:15]
    ds_read_b128 v[44:47], v150 offset:35840
    global_load_lds_dwordx4 v150, s[38:39] offset:0 sc1
    s_waitcnt lgkmcnt(6)
    v_mfma_f32_32x32x16_bf16 v[0:15], a[112:115], v[48:51], v[0:15]
    ds_read_b128 v[48:51], v150 offset:36864
    global_load_lds_dwordx4 v150, s[38:39] offset:1024 sc1
    v_mfma_f32_32x32x16_bf16 v[0:15], a[116:119], v[52:55], v[0:15]
    ds_read_b128 v[52:55], v150 offset:37888
    global_load_lds_dwordx4 v150, s[38:39] offset:2048 sc1
    s_waitcnt lgkmcnt(6)
    v_mfma_f32_32x32x16_bf16 v[0:15], a[120:123], v[56:59], v[0:15]
    ds_read_b128 v[56:59], v150 offset:38912
    global_load_lds_dwordx4 v150, s[38:39] offset:3072 sc1
    s_add_u32 s38, s38, s53
    s_addc_u32 s39, s39, 0
    v_mfma_f32_32x32x16_bf16 v[0:15], a[124:127], v[60:63], v[0:15]
    ds_read_b128 v[60:63], v150 offset:39936
    s_waitcnt lgkmcnt(6)
    v_mfma_f32_32x32x16_bf16 v[16:31], a[0:3], v[32:35], 0
    ds_read_b128 v[32:35], v150 offset:40960
    v_mfma_f32_32x32x16_bf16 v[16:31], a[4:7], v[36:39], v[16:31]
    ds_read_b128 v[36:39], v150 offset:41984
    s_waitcnt lgkmcnt(6)
    v_mfma_f32_32x32x16_bf16 v[16:31], a[8:11], v[40:43], v[16:31]
    ds_read_b128 v[40:43], v150 offset:43008
    v_mfma_f32_32x32x16_bf16 v[16:31], a[12:15], v[44:47], v[16:31]
    ds_read_b128 v[44:47], v150 offset:44032
    s_waitcnt lgkmcnt(6)
    v_mfma_f32_32x32x16_bf16 v[16:31], a[16:19], v[48:51], v[16:31]
    ds_read_b128 v[48:51], v150 offset:45056
    v_mfma_f32_32x32x16_bf16 v[16:31], a[20:23], v[52:55], v[16:31]
    ds_read_b128 v[52:55], v150 offset:46080
    v_cvt_pk_bf16_f32 v64, v0, v1
    s_waitcnt lgkmcnt(6)
    v_mfma_f32_32x32x16_bf16 v[16:31], a[24:27], v[56:59], v[16:31]
    ds_read_b128 v[56:59], v150 offset:47104
    v_cvt_pk_bf16_f32 v65, v2, v3
    v_mfma_f32_32x32x16_bf16 v[16:31], a[28:31], v[60:63], v[16:31]
    ds_read_b128 v[60:63], v150 offset:48128
    v_cvt_pk_bf16_f32 v66, v4, v5
    s_waitcnt lgkmcnt(6)
    v_mfma_f32_32x32x16_bf16 v[16:31], a[32:35], v[32:35], v[16:31]
    ds_read_b128 v[32:35], v150 offset:49152
    v_cvt_pk_bf16_f32 v67, v6, v7
    v_mfma_f32_32x32x16_bf16 v[16:31], a[36:39], v[36:39], v[16:31]
    ds_read_b128 v[36:39], v150 offset:50176
    v_cvt_pk_bf16_f32 v68, v8, v9
    s_waitcnt lgkmcnt(6)
    v_mfma_f32_32x32x16_bf16 v[16:31], a[40:43], v[40:43], v[16:31]
    ds_read_b128 v[40:43], v150 offset:51200
    v_cvt_pk_bf16_f32 v69, v10, v11
    v_mfma_f32_32x32x16_bf16 v[16:31], a[44:47], v[44:47], v[16:31]
    ds_read_b128 v[44:47], v150 offset:52224
    v_cvt_pk_bf16_f32 v70, v12, v13
    s_waitcnt lgkmcnt(6)
    v_mfma_f32_32x32x16_bf16 v[16:31], a[48:51], v[48:51], v[16:31]
    ds_read_b128 v[48:51], v150 offset:53248
    v_cvt_pk_bf16_f32 v71, v14, v15
    v_mfma_f32_32x32x16_bf16 v[16:31], a[52:55], v[52:55], v[16:31]
    ds_read_b128 v[52:55], v150 offset:54272
    global_store_dwordx4 v150, v[64:67], s[42:43] offset:0 sc1
    s_waitcnt lgkmcnt(6)
    v_mfma_f32_32x32x16_bf16 v[16:31], a[56:59], v[56:59], v[16:31]
    ds_read_b128 v[56:59], v150 offset:55296
    global_store_dwordx4 v150, v[68:71], s[42:43] offset:1024 sc1
    v_mfma_f32_32x32x16_bf16 v[16:31], a[60:63], v[60:63], v[16:31]
    ds_read_b128 v[60:63], v150 offset:56320
    s_add_u32 s42, s42, s54
    s_waitcnt lgkmcnt(6)
    v_mfma_f32_32x32x16_bf16 v[16:31], a[64:67], v[32:35], v[16:31]
    ds_read_b128 v[32:35], v150 offset:57344
    s_addc_u32 s43, s43, 0
    v_mfma_f32_32x32x16_bf16 v[16:31], a[68:71], v[36:39], v[16:31]
    ds_read_b128 v[36:39], v150 offset:58368
    s_waitcnt lgkmcnt(6)
    v_mfma_f32_32x32x16_bf16 v[16:31], a[72:75], v[40:43], v[16:31]
    ds_read_b128 v[40:43], v150 offset:59392
    v_mfma_f32_32x32x16_bf16 v[16:31], a[76:79], v[44:47], v[16:31]
    ds_read_b128 v[44:47], v150 offset:60416
    s_waitcnt vmcnt(10)
    s_barrier
    s_waitcnt lgkmcnt(6)
    v_mfma_f32_32x32x16_bf16 v[16:31], a[80:83], v[48:51], v[16:31]
    ds_read_b128 v[48:51], v150 offset:61440
    v_mfma_f32_32x32x16_bf16 v[16:31], a[84:87], v[52:55], v[16:31]
    ds_read_b128 v[52:55], v150 offset:62464
    s_add_u32 m0, s52, 0
    s_waitcnt lgkmcnt(6)
    v_mfma_f32_32x32x16_bf16 v[16:31], a[88:91], v[56:59], v[16:31]
    ds_read_b128 v[56:59], v150 offset:63488
    global_load_lds_dwordx4 v150, s[38:39] offset:0 sc1
    v_mfma_f32_32x32x16_bf16 v[16:31], a[92:95], v[60:63], v[16:31]
    ds_read_b128 v[60:63], v150 offset:64512
    global_load_lds_dwordx4 v150, s[38:39] offset:1024 sc1
    s_waitcnt lgkmcnt(6)
    v_mfma_f32_32x32x16_bf16 v[16:31], a[96:99], v[32:35], v[16:31]
    ds_read_b128 v[32:35], v151 offset:0
    global_load_lds_dwordx4 v150, s[38:39] offset:2048 sc1
    v_mfma_f32_32x32x16_bf16 v[16:31], a[100:103], v[36:39], v[16:31]
    ds_read_b128 v[36:39], v151 offset:1024
    global_load_lds_dwordx4 v150, s[38:39] offset:3072 sc1
    s_add_u32 s38, s38, 4096
    s_addc_u32 s39, s39, 0
    s_waitcnt lgkmcnt(6)
    v_mfma_f32_32x32x16_bf16 v[16:31], a[104:107], v[40:43], v[16:31]
    ds_read_b128 v[40:43], v151 offset:2048
    s_add_u32 m0, s52, 4096
    v_mfma_f32_32x32x16_bf16 v[16:31], a[108:111], v[44:47], v[16:31]
    ds_read_b128 v[44:47], v151 offset:3072
    global_load_lds_dwordx4 v150, s[38:39] offset:0 sc1
    s_waitcnt lgkmcnt(6)
    v_mfma_f32_32x32x16_bf16 v[16:31], a[112:115], v[48:51], v[16:31]
    ds_read_b128 v[48:51], v151 offset:4096
    global_load_lds_dwordx4 v150, s[38:39] offset:1024 sc1
    v_mfma_f32_32x32x16_bf16 v[16:31], a[116:119], v[52:55], v[16:31]
    ds_read_b128 v[52:55], v151 offset:5120
    global_load_lds_dwordx4 v150, s[38:39] offset:2048 sc1
    s_waitcnt lgkmcnt(6)
    v_mfma_f32_32x32x16_bf16 v[16:31], a[120:123], v[56:59], v[16:31]
    ds_read_b128 v[56:59], v151 offset:6144
    global_load_lds_dwordx4 v150, s[38:39] offset:3072 sc1
    s_add_u32 s38, s38, s53
    s_addc_u32 s39, s39, 0
    v_mfma_f32_32x32x16_bf16 v[16:31], a[124:127], v[60:63], v[16:31]
    ds_read_b128 v[60:63], v151 offset:7168
    s_waitcnt lgkmcnt(6)
    v_mfma_f32_32x32x16_bf16 v[0:15], a[0:3], v[32:35], 0
    ds_read_b128 v[32:35], v151 offset:8192
    v_mfma_f32_32x32x16_bf16 v[0:15], a[4:7], v[36:39], v[0:15]
    ds_read_b128 v[36:39], v151 offset:9216
    s_waitcnt lgkmcnt(6)
    v_mfma_f32_32x32x16_bf16 v[0:15], a[8:11], v[40:43], v[0:15]
    ds_read_b128 v[40:43], v151 offset:10240
    v_mfma_f32_32x32x16_bf16 v[0:15], a[12:15], v[44:47], v[0:15]
    ds_read_b128 v[44:47], v151 offset:11264
    s_waitcnt lgkmcnt(6)
    v_mfma_f32_32x32x16_bf16 v[0:15], a[16:19], v[48:51], v[0:15]
    ds_read_b128 v[48:51], v151 offset:12288
    v_mfma_f32_32x32x16_bf16 v[0:15], a[20:23], v[52:55], v[0:15]
    ds_read_b128 v[52:55], v151 offset:13312
    v_cvt_pk_bf16_f32 v64, v16, v17
    s_waitcnt lgkmcnt(6)
    v_mfma_f32_32x32x16_bf16 v[0:15], a[24:27], v[56:59], v[0:15]
    ds_read_b128 v[56:59], v151 offset:14336
    v_cvt_pk_bf16_f32 v65, v18, v19
    v_mfma_f32_32x32x16_bf16 v[0:15], a[28:31], v[60:63], v[0:15]
    ds_read_b128 v[60:63], v151 offset:15360
    v_cvt_pk_bf16_f32 v66, v20, v21
    s_waitcnt lgkmcnt(6)
    v_mfma_f32_32x32x16_bf16 v[0:15], a[32:35], v[32:35], v[0:15]
    ds_read_b128 v[32:35], v151 offset:16384
    v_cvt_pk_bf16_f32 v67, v22, v23
    v_mfma_f32_32x32x16_bf16 v[0:15], a[36:39], v[36:39], v[0:15]
    ds_read_b128 v[36:39], v151 offset:17408
    v_cvt_pk_bf16_f32 v68, v24, v25
    s_waitcnt lgkmcnt(6)
    v_mfma_f32_32x32x16_bf16 v[0:15], a[40:43], v[40:43], v[0:15]
    ds_read_b128 v[40:43], v151 offset:18432
    v_cvt_pk_bf16_f32 v69, v26, v27
    v_mfma_f32_32x32x16_bf16 v[0:15], a[44:47], v[44:47], v[0:15]
    ds_read_b128 v[44:47], v151 offset:19456
    v_cvt_pk_bf16_f32 v70, v28, v29
    s_waitcnt lgkmcnt(6)
    v_mfma_f32_32x32x16_bf16 v[0:15], a[48:51], v[48:51], v[0:15]
    ds_read_b128 v[48:51], v151 offset:20480
    v_cvt_pk_bf16_f32 v71, v30, v31
    v_mfma_f32_32x32x16_bf16 v[0:15], a[52:55], v[52:55], v[0:15]
    ds_read_b128 v[52:55], v151 offset:21504
    global_store_dwordx4 v150, v[64:67], s[42:43] offset:0 sc1
    s_waitcnt lgkmcnt(6)
    v_mfma_f32_32x32x16_bf16 v[0:15], a[56:59], v[56:59], v[0:15]
    ds_read_b128 v[56:59], v151 offset:22528
    global_store_dwordx4 v150, v[68:71], s[42:43] offset:1024 sc1
    v_mfma_f32_32x32x16_bf16 v[0:15], a[60:63], v[60:63], v[0:15]
    ds_read_b128 v[60:63], v151 offset:23552
    s_add_u32 s42, s42, s54
    s_waitcnt lgkmcnt(6)
    v_mfma_f32_32x32x16_bf16 v[0:15], a[64:67], v[32:35], v[0:15]
    ds_read_b128 v[32:35], v151 offset:24576
    s_addc_u32 s43, s43, 0
    v_mfma_f32_32x32x16_bf16 v[0:15], a[68:71], v[36:39], v[0:15]
    ds_read_b128 v[36:39], v151 offset:25600
    s_waitcnt lgkmcnt(6)
    v_mfma_f32_32x32x16_bf16 v[0:15], a[72:75], v[40:43], v[0:15]
    ds_read_b128 v[40:43], v151 offset:26624
    v_mfma_f32_32x32x16_bf16 v[0:15], a[76:79], v[44:47], v[0:15]
    ds_read_b128 v[44:47], v151 offset:27648
    s_waitcnt vmcnt(10)
    s_barrier
    s_mov_b64 exec, 1
    global_store_dword v152, v153, s[46:47] sc1
    s_mov_b64 exec, -1
    s_add_u32 s46, s46, s55
    s_addc_u32 s47, s47, 0
    s_waitcnt lgkmcnt(6)
    v_mfma_f32_32x32x16_bf16 v[0:15], a[80:83], v[48:51], v[0:15]
    ds_read_b128 v[48:51], v151 offset:28672
    v_mfma_f32_32x32x16_bf16 v[0:15], a[84:87], v[52:55], v[0:15]
    ds_read_b128 v[52:55], v151 offset:29696
    s_add_u32 m0, s52, 32768
    s_waitcnt lgkmcnt(6)
    v_mfma_f32_32x32x16_bf16 v[0:15], a[88:91], v[56:59], v[0:15]
    ds_read_b128 v[56:59], v151 offset:30720
    global_load_lds_dwordx4 v150, s[38:39] offset:0 sc1
    v_mfma_f32_32x32x16_bf16 v[0:15], a[92:95], v[60:63], v[0:15]
    ds_read_b128 v[60:63], v151 offset:31744
    global_load_lds_dwordx4 v150, s[38:39] offset:1024 sc1
    s_waitcnt lgkmcnt(6)
    v_mfma_f32_32x32x16_bf16 v[0:15], a[96:99], v[32:35], v[0:15]
    ds_read_b128 v[32:35], v151 offset:32768
    global_load_lds_dwordx4 v150, s[38:39] offset:2048 sc1
    v_mfma_f32_32x32x16_bf16 v[0:15], a[100:103], v[36:39], v[0:15]
    ds_read_b128 v[36:39], v151 offset:33792
    global_load_lds_dwordx4 v150, s[38:39] offset:3072 sc1
    s_add_u32 s38, s38, 4096
    s_addc_u32 s39, s39, 0
    s_waitcnt lgkmcnt(6)
    v_mfma_f32_32x32x16_bf16 v[0:15], a[104:107], v[40:43], v[0:15]
    ds_read_b128 v[40:43], v151 offset:34816
    s_add_u32 m0, s52, 36864
    v_mfma_f32_32x32x16_bf16 v[0:15], a[108:111], v[44:47], v[0:15]
    ds_read_b128 v[44:47], v151 offset:35840
    global_load_lds_dwordx4 v150, s[38:39] offset:0 sc1
    s_waitcnt lgkmcnt(6)
    v_mfma_f32_32x32x16_bf16 v[0:15], a[112:115], v[48:51], v[0:15]
    ds_read_b128 v[48:51], v151 offset:36864
    global_load_lds_dwordx4 v150, s[38:39] offset:1024 sc1
    v_mfma_f32_32x32x16_bf16 v[0:15], a[116:119], v[52:55], v[0:15]
    ds_read_b128 v[52:55], v151 offset:37888
    global_load_lds_dwordx4 v150, s[38:39] offset:2048 sc1
    s_waitcnt lgkmcnt(6)
    v_mfma_f32_32x32x16_bf16 v[0:15], a[120:123], v[56:59], v[0:15]
    ds_read_b128 v[56:59], v151 offset:38912
    global_load_lds_dwordx4 v150, s[38:39] offset:3072 sc1
    s_add_u32 s38, s38, s53
    s_addc_u32 s39, s39, 0
    v_mfma_f32_32x32x16_bf16 v[0:15], a[124:127], v[60:63], v[0:15]
    ds_read_b128 v[60:63], v151 offset:39936
    s_waitcnt lgkmcnt(6)
    v_mfma_f32_32x32x16_bf16 v[16:31], a[0:3], v[32:35], 0
    ds_read_b128 v[32:35], v151 offset:40960
    v_mfma_f32_32x32x16_bf16 v[16:31], a[4:7], v[36:39], v[16:31]
    ds_read_b128 v[36:39], v151 offset:41984
    s_waitcnt lgkmcnt(6)
    v_mfma_f32_32x32x16_bf16 v[16:31], a[8:11], v[40:43], v[16:31]
    ds_read_b128 v[40:43], v151 offset:43008
    v_mfma_f32_32x32x16_bf16 v[16:31], a[12:15], v[44:47], v[16:31]
    ds_read_b128 v[44:47], v151 offset:44032
    s_waitcnt lgkmcnt(6)
    v_mfma_f32_32x32x16_bf16 v[16:31], a[16:19], v[48:51], v[16:31]
    ds_read_b128 v[48:51], v151 offset:45056
    v_mfma_f32_32x32x16_bf16 v[16:31], a[20:23], v[52:55], v[16:31]
    ds_read_b128 v[52:55], v151 offset:46080
    v_cvt_pk_bf16_f32 v64, v0, v1
    s_waitcnt lgkmcnt(6)
    v_mfma_f32_32x32x16_bf16 v[16:31], a[24:27], v[56:59], v[16:31]
    ds_read_b128 v[56:59], v151 offset:47104
    v_cvt_pk_bf16_f32 v65, v2, v3
    v_mfma_f32_32x32x16_bf16 v[16:31], a[28:31], v[60:63], v[16:31]
    ds_read_b128 v[60:63], v151 offset:48128
    v_cvt_pk_bf16_f32 v66, v4, v5
    s_waitcnt lgkmcnt(6)
    v_mfma_f32_32x32x16_bf16 v[16:31], a[32:35], v[32:35], v[16:31]
    ds_read_b128 v[32:35], v151 offset:49152
    v_cvt_pk_bf16_f32 v67, v6, v7
    v_mfma_f32_32x32x16_bf16 v[16:31], a[36:39], v[36:39], v[16:31]
    ds_read_b128 v[36:39], v151 offset:50176
    v_cvt_pk_bf16_f32 v68, v8, v9
    s_waitcnt lgkmcnt(6)
    v_mfma_f32_32x32x16_bf16 v[16:31], a[40:43], v[40:43], v[16:31]
    ds_read_b128 v[40:43], v151 offset:51200
    v_cvt_pk_bf16_f32 v69, v10, v11
    v_mfma_f32_32x32x16_bf16 v[16:31], a[44:47], v[44:47], v[16:31]
    ds_read_b128 v[44:47], v151 offset:52224
    v_cvt_pk_bf16_f32 v70, v12, v13
    s_waitcnt lgkmcnt(6)
    v_mfma_f32_32x32x16_bf16 v[16:31], a[48:51], v[48:51], v[16:31]
    ds_read_b128 v[48:51], v151 offset:53248
    v_cvt_pk_bf16_f32 v71, v14, v15
    v_mfma_f32_32x32x16_bf16 v[16:31], a[52:55], v[52:55], v[16:31]
    ds_read_b128 v[52:55], v151 offset:54272
    global_store_dwordx4 v150, v[64:67], s[42:43] offset:0 sc1
    s_waitcnt lgkmcnt(6)
    v_mfma_f32_32x32x16_bf16 v[16:31], a[56:59], v[56:59], v[16:31]
    ds_read_b128 v[56:59], v151 offset:55296
    global_store_dwordx4 v150, v[68:71], s[42:43] offset:1024 sc1
    v_mfma_f32_32x32x16_bf16 v[16:31], a[60:63], v[60:63], v[16:31]
    ds_read_b128 v[60:63], v151 offset:56320
    s_add_u32 s42, s42, s54
    s_waitcnt lgkmcnt(6)
    v_mfma_f32_32x32x16_bf16 v[16:31], a[64:67], v[32:35], v[16:31]
    ds_read_b128 v[32:35], v151 offset:57344
    s_addc_u32 s43, s43, 0
    v_mfma_f32_32x32x16_bf16 v[16:31], a[68:71], v[36:39], v[16:31]
    ds_read_b128 v[36:39], v151 offset:58368
    s_waitcnt lgkmcnt(6)
    v_mfma_f32_32x32x16_bf16 v[16:31], a[72:75], v[40:43], v[16:31]
    ds_read_b128 v[40:43], v151 offset:59392
    v_mfma_f32_32x32x16_bf16 v[16:31], a[76:79], v[44:47], v[16:31]
    ds_read_b128 v[44:47], v151 offset:60416
    s_waitcnt vmcnt(11)
    s_barrier
    s_mov_b64 exec, 1
    global_store_dword v152, v153, s[46:47] sc1
    s_mov_b64 exec, -1
    s_add_u32 s46, s46, s55
    s_addc_u32 s47, s47, 0
    s_waitcnt lgkmcnt(6)
    v_mfma_f32_32x32x16_bf16 v[16:31], a[80:83], v[48:51], v[16:31]
    ds_read_b128 v[48:51], v151 offset:61440
    v_mfma_f32_32x32x16_bf16 v[16:31], a[84:87], v[52:55], v[16:31]
    ds_read_b128 v[52:55], v151 offset:62464
    s_add_u32 m0, s52, 65536
    s_waitcnt lgkmcnt(6)
    v_mfma_f32_32x32x16_bf16 v[16:31], a[88:91], v[56:59], v[16:31]
    ds_read_b128 v[56:59], v151 offset:63488
    global_load_lds_dwordx4 v150, s[38:39] offset:0 sc1
    v_mfma_f32_32x32x16_bf16 v[16:31], a[92:95], v[60:63], v[16:31]
    ds_read_b128 v[60:63], v151 offset:64512
    global_load_lds_dwordx4 v150, s[38:39] offset:1024 sc1
    s_waitcnt lgkmcnt(6)
    v_mfma_f32_32x32x16_bf16 v[16:31], a[96:99], v[32:35], v[16:31]
    ds_read_b128 v[32:35], v150 offset:0
    global_load_lds_dwordx4 v150, s[38:39] offset:2048 sc1
    v_mfma_f32_32x32x16_bf16 v[16:31], a[100:103], v[36:39], v[16:31]
    ds_read_b128 v[36:39], v150 offset:1024
    global_load_lds_dwordx4 v150, s[38:39] offset:3072 sc1
    s_add_u32 s38, s38, 4096
    s_addc_u32 s39, s39, 0
    s_waitcnt lgkmcnt(6)
    v_mfma_f32_32x32x16_bf16 v[16:31], a[104:107], v[40:43], v[16:31]
    ds_read_b128 v[40:43], v150 offset:2048
    s_add_u32 m0, s52, 69632
    v_mfma_f32_32x32x16_bf16 v[16:31], a[108:111], v[44:47], v[16:31]
    ds_read_b128 v[44:47], v150 offset:3072
    global_load_lds_dwordx4 v150, s[38:39] offset:0 sc1
    s_waitcnt lgkmcnt(6)
    v_mfma_f32_32x32x16_bf16 v[16:31], a[112:115], v[48:51], v[16:31]
    ds_read_b128 v[48:51], v150 offset:4096
    global_load_lds_dwordx4 v150, s[38:39] offset:1024 sc1
    v_mfma_f32_32x32x16_bf16 v[16:31], a[116:119], v[52:55], v[16:31]
    ds_read_b128 v[52:55], v150 offset:5120
    global_load_lds_dwordx4 v150, s[38:39] offset:2048 sc1
    s_waitcnt lgkmcnt(6)
    v_mfma_f32_32x32x16_bf16 v[16:31], a[120:123], v[56:59], v[16:31]
    ds_read_b128 v[56:59], v150 offset:6144
    global_load_lds_dwordx4 v150, s[38:39] offset:3072 sc1
    s_add_u32 s38, s38, s53
    s_addc_u32 s39, s39, 0
    v_mfma_f32_32x32x16_bf16 v[16:31], a[124:127], v[60:63], v[16:31]
    ds_read_b128 v[60:63], v150 offset:7168
    s_waitcnt lgkmcnt(6)
    v_mfma_f32_32x32x16_bf16 v[0:15], a[0:3], v[32:35], 0
    ds_read_b128 v[32:35], v150 offset:8192
    v_mfma_f32_32x32x16_bf16 v[0:15], a[4:7], v[36:39], v[0:15]
    ds_read_b128 v[36:39], v150 offset:9216
    s_waitcnt lgkmcnt(6)
    v_mfma_f32_32x32x16_bf16 v[0:15], a[8:11], v[40:43], v[0:15]
    ds_read_b128 v[40:43], v150 offset:10240
    v_mfma_f32_32x32x16_bf16 v[0:15], a[12:15], v[44:47], v[0:15]
    ds_read_b128 v[44:47], v150 offset:11264
    s_waitcnt lgkmcnt(6)
    v_mfma_f32_32x32x16_bf16 v[0:15], a[16:19], v[48:51], v[0:15]
    ds_read_b128 v[48:51], v150 offset:12288
    v_mfma_f32_32x32x16_bf16 v[0:15], a[20:23], v[52:55], v[0:15]
    ds_read_b128 v[52:55], v150 offset:13312
    v_cvt_pk_bf16_f32 v64, v16, v17
    s_waitcnt lgkmcnt(6)
    v_mfma_f32_32x32x16_bf16 v[0:15], a[24:27], v[56:59], v[0:15]
    ds_read_b128 v[56:59], v150 offset:14336
    v_cvt_pk_bf16_f32 v65, v18, v19
    v_mfma_f32_32x32x16_bf16 v[0:15], a[28:31], v[60:63], v[0:15]
    ds_read_b128 v[60:63], v150 offset:15360
    v_cvt_pk_bf16_f32 v66, v20, v21
    s_waitcnt lgkmcnt(6)
    v_mfma_f32_32x32x16_bf16 v[0:15], a[32:35], v[32:35], v[0:15]
    ds_read_b128 v[32:35], v150 offset:16384
    v_cvt_pk_bf16_f32 v67, v22, v23
    v_mfma_f32_32x32x16_bf16 v[0:15], a[36:39], v[36:39], v[0:15]
    ds_read_b128 v[36:39], v150 offset:17408
    v_cvt_pk_bf16_f32 v68, v24, v25
    s_waitcnt lgkmcnt(6)
    v_mfma_f32_32x32x16_bf16 v[0:15], a[40:43], v[40:43], v[0:15]
    ds_read_b128 v[40:43], v150 offset:18432
    v_cvt_pk_bf16_f32 v69, v26, v27
    v_mfma_f32_32x32x16_bf16 v[0:15], a[44:47], v[44:47], v[0:15]
    ds_read_b128 v[44:47], v150 offset:19456
    v_cvt_pk_bf16_f32 v70, v28, v29
    s_waitcnt lgkmcnt(6)
    v_mfma_f32_32x32x16_bf16 v[0:15], a[48:51], v[48:51], v[0:15]
    ds_read_b128 v[48:51], v150 offset:20480
    v_cvt_pk_bf16_f32 v71, v30, v31
    v_mfma_f32_32x32x16_bf16 v[0:15], a[52:55], v[52:55], v[0:15]
    ds_read_b128 v[52:55], v150 offset:21504
    global_store_dwordx4 v150, v[64:67], s[42:43] offset:0 sc1
    s_waitcnt lgkmcnt(6)
    v_mfma_f32_32x32x16_bf16 v[0:15], a[56:59], v[56:59], v[0:15]
    ds_read_b128 v[56:59], v150 offset:22528
    global_store_dwordx4 v150, v[68:71], s[42:43] offset:1024 sc1
    v_mfma_f32_32x32x16_bf16 v[0:15], a[60:63], v[60:63], v[0:15]
    ds_read_b128 v[60:63], v150 offset:23552
    s_add_u32 s42, s42, s54
    s_waitcnt lgkmcnt(6)
    v_mfma_f32_32x32x16_bf16 v[0:15], a[64:67], v[32:35], v[0:15]
    ds_read_b128 v[32:35], v150 offset:24576
    s_addc_u32 s43, s43, 0
    v_mfma_f32_32x32x16_bf16 v[0:15], a[68:71], v[36:39], v[0:15]
    ds_read_b128 v[36:39], v150 offset:25600
    s_waitcnt lgkmcnt(6)
    v_mfma_f32_32x32x16_bf16 v[0:15], a[72:75], v[40:43], v[0:15]
    ds_read_b128 v[40:43], v150 offset:26624
    v_mfma_f32_32x32x16_bf16 v[0:15], a[76:79], v[44:47], v[0:15]
    ds_read_b128 v[44:47], v150 offset:27648
    s_waitcnt vmcnt(11)
    s_barrier
    s_mov_b64 exec, 1
    global_store_dword v152, v153, s[46:47] sc1
    s_mov_b64 exec, -1
    s_add_u32 s46, s46, s55
    s_addc_u32 s47, s47, 0
    s_waitcnt lgkmcnt(6)
    v_mfma_f32_32x32x16_bf16 v[0:15], a[80:83], v[48:51], v[0:15]
    ds_read_b128 v[48:51], v150 offset:28672
    v_mfma_f32_32x32x16_bf16 v[0:15], a[84:87], v[52:55], v[0:15]
    ds_read_b128 v[52:55], v150 offset:29696
    s_add_u32 m0, s52, 98304
    s_waitcnt lgkmcnt(6)
    v_mfma_f32_32x32x16_bf16 v[0:15], a[88:91], v[56:59], v[0:15]
    ds_read_b128 v[56:59], v150 offset:30720
    global_load_lds_dwordx4 v150, s[38:39] offset:0 sc1
    v_mfma_f32_32x32x16_bf16 v[0:15], a[92:95], v[60:63], v[0:15]
    ds_read_b128 v[60:63], v150 offset:31744
    global_load_lds_dwordx4 v150, s[38:39] offset:1024 sc1
    s_waitcnt lgkmcnt(6)
    v_mfma_f32_32x32x16_bf16 v[0:15], a[96:99], v[32:35], v[0:15]
    ds_read_b128 v[32:35], v150 offset:32768
    global_load_lds_dwordx4 v150, s[38:39] offset:2048 sc1
    v_mfma_f32_32x32x16_bf16 v[0:15], a[100:103], v[36:39], v[0:15]
    ds_read_b128 v[36:39], v150 offset:33792
    global_load_lds_dwordx4 v150, s[38:39] offset:3072 sc1
    s_add_u32 s38, s38, 4096
    s_addc_u32 s39, s39, 0
    s_waitcnt lgkmcnt(6)
    v_mfma_f32_32x32x16_bf16 v[0:15], a[104:107], v[40:43], v[0:15]
    ds_read_b128 v[40:43], v150 offset:34816
    s_add_u32 m0, s52, 102400
    v_mfma_f32_32x32x16_bf16 v[0:15], a[108:111], v[44:47], v[0:15]
    ds_read_b128 v[44:47], v150 offset:35840
    global_load_lds_dwordx4 v150, s[38:39] offset:0 sc1
    s_waitcnt lgkmcnt(6)
    v_mfma_f32_32x32x16_bf16 v[0:15], a[112:115], v[48:51], v[0:15]
    ds_read_b128 v[48:51], v150 offset:36864
    global_load_lds_dwordx4 v150, s[38:39] offset:1024 sc1
    v_mfma_f32_32x32x16_bf16 v[0:15], a[116:119], v[52:55], v[0:15]
    ds_read_b128 v[52:55], v150 offset:37888
    global_load_lds_dwordx4 v150, s[38:39] offset:2048 sc1
    s_waitcnt lgkmcnt(6)
    v_mfma_f32_32x32x16_bf16 v[0:15], a[120:123], v[56:59], v[0:15]
    ds_read_b128 v[56:59], v150 offset:38912
    global_load_lds_dwordx4 v150, s[38:39] offset:3072 sc1
    s_add_u32 s38, s38, s53
    s_addc_u32 s39, s39, 0
    v_mfma_f32_32x32x16_bf16 v[0:15], a[124:127], v[60:63], v[0:15]
    ds_read_b128 v[60:63], v150 offset:39936
    s_waitcnt lgkmcnt(6)
    v_mfma_f32_32x32x16_bf16 v[16:31], a[0:3], v[32:35], 0
    ds_read_b128 v[32:35], v150 offset:40960
    v_mfma_f32_32x32x16_bf16 v[16:31], a[4:7], v[36:39], v[16:31]
    ds_read_b128 v[36:39], v150 offset:41984
    s_waitcnt lgkmcnt(6)
    v_mfma_f32_32x32x16_bf16 v[16:31], a[8:11], v[40:43], v[16:31]
    ds_read_b128 v[40:43], v150 offset:43008
    v_mfma_f32_32x32x16_bf16 v[16:31], a[12:15], v[44:47], v[16:31]
    ds_read_b128 v[44:47], v150 offset:44032
    s_waitcnt lgkmcnt(6)
    v_mfma_f32_32x32x16_bf16 v[16:31], a[16:19], v[48:51], v[16:31]
    ds_read_b128 v[48:51], v150 offset:45056
    v_mfma_f32_32x32x16_bf16 v[16:31], a[20:23], v[52:55], v[16:31]
    ds_read_b128 v[52:55], v150 offset:46080
    v_cvt_pk_bf16_f32 v64, v0, v1
    s_waitcnt lgkmcnt(6)
    v_mfma_f32_32x32x16_bf16 v[16:31], a[24:27], v[56:59], v[16:31]
    ds_read_b128 v[56:59], v150 offset:47104
    v_cvt_pk_bf16_f32 v65, v2, v3
    v_mfma_f32_32x32x16_bf16 v[16:31], a[28:31], v[60:63], v[16:31]
    ds_read_b128 v[60:63], v150 offset:48128
    v_cvt_pk_bf16_f32 v66, v4, v5
    s_waitcnt lgkmcnt(6)
    v_mfma_f32_32x32x16_bf16 v[16:31], a[32:35], v[32:35], v[16:31]
    ds_read_b128 v[32:35], v150 offset:49152
    v_cvt_pk_bf16_f32 v67, v6, v7
    v_mfma_f32_32x32x16_bf16 v[16:31], a[36:39], v[36:39], v[16:31]
    ds_read_b128 v[36:39], v150 offset:50176
    v_cvt_pk_bf16_f32 v68, v8, v9
    s_waitcnt lgkmcnt(6)
    v_mfma_f32_32x32x16_bf16 v[16:31], a[40:43], v[40:43], v[16:31]
    ds_read_b128 v[40:43], v150 offset:51200
    v_cvt_pk_bf16_f32 v69, v10, v11
    v_mfma_f32_32x32x16_bf16 v[16:31], a[44:47], v[44:47], v[16:31]
    ds_read_b128 v[44:47], v150 offset:52224
    v_cvt_pk_bf16_f32 v70, v12, v13
    s_waitcnt lgkmcnt(6)
    v_mfma_f32_32x32x16_bf16 v[16:31], a[48:51], v[48:51], v[16:31]
    ds_read_b128 v[48:51], v150 offset:53248
    v_cvt_pk_bf16_f32 v71, v14, v15
    v_mfma_f32_32x32x16_bf16 v[16:31], a[52:55], v[52:55], v[16:31]
    ds_read_b128 v[52:55], v150 offset:54272
    global_store_dwordx4 v150, v[64:67], s[42:43] offset:0 sc1
    s_waitcnt lgkmcnt(6)
    v_mfma_f32_32x32x16_bf16 v[16:31], a[56:59], v[56:59], v[16:31]
    ds_read_b128 v[56:59], v150 offset:55296
    global_store_dwordx4 v150, v[68:71], s[42:43] offset:1024 sc1
    v_mfma_f32_32x32x16_bf16 v[16:31], a[60:63], v[60:63], v[16:31]
    ds_read_b128 v[60:63], v150 offset:56320
    s_add_u32 s42, s42, s54
    s_waitcnt lgkmcnt(6)
    v_mfma_f32_32x32x16_bf16 v[16:31], a[64:67], v[32:35], v[16:31]
    ds_read_b128 v[32:35], v150 offset:57344
    s_addc_u32 s43, s43, 0
    v_mfma_f32_32x32x16_bf16 v[16:31], a[68:71], v[36:39], v[16:31]
    ds_read_b128 v[36:39], v150 offset:58368
    s_waitcnt lgkmcnt(6)
    v_mfma_f32_32x32x16_bf16 v[16:31], a[72:75], v[40:43], v[16:31]
    ds_read_b128 v[40:43], v150 offset:59392
    v_mfma_f32_32x32x16_bf16 v[16:31], a[76:79], v[44:47], v[16:31]
    ds_read_b128 v[44:47], v150 offset:60416
    s_waitcnt vmcnt(11)
    s_barrier
    s_mov_b64 exec, 1
    global_store_dword v152, v153, s[46:47] sc1
    s_mov_b64 exec, -1
    s_add_u32 s46, s46, s55
    s_addc_u32 s47, s47, 0
    s_waitcnt lgkmcnt(6)
    v_mfma_f32_32x32x16_bf16 v[16:31], a[80:83], v[48:51], v[16:31]
    ds_read_b128 v[48:51], v150 offset:61440
    v_mfma_f32_32x32x16_bf16 v[16:31], a[84:87], v[52:55], v[16:31]
    ds_read_b128 v[52:55], v150 offset:62464
    s_waitcnt lgkmcnt(6)
    v_mfma_f32_32x32x16_bf16 v[16:31], a[88:91], v[56:59], v[16:31]
    ds_read_b128 v[56:59], v150 offset:63488
    v_mfma_f32_32x32x16_bf16 v[16:31], a[92:95], v[60:63], v[16:31]
    ds_read_b128 v[60:63], v150 offset:64512
    s_waitcnt lgkmcnt(6)
    v_mfma_f32_32x32x16_bf16 v[16:31], a[96:99], v[32:35], v[16:31]
    ds_read_b128 v[32:35], v151 offset:0
    v_mfma_f32_32x32x16_bf16 v[16:31], a[100:103], v[36:39], v[16:31]
    ds_read_b128 v[36:39], v151 offset:1024
    s_waitcnt lgkmcnt(6)
    v_mfma_f32_32x32x16_bf16 v[16:31], a[104:107], v[40:43], v[16:31]
    ds_read_b128 v[40:43], v151 offset:2048
    v_mfma_f32_32x32x16_bf16 v[16:31], a[108:111], v[44:47], v[16:31]
    ds_read_b128 v[44:47], v151 offset:3072
    s_waitcnt lgkmcnt(6)
    v_mfma_f32_32x32x16_bf16 v[16:31], a[112:115], v[48:51], v[16:31]
    ds_read_b128 v[48:51], v151 offset:4096
    v_mfma_f32_32x32x16_bf16 v[16:31], a[116:119], v[52:55], v[16:31]
    ds_read_b128 v[52:55], v151 offset:5120
    s_waitcnt lgkmcnt(6)
    v_mfma_f32_32x32x16_bf16 v[16:31], a[120:123], v[56:59], v[16:31]
    ds_read_b128 v[56:59], v151 offset:6144
    v_mfma_f32_32x32x16_bf16 v[16:31], a[124:127], v[60:63], v[16:31]
    ds_read_b128 v[60:63], v151 offset:7168
    s_waitcnt lgkmcnt(6)
    v_mfma_f32_32x32x16_bf16 v[0:15], a[0:3], v[32:35], 0
    ds_read_b128 v[32:35], v151 offset:8192
    v_mfma_f32_32x32x16_bf16 v[0:15], a[4:7], v[36:39], v[0:15]
    ds_read_b128 v[36:39], v151 offset:9216
    s_waitcnt lgkmcnt(6)
    v_mfma_f32_32x32x16_bf16 v[0:15], a[8:11], v[40:43], v[0:15]
    ds_read_b128 v[40:43], v151 offset:10240
    v_mfma_f32_32x32x16_bf16 v[0:15], a[12:15], v[44:47], v[0:15]
    ds_read_b128 v[44:47], v151 offset:11264
    s_waitcnt lgkmcnt(6)
    v_mfma_f32_32x32x16_bf16 v[0:15], a[16:19], v[48:51], v[0:15]
    ds_read_b128 v[48:51], v151 offset:12288
    v_mfma_f32_32x32x16_bf16 v[0:15], a[20:23], v[52:55], v[0:15]
    ds_read_b128 v[52:55], v151 offset:13312
    v_cvt_pk_bf16_f32 v64, v16, v17
    s_waitcnt lgkmcnt(6)
    v_mfma_f32_32x32x16_bf16 v[0:15], a[24:27], v[56:59], v[0:15]
    ds_read_b128 v[56:59], v151 offset:14336
    v_cvt_pk_bf16_f32 v65, v18, v19
    v_mfma_f32_32x32x16_bf16 v[0:15], a[28:31], v[60:63], v[0:15]
    ds_read_b128 v[60:63], v151 offset:15360
    v_cvt_pk_bf16_f32 v66, v20, v21
    s_waitcnt lgkmcnt(6)
    v_mfma_f32_32x32x16_bf16 v[0:15], a[32:35], v[32:35], v[0:15]
    ds_read_b128 v[32:35], v151 offset:16384
    v_cvt_pk_bf16_f32 v67, v22, v23
    v_mfma_f32_32x32x16_bf16 v[0:15], a[36:39], v[36:39], v[0:15]
    ds_read_b128 v[36:39], v151 offset:17408
    v_cvt_pk_bf16_f32 v68, v24, v25
    s_waitcnt lgkmcnt(6)
    v_mfma_f32_32x32x16_bf16 v[0:15], a[40:43], v[40:43], v[0:15]
    ds_read_b128 v[40:43], v151 offset:18432
    v_cvt_pk_bf16_f32 v69, v26, v27
    v_mfma_f32_32x32x16_bf16 v[0:15], a[44:47], v[44:47], v[0:15]
    ds_read_b128 v[44:47], v151 offset:19456
    v_cvt_pk_bf16_f32 v70, v28, v29
    s_waitcnt lgkmcnt(6)
    v_mfma_f32_32x32x16_bf16 v[0:15], a[48:51], v[48:51], v[0:15]
    ds_read_b128 v[48:51], v151 offset:20480
    v_cvt_pk_bf16_f32 v71, v30, v31
    v_mfma_f32_32x32x16_bf16 v[0:15], a[52:55], v[52:55], v[0:15]
    ds_read_b128 v[52:55], v151 offset:21504
    global_store_dwordx4 v150, v[64:67], s[42:43] offset:0 sc1
    s_waitcnt lgkmcnt(6)
    v_mfma_f32_32x32x16_bf16 v[0:15], a[56:59], v[56:59], v[0:15]
    ds_read_b128 v[56:59], v151 offset:22528
    global_store_dwordx4 v150, v[68:71], s[42:43] offset:1024 sc1
    v_mfma_f32_32x32x16_bf16 v[0:15], a[60:63], v[60:63], v[0:15]
    ds_read_b128 v[60:63], v151 offset:23552
    s_add_u32 s42, s42, s54
    s_waitcnt lgkmcnt(6)
    v_mfma_f32_32x32x16_bf16 v[0:15], a[64:67], v[32:35], v[0:15]
    ds_read_b128 v[32:35], v151 offset:24576
    s_addc_u32 s43, s43, 0
    v_mfma_f32_32x32x16_bf16 v[0:15], a[68:71], v[36:39], v[0:15]
    ds_read_b128 v[36:39], v151 offset:25600
    s_waitcnt lgkmcnt(6)
    v_mfma_f32_32x32x16_bf16 v[0:15], a[72:75], v[40:43], v[0:15]
    ds_read_b128 v[40:43], v151 offset:26624
    v_mfma_f32_32x32x16_bf16 v[0:15], a[76:79], v[44:47], v[0:15]
    ds_read_b128 v[44:47], v151 offset:27648
    s_waitcnt vmcnt(3)
    s_barrier
    s_mov_b64 exec, 1
    global_store_dword v152, v153, s[46:47] sc1
    s_mov_b64 exec, -1
    s_add_u32 s46, s46, s55
    s_addc_u32 s47, s47, 0
    s_waitcnt lgkmcnt(6)
    v_mfma_f32_32x32x16_bf16 v[0:15], a[80:83], v[48:51], v[0:15]
    ds_read_b128 v[48:51], v151 offset:28672
    v_mfma_f32_32x32x16_bf16 v[0:15], a[84:87], v[52:55], v[0:15]
    ds_read_b128 v[52:55], v151 offset:29696
    s_waitcnt lgkmcnt(6)
    v_mfma_f32_32x32x16_bf16 v[0:15], a[88:91], v[56:59], v[0:15]
    ds_read_b128 v[56:59], v151 offset:30720
    v_mfma_f32_32x32x16_bf16 v[0:15], a[92:95], v[60:63], v[0:15]
    ds_read_b128 v[60:63], v151 offset:31744
    s_waitcnt lgkmcnt(6)
    v_mfma_f32_32x32x16_bf16 v[0:15], a[96:99], v[32:35], v[0:15]
    ds_read_b128 v[32:35], v151 offset:32768
    v_mfma_f32_32x32x16_bf16 v[0:15], a[100:103], v[36:39], v[0:15]
    ds_read_b128 v[36:39], v151 offset:33792
    s_waitcnt lgkmcnt(6)
    v_mfma_f32_32x32x16_bf16 v[0:15], a[104:107], v[40:43], v[0:15]
    ds_read_b128 v[40:43], v151 offset:34816
    v_mfma_f32_32x32x16_bf16 v[0:15], a[108:111], v[44:47], v[0:15]
    ds_read_b128 v[44:47], v151 offset:35840
    s_waitcnt lgkmcnt(6)
    v_mfma_f32_32x32x16_bf16 v[0:15], a[112:115], v[48:51], v[0:15]
    ds_read_b128 v[48:51], v151 offset:36864
    v_mfma_f32_32x32x16_bf16 v[0:15], a[116:119], v[52:55], v[0:15]
    ds_read_b128 v[52:55], v151 offset:37888
    s_waitcnt lgkmcnt(6)
    v_mfma_f32_32x32x16_bf16 v[0:15], a[120:123], v[56:59], v[0:15]
    ds_read_b128 v[56:59], v151 offset:38912
    v_mfma_f32_32x32x16_bf16 v[0:15], a[124:127], v[60:63], v[0:15]
    ds_read_b128 v[60:63], v151 offset:39936
    s_waitcnt lgkmcnt(6)
    v_mfma_f32_32x32x16_bf16 v[16:31], a[0:3], v[32:35], 0
    ds_read_b128 v[32:35], v151 offset:40960
    v_mfma_f32_32x32x16_bf16 v[16:31], a[4:7], v[36:39], v[16:31]
    ds_read_b128 v[36:39], v151 offset:41984
    s_waitcnt lgkmcnt(6)
    v_mfma_f32_32x32x16_bf16 v[16:31], a[8:11], v[40:43], v[16:31]
    ds_read_b128 v[40:43], v151 offset:43008
    v_mfma_f32_32x32x16_bf16 v[16:31], a[12:15], v[44:47], v[16:31]
    ds_read_b128 v[44:47], v151 offset:44032
    s_waitcnt lgkmcnt(6)
    v_mfma_f32_32x32x16_bf16 v[16:31], a[16:19], v[48:51], v[16:31]
    ds_read_b128 v[48:51], v151 offset:45056
    v_mfma_f32_32x32x16_bf16 v[16:31], a[20:23], v[52:55], v[16:31]
    ds_read_b128 v[52:55], v151 offset:46080
    v_cvt_pk_bf16_f32 v64, v0, v1
    s_waitcnt lgkmcnt(6)
    v_mfma_f32_32x32x16_bf16 v[16:31], a[24:27], v[56:59], v[16:31]
    ds_read_b128 v[56:59], v151 offset:47104
    v_cvt_pk_bf16_f32 v65, v2, v3
    v_mfma_f32_32x32x16_bf16 v[16:31], a[28:31], v[60:63], v[16:31]
    ds_read_b128 v[60:63], v151 offset:48128
    v_cvt_pk_bf16_f32 v66, v4, v5
    s_waitcnt lgkmcnt(6)
    v_mfma_f32_32x32x16_bf16 v[16:31], a[32:35], v[32:35], v[16:31]
    ds_read_b128 v[32:35], v151 offset:49152
    v_cvt_pk_bf16_f32 v67, v6, v7
    v_mfma_f32_32x32x16_bf16 v[16:31], a[36:39], v[36:39], v[16:31]
    ds_read_b128 v[36:39], v151 offset:50176
    v_cvt_pk_bf16_f32 v68, v8, v9
    s_waitcnt lgkmcnt(6)
    v_mfma_f32_32x32x16_bf16 v[16:31], a[40:43], v[40:43], v[16:31]
    ds_read_b128 v[40:43], v151 offset:51200
    v_cvt_pk_bf16_f32 v69, v10, v11
    v_mfma_f32_32x32x16_bf16 v[16:31], a[44:47], v[44:47], v[16:31]
    ds_read_b128 v[44:47], v151 offset:52224
    v_cvt_pk_bf16_f32 v70, v12, v13
    s_waitcnt lgkmcnt(6)
    v_mfma_f32_32x32x16_bf16 v[16:31], a[48:51], v[48:51], v[16:31]
    ds_read_b128 v[48:51], v151 offset:53248
    v_cvt_pk_bf16_f32 v71, v14, v15
    v_mfma_f32_32x32x16_bf16 v[16:31], a[52:55], v[52:55], v[16:31]
    ds_read_b128 v[52:55], v151 offset:54272
    global_store_dwordx4 v150, v[64:67], s[42:43] offset:0 sc1
    s_waitcnt lgkmcnt(6)
    v_mfma_f32_32x32x16_bf16 v[16:31], a[56:59], v[56:59], v[16:31]
    ds_read_b128 v[56:59], v151 offset:55296
    global_store_dwordx4 v150, v[68:71], s[42:43] offset:1024 sc1
    v_mfma_f32_32x32x16_bf16 v[16:31], a[60:63], v[60:63], v[16:31]
    ds_read_b128 v[60:63], v151 offset:56320
    s_add_u32 s42, s42, s54
    s_waitcnt lgkmcnt(6)
    v_mfma_f32_32x32x16_bf16 v[16:31], a[64:67], v[32:35], v[16:31]
    ds_read_b128 v[32:35], v151 offset:57344
    s_addc_u32 s43, s43, 0
    v_mfma_f32_32x32x16_bf16 v[16:31], a[68:71], v[36:39], v[16:31]
    ds_read_b128 v[36:39], v151 offset:58368
    s_waitcnt lgkmcnt(6)
    v_mfma_f32_32x32x16_bf16 v[16:31], a[72:75], v[40:43], v[16:31]
    ds_read_b128 v[40:43], v151 offset:59392
    v_mfma_f32_32x32x16_bf16 v[16:31], a[76:79], v[44:47], v[16:31]
    ds_read_b128 v[44:47], v151 offset:60416
    s_waitcnt vmcnt(3)
    s_mov_b64 exec, 1
    global_store_dword v152, v153, s[46:47] sc1
    s_mov_b64 exec, -1
    s_add_u32 s46, s46, s55
    s_addc_u32 s47, s47, 0
    s_waitcnt lgkmcnt(6)
    v_mfma_f32_32x32x16_bf16 v[16:31], a[80:83], v[48:51], v[16:31]
    ds_read_b128 v[48:51], v151 offset:61440
    v_mfma_f32_32x32x16_bf16 v[16:31], a[84:87], v[52:55], v[16:31]
    ds_read_b128 v[52:55], v151 offset:62464
    s_waitcnt lgkmcnt(6)
    v_mfma_f32_32x32x16_bf16 v[16:31], a[88:91], v[56:59], v[16:31]
    ds_read_b128 v[56:59], v151 offset:63488
    v_mfma_f32_32x32x16_bf16 v[16:31], a[92:95], v[60:63], v[16:31]
    ds_read_b128 v[60:63], v151 offset:64512
    s_waitcnt lgkmcnt(6)
    v_mfma_f32_32x32x16_bf16 v[16:31], a[96:99], v[32:35], v[16:31]
    v_mfma_f32_32x32x16_bf16 v[16:31], a[100:103], v[36:39], v[16:31]
    s_waitcnt lgkmcnt(4)
    v_mfma_f32_32x32x16_bf16 v[16:31], a[104:107], v[40:43], v[16:31]
    v_mfma_f32_32x32x16_bf16 v[16:31], a[108:111], v[44:47], v[16:31]
    s_waitcnt lgkmcnt(2)
    v_mfma_f32_32x32x16_bf16 v[16:31], a[112:115], v[48:51], v[16:31]
    v_mfma_f32_32x32x16_bf16 v[16:31], a[116:119], v[52:55], v[16:31]
    s_waitcnt lgkmcnt(0)
    v_mfma_f32_32x32x16_bf16 v[16:31], a[120:123], v[56:59], v[16:31]
    v_mfma_f32_32x32x16_bf16 v[16:31], a[124:127], v[60:63], v[16:31]
    s_nop 11
    v_cvt_pk_bf16_f32 v64, v16, v17
    v_cvt_pk_bf16_f32 v65, v18, v19
    v_cvt_pk_bf16_f32 v66, v20, v21
    v_cvt_pk_bf16_f32 v67, v22, v23
    v_cvt_pk_bf16_f32 v68, v24, v25
    v_cvt_pk_bf16_f32 v69, v26, v27
    v_cvt_pk_bf16_f32 v70, v28, v29
    v_cvt_pk_bf16_f32 v71, v30, v31
    global_store_dwordx4 v150, v[64:67], s[42:43] offset:0 sc1
    global_store_dwordx4 v150, v[68:71], s[42:43] offset:1024 sc1
    s_add_u32 s42, s42, s54
    s_addc_u32 s43, s43, 0
    s_branch L_g0_end
L_g0_gq:
    s_waitcnt vmcnt(16)
    s_barrier
    ds_read_b128 v[32:35], v150 offset:0
    ds_read_b128 v[36:39], v150 offset:1024
    ds_read_b128 v[40:43], v150 offset:2048
    ds_read_b128 v[44:47], v150 offset:3072
    ds_read_b128 v[48:51], v150 offset:4096
    ds_read_b128 v[52:55], v150 offset:5120
    ds_read_b128 v[56:59], v150 offset:6144
    ds_read_b128 v[60:63], v150 offset:7168
    s_waitcnt lgkmcnt(6)
    v_mfma_f32_32x32x16_bf16 v[0:15], a[0:3], v[32:35], 0
    ds_read_b128 v[32:35], v150 offset:8192
    v_mfma_f32_32x32x16_bf16 v[0:15], a[4:7], v[36:39], v[0:15]
    ds_read_b128 v[36:39], v150 offset:9216
    s_waitcnt lgkmcnt(6)
    v_mfma_f32_32x32x16_bf16 v[0:15], a[8:11], v[40:43], v[0:15]
    ds_read_b128 v[40:43], v150 offset:10240
    v_mfma_f32_32x32x16_bf16 v[0:15], a[12:15], v[44:47], v[0:15]
    ds_read_b128 v[44:47], v150 offset:11264
    s_waitcnt lgkmcnt(6)
    v_mfma_f32_32x32x16_bf16 v[0:15], a[16:19], v[48:51], v[0:15]
    ds_read_b128 v[48:51], v150 offset:12288
    v_mfma_f32_32x32x16_bf16 v[0:15], a[20:23], v[52:55], v[0:15]
    ds_read_b128 v[52:55], v150 offset:13312
    s_waitcnt lgkmcnt(6)
    v_mfma_f32_32x32x16_bf16 v[0:15], a[24:27], v[56:59], v[0:15]
    ds_read_b128 v[56:59], v150 offset:14336
    v_mfma_f32_32x32x16_bf16 v[0:15], a[28:31], v[60:63], v[0:15]
    ds_read_b128 v[60:63], v150 offset:15360
    s_waitcnt lgkmcnt(6)
    v_mfma_f32_32x32x16_bf16 v[0:15], a[32:35], v[32:35], v[0:15]
    ds_read_b128 v[32:35], v150 offset:16384
    v_mfma_f32_32x32x16_bf16 v[0:15], a[36:39], v[36:39], v[0:15]
    ds_read_b128 v[36:39], v150 offset:17408
    s_waitcnt lgkmcnt(6)
    v_mfma_f32_32x32x16_bf16 v[0:15], a[40:43], v[40:43], v[0:15]
    ds_read_b128 v[40:43], v150 offset:18432
    v_mfma_f32_32x32x16_bf16 v[0:15], a[44:47], v[44:47], v[0:15]
    ds_read_b128 v[44:47], v150 offset:19456
    s_waitcnt lgkmcnt(6)
    v_mfma_f32_32x32x16_bf16 v[0:15], a[48:51], v[48:51], v[0:15]
    ds_read_b128 v[48:51], v150 offset:20480
    v_mfma_f32_32x32x16_bf16 v[0:15], a[52:55], v[52:55], v[0:15]
    ds_read_b128 v[52:55], v150 offset:21504
    s_waitcnt lgkmcnt(6)
    v_mfma_f32_32x32x16_bf16 v[0:15], a[56:59], v[56:59], v[0:15]
    ds_read_b128 v[56:59], v150 offset:22528
    v_mfma_f32_32x32x16_bf16 v[0:15], a[60:63], v[60:63], v[0:15]
    ds_read_b128 v[60:63], v150 offset:23552
    s_waitcnt lgkmcnt(6)
    v_mfma_f32_32x32x16_bf16 v[0:15], a[64:67], v[32:35], v[0:15]
    ds_read_b128 v[32:35], v150 offset:24576
    v_mfma_f32_32x32x16_bf16 v[0:15], a[68:71], v[36:39], v[0:15]
    ds_read_b128 v[36:39], v150 offset:25600
    s_waitcnt lgkmcnt(6)
    v_mfma_f32_32x32x16_bf16 v[0:15], a[72:75], v[40:43], v[0:15]
    ds_read_b128 v[40:43], v150 offset:26624
    v_mfma_f32_32x32x16_bf16 v[0:15], a[76:79], v[44:47], v[0:15]
    ds_read_b128 v[44:47], v150 offset:27648
    s_waitcnt vmcnt(8)
    s_barrier
    s_waitcnt lgkmcnt(6)
    v_mfma_f32_32x32x16_bf16 v[0:15], a[80:83], v[48:51], v[0:15]
    ds_read_b128 v[48:51], v150 offset:28672
    v_mfma_f32_32x32x16_bf16 v[0:15], a[84:87], v[52:55], v[0:15]
    ds_read_b128 v[52:55], v150 offset:29696
    s_add_u32 m0, s52, 98304
    s_waitcnt lgkmcnt(6)
    v_mfma_f32_32x32x16_bf16 v[0:15], a[88:91], v[56:59], v[0:15]
    ds_read_b128 v[56:59], v150 offset:30720
    global_load_lds_dwordx4 v150, s[38:39] offset:0 sc1
    v_mfma_f32_32x32x16_bf16 v[0:15], a[92:95], v[60:63], v[0:15]
    ds_read_b128 v[60:63], v150 offset:31744
    global_load_lds_dwordx4 v150, s[38:39] offset:1024 sc1
    s_waitcnt lgkmcnt(6)
    v_mfma_f32_32x32x16_bf16 v[0:15], a[96:99], v[32:35], v[0:15]
    ds_read_b128 v[32:35], v150 offset:32768
    global_load_lds_dwordx4 v150, s[38:39] offset:2048 sc1
    v_mfma_f32_32x32x16_bf16 v[0:15], a[100:103], v[36:39], v[0:15]
    ds_read_b128 v[36:39], v150 offset:33792
    global_load_lds_dwordx4 v150, s[38:39] offset:3072 sc1
    s_add_u32 s38, s38, 4096
    s_addc_u32 s39, s39, 0
    s_waitcnt lgkmcnt(6)
    v_mfma_f32_32x32x16_bf16 v[0:15], a[104:107], v[40:43], v[0:15]
    ds_read_b128 v[40:43], v150 offset:34816
    s_add_u32 m0, s52, 102400
    v_mfma_f32_32x32x16_bf16 v[0:15], a[108:111], v[44:47], v[0:15]
    ds_read_b128 v[44:47], v150 offset:35840
    global_load_lds_dwordx4 v150, s[38:39] offset:0 sc1
    s_waitcnt lgkmcnt(6)
    v_mfma_f32_32x32x16_bf16 v[0:15], a[112:115], v[48:51], v[0:15]
    ds_read_b128 v[48:51], v150 offset:36864
    global_load_lds_dwordx4 v150, s[38:39] offset:1024 sc1
    v_mfma_f32_32x32x16_bf16 v[0:15], a[116:119], v[52:55], v[0:15]
    ds_read_b128 v[52:55], v150 offset:37888
    global_load_lds_dwordx4 v150, s[38:39] offset:2048 sc1
    s_waitcnt lgkmcnt(6)
    v_mfma_f32_32x32x16_bf16 v[0:15], a[120:123], v[56:59], v[0:15]
    ds_read_b128 v[56:59], v150 offset:38912
    global_load_lds_dwordx4 v150, s[38:39] offset:3072 sc1
    s_add_u32 s38, s38, s53
    s_addc_u32 s39, s39, 0
    v_mfma_f32_32x32x16_bf16 v[0:15], a[124:127], v[60:63], v[0:15]
    ds_read_b128 v[60:63], v150 offset:39936
    s_waitcnt lgkmcnt(6)
    v_mfma_f32_32x32x16_bf16 v[16:31], a[0:3], v[32:35], 0
    ds_read_b128 v[32:35], v150 offset:40960
    v_mfma_f32_32x32x16_bf16 v[16:31], a[4:7], v[36:39], v[16:31]
    ds_read_b128 v[36:39], v150 offset:41984
    s_waitcnt lgkmcnt(6)
    v_mfma_f32_32x32x16_bf16 v[16:31], a[8:11], v[40:43], v[16:31]
    ds_read_b128 v[40:43], v150 offset:43008
    v_mfma_f32_32x32x16_bf16 v[16:31], a[12:15], v[44:47], v[16:31]
    ds_read_b128 v[44:47], v150 offset:44032
    s_waitcnt lgkmcnt(6)
    v_mfma_f32_32x32x16_bf16 v[16:31], a[16:19], v[48:51], v[16:31]
    ds_read_b128 v[48:51], v150 offset:45056
    v_mfma_f32_32x32x16_bf16 v[16:31], a[20:23], v[52:55], v[16:31]
    ds_read_b128 v[52:55], v150 offset:46080
    v_mul_f32 v0, s50, v0
    v_mul_f32 v1, s50, v1
    s_waitcnt lgkmcnt(6)
    v_mfma_f32_32x32x16_bf16 v[16:31], a[24:27], v[56:59], v[16:31]
    ds_read_b128 v[56:59], v150 offset:47104
    v_mul_f32 v2, s50, v2
    v_mul_f32 v3, s50, v3
    v_mfma_f32_32x32x16_bf16 v[16:31], a[28:31], v[60:63], v[16:31]
    ds_read_b128 v[60:63], v150 offset:48128
    v_mul_f32 v4, s50, v4
    v_mul_f32 v5, s50, v5
    s_waitcnt lgkmcnt(6)
    v_mfma_f32_32x32x16_bf16 v[16:31], a[32:35], v[32:35], v[16:31]
    ds_read_b128 v[32:35], v150 offset:49152
    v_mul_f32 v6, s50, v6
    v_mul_f32 v7, s50, v7
    v_mfma_f32_32x32x16_bf16 v[16:31], a[36:39], v[36:39], v[16:31]
    ds_read_b128 v[36:39], v150 offset:50176
    v_mul_f32 v8, s50, v8
    v_mul_f32 v9, s50, v9
    s_waitcnt lgkmcnt(6)
    v_mfma_f32_32x32x16_bf16 v[16:31], a[40:43], v[40:43], v[16:31]
    ds_read_b128 v[40:43], v150 offset:51200
    v_mul_f32 v10, s50, v10
    v_mul_f32 v11, s50, v11
    v_mfma_f32_32x32x16_bf16 v[16:31], a[44:47], v[44:47], v[16:31]
    ds_read_b128 v[44:47], v150 offset:52224
    v_mul_f32 v12, s50, v12
    v_mul_f32 v13, s50, v13
    s_waitcnt lgkmcnt(6)
    v_mfma_f32_32x32x16_bf16 v[16:31], a[48:51], v[48:51], v[16:31]
    ds_read_b128 v[48:51], v150 offset:53248
    v_mul_f32 v14, s50, v14
    v_mul_f32 v15, s50, v15
    v_mfma_f32_32x32x16_bf16 v[16:31], a[52:55], v[52:55], v[16:31]
    ds_read_b128 v[52:55], v150 offset:54272
    v_cvt_pk_bf16_f32 v64, v0, v1
    v_cvt_pk_bf16_f32 v65, v2, v3
    s_waitcnt lgkmcnt(6)
    v_mfma_f32_32x32x16_bf16 v[16:31], a[56:59], v[56:59], v[16:31]
    ds_read_b128 v[56:59], v150 offset:55296
    v_cvt_pk_bf16_f32 v66, v4, v5
    v_cvt_pk_bf16_f32 v67, v6, v7
    v_mfma_f32_32x32x16_bf16 v[16:31], a[60:63], v[60:63], v[16:31]
    ds_read_b128 v[60:63], v150 offset:56320
    v_cvt_pk_bf16_f32 v68, v8, v9
    v_cvt_pk_bf16_f32 v69, v10, v11
    s_waitcnt lgkmcnt(6)
    v_mfma_f32_32x32x16_bf16 v[16:31], a[64:67], v[32:35], v[16:31]
    ds_read_b128 v[32:35], v150 offset:57344
    v_cvt_pk_bf16_f32 v70, v12, v13
    v_cvt_pk_bf16_f32 v71, v14, v15
    v_mfma_f32_32x32x16_bf16 v[16:31], a[68:71], v[36:39], v[16:31]
    ds_read_b128 v[36:39], v150 offset:58368
    global_store_dwordx4 v150, v[64:67], s[42:43] offset:0 sc1
    global_store_dwordx4 v150, v[68:71], s[42:43] offset:1024 sc1
    s_waitcnt lgkmcnt(6)
    v_mfma_f32_32x32x16_bf16 v[16:31], a[72:75], v[40:43], v[16:31]
    ds_read_b128 v[40:43], v150 offset:59392
    s_add_u32 s42, s42, s54
    s_addc_u32 s43, s43, 0
    v_mfma_f32_32x32x16_bf16 v[16:31], a[76:79], v[44:47], v[16:31]
    ds_read_b128 v[44:47], v150 offset:60416
    s_waitcnt vmcnt(10)
    s_barrier
    s_waitcnt lgkmcnt(6)
    v_mfma_f32_32x32x16_bf16 v[16:31], a[80:83], v[48:51], v[16:31]
    ds_read_b128 v[48:51], v150 offset:61440
    v_mfma_f32_32x32x16_bf16 v[16:31], a[84:87], v[52:55], v[16:31]
    ds_read_b128 v[52:55], v150 offset:62464
    s_add_u32 m0, s52, 0
    s_waitcnt lgkmcnt(6)
    v_mfma_f32_32x32x16_bf16 v[16:31], a[88:91], v[56:59], v[16:31]
    ds_read_b128 v[56:59], v150 offset:63488
    global_load_lds_dwordx4 v150, s[38:39] offset:0 sc1
    v_mfma_f32_32x32x16_bf16 v[16:31], a[92:95], v[60:63], v[16:31]
    ds_read_b128 v[60:63], v150 offset:64512
    global_load_lds_dwordx4 v150, s[38:39] offset:1024 sc1
    s_waitcnt lgkmcnt(6)
    v_mfma_f32_32x32x16_bf16 v[16:31], a[96:99], v[32:35], v[16:31]
    ds_read_b128 v[32:35], v151 offset:0
    global_load_lds_dwordx4 v150, s[38:39] offset:2048 sc1
    v_mfma_f32_32x32x16_bf16 v[16:31], a[100:103], v[36:39], v[16:31]
    ds_read_b128 v[36:39], v151 offset:1024
    global_load_lds_dwordx4 v150, s[38:39] offset:3072 sc1
    s_add_u32 s38, s38, 4096
    s_addc_u32 s39, s39, 0
    s_waitcnt lgkmcnt(6)
    v_mfma_f32_32x32x16_bf16 v[16:31], a[104:107], v[40:43], v[16:31]
    ds_read_b128 v[40:43], v151 offset:2048
    s_add_u32 m0, s52, 4096
    v_mfma_f32_32x32x16_bf16 v[16:31], a[108:111], v[44:47], v[16:31]
    ds_read_b128 v[44:47], v151 offset:3072
    global_load_lds_dwordx4 v150, s[38:39] offset:0 sc1
    s_waitcnt lgkmcnt(6)
    v_mfma_f32_32x32x16_bf16 v[16:31], a[112:115], v[48:51], v[16:31]
    ds_read_b128 v[48:51], v151 offset:4096
    global_load_lds_dwordx4 v150, s[38:39] offset:1024 sc1
    v_mfma_f32_32x32x16_bf16 v[16:31], a[116:119], v[52:55], v[16:31]
    ds_read_b128 v[52:55], v151 offset:5120
    global_load_lds_dwordx4 v150, s[38:39] offset:2048 sc1
    s_waitcnt lgkmcnt(6)
    v_mfma_f32_32x32x16_bf16 v[16:31], a[120:123], v[56:59], v[16:31]
    ds_read_b128 v[56:59], v151 offset:6144
    global_load_lds_dwordx4 v150, s[38:39] offset:3072 sc1
    s_add_u32 s38, s38, s53
    s_addc_u32 s39, s39, 0
    v_mfma_f32_32x32x16_bf16 v[16:31], a[124:127], v[60:63], v[16:31]
    ds_read_b128 v[60:63], v151 offset:7168
    s_waitcnt lgkmcnt(6)
    v_mfma_f32_32x32x16_bf16 v[0:15], a[0:3], v[32:35], 0
    ds_read_b128 v[32:35], v151 offset:8192
    v_mfma_f32_32x32x16_bf16 v[0:15], a[4:7], v[36:39], v[0:15]
    ds_read_b128 v[36:39], v151 offset:9216
    s_waitcnt lgkmcnt(6)
    v_mfma_f32_32x32x16_bf16 v[0:15], a[8:11], v[40:43], v[0:15]
    ds_read_b128 v[40:43], v151 offset:10240
    v_mfma_f32_32x32x16_bf16 v[0:15], a[12:15], v[44:47], v[0:15]
    ds_read_b128 v[44:47], v151 offset:11264
    s_waitcnt lgkmcnt(6)
    v_mfma_f32_32x32x16_bf16 v[0:15], a[16:19], v[48:51], v[0:15]
    ds_read_b128 v[48:51], v151 offset:12288
    v_mfma_f32_32x32x16_bf16 v[0:15], a[20:23], v[52:55], v[0:15]
    ds_read_b128 v[52:55], v151 offset:13312
    v_mul_f32 v16, s50, v16
    v_mul_f32 v17, s50, v17
    s_waitcnt lgkmcnt(6)
    v_mfma_f32_32x32x16_bf16 v[0:15], a[24:27], v[56:59], v[0:15]
    ds_read_b128 v[56:59], v151 offset:14336
    v_mul_f32 v18, s50, v18
    v_mul_f32 v19, s50, v19
    v_mfma_f32_32x32x16_bf16 v[0:15], a[28:31], v[60:63], v[0:15]
    ds_read_b128 v[60:63], v151 offset:15360
    v_mul_f32 v20, s50, v20
    v_mul_f32 v21, s50, v21
    s_waitcnt lgkmcnt(6)
    v_mfma_f32_32x32x16_bf16 v[0:15], a[32:35], v[32:35], v[0:15]
    ds_read_b128 v[32:35], v151 offset:16384
    v_mul_f32 v22, s50, v22
    v_mul_f32 v23, s50, v23
    v_mfma_f32_32x32x16_bf16 v[0:15], a[36:39], v[36:39], v[0:15]
    ds_read_b128 v[36:39], v151 offset:17408
    v_mul_f32 v24, s50, v24
    v_mul_f32 v25, s50, v25
    s_waitcnt lgkmcnt(6)
    v_mfma_f32_32x32x16_bf16 v[0:15], a[40:43], v[40:43], v[0:15]
    ds_read_b128 v[40:43], v151 offset:18432
    v_mul_f32 v26, s50, v26
    v_mul_f32 v27, s50, v27
    v_mfma_f32_32x32x16_bf16 v[0:15], a[44:47], v[44:47], v[0:15]
    ds_read_b128 v[44:47], v151 offset:19456
    v_mul_f32 v28, s50, v28
    v_mul_f32 v29, s50, v29
    s_waitcnt lgkmcnt(6)
    v_mfma_f32_32x32x16_bf16 v[0:15], a[48:51], v[48:51], v[0:15]
    ds_read_b128 v[48:51], v151 offset:20480
    v_mul_f32 v30, s50, v30
    v_mul_f32 v31, s50, v31
    v_mfma_f32_32x32x16_bf16 v[0:15], a[52:55], v[52:55], v[0:15]
    ds_read_b128 v[52:55], v151 offset:21504
    v_cvt_pk_bf16_f32 v64, v16, v17
    v_cvt_pk_bf16_f32 v65, v18, v19
    s_waitcnt lgkmcnt(6)
    v_mfma_f32_32x32x16_bf16 v[0:15], a[56:59], v[56:59], v[0:15]
    ds_read_b128 v[56:59], v151 offset:22528
    v_cvt_pk_bf16_f32 v66, v20, v21
    v_cvt_pk_bf16_f32 v67, v22, v23
    v_mfma_f32_32x32x16_bf16 v[0:15], a[60:63], v[60:63], v[0:15]
    ds_read_b128 v[60:63], v151 offset:23552
    v_cvt_pk_bf16_f32 v68, v24, v25
    v_cvt_pk_bf16_f32 v69, v26, v27
    s_waitcnt lgkmcnt(6)
    v_mfma_f32_32x32x16_bf16 v[0:15], a[64:67], v[32:35], v[0:15]
    ds_read_b128 v[32:35], v151 offset:24576
    v_cvt_pk_bf16_f32 v70, v28, v29
    v_cvt_pk_bf16_f32 v71, v30, v31
    v_mfma_f32_32x32x16_bf16 v[0:15], a[68:71], v[36:39], v[0:15]
    ds_read_b128 v[36:39], v151 offset:25600
    global_store_dwordx4 v150, v[64:67], s[42:43] offset:0 sc1
    global_store_dwordx4 v150, v[68:71], s[42:43] offset:1024 sc1
    s_waitcnt lgkmcnt(6)
    v_mfma_f32_32x32x16_bf16 v[0:15], a[72:75], v[40:43], v[0:15]
    ds_read_b128 v[40:43], v151 offset:26624
    s_add_u32 s42, s42, s54
    s_addc_u32 s43, s43, 0
    v_mfma_f32_32x32x16_bf16 v[0:15], a[76:79], v[44:47], v[0:15]
    ds_read_b128 v[44:47], v151 offset:27648
    s_waitcnt vmcnt(10)
    s_barrier
    s_mov_b64 exec, 1
    global_store_dword v152, v153, s[46:47] sc1
    s_mov_b64 exec, -1
    s_add_u32 s46, s46, s55
    s_addc_u32 s47, s47, 0
    s_waitcnt lgkmcnt(6)
    v_mfma_f32_32x32x16_bf16 v[0:15], a[80:83], v[48:51], v[0:15]
    ds_read_b128 v[48:51], v151 offset:28672
    v_mfma_f32_32x32x16_bf16 v[0:15], a[84:87], v[52:55], v[0:15]
    ds_read_b128 v[52:55], v151 offset:29696
    s_add_u32 m0, s52, 32768
    s_waitcnt lgkmcnt(6)
    v_mfma_f32_32x32x16_bf16 v[0:15], a[88:91], v[56:59], v[0:15]
    ds_read_b128 v[56:59], v151 offset:30720
    global_load_lds_dwordx4 v150, s[38:39] offset:0 sc1
    v_mfma_f32_32x32x16_bf16 v[0:15], a[92:95], v[60:63], v[0:15]
    ds_read_b128 v[60:63], v151 offset:31744
    global_load_lds_dwordx4 v150, s[38:39] offset:1024 sc1
    s_waitcnt lgkmcnt(6)
    v_mfma_f32_32x32x16_bf16 v[0:15], a[96:99], v[32:35], v[0:15]
    ds_read_b128 v[32:35], v151 offset:32768
    global_load_lds_dwordx4 v150, s[38:39] offset:2048 sc1
    v_mfma_f32_32x32x16_bf16 v[0:15], a[100:103], v[36:39], v[0:15]
    ds_read_b128 v[36:39], v151 offset:33792
    global_load_lds_dwordx4 v150, s[38:39] offset:3072 sc1
    s_add_u32 s38, s38, 4096
    s_addc_u32 s39, s39, 0
    s_waitcnt lgkmcnt(6)
    v_mfma_f32_32x32x16_bf16 v[0:15], a[104:107], v[40:43], v[0:15]
    ds_read_b128 v[40:43], v151 offset:34816
    s_add_u32 m0, s52, 36864
    v_mfma_f32_32x32x16_bf16 v[0:15], a[108:111], v[44:47], v[0:15]
    ds_read_b128 v[44:47], v151 offset:35840
    global_load_lds_dwordx4 v150, s[38:39] offset:0 sc1
    s_waitcnt lgkmcnt(6)
    v_mfma_f32_32x32x16_bf16 v[0:15], a[112:115], v[48:51], v[0:15]
    ds_read_b128 v[48:51], v151 offset:36864
    global_load_lds_dwordx4 v150, s[38:39] offset:1024 sc1
    v_mfma_f32_32x32x16_bf16 v[0:15], a[116:119], v[52:55], v[0:15]
    ds_read_b128 v[52:55], v151 offset:37888
    global_load_lds_dwordx4 v150, s[38:39] offset:2048 sc1
    s_waitcnt lgkmcnt(6)
    v_mfma_f32_32x32x16_bf16 v[0:15], a[120:123], v[56:59], v[0:15]
    ds_read_b128 v[56:59], v151 offset:38912
    global_load_lds_dwordx4 v150, s[38:39] offset:3072 sc1
    s_add_u32 s38, s38, s53
    s_addc_u32 s39, s39, 0
    v_mfma_f32_32x32x16_bf16 v[0:15], a[124:127], v[60:63], v[0:15]
    ds_read_b128 v[60:63], v151 offset:39936
    s_waitcnt lgkmcnt(6)
    v_mfma_f32_32x32x16_bf16 v[16:31], a[0:3], v[32:35], 0
    ds_read_b128 v[32:35], v151 offset:40960
    v_mfma_f32_32x32x16_bf16 v[16:31], a[4:7], v[36:39], v[16:31]
    ds_read_b128 v[36:39], v151 offset:41984
    s_waitcnt lgkmcnt(6)
    v_mfma_f32_32x32x16_bf16 v[16:31], a[8:11], v[40:43], v[16:31]
    ds_read_b128 v[40:43], v151 offset:43008
    v_mfma_f32_32x32x16_bf16 v[16:31], a[12:15], v[44:47], v[16:31]
    ds_read_b128 v[44:47], v151 offset:44032
    s_waitcnt lgkmcnt(6)
    v_mfma_f32_32x32x16_bf16 v[16:31], a[16:19], v[48:51], v[16:31]
    ds_read_b128 v[48:51], v151 offset:45056
    v_mfma_f32_32x32x16_bf16 v[16:31], a[20:23], v[52:55], v[16:31]
    ds_read_b128 v[52:55], v151 offset:46080
    v_mul_f32 v0, s50, v0
    v_mul_f32 v1, s50, v1
    s_waitcnt lgkmcnt(6)
    v_mfma_f32_32x32x16_bf16 v[16:31], a[24:27], v[56:59], v[16:31]
    ds_read_b128 v[56:59], v151 offset:47104
    v_mul_f32 v2, s50, v2
    v_mul_f32 v3, s50, v3
    v_mfma_f32_32x32x16_bf16 v[16:31], a[28:31], v[60:63], v[16:31]
    ds_read_b128 v[60:63], v151 offset:48128
    v_mul_f32 v4, s50, v4
    v_mul_f32 v5, s50, v5
    s_waitcnt lgkmcnt(6)
    v_mfma_f32_32x32x16_bf16 v[16:31], a[32:35], v[32:35], v[16:31]
    ds_read_b128 v[32:35], v151 offset:49152
    v_mul_f32 v6, s50, v6
    v_mul_f32 v7, s50, v7
    v_mfma_f32_32x32x16_bf16 v[16:31], a[36:39], v[36:39], v[16:31]
    ds_read_b128 v[36:39], v151 offset:50176
    v_mul_f32 v8, s50, v8
    v_mul_f32 v9, s50, v9
    s_waitcnt lgkmcnt(6)
    v_mfma_f32_32x32x16_bf16 v[16:31], a[40:43], v[40:43], v[16:31]
    ds_read_b128 v[40:43], v151 offset:51200
    v_mul_f32 v10, s50, v10
    v_mul_f32 v11, s50, v11
    v_mfma_f32_32x32x16_bf16 v[16:31], a[44:47], v[44:47], v[16:31]
    ds_read_b128 v[44:47], v151 offset:52224
    v_mul_f32 v12, s50, v12
    v_mul_f32 v13, s50, v13
    s_waitcnt lgkmcnt(6)
    v_mfma_f32_32x32x16_bf16 v[16:31], a[48:51], v[48:51], v[16:31]
    ds_read_b128 v[48:51], v151 offset:53248
    v_mul_f32 v14, s50, v14
    v_mul_f32 v15, s50, v15
    v_mfma_f32_32x32x16_bf16 v[16:31], a[52:55], v[52:55], v[16:31]
    ds_read_b128 v[52:55], v151 offset:54272
    v_cvt_pk_bf16_f32 v64, v0, v1
    v_cvt_pk_bf16_f32 v65, v2, v3
    s_waitcnt lgkmcnt(6)
    v_mfma_f32_32x32x16_bf16 v[16:31], a[56:59], v[56:59], v[16:31]
    ds_read_b128 v[56:59], v151 offset:55296
    v_cvt_pk_bf16_f32 v66, v4, v5
    v_cvt_pk_bf16_f32 v67, v6, v7
    v_mfma_f32_32x32x16_bf16 v[16:31], a[60:63], v[60:63], v[16:31]
    ds_read_b128 v[60:63], v151 offset:56320
    v_cvt_pk_bf16_f32 v68, v8, v9
    v_cvt_pk_bf16_f32 v69, v10, v11
    s_waitcnt lgkmcnt(6)
    v_mfma_f32_32x32x16_bf16 v[16:31], a[64:67], v[32:35], v[16:31]
    ds_read_b128 v[32:35], v151 offset:57344
    v_cvt_pk_bf16_f32 v70, v12, v13
    v_cvt_pk_bf16_f32 v71, v14, v15
    v_mfma_f32_32x32x16_bf16 v[16:31], a[68:71], v[36:39], v[16:31]
    ds_read_b128 v[36:39], v151 offset:58368
    global_store_dwordx4 v150, v[64:67], s[42:43] offset:0 sc1
    global_store_dwordx4 v150, v[68:71], s[42:43] offset:1024 sc1
    s_waitcnt lgkmcnt(6)
    v_mfma_f32_32x32x16_bf16 v[16:31], a[72:75], v[40:43], v[16:31]
    ds_read_b128 v[40:43], v151 offset:59392
    s_add_u32 s42, s42, s54
    s_addc_u32 s43, s43, 0
    v_mfma_f32_32x32x16_bf16 v[16:31], a[76:79], v[44:47], v[16:31]
    ds_read_b128 v[44:47], v151 offset:60416
    s_waitcnt vmcnt(11)
    s_barrier
    s_mov_b64 exec, 1
    global_store_dword v152, v153, s[46:47] sc1
    s_mov_b64 exec, -1
    s_add_u32 s46, s46, s55
    s_addc_u32 s47, s47, 0
    s_waitcnt lgkmcnt(6)
    v_mfma_f32_32x32x16_bf16 v[16:31], a[80:83], v[48:51], v[16:31]
    ds_read_b128 v[48:51], v151 offset:61440
    v_mfma_f32_32x32x16_bf16 v[16:31], a[84:87], v[52:55], v[16:31]
    ds_read_b128 v[52:55], v151 offset:62464
    s_add_u32 m0, s52, 65536
    s_waitcnt lgkmcnt(6)
    v_mfma_f32_32x32x16_bf16 v[16:31], a[88:91], v[56:59], v[16:31]
    ds_read_b128 v[56:59], v151 offset:63488
    global_load_lds_dwordx4 v150, s[38:39] offset:0 sc1
    v_mfma_f32_32x32x16_bf16 v[16:31], a[92:95], v[60:63], v[16:31]
    ds_read_b128 v[60:63], v151 offset:64512
    global_load_lds_dwordx4 v150, s[38:39] offset:1024 sc1
    s_waitcnt lgkmcnt(6)
    v_mfma_f32_32x32x16_bf16 v[16:31], a[96:99], v[32:35], v[16:31]
    ds_read_b128 v[32:35], v150 offset:0
    global_load_lds_dwordx4 v150, s[38:39] offset:2048 sc1
    v_mfma_f32_32x32x16_bf16 v[16:31], a[100:103], v[36:39], v[16:31]
    ds_read_b128 v[36:39], v150 offset:1024
    global_load_lds_dwordx4 v150, s[38:39] offset:3072 sc1
    s_add_u32 s38, s38, 4096
    s_addc_u32 s39, s39, 0
    s_waitcnt lgkmcnt(6)
    v_mfma_f32_32x32x16_bf16 v[16:31], a[104:107], v[40:43], v[16:31]
    ds_read_b128 v[40:43], v150 offset:2048
    s_add_u32 m0, s52, 69632
    v_mfma_f32_32x32x16_bf16 v[16:31], a[108:111], v[44:47], v[16:31]
    ds_read_b128 v[44:47], v150 offset:3072
    global_load_lds_dwordx4 v150, s[38:39] offset:0 sc1
    s_waitcnt lgkmcnt(6)
    v_mfma_f32_32x32x16_bf16 v[16:31], a[112:115], v[48:51], v[16:31]
    ds_read_b128 v[48:51], v150 offset:4096
    global_load_lds_dwordx4 v150, s[38:39] offset:1024 sc1
    v_mfma_f32_32x32x16_bf16 v[16:31], a[116:119], v[52:55], v[16:31]
    ds_read_b128 v[52:55], v150 offset:5120
    global_load_lds_dwordx4 v150, s[38:39] offset:2048 sc1
    s_waitcnt lgkmcnt(6)
    v_mfma_f32_32x32x16_bf16 v[16:31], a[120:123], v[56:59], v[16:31]
    ds_read_b128 v[56:59], v150 offset:6144
    global_load_lds_dwordx4 v150, s[38:39] offset:3072 sc1
    s_add_u32 s38, s38, s53
    s_addc_u32 s39, s39, 0
    v_mfma_f32_32x32x16_bf16 v[16:31], a[124:127], v[60:63], v[16:31]
    ds_read_b128 v[60:63], v150 offset:7168
    s_waitcnt lgkmcnt(6)
    v_mfma_f32_32x32x16_bf16 v[0:15], a[0:3], v[32:35], 0
    ds_read_b128 v[32:35], v150 offset:8192
    v_mfma_f32_32x32x16_bf16 v[0:15], a[4:7], v[36:39], v[0:15]
    ds_read_b128 v[36:39], v150 offset:9216
    s_waitcnt lgkmcnt(6)
    v_mfma_f32_32x32x16_bf16 v[0:15], a[8:11], v[40:43], v[0:15]
    ds_read_b128 v[40:43], v150 offset:10240
    v_mfma_f32_32x32x16_bf16 v[0:15], a[12:15], v[44:47], v[0:15]
    ds_read_b128 v[44:47], v150 offset:11264
    s_waitcnt lgkmcnt(6)
    v_mfma_f32_32x32x16_bf16 v[0:15], a[16:19], v[48:51], v[0:15]
    ds_read_b128 v[48:51], v150 offset:12288
    v_mfma_f32_32x32x16_bf16 v[0:15], a[20:23], v[52:55], v[0:15]
    ds_read_b128 v[52:55], v150 offset:13312
    v_mul_f32 v16, s50, v16
    v_mul_f32 v17, s50, v17
    s_waitcnt lgkmcnt(6)
    v_mfma_f32_32x32x16_bf16 v[0:15], a[24:27], v[56:59], v[0:15]
    ds_read_b128 v[56:59], v150 offset:14336
    v_mul_f32 v18, s50, v18
    v_mul_f32 v19, s50, v19
    v_mfma_f32_32x32x16_bf16 v[0:15], a[28:31], v[60:63], v[0:15]
    ds_read_b128 v[60:63], v150 offset:15360
    v_mul_f32 v20, s50, v20
    v_mul_f32 v21, s50, v21
    s_waitcnt lgkmcnt(6)
    v_mfma_f32_32x32x16_bf16 v[0:15], a[32:35], v[32:35], v[0:15]
    ds_read_b128 v[32:35], v150 offset:16384
    v_mul_f32 v22, s50, v22
    v_mul_f32 v23, s50, v23
    v_mfma_f32_32x32x16_bf16 v[0:15], a[36:39], v[36:39], v[0:15]
    ds_read_b128 v[36:39], v150 offset:17408
    v_mul_f32 v24, s50, v24
    v_mul_f32 v25, s50, v25
    s_waitcnt lgkmcnt(6)
    v_mfma_f32_32x32x16_bf16 v[0:15], a[40:43], v[40:43], v[0:15]
    ds_read_b128 v[40:43], v150 offset:18432
    v_mul_f32 v26, s50, v26
    v_mul_f32 v27, s50, v27
    v_mfma_f32_32x32x16_bf16 v[0:15], a[44:47], v[44:47], v[0:15]
    ds_read_b128 v[44:47], v150 offset:19456
    v_mul_f32 v28, s50, v28
    v_mul_f32 v29, s50, v29
    s_waitcnt lgkmcnt(6)
    v_mfma_f32_32x32x16_bf16 v[0:15], a[48:51], v[48:51], v[0:15]
    ds_read_b128 v[48:51], v150 offset:20480
    v_mul_f32 v30, s50, v30
    v_mul_f32 v31, s50, v31
    v_mfma_f32_32x32x16_bf16 v[0:15], a[52:55], v[52:55], v[0:15]
    ds_read_b128 v[52:55], v150 offset:21504
    v_cvt_pk_bf16_f32 v64, v16, v17
    v_cvt_pk_bf16_f32 v65, v18, v19
    s_waitcnt lgkmcnt(6)
    v_mfma_f32_32x32x16_bf16 v[0:15], a[56:59], v[56:59], v[0:15]
    ds_read_b128 v[56:59], v150 offset:22528
    v_cvt_pk_bf16_f32 v66, v20, v21
    v_cvt_pk_bf16_f32 v67, v22, v23
    v_mfma_f32_32x32x16_bf16 v[0:15], a[60:63], v[60:63], v[0:15]
    ds_read_b128 v[60:63], v150 offset:23552
    v_cvt_pk_bf16_f32 v68, v24, v25
    v_cvt_pk_bf16_f32 v69, v26, v27
    s_waitcnt lgkmcnt(6)
    v_mfma_f32_32x32x16_bf16 v[0:15], a[64:67], v[32:35], v[0:15]
    ds_read_b128 v[32:35], v150 offset:24576
    v_cvt_pk_bf16_f32 v70, v28, v29
    v_cvt_pk_bf16_f32 v71, v30, v31
    v_mfma_f32_32x32x16_bf16 v[0:15], a[68:71], v[36:39], v[0:15]
    ds_read_b128 v[36:39], v150 offset:25600
    global_store_dwordx4 v150, v[64:67], s[42:43] offset:0 sc1
    global_store_dwordx4 v150, v[68:71], s[42:43] offset:1024 sc1
    s_waitcnt lgkmcnt(6)
    v_mfma_f32_32x32x16_bf16 v[0:15], a[72:75], v[40:43], v[0:15]
    ds_read_b128 v[40:43], v150 offset:26624
    s_add_u32 s42, s42, s54
    s_addc_u32 s43, s43, 0
    v_mfma_f32_32x32x16_bf16 v[0:15], a[76:79], v[44:47], v[0:15]
    ds_read_b128 v[44:47], v150 offset:27648
    s_waitcnt vmcnt(11)
    s_barrier
    s_mov_b64 exec, 1
    global_store_dword v152, v153, s[46:47] sc1
    s_mov_b64 exec, -1
    s_add_u32 s46, s46, s55
    s_addc_u32 s47, s47, 0
    s_waitcnt lgkmcnt(6)
    v_mfma_f32_32x32x16_bf16 v[0:15], a[80:83], v[48:51], v[0:15]
    ds_read_b128 v[48:51], v150 offset:28672
    v_mfma_f32_32x32x16_bf16 v[0:15], a[84:87], v[52:55], v[0:15]
    ds_read_b128 v[52:55], v150 offset:29696
    s_add_u32 m0, s52, 98304
    s_waitcnt lgkmcnt(6)
    v_mfma_f32_32x32x16_bf16 v[0:15], a[88:91], v[56:59], v[0:15]
    ds_read_b128 v[56:59], v150 offset:30720
    global_load_lds_dwordx4 v150, s[38:39] offset:0 sc1
    v_mfma_f32_32x32x16_bf16 v[0:15], a[92:95], v[60:63], v[0:15]
    ds_read_b128 v[60:63], v150 offset:31744
    global_load_lds_dwordx4 v150, s[38:39] offset:1024 sc1
    s_waitcnt lgkmcnt(6)
    v_mfma_f32_32x32x16_bf16 v[0:15], a[96:99], v[32:35], v[0:15]
    ds_read_b128 v[32:35], v150 offset:32768
    global_load_lds_dwordx4 v150, s[38:39] offset:2048 sc1
    v_mfma_f32_32x32x16_bf16 v[0:15], a[100:103], v[36:39], v[0:15]
    ds_read_b128 v[36:39], v150 offset:33792
    global_load_lds_dwordx4 v150, s[38:39] offset:3072 sc1
    s_add_u32 s38, s38, 4096
    s_addc_u32 s39, s39, 0
    s_waitcnt lgkmcnt(6)
    v_mfma_f32_32x32x16_bf16 v[0:15], a[104:107], v[40:43], v[0:15]
    ds_read_b128 v[40:43], v150 offset:34816
    s_add_u32 m0, s52, 102400
    v_mfma_f32_32x32x16_bf16 v[0:15], a[108:111], v[44:47], v[0:15]
    ds_read_b128 v[44:47], v150 offset:35840
    global_load_lds_dwordx4 v150, s[38:39] offset:0 sc1
    s_waitcnt lgkmcnt(6)
    v_mfma_f32_32x32x16_bf16 v[0:15], a[112:115], v[48:51], v[0:15]
    ds_read_b128 v[48:51], v150 offset:36864
    global_load_lds_dwordx4 v150, s[38:39] offset:1024 sc1
    v_mfma_f32_32x32x16_bf16 v[0:15], a[116:119], v[52:55], v[0:15]
    ds_read_b128 v[52:55], v150 offset:37888
    global_load_lds_dwordx4 v150, s[38:39] offset:2048 sc1
    s_waitcnt lgkmcnt(6)
    v_mfma_f32_32x32x16_bf16 v[0:15], a[120:123], v[56:59], v[0:15]
    ds_read_b128 v[56:59], v150 offset:38912
    global_load_lds_dwordx4 v150, s[38:39] offset:3072 sc1
    s_add_u32 s38, s38, s53
    s_addc_u32 s39, s39, 0
    v_mfma_f32_32x32x16_bf16 v[0:15], a[124:127], v[60:63], v[0:15]
    ds_read_b128 v[60:63], v150 offset:39936
    s_waitcnt lgkmcnt(6)
    v_mfma_f32_32x32x16_bf16 v[16:31], a[0:3], v[32:35], 0
    ds_read_b128 v[32:35], v150 offset:40960
    v_mfma_f32_32x32x16_bf16 v[16:31], a[4:7], v[36:39], v[16:31]
    ds_read_b128 v[36:39], v150 offset:41984
    s_waitcnt lgkmcnt(6)
    v_mfma_f32_32x32x16_bf16 v[16:31], a[8:11], v[40:43], v[16:31]
    ds_read_b128 v[40:43], v150 offset:43008
    v_mfma_f32_32x32x16_bf16 v[16:31], a[12:15], v[44:47], v[16:31]
    ds_read_b128 v[44:47], v150 offset:44032
    s_waitcnt lgkmcnt(6)
    v_mfma_f32_32x32x16_bf16 v[16:31], a[16:19], v[48:51], v[16:31]
    ds_read_b128 v[48:51], v150 offset:45056
    v_mfma_f32_32x32x16_bf16 v[16:31], a[20:23], v[52:55], v[16:31]
    ds_read_b128 v[52:55], v150 offset:46080
    v_mul_f32 v0, s50, v0
    v_mul_f32 v1, s50, v1
    s_waitcnt lgkmcnt(6)
    v_mfma_f32_32x32x16_bf16 v[16:31], a[24:27], v[56:59], v[16:31]
    ds_read_b128 v[56:59], v150 offset:47104
    v_mul_f32 v2, s50, v2
    v_mul_f32 v3, s50, v3
    v_mfma_f32_32x32x16_bf16 v[16:31], a[28:31], v[60:63], v[16:31]
    ds_read_b128 v[60:63], v150 offset:48128
    v_mul_f32 v4, s50, v4
    v_mul_f32 v5, s50, v5
    s_waitcnt lgkmcnt(6)
    v_mfma_f32_32x32x16_bf16 v[16:31], a[32:35], v[32:35], v[16:31]
    ds_read_b128 v[32:35], v150 offset:49152
    v_mul_f32 v6, s50, v6
    v_mul_f32 v7, s50, v7
    v_mfma_f32_32x32x16_bf16 v[16:31], a[36:39], v[36:39], v[16:31]
    ds_read_b128 v[36:39], v150 offset:50176
    v_mul_f32 v8, s50, v8
    v_mul_f32 v9, s50, v9
    s_waitcnt lgkmcnt(6)
    v_mfma_f32_32x32x16_bf16 v[16:31], a[40:43], v[40:43], v[16:31]
    ds_read_b128 v[40:43], v150 offset:51200
    v_mul_f32 v10, s50, v10
    v_mul_f32 v11, s50, v11
    v_mfma_f32_32x32x16_bf16 v[16:31], a[44:47], v[44:47], v[16:31]
    ds_read_b128 v[44:47], v150 offset:52224
    v_mul_f32 v12, s50, v12
    v_mul_f32 v13, s50, v13
    s_waitcnt lgkmcnt(6)
    v_mfma_f32_32x32x16_bf16 v[16:31], a[48:51], v[48:51], v[16:31]
    ds_read_b128 v[48:51], v150 offset:53248
    v_mul_f32 v14, s50, v14
    v_mul_f32 v15, s50, v15
    v_mfma_f32_32x32x16_bf16 v[16:31], a[52:55], v[52:55], v[16:31]
    ds_read_b128 v[52:55], v150 offset:54272
    v_cvt_pk_bf16_f32 v64, v0, v1
    v_cvt_pk_bf16_f32 v65, v2, v3
    s_waitcnt lgkmcnt(6)
    v_mfma_f32_32x32x16_bf16 v[16:31], a[56:59], v[56:59], v[16:31]
    ds_read_b128 v[56:59], v150 offset:55296
    v_cvt_pk_bf16_f32 v66, v4, v5
    v_cvt_pk_bf16_f32 v67, v6, v7
    v_mfma_f32_32x32x16_bf16 v[16:31], a[60:63], v[60:63], v[16:31]
    ds_read_b128 v[60:63], v150 offset:56320
    v_cvt_pk_bf16_f32 v68, v8, v9
    v_cvt_pk_bf16_f32 v69, v10, v11
    s_waitcnt lgkmcnt(6)
    v_mfma_f32_32x32x16_bf16 v[16:31], a[64:67], v[32:35], v[16:31]
    ds_read_b128 v[32:35], v150 offset:57344
    v_cvt_pk_bf16_f32 v70, v12, v13
    v_cvt_pk_bf16_f32 v71, v14, v15
    v_mfma_f32_32x32x16_bf16 v[16:31], a[68:71], v[36:39], v[16:31]
    ds_read_b128 v[36:39], v150 offset:58368
    global_store_dwordx4 v150, v[64:67], s[42:43] offset:0 sc1
    global_store_dwordx4 v150, v[68:71], s[42:43] offset:1024 sc1
    s_waitcnt lgkmcnt(6)
    v_mfma_f32_32x32x16_bf16 v[16:31], a[72:75], v[40:43], v[16:31]
    ds_read_b128 v[40:43], v150 offset:59392
    s_add_u32 s42, s42, s54
    s_addc_u32 s43, s43, 0
    v_mfma_f32_32x32x16_bf16 v[16:31], a[76:79], v[44:47], v[16:31]
    ds_read_b128 v[44:47], v150 offset:60416
    s_waitcnt vmcnt(11)
    s_barrier
    s_mov_b64 exec, 1
    global_store_dword v152, v153, s[46:47] sc1
    s_mov_b64 exec, -1
    s_add_u32 s46, s46, s55
    s_addc_u32 s47, s47, 0
    s_waitcnt lgkmcnt(6)
    v_mfma_f32_32x32x16_bf16 v[16:31], a[80:83], v[48:51], v[16:31]
    ds_read_b128 v[48:51], v150 offset:61440
    v_mfma_f32_32x32x16_bf16 v[16:31], a[84:87], v[52:55], v[16:31]
    ds_read_b128 v[52:55], v150 offset:62464
    s_waitcnt lgkmcnt(6)
    v_mfma_f32_32x32x16_bf16 v[16:31], a[88:91], v[56:59], v[16:31]
    ds_read_b128 v[56:59], v150 offset:63488
    v_mfma_f32_32x32x16_bf16 v[16:31], a[92:95], v[60:63], v[16:31]
    ds_read_b128 v[60:63], v150 offset:64512
    s_waitcnt lgkmcnt(6)
    v_mfma_f32_32x32x16_bf16 v[16:31], a[96:99], v[32:35], v[16:31]
    ds_read_b128 v[32:35], v151 offset:0
    v_mfma_f32_32x32x16_bf16 v[16:31], a[100:103], v[36:39], v[16:31]
    ds_read_b128 v[36:39], v151 offset:1024
    s_waitcnt lgkmcnt(6)
    v_mfma_f32_32x32x16_bf16 v[16:31], a[104:107], v[40:43], v[16:31]
    ds_read_b128 v[40:43], v151 offset:2048
    v_mfma_f32_32x32x16_bf16 v[16:31], a[108:111], v[44:47], v[16:31]
    ds_read_b128 v[44:47], v151 offset:3072
    s_waitcnt lgkmcnt(6)
    v_mfma_f32_32x32x16_bf16 v[16:31], a[112:115], v[48:51], v[16:31]
    ds_read_b128 v[48:51], v151 offset:4096
    v_mfma_f32_32x32x16_bf16 v[16:31], a[116:119], v[52:55], v[16:31]
    ds_read_b128 v[52:55], v151 offset:5120
    s_waitcnt lgkmcnt(6)
    v_mfma_f32_32x32x16_bf16 v[16:31], a[120:123], v[56:59], v[16:31]
    ds_read_b128 v[56:59], v151 offset:6144
    v_mfma_f32_32x32x16_bf16 v[16:31], a[124:127], v[60:63], v[16:31]
    ds_read_b128 v[60:63], v151 offset:7168
    s_waitcnt lgkmcnt(6)
    v_mfma_f32_32x32x16_bf16 v[0:15], a[0:3], v[32:35], 0
    ds_read_b128 v[32:35], v151 offset:8192
    v_mfma_f32_32x32x16_bf16 v[0:15], a[4:7], v[36:39], v[0:15]
    ds_read_b128 v[36:39], v151 offset:9216
    s_waitcnt lgkmcnt(6)
    v_mfma_f32_32x32x16_bf16 v[0:15], a[8:11], v[40:43], v[0:15]
    ds_read_b128 v[40:43], v151 offset:10240
    v_mfma_f32_32x32x16_bf16 v[0:15], a[12:15], v[44:47], v[0:15]
    ds_read_b128 v[44:47], v151 offset:11264
    s_waitcnt lgkmcnt(6)
    v_mfma_f32_32x32x16_bf16 v[0:15], a[16:19], v[48:51], v[0:15]
    ds_read_b128 v[48:51], v151 offset:12288
    v_mfma_f32_32x32x16_bf16 v[0:15], a[20:23], v[52:55], v[0:15]
    ds_read_b128 v[52:55], v151 offset:13312
    v_mul_f32 v16, s50, v16
    v_mul_f32 v17, s50, v17
    s_waitcnt lgkmcnt(6)
    v_mfma_f32_32x32x16_bf16 v[0:15], a[24:27], v[56:59], v[0:15]
    ds_read_b128 v[56:59], v151 offset:14336
    v_mul_f32 v18, s50, v18
    v_mul_f32 v19, s50, v19
    v_mfma_f32_32x32x16_bf16 v[0:15], a[28:31], v[60:63], v[0:15]
    ds_read_b128 v[60:63], v151 offset:15360
    v_mul_f32 v20, s50, v20
    v_mul_f32 v21, s50, v21
    s_waitcnt lgkmcnt(6)
    v_mfma_f32_32x32x16_bf16 v[0:15], a[32:35], v[32:35], v[0:15]
    ds_read_b128 v[32:35], v151 offset:16384
    v_mul_f32 v22, s50, v22
    v_mul_f32 v23, s50, v23
    v_mfma_f32_32x32x16_bf16 v[0:15], a[36:39], v[36:39], v[0:15]
    ds_read_b128 v[36:39], v151 offset:17408
    v_mul_f32 v24, s50, v24
    v_mul_f32 v25, s50, v25
    s_waitcnt lgkmcnt(6)
    v_mfma_f32_32x32x16_bf16 v[0:15], a[40:43], v[40:43], v[0:15]
    ds_read_b128 v[40:43], v151 offset:18432
    v_mul_f32 v26, s50, v26
    v_mul_f32 v27, s50, v27
    v_mfma_f32_32x32x16_bf16 v[0:15], a[44:47], v[44:47], v[0:15]
    ds_read_b128 v[44:47], v151 offset:19456
    v_mul_f32 v28, s50, v28
    v_mul_f32 v29, s50, v29
    s_waitcnt lgkmcnt(6)
    v_mfma_f32_32x32x16_bf16 v[0:15], a[48:51], v[48:51], v[0:15]
    ds_read_b128 v[48:51], v151 offset:20480
    v_mul_f32 v30, s50, v30
    v_mul_f32 v31, s50, v31
    v_mfma_f32_32x32x16_bf16 v[0:15], a[52:55], v[52:55], v[0:15]
    ds_read_b128 v[52:55], v151 offset:21504
    v_cvt_pk_bf16_f32 v64, v16, v17
    v_cvt_pk_bf16_f32 v65, v18, v19
    s_waitcnt lgkmcnt(6)
    v_mfma_f32_32x32x16_bf16 v[0:15], a[56:59], v[56:59], v[0:15]
    ds_read_b128 v[56:59], v151 offset:22528
    v_cvt_pk_bf16_f32 v66, v20, v21
    v_cvt_pk_bf16_f32 v67, v22, v23
    v_mfma_f32_32x32x16_bf16 v[0:15], a[60:63], v[60:63], v[0:15]
    ds_read_b128 v[60:63], v151 offset:23552
    v_cvt_pk_bf16_f32 v68, v24, v25
    v_cvt_pk_bf16_f32 v69, v26, v27
    s_waitcnt lgkmcnt(6)
    v_mfma_f32_32x32x16_bf16 v[0:15], a[64:67], v[32:35], v[0:15]
    ds_read_b128 v[32:35], v151 offset:24576
    v_cvt_pk_bf16_f32 v70, v28, v29
    v_cvt_pk_bf16_f32 v71, v30, v31
    v_mfma_f32_32x32x16_bf16 v[0:15], a[68:71], v[36:39], v[0:15]
    ds_read_b128 v[36:39], v151 offset:25600
    global_store_dwordx4 v150, v[64:67], s[42:43] offset:0 sc1
    global_store_dwordx4 v150, v[68:71], s[42:43] offset:1024 sc1
    s_waitcnt lgkmcnt(6)
    v_mfma_f32_32x32x16_bf16 v[0:15], a[72:75], v[40:43], v[0:15]
    ds_read_b128 v[40:43], v151 offset:26624
    s_add_u32 s42, s42, s54
    s_addc_u32 s43, s43, 0
    v_mfma_f32_32x32x16_bf16 v[0:15], a[76:79], v[44:47], v[0:15]
    ds_read_b128 v[44:47], v151 offset:27648
    s_waitcnt vmcnt(3)
    s_barrier
    s_mov_b64 exec, 1
    global_store_dword v152, v153, s[46:47] sc1
    s_mov_b64 exec, -1
    s_add_u32 s46, s46, s55
    s_addc_u32 s47, s47, 0
    s_waitcnt lgkmcnt(6)
    v_mfma_f32_32x32x16_bf16 v[0:15], a[80:83], v[48:51], v[0:15]
    ds_read_b128 v[48:51], v151 offset:28672
    v_mfma_f32_32x32x16_bf16 v[0:15], a[84:87], v[52:55], v[0:15]
    ds_read_b128 v[52:55], v151 offset:29696
    s_waitcnt lgkmcnt(6)
    v_mfma_f32_32x32x16_bf16 v[0:15], a[88:91], v[56:59], v[0:15]
    ds_read_b128 v[56:59], v151 offset:30720
    v_mfma_f32_32x32x16_bf16 v[0:15], a[92:95], v[60:63], v[0:15]
    ds_read_b128 v[60:63], v151 offset:31744
    s_waitcnt lgkmcnt(6)
    v_mfma_f32_32x32x16_bf16 v[0:15], a[96:99], v[32:35], v[0:15]
    ds_read_b128 v[32:35], v151 offset:32768
    v_mfma_f32_32x32x16_bf16 v[0:15], a[100:103], v[36:39], v[0:15]
    ds_read_b128 v[36:39], v151 offset:33792
    s_waitcnt lgkmcnt(6)
    v_mfma_f32_32x32x16_bf16 v[0:15], a[104:107], v[40:43], v[0:15]
    ds_read_b128 v[40:43], v151 offset:34816
    v_mfma_f32_32x32x16_bf16 v[0:15], a[108:111], v[44:47], v[0:15]
    ds_read_b128 v[44:47], v151 offset:35840
    s_waitcnt lgkmcnt(6)
    v_mfma_f32_32x32x16_bf16 v[0:15], a[112:115], v[48:51], v[0:15]
    ds_read_b128 v[48:51], v151 offset:36864
    v_mfma_f32_32x32x16_bf16 v[0:15], a[116:119], v[52:55], v[0:15]
    ds_read_b128 v[52:55], v151 offset:37888
    s_waitcnt lgkmcnt(6)
    v_mfma_f32_32x32x16_bf16 v[0:15], a[120:123], v[56:59], v[0:15]
    ds_read_b128 v[56:59], v151 offset:38912
    v_mfma_f32_32x32x16_bf16 v[0:15], a[124:127], v[60:63], v[0:15]
    ds_read_b128 v[60:63], v151 offset:39936
    s_waitcnt lgkmcnt(6)
    v_mfma_f32_32x32x16_bf16 v[16:31], a[0:3], v[32:35], 0
    ds_read_b128 v[32:35], v151 offset:40960
    v_mfma_f32_32x32x16_bf16 v[16:31], a[4:7], v[36:39], v[16:31]
    ds_read_b128 v[36:39], v151 offset:41984
    s_waitcnt lgkmcnt(6)
    v_mfma_f32_32x32x16_bf16 v[16:31], a[8:11], v[40:43], v[16:31]
    ds_read_b128 v[40:43], v151 offset:43008
    v_mfma_f32_32x32x16_bf16 v[16:31], a[12:15], v[44:47], v[16:31]
    ds_read_b128 v[44:47], v151 offset:44032
    s_waitcnt lgkmcnt(6)
    v_mfma_f32_32x32x16_bf16 v[16:31], a[16:19], v[48:51], v[16:31]
    ds_read_b128 v[48:51], v151 offset:45056
    v_mfma_f32_32x32x16_bf16 v[16:31], a[20:23], v[52:55], v[16:31]
    ds_read_b128 v[52:55], v151 offset:46080
    v_mul_f32 v0, s50, v0
    v_mul_f32 v1, s50, v1
    s_waitcnt lgkmcnt(6)
    v_mfma_f32_32x32x16_bf16 v[16:31], a[24:27], v[56:59], v[16:31]
    ds_read_b128 v[56:59], v151 offset:47104
    v_mul_f32 v2, s50, v2
    v_mul_f32 v3, s50, v3
    v_mfma_f32_32x32x16_bf16 v[16:31], a[28:31], v[60:63], v[16:31]
    ds_read_b128 v[60:63], v151 offset:48128
    v_mul_f32 v4, s50, v4
    v_mul_f32 v5, s50, v5
    s_waitcnt lgkmcnt(6)
    v_mfma_f32_32x32x16_bf16 v[16:31], a[32:35], v[32:35], v[16:31]
    ds_read_b128 v[32:35], v151 offset:49152
    v_mul_f32 v6, s50, v6
    v_mul_f32 v7, s50, v7
    v_mfma_f32_32x32x16_bf16 v[16:31], a[36:39], v[36:39], v[16:31]
    ds_read_b128 v[36:39], v151 offset:50176
    v_mul_f32 v8, s50, v8
    v_mul_f32 v9, s50, v9
    s_waitcnt lgkmcnt(6)
    v_mfma_f32_32x32x16_bf16 v[16:31], a[40:43], v[40:43], v[16:31]
    ds_read_b128 v[40:43], v151 offset:51200
    v_mul_f32 v10, s50, v10
    v_mul_f32 v11, s50, v11
    v_mfma_f32_32x32x16_bf16 v[16:31], a[44:47], v[44:47], v[16:31]
    ds_read_b128 v[44:47], v151 offset:52224
    v_mul_f32 v12, s50, v12
    v_mul_f32 v13, s50, v13
    s_waitcnt lgkmcnt(6)
    v_mfma_f32_32x32x16_bf16 v[16:31], a[48:51], v[48:51], v[16:31]
    ds_read_b128 v[48:51], v151 offset:53248
    v_mul_f32 v14, s50, v14
    v_mul_f32 v15, s50, v15
    v_mfma_f32_32x32x16_bf16 v[16:31], a[52:55], v[52:55], v[16:31]
    ds_read_b128 v[52:55], v151 offset:54272
    v_cvt_pk_bf16_f32 v64, v0, v1
    v_cvt_pk_bf16_f32 v65, v2, v3
    s_waitcnt lgkmcnt(6)
    v_mfma_f32_32x32x16_bf16 v[16:31], a[56:59], v[56:59], v[16:31]
    ds_read_b128 v[56:59], v151 offset:55296
    v_cvt_pk_bf16_f32 v66, v4, v5
    v_cvt_pk_bf16_f32 v67, v6, v7
    v_mfma_f32_32x32x16_bf16 v[16:31], a[60:63], v[60:63], v[16:31]
    ds_read_b128 v[60:63], v151 offset:56320
    v_cvt_pk_bf16_f32 v68, v8, v9
    v_cvt_pk_bf16_f32 v69, v10, v11
    s_waitcnt lgkmcnt(6)
    v_mfma_f32_32x32x16_bf16 v[16:31], a[64:67], v[32:35], v[16:31]
    ds_read_b128 v[32:35], v151 offset:57344
    v_cvt_pk_bf16_f32 v70, v12, v13
    v_cvt_pk_bf16_f32 v71, v14, v15
    v_mfma_f32_32x32x16_bf16 v[16:31], a[68:71], v[36:39], v[16:31]
    ds_read_b128 v[36:39], v151 offset:58368
    global_store_dwordx4 v150, v[64:67], s[42:43] offset:0 sc1
    global_store_dwordx4 v150, v[68:71], s[42:43] offset:1024 sc1
    s_waitcnt lgkmcnt(6)
    v_mfma_f32_32x32x16_bf16 v[16:31], a[72:75], v[40:43], v[16:31]
    ds_read_b128 v[40:43], v151 offset:59392
    s_add_u32 s42, s42, s54
    s_addc_u32 s43, s43, 0
    v_mfma_f32_32x32x16_bf16 v[16:31], a[76:79], v[44:47], v[16:31]
    ds_read_b128 v[44:47], v151 offset:60416
    s_waitcnt vmcnt(3)
    s_mov_b64 exec, 1
    global_store_dword v152, v153, s[46:47] sc1
    s_mov_b64 exec, -1
    s_add_u32 s46, s46, s55
    s_addc_u32 s47, s47, 0
    s_waitcnt lgkmcnt(6)
    v_mfma_f32_32x32x16_bf16 v[16:31], a[80:83], v[48:51], v[16:31]
    ds_read_b128 v[48:51], v151 offset:61440
    v_mfma_f32_32x32x16_bf16 v[16:31], a[84:87], v[52:55], v[16:31]
    ds_read_b128 v[52:55], v151 offset:62464
    s_waitcnt lgkmcnt(6)
    v_mfma_f32_32x32x16_bf16 v[16:31], a[88:91], v[56:59], v[16:31]
    ds_read_b128 v[56:59], v151 offset:63488
    v_mfma_f32_32x32x16_bf16 v[16:31], a[92:95], v[60:63], v[16:31]
    ds_read_b128 v[60:63], v151 offset:64512
    s_waitcnt lgkmcnt(6)
    v_mfma_f32_32x32x16_bf16 v[16:31], a[96:99], v[32:35], v[16:31]
    v_mfma_f32_32x32x16_bf16 v[16:31], a[100:103], v[36:39], v[16:31]
    s_waitcnt lgkmcnt(4)
    v_mfma_f32_32x32x16_bf16 v[16:31], a[104:107], v[40:43], v[16:31]
    v_mfma_f32_32x32x16_bf16 v[16:31], a[108:111], v[44:47], v[16:31]
    s_waitcnt lgkmcnt(2)
    v_mfma_f32_32x32x16_bf16 v[16:31], a[112:115], v[48:51], v[16:31]
    v_mfma_f32_32x32x16_bf16 v[16:31], a[116:119], v[52:55], v[16:31]
    s_waitcnt lgkmcnt(0)
    v_mfma_f32_32x32x16_bf16 v[16:31], a[120:123], v[56:59], v[16:31]
    v_mfma_f32_32x32x16_bf16 v[16:31], a[124:127], v[60:63], v[16:31]
    s_nop 11
    v_mul_f32 v16, s50, v16
    v_mul_f32 v17, s50, v17
    v_mul_f32 v18, s50, v18
    v_mul_f32 v19, s50, v19
    v_mul_f32 v20, s50, v20
    v_mul_f32 v21, s50, v21
    v_mul_f32 v22, s50, v22
    v_mul_f32 v23, s50, v23
    v_mul_f32 v24, s50, v24
    v_mul_f32 v25, s50, v25
    v_mul_f32 v26, s50, v26
    v_mul_f32 v27, s50, v27
    v_mul_f32 v28, s50, v28
    v_mul_f32 v29, s50, v29
    v_mul_f32 v30, s50, v30
    v_mul_f32 v31, s50, v31
    v_cvt_pk_bf16_f32 v64, v16, v17
    v_cvt_pk_bf16_f32 v65, v18, v19
    v_cvt_pk_bf16_f32 v66, v20, v21
    v_cvt_pk_bf16_f32 v67, v22, v23
    v_cvt_pk_bf16_f32 v68, v24, v25
    v_cvt_pk_bf16_f32 v69, v26, v27
    v_cvt_pk_bf16_f32 v70, v28, v29
    v_cvt_pk_bf16_f32 v71, v30, v31
    global_store_dwordx4 v150, v[64:67], s[42:43] offset:0 sc1
    global_store_dwordx4 v150, v[68:71], s[42:43] offset:1024 sc1
    s_add_u32 s42, s42, s54
    s_addc_u32 s43, s43, 0
    s_branch L_g0_end
L_g0_gv:
    s_waitcnt vmcnt(16)
    s_barrier
    ds_read_b128 v[32:35], v150 offset:0
    ds_read_b128 v[36:39], v150 offset:1024
    ds_read_b128 v[40:43], v150 offset:2048
    ds_read_b128 v[44:47], v150 offset:3072
    ds_read_b128 v[48:51], v150 offset:4096
    ds_read_b128 v[52:55], v150 offset:5120
    ds_read_b128 v[56:59], v150 offset:6144
    ds_read_b128 v[60:63], v150 offset:7168
    s_waitcnt lgkmcnt(6)
    v_mfma_f32_32x32x16_bf16 v[0:15], v[32:35], a[0:3], 0
    ds_read_b128 v[32:35], v150 offset:8192
    v_mfma_f32_32x32x16_bf16 v[0:15], v[36:39], a[4:7], v[0:15]
    ds_read_b128 v[36:39], v150 offset:9216
    s_waitcnt lgkmcnt(6)
    v_mfma_f32_32x32x16_bf16 v[0:15], v[40:43], a[8:11], v[0:15]
    ds_read_b128 v[40:43], v150 offset:10240
    v_mfma_f32_32x32x16_bf16 v[0:15], v[44:47], a[12:15], v[0:15]
    ds_read_b128 v[44:47], v150 offset:11264
    s_waitcnt lgkmcnt(6)
    v_mfma_f32_32x32x16_bf16 v[0:15], v[48:51], a[16:19], v[0:15]
    ds_read_b128 v[48:51], v150 offset:12288
    v_mfma_f32_32x32x16_bf16 v[0:15], v[52:55], a[20:23], v[0:15]
    ds_read_b128 v[52:55], v150 offset:13312
    s_waitcnt lgkmcnt(6)
    v_mfma_f32_32x32x16_bf16 v[0:15], v[56:59], a[24:27], v[0:15]
    ds_read_b128 v[56:59], v150 offset:14336
    v_mfma_f32_32x32x16_bf16 v[0:15], v[60:63], a[28:31], v[0:15]
    ds_read_b128 v[60:63], v150 offset:15360
    s_waitcnt lgkmcnt(6)
    v_mfma_f32_32x32x16_bf16 v[0:15], v[32:35], a[32:35], v[0:15]
    ds_read_b128 v[32:35], v150 offset:16384
    v_mfma_f32_32x32x16_bf16 v[0:15], v[36:39], a[36:39], v[0:15]
    ds_read_b128 v[36:39], v150 offset:17408
    s_waitcnt lgkmcnt(6)
    v_mfma_f32_32x32x16_bf16 v[0:15], v[40:43], a[40:43], v[0:15]
    ds_read_b128 v[40:43], v150 offset:18432
    v_mfma_f32_32x32x16_bf16 v[0:15], v[44:47], a[44:47], v[0:15]
    ds_read_b128 v[44:47], v150 offset:19456
    s_waitcnt lgkmcnt(6)
    v_mfma_f32_32x32x16_bf16 v[0:15], v[48:51], a[48:51], v[0:15]
    ds_read_b128 v[48:51], v150 offset:20480
    v_mfma_f32_32x32x16_bf16 v[0:15], v[52:55], a[52:55], v[0:15]
    ds_read_b128 v[52:55], v150 offset:21504
    s_waitcnt lgkmcnt(6)
    v_mfma_f32_32x32x16_bf16 v[0:15], v[56:59], a[56:59], v[0:15]
    ds_read_b128 v[56:59], v150 offset:22528
    v_mfma_f32_32x32x16_bf16 v[0:15], v[60:63], a[60:63], v[0:15]
    ds_read_b128 v[60:63], v150 offset:23552
    s_waitcnt lgkmcnt(6)
    v_mfma_f32_32x32x16_bf16 v[0:15], v[32:35], a[64:67], v[0:15]
    ds_read_b128 v[32:35], v150 offset:24576
    v_mfma_f32_32x32x16_bf16 v[0:15], v[36:39], a[68:71], v[0:15]
    ds_read_b128 v[36:39], v150 offset:25600
    s_waitcnt lgkmcnt(6)
    v_mfma_f32_32x32x16_bf16 v[0:15], v[40:43], a[72:75], v[0:15]
    ds_read_b128 v[40:43], v150 offset:26624
    v_mfma_f32_32x32x16_bf16 v[0:15], v[44:47], a[76:79], v[0:15]
    ds_read_b128 v[44:47], v150 offset:27648
    s_waitcnt vmcnt(8)
    s_barrier
    s_waitcnt lgkmcnt(6)
    v_mfma_f32_32x32x16_bf16 v[0:15], v[48:51], a[80:83], v[0:15]
    ds_read_b128 v[48:51], v150 offset:28672
    v_mfma_f32_32x32x16_bf16 v[0:15], v[52:55], a[84:87], v[0:15]
    ds_read_b128 v[52:55], v150 offset:29696
    s_add_u32 m0, s52, 98304
    s_waitcnt lgkmcnt(6)
    v_mfma_f32_32x32x16_bf16 v[0:15], v[56:59], a[88:91], v[0:15]
    ds_read_b128 v[56:59], v150 offset:30720
    global_load_lds_dwordx4 v150, s[38:39] offset:0 sc1
    v_mfma_f32_32x32x16_bf16 v[0:15], v[60:63], a[92:95], v[0:15]
    ds_read_b128 v[60:63], v150 offset:31744
    global_load_lds_dwordx4 v150, s[38:39] offset:1024 sc1
    s_waitcnt lgkmcnt(6)
    v_mfma_f32_32x32x16_bf16 v[0:15], v[32:35], a[96:99], v[0:15]
    ds_read_b128 v[32:35], v150 offset:32768
    global_load_lds_dwordx4 v150, s[38:39] offset:2048 sc1
    v_mfma_f32_32x32x16_bf16 v[0:15], v[36:39], a[100:103], v[0:15]
    ds_read_b128 v[36:39], v150 offset:33792
    global_load_lds_dwordx4 v150, s[38:39] offset:3072 sc1
    s_add_u32 s38, s38, 4096
    s_addc_u32 s39, s39, 0
    s_waitcnt lgkmcnt(6)
    v_mfma_f32_32x32x16_bf16 v[0:15], v[40:43], a[104:107], v[0:15]
    ds_read_b128 v[40:43], v150 offset:34816
    s_add_u32 m0, s52, 102400
    v_mfma_f32_32x32x16_bf16 v[0:15], v[44:47], a[108:111], v[0:15]
    ds_read_b128 v[44:47], v150 offset:35840
    global_load_lds_dwordx4 v150, s[38:39] offset:0 sc1
    s_waitcnt lgkmcnt(6)
    v_mfma_f32_32x32x16_bf16 v[0:15], v[48:51], a[112:115], v[0:15]
    ds_read_b128 v[48:51], v150 offset:36864
    global_load_lds_dwordx4 v150, s[38:39] offset:1024 sc1
    v_mfma_f32_32x32x16_bf16 v[0:15], v[52:55], a[116:119], v[0:15]
    ds_read_b128 v[52:55], v150 offset:37888
    global_load_lds_dwordx4 v150, s[38:39] offset:2048 sc1
    s_waitcnt lgkmcnt(6)
    v_mfma_f32_32x32x16_bf16 v[0:15], v[56:59], a[120:123], v[0:15]
    ds_read_b128 v[56:59], v150 offset:38912
    global_load_lds_dwordx4 v150, s[38:39] offset:3072 sc1
    s_add_u32 s38, s38, s53
    s_addc_u32 s39, s39, 0
    v_mfma_f32_32x32x16_bf16 v[0:15], v[60:63], a[124:127], v[0:15]
    ds_read_b128 v[60:63], v150 offset:39936
    s_waitcnt lgkmcnt(6)
    v_mfma_f32_32x32x16_bf16 v[16:31], v[32:35], a[0:3], 0
    ds_read_b128 v[32:35], v150 offset:40960
    v_mfma_f32_32x32x16_bf16 v[16:31], v[36:39], a[4:7], v[16:31]
    ds_read_b128 v[36:39], v150 offset:41984
    s_waitcnt lgkmcnt(6)
    v_mfma_f32_32x32x16_bf16 v[16:31], v[40:43], a[8:11], v[16:31]
    ds_read_b128 v[40:43], v150 offset:43008
    v_mfma_f32_32x32x16_bf16 v[16:31], v[44:47], a[12:15], v[16:31]
    ds_read_b128 v[44:47], v150 offset:44032
    s_waitcnt lgkmcnt(6)
    v_mfma_f32_32x32x16_bf16 v[16:31], v[48:51], a[16:19], v[16:31]
    ds_read_b128 v[48:51], v150 offset:45056
    v_mfma_f32_32x32x16_bf16 v[16:31], v[52:55], a[20:23], v[16:31]
    ds_read_b128 v[52:55], v150 offset:46080
    v_cvt_pk_bf16_f32 v64, v0, v1
    s_waitcnt lgkmcnt(6)
    v_mfma_f32_32x32x16_bf16 v[16:31], v[56:59], a[24:27], v[16:31]
    ds_read_b128 v[56:59], v150 offset:47104
    v_cvt_pk_bf16_f32 v65, v2, v3
    v_mfma_f32_32x32x16_bf16 v[16:31], v[60:63], a[28:31], v[16:31]
    ds_read_b128 v[60:63], v150 offset:48128
    v_cvt_pk_bf16_f32 v66, v4, v5
    s_waitcnt lgkmcnt(6)
    v_mfma_f32_32x32x16_bf16 v[16:31], v[32:35], a[32:35], v[16:31]
    ds_read_b128 v[32:35], v150 offset:49152
    v_cvt_pk_bf16_f32 v67, v6, v7
    v_mfma_f32_32x32x16_bf16 v[16:31], v[36:39], a[36:39], v[16:31]
    ds_read_b128 v[36:39], v150 offset:50176
    v_cvt_pk_bf16_f32 v68, v8, v9
    s_waitcnt lgkmcnt(6)
    v_mfma_f32_32x32x16_bf16 v[16:31], v[40:43], a[40:43], v[16:31]
    ds_read_b128 v[40:43], v150 offset:51200
    v_cvt_pk_bf16_f32 v69, v10, v11
    v_mfma_f32_32x32x16_bf16 v[16:31], v[44:47], a[44:47], v[16:31]
    ds_read_b128 v[44:47], v150 offset:52224
    v_cvt_pk_bf16_f32 v70, v12, v13
    s_waitcnt lgkmcnt(6)
    v_mfma_f32_32x32x16_bf16 v[16:31], v[48:51], a[48:51], v[16:31]
    ds_read_b128 v[48:51], v150 offset:53248
    v_cvt_pk_bf16_f32 v71, v14, v15
    v_mfma_f32_32x32x16_bf16 v[16:31], v[52:55], a[52:55], v[16:31]
    ds_read_b128 v[52:55], v150 offset:54272
    global_store_dwordx4 v150, v[64:67], s[42:43] offset:0 sc1
    s_waitcnt lgkmcnt(6)
    v_mfma_f32_32x32x16_bf16 v[16:31], v[56:59], a[56:59], v[16:31]
    ds_read_b128 v[56:59], v150 offset:55296
    global_store_dwordx4 v150, v[68:71], s[42:43] offset:1024 sc1
    v_mfma_f32_32x32x16_bf16 v[16:31], v[60:63], a[60:63], v[16:31]
    ds_read_b128 v[60:63], v150 offset:56320
    s_add_u32 s42, s42, s54
    s_waitcnt lgkmcnt(6)
    v_mfma_f32_32x32x16_bf16 v[16:31], v[32:35], a[64:67], v[16:31]
    ds_read_b128 v[32:35], v150 offset:57344
    s_addc_u32 s43, s43, 0
    v_mfma_f32_32x32x16_bf16 v[16:31], v[36:39], a[68:71], v[16:31]
    ds_read_b128 v[36:39], v150 offset:58368
    s_waitcnt lgkmcnt(6)
    v_mfma_f32_32x32x16_bf16 v[16:31], v[40:43], a[72:75], v[16:31]
    ds_read_b128 v[40:43], v150 offset:59392
    v_mfma_f32_32x32x16_bf16 v[16:31], v[44:47], a[76:79], v[16:31]
    ds_read_b128 v[44:47], v150 offset:60416
    s_waitcnt vmcnt(10)
    s_barrier
    s_waitcnt lgkmcnt(6)
    v_mfma_f32_32x32x16_bf16 v[16:31], v[48:51], a[80:83], v[16:31]
    ds_read_b128 v[48:51], v150 offset:61440
    v_mfma_f32_32x32x16_bf16 v[16:31], v[52:55], a[84:87], v[16:31]
    ds_read_b128 v[52:55], v150 offset:62464
    s_add_u32 m0, s52, 0
    s_waitcnt lgkmcnt(6)
    v_mfma_f32_32x32x16_bf16 v[16:31], v[56:59], a[88:91], v[16:31]
    ds_read_b128 v[56:59], v150 offset:63488
    global_load_lds_dwordx4 v150, s[38:39] offset:0 sc1
    v_mfma_f32_32x32x16_bf16 v[16:31], v[60:63], a[92:95], v[16:31]
    ds_read_b128 v[60:63], v150 offset:64512
    global_load_lds_dwordx4 v150, s[38:39] offset:1024 sc1
    s_waitcnt lgkmcnt(6)
    v_mfma_f32_32x32x16_bf16 v[16:31], v[32:35], a[96:99], v[16:31]
    ds_read_b128 v[32:35], v151 offset:0
    global_load_lds_dwordx4 v150, s[38:39] offset:2048 sc1
    v_mfma_f32_32x32x16_bf16 v[16:31], v[36:39], a[100:103], v[16:31]
    ds_read_b128 v[36:39], v151 offset:1024
    global_load_lds_dwordx4 v150, s[38:39] offset:3072 sc1
    s_add_u32 s38, s38, 4096
    s_addc_u32 s39, s39, 0
    s_waitcnt lgkmcnt(6)
    v_mfma_f32_32x32x16_bf16 v[16:31], v[40:43], a[104:107], v[16:31]
    ds_read_b128 v[40:43], v151 offset:2048
    s_add_u32 m0, s52, 4096
    v_mfma_f32_32x32x16_bf16 v[16:31], v[44:47], a[108:111], v[16:31]
    ds_read_b128 v[44:47], v151 offset:3072
    global_load_lds_dwordx4 v150, s[38:39] offset:0 sc1
    s_waitcnt lgkmcnt(6)
    v_mfma_f32_32x32x16_bf16 v[16:31], v[48:51], a[112:115], v[16:31]
    ds_read_b128 v[48:51], v151 offset:4096
    global_load_lds_dwordx4 v150, s[38:39] offset:1024 sc1
    v_mfma_f32_32x32x16_bf16 v[16:31], v[52:55], a[116:119], v[16:31]
    ds_read_b128 v[52:55], v151 offset:5120
    global_load_lds_dwordx4 v150, s[38:39] offset:2048 sc1
    s_waitcnt lgkmcnt(6)
    v_mfma_f32_32x32x16_bf16 v[16:31], v[56:59], a[120:123], v[16:31]
    ds_read_b128 v[56:59], v151 offset:6144
    global_load_lds_dwordx4 v150, s[38:39] offset:3072 sc1
    s_add_u32 s38, s38, s53
    s_addc_u32 s39, s39, 0
    v_mfma_f32_32x32x16_bf16 v[16:31], v[60:63], a[124:127], v[16:31]
    ds_read_b128 v[60:63], v151 offset:7168
    s_waitcnt lgkmcnt(6)
    v_mfma_f32_32x32x16_bf16 v[0:15], v[32:35], a[0:3], 0
    ds_read_b128 v[32:35], v151 offset:8192
    v_mfma_f32_32x32x16_bf16 v[0:15], v[36:39], a[4:7], v[0:15]
    ds_read_b128 v[36:39], v151 offset:9216
    s_waitcnt lgkmcnt(6)
    v_mfma_f32_32x32x16_bf16 v[0:15], v[40:43], a[8:11], v[0:15]
    ds_read_b128 v[40:43], v151 offset:10240
    v_mfma_f32_32x32x16_bf16 v[0:15], v[44:47], a[12:15], v[0:15]
    ds_read_b128 v[44:47], v151 offset:11264
    s_waitcnt lgkmcnt(6)
    v_mfma_f32_32x32x16_bf16 v[0:15], v[48:51], a[16:19], v[0:15]
    ds_read_b128 v[48:51], v151 offset:12288
    v_mfma_f32_32x32x16_bf16 v[0:15], v[52:55], a[20:23], v[0:15]
    ds_read_b128 v[52:55], v151 offset:13312
    v_cvt_pk_bf16_f32 v64, v16, v17
    s_waitcnt lgkmcnt(6)
    v_mfma_f32_32x32x16_bf16 v[0:15], v[56:59], a[24:27], v[0:15]
    ds_read_b128 v[56:59], v151 offset:14336
    v_cvt_pk_bf16_f32 v65, v18, v19
    v_mfma_f32_32x32x16_bf16 v[0:15], v[60:63], a[28:31], v[0:15]
    ds_read_b128 v[60:63], v151 offset:15360
    v_cvt_pk_bf16_f32 v66, v20, v21
    s_waitcnt lgkmcnt(6)
    v_mfma_f32_32x32x16_bf16 v[0:15], v[32:35], a[32:35], v[0:15]
    ds_read_b128 v[32:35], v151 offset:16384
    v_cvt_pk_bf16_f32 v67, v22, v23
    v_mfma_f32_32x32x16_bf16 v[0:15], v[36:39], a[36:39], v[0:15]
    ds_read_b128 v[36:39], v151 offset:17408
    v_cvt_pk_bf16_f32 v68, v24, v25
    s_waitcnt lgkmcnt(6)
    v_mfma_f32_32x32x16_bf16 v[0:15], v[40:43], a[40:43], v[0:15]
    ds_read_b128 v[40:43], v151 offset:18432
    v_cvt_pk_bf16_f32 v69, v26, v27
    v_mfma_f32_32x32x16_bf16 v[0:15], v[44:47], a[44:47], v[0:15]
    ds_read_b128 v[44:47], v151 offset:19456
    v_cvt_pk_bf16_f32 v70, v28, v29
    s_waitcnt lgkmcnt(6)
    v_mfma_f32_32x32x16_bf16 v[0:15], v[48:51], a[48:51], v[0:15]
    ds_read_b128 v[48:51], v151 offset:20480
    v_cvt_pk_bf16_f32 v71, v30, v31
    v_mfma_f32_32x32x16_bf16 v[0:15], v[52:55], a[52:55], v[0:15]
    ds_read_b128 v[52:55], v151 offset:21504
    global_store_dwordx4 v150, v[64:67], s[42:43] offset:0 sc1
    s_waitcnt lgkmcnt(6)
    v_mfma_f32_32x32x16_bf16 v[0:15], v[56:59], a[56:59], v[0:15]
    ds_read_b128 v[56:59], v151 offset:22528
    global_store_dwordx4 v150, v[68:71], s[42:43] offset:1024 sc1
    v_mfma_f32_32x32x16_bf16 v[0:15], v[60:63], a[60:63], v[0:15]
    ds_read_b128 v[60:63], v151 offset:23552
    s_add_u32 s42, s42, s54
    s_waitcnt lgkmcnt(6)
    v_mfma_f32_32x32x16_bf16 v[0:15], v[32:35], a[64:67], v[0:15]
    ds_read_b128 v[32:35], v151 offset:24576
    s_addc_u32 s43, s43, 0
    v_mfma_f32_32x32x16_bf16 v[0:15], v[36:39], a[68:71], v[0:15]
    ds_read_b128 v[36:39], v151 offset:25600
    s_waitcnt lgkmcnt(6)
    v_mfma_f32_32x32x16_bf16 v[0:15], v[40:43], a[72:75], v[0:15]
    ds_read_b128 v[40:43], v151 offset:26624
    v_mfma_f32_32x32x16_bf16 v[0:15], v[44:47], a[76:79], v[0:15]
    ds_read_b128 v[44:47], v151 offset:27648
    s_waitcnt vmcnt(10)
    s_barrier
    s_mov_b64 exec, 1
    global_store_dword v152, v153, s[46:47] sc1
    s_mov_b64 exec, -1
    s_add_u32 s46, s46, s55
    s_addc_u32 s47, s47, 0
    s_waitcnt lgkmcnt(6)
    v_mfma_f32_32x32x16_bf16 v[0:15], v[48:51], a[80:83], v[0:15]
    ds_read_b128 v[48:51], v151 offset:28672
    v_mfma_f32_32x32x16_bf16 v[0:15], v[52:55], a[84:87], v[0:15]
    ds_read_b128 v[52:55], v151 offset:29696
    s_add_u32 m0, s52, 32768
    s_waitcnt lgkmcnt(6)
    v_mfma_f32_32x32x16_bf16 v[0:15], v[56:59], a[88:91], v[0:15]
    ds_read_b128 v[56:59], v151 offset:30720
    global_load_lds_dwordx4 v150, s[38:39] offset:0 sc1
    v_mfma_f32_32x32x16_bf16 v[0:15], v[60:63], a[92:95], v[0:15]
    ds_read_b128 v[60:63], v151 offset:31744
    global_load_lds_dwordx4 v150, s[38:39] offset:1024 sc1
    s_waitcnt lgkmcnt(6)
    v_mfma_f32_32x32x16_bf16 v[0:15], v[32:35], a[96:99], v[0:15]
    ds_read_b128 v[32:35], v151 offset:32768
    global_load_lds_dwordx4 v150, s[38:39] offset:2048 sc1
    v_mfma_f32_32x32x16_bf16 v[0:15], v[36:39], a[100:103], v[0:15]
    ds_read_b128 v[36:39], v151 offset:33792
    global_load_lds_dwordx4 v150, s[38:39] offset:3072 sc1
    s_add_u32 s38, s38, 4096
    s_addc_u32 s39, s39, 0
    s_waitcnt lgkmcnt(6)
    v_mfma_f32_32x32x16_bf16 v[0:15], v[40:43], a[104:107], v[0:15]
    ds_read_b128 v[40:43], v151 offset:34816
    s_add_u32 m0, s52, 36864
    v_mfma_f32_32x32x16_bf16 v[0:15], v[44:47], a[108:111], v[0:15]
    ds_read_b128 v[44:47], v151 offset:35840
    global_load_lds_dwordx4 v150, s[38:39] offset:0 sc1
    s_waitcnt lgkmcnt(6)
    v_mfma_f32_32x32x16_bf16 v[0:15], v[48:51], a[112:115], v[0:15]
    ds_read_b128 v[48:51], v151 offset:36864
    global_load_lds_dwordx4 v150, s[38:39] offset:1024 sc1
    v_mfma_f32_32x32x16_bf16 v[0:15], v[52:55], a[116:119], v[0:15]
    ds_read_b128 v[52:55], v151 offset:37888
    global_load_lds_dwordx4 v150, s[38:39] offset:2048 sc1
    s_waitcnt lgkmcnt(6)
    v_mfma_f32_32x32x16_bf16 v[0:15], v[56:59], a[120:123], v[0:15]
    ds_read_b128 v[56:59], v151 offset:38912
    global_load_lds_dwordx4 v150, s[38:39] offset:3072 sc1
    s_add_u32 s38, s38, s53
    s_addc_u32 s39, s39, 0
    v_mfma_f32_32x32x16_bf16 v[0:15], v[60:63], a[124:127], v[0:15]
    ds_read_b128 v[60:63], v151 offset:39936
    s_waitcnt lgkmcnt(6)
    v_mfma_f32_32x32x16_bf16 v[16:31], v[32:35], a[0:3], 0
    ds_read_b128 v[32:35], v151 offset:40960
    v_mfma_f32_32x32x16_bf16 v[16:31], v[36:39], a[4:7], v[16:31]
    ds_read_b128 v[36:39], v151 offset:41984
    s_waitcnt lgkmcnt(6)
    v_mfma_f32_32x32x16_bf16 v[16:31], v[40:43], a[8:11], v[16:31]
    ds_read_b128 v[40:43], v151 offset:43008
    v_mfma_f32_32x32x16_bf16 v[16:31], v[44:47], a[12:15], v[16:31]
    ds_read_b128 v[44:47], v151 offset:44032
    s_waitcnt lgkmcnt(6)
    v_mfma_f32_32x32x16_bf16 v[16:31], v[48:51], a[16:19], v[16:31]
    ds_read_b128 v[48:51], v151 offset:45056
    v_mfma_f32_32x32x16_bf16 v[16:31], v[52:55], a[20:23], v[16:31]
    ds_read_b128 v[52:55], v151 offset:46080
    v_cvt_pk_bf16_f32 v64, v0, v1
    s_waitcnt lgkmcnt(6)
    v_mfma_f32_32x32x16_bf16 v[16:31], v[56:59], a[24:27], v[16:31]
    ds_read_b128 v[56:59], v151 offset:47104
    v_cvt_pk_bf16_f32 v65, v2, v3
    v_mfma_f32_32x32x16_bf16 v[16:31], v[60:63], a[28:31], v[16:31]
    ds_read_b128 v[60:63], v151 offset:48128
    v_cvt_pk_bf16_f32 v66, v4, v5
    s_waitcnt lgkmcnt(6)
    v_mfma_f32_32x32x16_bf16 v[16:31], v[32:35], a[32:35], v[16:31]
    ds_read_b128 v[32:35], v151 offset:49152
    v_cvt_pk_bf16_f32 v67, v6, v7
    v_mfma_f32_32x32x16_bf16 v[16:31], v[36:39], a[36:39], v[16:31]
    ds_read_b128 v[36:39], v151 offset:50176
    v_cvt_pk_bf16_f32 v68, v8, v9
    s_waitcnt lgkmcnt(6)
    v_mfma_f32_32x32x16_bf16 v[16:31], v[40:43], a[40:43], v[16:31]
    ds_read_b128 v[40:43], v151 offset:51200
    v_cvt_pk_bf16_f32 v69, v10, v11
    v_mfma_f32_32x32x16_bf16 v[16:31], v[44:47], a[44:47], v[16:31]
    ds_read_b128 v[44:47], v151 offset:52224
    v_cvt_pk_bf16_f32 v70, v12, v13
    s_waitcnt lgkmcnt(6)
    v_mfma_f32_32x32x16_bf16 v[16:31], v[48:51], a[48:51], v[16:31]
    ds_read_b128 v[48:51], v151 offset:53248
    v_cvt_pk_bf16_f32 v71, v14, v15
    v_mfma_f32_32x32x16_bf16 v[16:31], v[52:55], a[52:55], v[16:31]
    ds_read_b128 v[52:55], v151 offset:54272
    global_store_dwordx4 v150, v[64:67], s[42:43] offset:0 sc1
    s_waitcnt lgkmcnt(6)
    v_mfma_f32_32x32x16_bf16 v[16:31], v[56:59], a[56:59], v[16:31]
    ds_read_b128 v[56:59], v151 offset:55296
    global_store_dwordx4 v150, v[68:71], s[42:43] offset:1024 sc1
    v_mfma_f32_32x32x16_bf16 v[16:31], v[60:63], a[60:63], v[16:31]
    ds_read_b128 v[60:63], v151 offset:56320
    s_add_u32 s42, s42, s54
    s_waitcnt lgkmcnt(6)
    v_mfma_f32_32x32x16_bf16 v[16:31], v[32:35], a[64:67], v[16:31]
    ds_read_b128 v[32:35], v151 offset:57344
    s_addc_u32 s43, s43, 0
    v_mfma_f32_32x32x16_bf16 v[16:31], v[36:39], a[68:71], v[16:31]
    ds_read_b128 v[36:39], v151 offset:58368
    s_waitcnt lgkmcnt(6)
    v_mfma_f32_32x32x16_bf16 v[16:31], v[40:43], a[72:75], v[16:31]
    ds_read_b128 v[40:43], v151 offset:59392
    v_mfma_f32_32x32x16_bf16 v[16:31], v[44:47], a[76:79], v[16:31]
    ds_read_b128 v[44:47], v151 offset:60416
    s_waitcnt vmcnt(11)
    s_barrier
    s_mov_b64 exec, 1
    global_store_dword v152, v153, s[46:47] sc1
    s_mov_b64 exec, -1
    s_add_u32 s46, s46, s55
    s_addc_u32 s47, s47, 0
    s_waitcnt lgkmcnt(6)
    v_mfma_f32_32x32x16_bf16 v[16:31], v[48:51], a[80:83], v[16:31]
    ds_read_b128 v[48:51], v151 offset:61440
    v_mfma_f32_32x32x16_bf16 v[16:31], v[52:55], a[84:87], v[16:31]
    ds_read_b128 v[52:55], v151 offset:62464
    s_add_u32 m0, s52, 65536
    s_waitcnt lgkmcnt(6)
    v_mfma_f32_32x32x16_bf16 v[16:31], v[56:59], a[88:91], v[16:31]
    ds_read_b128 v[56:59], v151 offset:63488
    global_load_lds_dwordx4 v150, s[38:39] offset:0 sc1
    v_mfma_f32_32x32x16_bf16 v[16:31], v[60:63], a[92:95], v[16:31]
    ds_read_b128 v[60:63], v151 offset:64512
    global_load_lds_dwordx4 v150, s[38:39] offset:1024 sc1
    s_waitcnt lgkmcnt(6)
    v_mfma_f32_32x32x16_bf16 v[16:31], v[32:35], a[96:99], v[16:31]
    ds_read_b128 v[32:35], v150 offset:0
    global_load_lds_dwordx4 v150, s[38:39] offset:2048 sc1
    v_mfma_f32_32x32x16_bf16 v[16:31], v[36:39], a[100:103], v[16:31]
    ds_read_b128 v[36:39], v150 offset:1024
    global_load_lds_dwordx4 v150, s[38:39] offset:3072 sc1
    s_add_u32 s38, s38, 4096
    s_addc_u32 s39, s39, 0
    s_waitcnt lgkmcnt(6)
    v_mfma_f32_32x32x16_bf16 v[16:31], v[40:43], a[104:107], v[16:31]
    ds_read_b128 v[40:43], v150 offset:2048
    s_add_u32 m0, s52, 69632
    v_mfma_f32_32x32x16_bf16 v[16:31], v[44:47], a[108:111], v[16:31]
    ds_read_b128 v[44:47], v150 offset:3072
    global_load_lds_dwordx4 v150, s[38:39] offset:0 sc1
    s_waitcnt lgkmcnt(6)
    v_mfma_f32_32x32x16_bf16 v[16:31], v[48:51], a[112:115], v[16:31]
    ds_read_b128 v[48:51], v150 offset:4096
    global_load_lds_dwordx4 v150, s[38:39] offset:1024 sc1
    v_mfma_f32_32x32x16_bf16 v[16:31], v[52:55], a[116:119], v[16:31]
    ds_read_b128 v[52:55], v150 offset:5120
    global_load_lds_dwordx4 v150, s[38:39] offset:2048 sc1
    s_waitcnt lgkmcnt(6)
    v_mfma_f32_32x32x16_bf16 v[16:31], v[56:59], a[120:123], v[16:31]
    ds_read_b128 v[56:59], v150 offset:6144
    global_load_lds_dwordx4 v150, s[38:39] offset:3072 sc1
    s_add_u32 s38, s38, s53
    s_addc_u32 s39, s39, 0
    v_mfma_f32_32x32x16_bf16 v[16:31], v[60:63], a[124:127], v[16:31]
    ds_read_b128 v[60:63], v150 offset:7168
    s_waitcnt lgkmcnt(6)
    v_mfma_f32_32x32x16_bf16 v[0:15], v[32:35], a[0:3], 0
    ds_read_b128 v[32:35], v150 offset:8192
    v_mfma_f32_32x32x16_bf16 v[0:15], v[36:39], a[4:7], v[0:15]
    ds_read_b128 v[36:39], v150 offset:9216
    s_waitcnt lgkmcnt(6)
    v_mfma_f32_32x32x16_bf16 v[0:15], v[40:43], a[8:11], v[0:15]
    ds_read_b128 v[40:43], v150 offset:10240
    v_mfma_f32_32x32x16_bf16 v[0:15], v[44:47], a[12:15], v[0:15]
    ds_read_b128 v[44:47], v150 offset:11264
    s_waitcnt lgkmcnt(6)
    v_mfma_f32_32x32x16_bf16 v[0:15], v[48:51], a[16:19], v[0:15]
    ds_read_b128 v[48:51], v150 offset:12288
    v_mfma_f32_32x32x16_bf16 v[0:15], v[52:55], a[20:23], v[0:15]
    ds_read_b128 v[52:55], v150 offset:13312
    v_cvt_pk_bf16_f32 v64, v16, v17
    s_waitcnt lgkmcnt(6)
    v_mfma_f32_32x32x16_bf16 v[0:15], v[56:59], a[24:27], v[0:15]
    ds_read_b128 v[56:59], v150 offset:14336
    v_cvt_pk_bf16_f32 v65, v18, v19
    v_mfma_f32_32x32x16_bf16 v[0:15], v[60:63], a[28:31], v[0:15]
    ds_read_b128 v[60:63], v150 offset:15360
    v_cvt_pk_bf16_f32 v66, v20, v21
    s_waitcnt lgkmcnt(6)
    v_mfma_f32_32x32x16_bf16 v[0:15], v[32:35], a[32:35], v[0:15]
    ds_read_b128 v[32:35], v150 offset:16384
    v_cvt_pk_bf16_f32 v67, v22, v23
    v_mfma_f32_32x32x16_bf16 v[0:15], v[36:39], a[36:39], v[0:15]
    ds_read_b128 v[36:39], v150 offset:17408
    v_cvt_pk_bf16_f32 v68, v24, v25
    s_waitcnt lgkmcnt(6)
    v_mfma_f32_32x32x16_bf16 v[0:15], v[40:43], a[40:43], v[0:15]
    ds_read_b128 v[40:43], v150 offset:18432
    v_cvt_pk_bf16_f32 v69, v26, v27
    v_mfma_f32_32x32x16_bf16 v[0:15], v[44:47], a[44:47], v[0:15]
    ds_read_b128 v[44:47], v150 offset:19456
    v_cvt_pk_bf16_f32 v70, v28, v29
    s_waitcnt lgkmcnt(6)
    v_mfma_f32_32x32x16_bf16 v[0:15], v[48:51], a[48:51], v[0:15]
    ds_read_b128 v[48:51], v150 offset:20480
    v_cvt_pk_bf16_f32 v71, v30, v31
    v_mfma_f32_32x32x16_bf16 v[0:15], v[52:55], a[52:55], v[0:15]
    ds_read_b128 v[52:55], v150 offset:21504
    global_store_dwordx4 v150, v[64:67], s[42:43] offset:0 sc1
    s_waitcnt lgkmcnt(6)
    v_mfma_f32_32x32x16_bf16 v[0:15], v[56:59], a[56:59], v[0:15]
    ds_read_b128 v[56:59], v150 offset:22528
    global_store_dwordx4 v150, v[68:71], s[42:43] offset:1024 sc1
    v_mfma_f32_32x32x16_bf16 v[0:15], v[60:63], a[60:63], v[0:15]
    ds_read_b128 v[60:63], v150 offset:23552
    s_add_u32 s42, s42, s54
    s_waitcnt lgkmcnt(6)
    v_mfma_f32_32x32x16_bf16 v[0:15], v[32:35], a[64:67], v[0:15]
    ds_read_b128 v[32:35], v150 offset:24576
    s_addc_u32 s43, s43, 0
    v_mfma_f32_32x32x16_bf16 v[0:15], v[36:39], a[68:71], v[0:15]
    ds_read_b128 v[36:39], v150 offset:25600
    s_waitcnt lgkmcnt(6)
    v_mfma_f32_32x32x16_bf16 v[0:15], v[40:43], a[72:75], v[0:15]
    ds_read_b128 v[40:43], v150 offset:26624
    v_mfma_f32_32x32x16_bf16 v[0:15], v[44:47], a[76:79], v[0:15]
    ds_read_b128 v[44:47], v150 offset:27648
    s_waitcnt vmcnt(11)
    s_barrier
    s_mov_b64 exec, 1
    global_store_dword v152, v153, s[46:47] sc1
    s_mov_b64 exec, -1
    s_add_u32 s46, s46, s55
    s_addc_u32 s47, s47, 0
    s_waitcnt lgkmcnt(6)
    v_mfma_f32_32x32x16_bf16 v[0:15], v[48:51], a[80:83], v[0:15]
    ds_read_b128 v[48:51], v150 offset:28672
    v_mfma_f32_32x32x16_bf16 v[0:15], v[52:55], a[84:87], v[0:15]
    ds_read_b128 v[52:55], v150 offset:29696
    s_add_u32 m0, s52, 98304
    s_waitcnt lgkmcnt(6)
    v_mfma_f32_32x32x16_bf16 v[0:15], v[56:59], a[88:91], v[0:15]
    ds_read_b128 v[56:59], v150 offset:30720
    global_load_lds_dwordx4 v150, s[38:39] offset:0 sc1
    v_mfma_f32_32x32x16_bf16 v[0:15], v[60:63], a[92:95], v[0:15]
    ds_read_b128 v[60:63], v150 offset:31744
    global_load_lds_dwordx4 v150, s[38:39] offset:1024 sc1
    s_waitcnt lgkmcnt(6)
    v_mfma_f32_32x32x16_bf16 v[0:15], v[32:35], a[96:99], v[0:15]
    ds_read_b128 v[32:35], v150 offset:32768
    global_load_lds_dwordx4 v150, s[38:39] offset:2048 sc1
    v_mfma_f32_32x32x16_bf16 v[0:15], v[36:39], a[100:103], v[0:15]
    ds_read_b128 v[36:39], v150 offset:33792
    global_load_lds_dwordx4 v150, s[38:39] offset:3072 sc1
    s_add_u32 s38, s38, 4096
    s_addc_u32 s39, s39, 0
    s_waitcnt lgkmcnt(6)
    v_mfma_f32_32x32x16_bf16 v[0:15], v[40:43], a[104:107], v[0:15]
    ds_read_b128 v[40:43], v150 offset:34816
    s_add_u32 m0, s52, 102400
    v_mfma_f32_32x32x16_bf16 v[0:15], v[44:47], a[108:111], v[0:15]
    ds_read_b128 v[44:47], v150 offset:35840
    global_load_lds_dwordx4 v150, s[38:39] offset:0 sc1
    s_waitcnt lgkmcnt(6)
    v_mfma_f32_32x32x16_bf16 v[0:15], v[48:51], a[112:115], v[0:15]
    ds_read_b128 v[48:51], v150 offset:36864
    global_load_lds_dwordx4 v150, s[38:39] offset:1024 sc1
    v_mfma_f32_32x32x16_bf16 v[0:15], v[52:55], a[116:119], v[0:15]
    ds_read_b128 v[52:55], v150 offset:37888
    global_load_lds_dwordx4 v150, s[38:39] offset:2048 sc1
    s_waitcnt lgkmcnt(6)
    v_mfma_f32_32x32x16_bf16 v[0:15], v[56:59], a[120:123], v[0:15]
    ds_read_b128 v[56:59], v150 offset:38912
    global_load_lds_dwordx4 v150, s[38:39] offset:3072 sc1
    s_add_u32 s38, s38, s53
    s_addc_u32 s39, s39, 0
    v_mfma_f32_32x32x16_bf16 v[0:15], v[60:63], a[124:127], v[0:15]
    ds_read_b128 v[60:63], v150 offset:39936
    s_waitcnt lgkmcnt(6)
    v_mfma_f32_32x32x16_bf16 v[16:31], v[32:35], a[0:3], 0
    ds_read_b128 v[32:35], v150 offset:40960
    v_mfma_f32_32x32x16_bf16 v[16:31], v[36:39], a[4:7], v[16:31]
    ds_read_b128 v[36:39], v150 offset:41984
    s_waitcnt lgkmcnt(6)
    v_mfma_f32_32x32x16_bf16 v[16:31], v[40:43], a[8:11], v[16:31]
    ds_read_b128 v[40:43], v150 offset:43008
    v_mfma_f32_32x32x16_bf16 v[16:31], v[44:47], a[12:15], v[16:31]
    ds_read_b128 v[44:47], v150 offset:44032
    s_waitcnt lgkmcnt(6)
    v_mfma_f32_32x32x16_bf16 v[16:31], v[48:51], a[16:19], v[16:31]
    ds_read_b128 v[48:51], v150 offset:45056
    v_mfma_f32_32x32x16_bf16 v[16:31], v[52:55], a[20:23], v[16:31]
    ds_read_b128 v[52:55], v150 offset:46080
    v_cvt_pk_bf16_f32 v64, v0, v1
    s_waitcnt lgkmcnt(6)
    v_mfma_f32_32x32x16_bf16 v[16:31], v[56:59], a[24:27], v[16:31]
    ds_read_b128 v[56:59], v150 offset:47104
    v_cvt_pk_bf16_f32 v65, v2, v3
    v_mfma_f32_32x32x16_bf16 v[16:31], v[60:63], a[28:31], v[16:31]
    ds_read_b128 v[60:63], v150 offset:48128
    v_cvt_pk_bf16_f32 v66, v4, v5
    s_waitcnt lgkmcnt(6)
    v_mfma_f32_32x32x16_bf16 v[16:31], v[32:35], a[32:35], v[16:31]
    ds_read_b128 v[32:35], v150 offset:49152
    v_cvt_pk_bf16_f32 v67, v6, v7
    v_mfma_f32_32x32x16_bf16 v[16:31], v[36:39], a[36:39], v[16:31]
    ds_read_b128 v[36:39], v150 offset:50176
    v_cvt_pk_bf16_f32 v68, v8, v9
    s_waitcnt lgkmcnt(6)
    v_mfma_f32_32x32x16_bf16 v[16:31], v[40:43], a[40:43], v[16:31]
    ds_read_b128 v[40:43], v150 offset:51200
    v_cvt_pk_bf16_f32 v69, v10, v11
    v_mfma_f32_32x32x16_bf16 v[16:31], v[44:47], a[44:47], v[16:31]
    ds_read_b128 v[44:47], v150 offset:52224
    v_cvt_pk_bf16_f32 v70, v12, v13
    s_waitcnt lgkmcnt(6)
    v_mfma_f32_32x32x16_bf16 v[16:31], v[48:51], a[48:51], v[16:31]
    ds_read_b128 v[48:51], v150 offset:53248
    v_cvt_pk_bf16_f32 v71, v14, v15
    v_mfma_f32_32x32x16_bf16 v[16:31], v[52:55], a[52:55], v[16:31]
    ds_read_b128 v[52:55], v150 offset:54272
    global_store_dwordx4 v150, v[64:67], s[42:43] offset:0 sc1
    s_waitcnt lgkmcnt(6)
    v_mfma_f32_32x32x16_bf16 v[16:31], v[56:59], a[56:59], v[16:31]
    ds_read_b128 v[56:59], v150 offset:55296
    global_store_dwordx4 v150, v[68:71], s[42:43] offset:1024 sc1
    v_mfma_f32_32x32x16_bf16 v[16:31], v[60:63], a[60:63], v[16:31]
    ds_read_b128 v[60:63], v150 offset:56320
    s_add_u32 s42, s42, s54
    s_waitcnt lgkmcnt(6)
    v_mfma_f32_32x32x16_bf16 v[16:31], v[32:35], a[64:67], v[16:31]
    ds_read_b128 v[32:35], v150 offset:57344
    s_addc_u32 s43, s43, 0
    v_mfma_f32_32x32x16_bf16 v[16:31], v[36:39], a[68:71], v[16:31]
    ds_read_b128 v[36:39], v150 offset:58368
    s_waitcnt lgkmcnt(6)
    v_mfma_f32_32x32x16_bf16 v[16:31], v[40:43], a[72:75], v[16:31]
    ds_read_b128 v[40:43], v150 offset:59392
    v_mfma_f32_32x32x16_bf16 v[16:31], v[44:47], a[76:79], v[16:31]
    ds_read_b128 v[44:47], v150 offset:60416
    s_waitcnt vmcnt(11)
    s_barrier
    s_mov_b64 exec, 1
    global_store_dword v152, v153, s[46:47] sc1
    s_mov_b64 exec, -1
    s_add_u32 s46, s46, s55
    s_addc_u32 s47, s47, 0
    s_waitcnt lgkmcnt(6)
    v_mfma_f32_32x32x16_bf16 v[16:31], v[48:51], a[80:83], v[16:31]
    ds_read_b128 v[48:51], v150 offset:61440
    v_mfma_f32_32x32x16_bf16 v[16:31], v[52:55], a[84:87], v[16:31]
    ds_read_b128 v[52:55], v150 offset:62464
    s_waitcnt lgkmcnt(6)
    v_mfma_f32_32x32x16_bf16 v[16:31], v[56:59], a[88:91], v[16:31]
    ds_read_b128 v[56:59], v150 offset:63488
    v_mfma_f32_32x32x16_bf16 v[16:31], v[60:63], a[92:95], v[16:31]
    ds_read_b128 v[60:63], v150 offset:64512
    s_waitcnt lgkmcnt(6)
    v_mfma_f32_32x32x16_bf16 v[16:31], v[32:35], a[96:99], v[16:31]
    ds_read_b128 v[32:35], v151 offset:0
    v_mfma_f32_32x32x16_bf16 v[16:31], v[36:39], a[100:103], v[16:31]
    ds_read_b128 v[36:39], v151 offset:1024
    s_waitcnt lgkmcnt(6)
    v_mfma_f32_32x32x16_bf16 v[16:31], v[40:43], a[104:107], v[16:31]
    ds_read_b128 v[40:43], v151 offset:2048
    v_mfma_f32_32x32x16_bf16 v[16:31], v[44:47], a[108:111], v[16:31]
    ds_read_b128 v[44:47], v151 offset:3072
    s_waitcnt lgkmcnt(6)
    v_mfma_f32_32x32x16_bf16 v[16:31], v[48:51], a[112:115], v[16:31]
    ds_read_b128 v[48:51], v151 offset:4096
    v_mfma_f32_32x32x16_bf16 v[16:31], v[52:55], a[116:119], v[16:31]
    ds_read_b128 v[52:55], v151 offset:5120
    s_waitcnt lgkmcnt(6)
    v_mfma_f32_32x32x16_bf16 v[16:31], v[56:59], a[120:123], v[16:31]
    ds_read_b128 v[56:59], v151 offset:6144
    v_mfma_f32_32x32x16_bf16 v[16:31], v[60:63], a[124:127], v[16:31]
    ds_read_b128 v[60:63], v151 offset:7168
    s_waitcnt lgkmcnt(6)
    v_mfma_f32_32x32x16_bf16 v[0:15], v[32:35], a[0:3], 0
    ds_read_b128 v[32:35], v151 offset:8192
    v_mfma_f32_32x32x16_bf16 v[0:15], v[36:39], a[4:7], v[0:15]
    ds_read_b128 v[36:39], v151 offset:9216
    s_waitcnt lgkmcnt(6)
    v_mfma_f32_32x32x16_bf16 v[0:15], v[40:43], a[8:11], v[0:15]
    ds_read_b128 v[40:43], v151 offset:10240
    v_mfma_f32_32x32x16_bf16 v[0:15], v[44:47], a[12:15], v[0:15]
    ds_read_b128 v[44:47], v151 offset:11264
    s_waitcnt lgkmcnt(6)
    v_mfma_f32_32x32x16_bf16 v[0:15], v[48:51], a[16:19], v[0:15]
    ds_read_b128 v[48:51], v151 offset:12288
    v_mfma_f32_32x32x16_bf16 v[0:15], v[52:55], a[20:23], v[0:15]
    ds_read_b128 v[52:55], v151 offset:13312
    v_cvt_pk_bf16_f32 v64, v16, v17
    s_waitcnt lgkmcnt(6)
    v_mfma_f32_32x32x16_bf16 v[0:15], v[56:59], a[24:27], v[0:15]
    ds_read_b128 v[56:59], v151 offset:14336
    v_cvt_pk_bf16_f32 v65, v18, v19
    v_mfma_f32_32x32x16_bf16 v[0:15], v[60:63], a[28:31], v[0:15]
    ds_read_b128 v[60:63], v151 offset:15360
    v_cvt_pk_bf16_f32 v66, v20, v21
    s_waitcnt lgkmcnt(6)
    v_mfma_f32_32x32x16_bf16 v[0:15], v[32:35], a[32:35], v[0:15]
    ds_read_b128 v[32:35], v151 offset:16384
    v_cvt_pk_bf16_f32 v67, v22, v23
    v_mfma_f32_32x32x16_bf16 v[0:15], v[36:39], a[36:39], v[0:15]
    ds_read_b128 v[36:39], v151 offset:17408
    v_cvt_pk_bf16_f32 v68, v24, v25
    s_waitcnt lgkmcnt(6)
    v_mfma_f32_32x32x16_bf16 v[0:15], v[40:43], a[40:43], v[0:15]
    ds_read_b128 v[40:43], v151 offset:18432
    v_cvt_pk_bf16_f32 v69, v26, v27
    v_mfma_f32_32x32x16_bf16 v[0:15], v[44:47], a[44:47], v[0:15]
    ds_read_b128 v[44:47], v151 offset:19456
    v_cvt_pk_bf16_f32 v70, v28, v29
    s_waitcnt lgkmcnt(6)
    v_mfma_f32_32x32x16_bf16 v[0:15], v[48:51], a[48:51], v[0:15]
    ds_read_b128 v[48:51], v151 offset:20480
    v_cvt_pk_bf16_f32 v71, v30, v31
    v_mfma_f32_32x32x16_bf16 v[0:15], v[52:55], a[52:55], v[0:15]
    ds_read_b128 v[52:55], v151 offset:21504
    global_store_dwordx4 v150, v[64:67], s[42:43] offset:0 sc1
    s_waitcnt lgkmcnt(6)
    v_mfma_f32_32x32x16_bf16 v[0:15], v[56:59], a[56:59], v[0:15]
    ds_read_b128 v[56:59], v151 offset:22528
    global_store_dwordx4 v150, v[68:71], s[42:43] offset:1024 sc1
    v_mfma_f32_32x32x16_bf16 v[0:15], v[60:63], a[60:63], v[0:15]
    ds_read_b128 v[60:63], v151 offset:23552
    s_add_u32 s42, s42, s54
    s_waitcnt lgkmcnt(6)
    v_mfma_f32_32x32x16_bf16 v[0:15], v[32:35], a[64:67], v[0:15]
    ds_read_b128 v[32:35], v151 offset:24576
    s_addc_u32 s43, s43, 0
    v_mfma_f32_32x32x16_bf16 v[0:15], v[36:39], a[68:71], v[0:15]
    ds_read_b128 v[36:39], v151 offset:25600
    s_waitcnt lgkmcnt(6)
    v_mfma_f32_32x32x16_bf16 v[0:15], v[40:43], a[72:75], v[0:15]
    ds_read_b128 v[40:43], v151 offset:26624
    v_mfma_f32_32x32x16_bf16 v[0:15], v[44:47], a[76:79], v[0:15]
    ds_read_b128 v[44:47], v151 offset:27648
    s_waitcnt vmcnt(3)
    s_barrier
    s_mov_b64 exec, 1
    global_store_dword v152, v153, s[46:47] sc1
    s_mov_b64 exec, -1
    s_add_u32 s46, s46, s55
    s_addc_u32 s47, s47, 0
    s_waitcnt lgkmcnt(6)
    v_mfma_f32_32x32x16_bf16 v[0:15], v[48:51], a[80:83], v[0:15]
    ds_read_b128 v[48:51], v151 offset:28672
    v_mfma_f32_32x32x16_bf16 v[0:15], v[52:55], a[84:87], v[0:15]
    ds_read_b128 v[52:55], v151 offset:29696
    s_waitcnt lgkmcnt(6)
    v_mfma_f32_32x32x16_bf16 v[0:15], v[56:59], a[88:91], v[0:15]
    ds_read_b128 v[56:59], v151 offset:30720
    v_mfma_f32_32x32x16_bf16 v[0:15], v[60:63], a[92:95], v[0:15]
    ds_read_b128 v[60:63], v151 offset:31744
    s_waitcnt lgkmcnt(6)
    v_mfma_f32_32x32x16_bf16 v[0:15], v[32:35], a[96:99], v[0:15]
    ds_read_b128 v[32:35], v151 offset:32768
    v_mfma_f32_32x32x16_bf16 v[0:15], v[36:39], a[100:103], v[0:15]
    ds_read_b128 v[36:39], v151 offset:33792
    s_waitcnt lgkmcnt(6)
    v_mfma_f32_32x32x16_bf16 v[0:15], v[40:43], a[104:107], v[0:15]
    ds_read_b128 v[40:43], v151 offset:34816
    v_mfma_f32_32x32x16_bf16 v[0:15], v[44:47], a[108:111], v[0:15]
    ds_read_b128 v[44:47], v151 offset:35840
    s_waitcnt lgkmcnt(6)
    v_mfma_f32_32x32x16_bf16 v[0:15], v[48:51], a[112:115], v[0:15]
    ds_read_b128 v[48:51], v151 offset:36864
    v_mfma_f32_32x32x16_bf16 v[0:15], v[52:55], a[116:119], v[0:15]
    ds_read_b128 v[52:55], v151 offset:37888
    s_waitcnt lgkmcnt(6)
    v_mfma_f32_32x32x16_bf16 v[0:15], v[56:59], a[120:123], v[0:15]
    ds_read_b128 v[56:59], v151 offset:38912
    v_mfma_f32_32x32x16_bf16 v[0:15], v[60:63], a[124:127], v[0:15]
    ds_read_b128 v[60:63], v151 offset:39936
    s_waitcnt lgkmcnt(6)
    v_mfma_f32_32x32x16_bf16 v[16:31], v[32:35], a[0:3], 0
    ds_read_b128 v[32:35], v151 offset:40960
    v_mfma_f32_32x32x16_bf16 v[16:31], v[36:39], a[4:7], v[16:31]
    ds_read_b128 v[36:39], v151 offset:41984
    s_waitcnt lgkmcnt(6)
    v_mfma_f32_32x32x16_bf16 v[16:31], v[40:43], a[8:11], v[16:31]
    ds_read_b128 v[40:43], v151 offset:43008
    v_mfma_f32_32x32x16_bf16 v[16:31], v[44:47], a[12:15], v[16:31]
    ds_read_b128 v[44:47], v151 offset:44032
    s_waitcnt lgkmcnt(6)
    v_mfma_f32_32x32x16_bf16 v[16:31], v[48:51], a[16:19], v[16:31]
    ds_read_b128 v[48:51], v151 offset:45056
    v_mfma_f32_32x32x16_bf16 v[16:31], v[52:55], a[20:23], v[16:31]
    ds_read_b128 v[52:55], v151 offset:46080
    v_cvt_pk_bf16_f32 v64, v0, v1
    s_waitcnt lgkmcnt(6)
    v_mfma_f32_32x32x16_bf16 v[16:31], v[56:59], a[24:27], v[16:31]
    ds_read_b128 v[56:59], v151 offset:47104
    v_cvt_pk_bf16_f32 v65, v2, v3
    v_mfma_f32_32x32x16_bf16 v[16:31], v[60:63], a[28:31], v[16:31]
    ds_read_b128 v[60:63], v151 offset:48128
    v_cvt_pk_bf16_f32 v66, v4, v5
    s_waitcnt lgkmcnt(6)
    v_mfma_f32_32x32x16_bf16 v[16:31], v[32:35], a[32:35], v[16:31]
    ds_read_b128 v[32:35], v151 offset:49152
    v_cvt_pk_bf16_f32 v67, v6, v7
    v_mfma_f32_32x32x16_bf16 v[16:31], v[36:39], a[36:39], v[16:31]
    ds_read_b128 v[36:39], v151 offset:50176
    v_cvt_pk_bf16_f32 v68, v8, v9
    s_waitcnt lgkmcnt(6)
    v_mfma_f32_32x32x16_bf16 v[16:31], v[40:43], a[40:43], v[16:31]
    ds_read_b128 v[40:43], v151 offset:51200
    v_cvt_pk_bf16_f32 v69, v10, v11
    v_mfma_f32_32x32x16_bf16 v[16:31], v[44:47], a[44:47], v[16:31]
    ds_read_b128 v[44:47], v151 offset:52224
    v_cvt_pk_bf16_f32 v70, v12, v13
    s_waitcnt lgkmcnt(6)
    v_mfma_f32_32x32x16_bf16 v[16:31], v[48:51], a[48:51], v[16:31]
    ds_read_b128 v[48:51], v151 offset:53248
    v_cvt_pk_bf16_f32 v71, v14, v15
    v_mfma_f32_32x32x16_bf16 v[16:31], v[52:55], a[52:55], v[16:31]
    ds_read_b128 v[52:55], v151 offset:54272
    global_store_dwordx4 v150, v[64:67], s[42:43] offset:0 sc1
    s_waitcnt lgkmcnt(6)
    v_mfma_f32_32x32x16_bf16 v[16:31], v[56:59], a[56:59], v[16:31]
    ds_read_b128 v[56:59], v151 offset:55296
    global_store_dwordx4 v150, v[68:71], s[42:43] offset:1024 sc1
    v_mfma_f32_32x32x16_bf16 v[16:31], v[60:63], a[60:63], v[16:31]
    ds_read_b128 v[60:63], v151 offset:56320
    s_add_u32 s42, s42, s54
    s_waitcnt lgkmcnt(6)
    v_mfma_f32_32x32x16_bf16 v[16:31], v[32:35], a[64:67], v[16:31]
    ds_read_b128 v[32:35], v151 offset:57344
    s_addc_u32 s43, s43, 0
    v_mfma_f32_32x32x16_bf16 v[16:31], v[36:39], a[68:71], v[16:31]
    ds_read_b128 v[36:39], v151 offset:58368
    s_waitcnt lgkmcnt(6)
    v_mfma_f32_32x32x16_bf16 v[16:31], v[40:43], a[72:75], v[16:31]
    ds_read_b128 v[40:43], v151 offset:59392
    v_mfma_f32_32x32x16_bf16 v[16:31], v[44:47], a[76:79], v[16:31]
    ds_read_b128 v[44:47], v151 offset:60416
    s_waitcnt vmcnt(3)
    s_mov_b64 exec, 1
    global_store_dword v152, v153, s[46:47] sc1
    s_mov_b64 exec, -1
    s_add_u32 s46, s46, s55
    s_addc_u32 s47, s47, 0
    s_waitcnt lgkmcnt(6)
    v_mfma_f32_32x32x16_bf16 v[16:31], v[48:51], a[80:83], v[16:31]
    ds_read_b128 v[48:51], v151 offset:61440
    v_mfma_f32_32x32x16_bf16 v[16:31], v[52:55], a[84:87], v[16:31]
    ds_read_b128 v[52:55], v151 offset:62464
    s_waitcnt lgkmcnt(6)
    v_mfma_f32_32x32x16_bf16 v[16:31], v[56:59], a[88:91], v[16:31]
    ds_read_b128 v[56:59], v151 offset:63488
    v_mfma_f32_32x32x16_bf16 v[16:31], v[60:63], a[92:95], v[16:31]
    ds_read_b128 v[60:63], v151 offset:64512
    s_waitcnt lgkmcnt(6)
    v_mfma_f32_32x32x16_bf16 v[16:31], v[32:35], a[96:99], v[16:31]
    v_mfma_f32_32x32x16_bf16 v[16:31], v[36:39], a[100:103], v[16:31]
    s_waitcnt lgkmcnt(4)
    v_mfma_f32_32x32x16_bf16 v[16:31], v[40:43], a[104:107], v[16:31]
    v_mfma_f32_32x32x16_bf16 v[16:31], v[44:47], a[108:111], v[16:31]
    s_waitcnt lgkmcnt(2)
    v_mfma_f32_32x32x16_bf16 v[16:31], v[48:51], a[112:115], v[16:31]
    v_mfma_f32_32x32x16_bf16 v[16:31], v[52:55], a[116:119], v[16:31]
    s_waitcnt lgkmcnt(0)
    v_mfma_f32_32x32x16_bf16 v[16:31], v[56:59], a[120:123], v[16:31]
    v_mfma_f32_32x32x16_bf16 v[16:31], v[60:63], a[124:127], v[16:31]
    s_nop 11
    v_cvt_pk_bf16_f32 v64, v16, v17
    v_cvt_pk_bf16_f32 v65, v18, v19
    v_cvt_pk_bf16_f32 v66, v20, v21
    v_cvt_pk_bf16_f32 v67, v22, v23
    v_cvt_pk_bf16_f32 v68, v24, v25
    v_cvt_pk_bf16_f32 v69, v26, v27
    v_cvt_pk_bf16_f32 v70, v28, v29
    v_cvt_pk_bf16_f32 v71, v30, v31
    global_store_dwordx4 v150, v[64:67], s[42:43] offset:0 sc1
    global_store_dwordx4 v150, v[68:71], s[42:43] offset:1024 sc1
    s_add_u32 s42, s42, s54
    s_addc_u32 s43, s43, 0
L_g0_end:
    s_waitcnt vmcnt(3)
    s_mov_b64 exec, 1
    global_store_dword v152, v153, s[46:47] sc1
    s_mov_b64 exec, -1
    s_add_u32 s46, s46, s55
    s_addc_u32 s47, s47, 0
    s_waitcnt vmcnt(1)
    s_mov_b64 exec, 1
    global_store_dword v152, v153, s[46:47] sc1
    s_mov_b64 exec, -1
    s_add_u32 s46, s46, s55
    s_addc_u32 s47, s47, 0
    s_barrier
    s_cmp_eq_u32 s34, 8
    s_cbranch_scc1 L_xp
    s_cmp_eq_u32 s34, 0
    s_cbranch_scc1 L_qkva
    s_mov_b32 s34, 0
    s_add_u32 m0, s52, 0
    s_nop 0
    global_load_lds_dwordx4 v150, s[38:39] offset:0 sc1
    global_load_lds_dwordx4 v150, s[38:39] offset:1024 sc1
    global_load_lds_dwordx4 v150, s[38:39] offset:2048 sc1
    global_load_lds_dwordx4 v150, s[38:39] offset:3072 sc1
    s_add_u32 s38, s38, 4096
    s_addc_u32 s39, s39, 0
    s_add_u32 m0, s52, 4096
    s_nop 0
    global_load_lds_dwordx4 v150, s[38:39] offset:0 sc1
    global_load_lds_dwordx4 v150, s[38:39] offset:1024 sc1
    global_load_lds_dwordx4 v150, s[38:39] offset:2048 sc1
    global_load_lds_dwordx4 v150, s[38:39] offset:3072 sc1
    s_add_u32 s38, s38, s53
    s_addc_u32 s39, s39, 0
    s_branch L_g0_pass
L_qkva0:
    s_and_b32 s80, s30, 7
    s_lshl_b32 s80, s80, 16
    v_lshl_add_u32 v1, v0, 7, s80
    v_add_u32 v2, 0x8000, v1
    global_load_dword v254, v1, s[8:9]
    global_load_dword v254, v2, s[8:9]
L_qkva:
    s_and_b32 s33, s30, 1
    s_add_u32 s33, s33, 38
    s_lshr_b32 s80, s30, 1
    s_mov_b32 s52, 2
    s_mov_b32 s53, 64
L_qkva2:
    s_and_b32 s34, s80, 1
    s_lshr_b32 s32, s80, 1
    s_lshl_b32 s80, s32, 9
    s_add_u32 s70, s6, s80
    s_addc_u32 s71, s7, 0
    s_cmp_ge_u32 s32, 4
    s_cbranch_scc1 L_qa_wv
    v_mov_b32 v161, 0x0
    v_bfe_u32 v160, v255, 5, 1
    v_mul_u32_u24 v160, 0xc00, v160
    v_add_u32 v161, v161, v160
    v_bfe_u32 v160, v255, 6, 2
    v_mul_u32_u24 v160, 0xc000, v160
    v_add_u32 v161, v161, v160
    v_mov_b32 v162, 0x0
    v_bfe_i32 v160, v255, 0, 1
    v_and_b32 v160, 0x10, v160
    v_xor_b32 v162, v162, v160
    v_bfe_i32 v160, v255, 1, 1
    v_and_b32 v160, 0x20, v160
    v_xor_b32 v162, v162, v160
    v_bfe_i32 v160, v255, 2, 1
    v_and_b32 v160, 0x40, v160
    v_xor_b32 v162, v162, v160
    v_bfe_i32 v160, v255, 3, 1
    v_and_b32 v160, 0x80, v160
    v_xor_b32 v162, v162, v160
    v_bfe_i32 v160, v255, 4, 1
    v_and_b32 v160, 0x100, v160
    v_xor_b32 v162, v162, v160
    v_bfe_i32 v160, v255, 5, 1
    v_and_b32 v160, 0x40, v160
    v_xor_b32 v162, v162, v160
    v_add_u32 v161, v161, v162
    v_mov_b32 v162, 0x1800
    v_bfe_u32 v160, v255, 5, 1
    v_mul_u32_u24 v160, 0xc00, v160
    v_add_u32 v162, v162, v160
    v_bfe_u32 v160, v255, 6, 2
    v_mul_u32_u24 v160, 0xc000, v160
    v_add_u32 v162, v162, v160
    v_mov_b32 v163, 0x80
    v_bfe_i32 v160, v255, 0, 1
    v_and_b32 v160, 0x10, v160
    v_xor_b32 v163, v163, v160
    v_bfe_i32 v160, v255, 1, 1
    v_and_b32 v160, 0x20, v160
    v_xor_b32 v163, v163, v160
    v_bfe_i32 v160, v255, 2, 1
    v_and_b32 v160, 0x40, v160
    v_xor_b32 v163, v163, v160
    v_bfe_i32 v160, v255, 3, 1
    v_and_b32 v160, 0x80, v160
    v_xor_b32 v163, v163, v160
    v_bfe_i32 v160, v255, 4, 1
    v_and_b32 v160, 0x100, v160
    v_xor_b32 v163, v163, v160
    v_bfe_i32 v160, v255, 5, 1
    v_and_b32 v160, 0x40, v160
    v_xor_b32 v163, v163, v160
    v_add_u32 v162, v162, v163
    v_mov_b32 v163, 0x3000
    v_bfe_u32 v160, v255, 5, 1
    v_mul_u32_u24 v160, 0xc00, v160
    v_add_u32 v163, v163, v160
    v_bfe_u32 v160, v255, 6, 2
    v_mul_u32_u24 v160, 0xc000, v160
    v_add_u32 v163, v163, v160
    v_mov_b32 v164, 0x0
    v_bfe_i32 v160, v255, 0, 1
    v_and_b32 v160, 0x10, v160
    v_xor_b32 v164, v164, v160
    v_bfe_i32 v160, v255, 1, 1
    v_and_b32 v160, 0x20, v160
    v_xor_b32 v164, v164, v160
    v_bfe_i32 v160, v255, 2, 1
    v_and_b32 v160, 0x40, v160
    v_xor_b32 v164, v164, v160
    v_bfe_i32 v160, v255, 3, 1
    v_and_b32 v160, 0x80, v160
    v_xor_b32 v164, v164, v160
    v_bfe_i32 v160, v255, 4, 1
    v_and_b32 v160, 0x100, v160
    v_xor_b32 v164, v164, v160
    v_bfe_i32 v160, v255, 5, 1
    v_and_b32 v160, 0x40, v160
    v_xor_b32 v164, v164, v160
    v_add_u32 v163, v163, v164
    v_mov_b32 v164, 0x4800
    v_bfe_u32 v160, v255, 5, 1
    v_mul_u32_u24 v160, 0xc00, v160
    v_add_u32 v164, v164, v160
    v_bfe_u32 v160, v255, 6, 2
    v_mul_u32_u24 v160, 0xc000, v160
    v_add_u32 v164, v164, v160
    v_mov_b32 v165, 0x80
    v_bfe_i32 v160, v255, 0, 1
    v_and_b32 v160, 0x10, v160
    v_xor_b32 v165, v165, v160
    v_bfe_i32 v160, v255, 1, 1
    v_and_b32 v160, 0x20, v160
    v_xor_b32 v165, v165, v160
    v_bfe_i32 v160, v255, 2, 1
    v_and_b32 v160, 0x40, v160
    v_xor_b32 v165, v165, v160
    v_bfe_i32 v160, v255, 3, 1
    v_and_b32 v160, 0x80, v160
    v_xor_b32 v165, v165, v160
    v_bfe_i32 v160, v255, 4, 1
    v_and_b32 v160, 0x100, v160
    v_xor_b32 v165, v165, v160
    v_bfe_i32 v160, v255, 5, 1
    v_and_b32 v160, 0x40, v160
    v_xor_b32 v165, v165, v160
    v_add_u32 v164, v164, v165
    v_mov_b32 v165, 0x6000
    v_bfe_u32 v160, v255, 5, 1
    v_mul_u32_u24 v160, 0xc00, v160
    v_add_u32 v165, v165, v160
    v_bfe_u32 v160, v255, 6, 2
    v_mul_u32_u24 v160, 0xc000, v160
    v_add_u32 v165, v165, v160
    v_mov_b32 v166, 0x0
    v_bfe_i32 v160, v255, 0, 1
    v_and_b32 v160, 0x10, v160
    v_xor_b32 v166, v166, v160
    v_bfe_i32 v160, v255, 1, 1
    v_and_b32 v160, 0x20, v160
    v_xor_b32 v166, v166, v160
    v_bfe_i32 v160, v255, 2, 1
    v_and_b32 v160, 0x40, v160
    v_xor_b32 v166, v166, v160
    v_bfe_i32 v160, v255, 3, 1
    v_and_b32 v160, 0x80, v160
    v_xor_b32 v166, v166, v160
    v_bfe_i32 v160, v255, 4, 1
    v_and_b32 v160, 0x100, v160
    v_xor_b32 v166, v166, v160
    v_bfe_i32 v160, v255, 5, 1
    v_and_b32 v160, 0x40, v160
    v_xor_b32 v166, v166, v160
    v_add_u32 v165, v165, v166
    v_mov_b32 v166, 0x7800
    v_bfe_u32 v160, v255, 5, 1
    v_mul_u32_u24 v160, 0xc00, v160
    v_add_u32 v166, v166, v160
    v_bfe_u32 v160, v255, 6, 2
    v_mul_u32_u24 v160, 0xc000, v160
    v_add_u32 v166, v166, v160
    v_mov_b32 v167, 0x80
    v_bfe_i32 v160, v255, 0, 1
    v_and_b32 v160, 0x10, v160
    v_xor_b32 v167, v167, v160
    v_bfe_i32 v160, v255, 1, 1
    v_and_b32 v160, 0x20, v160
    v_xor_b32 v167, v167, v160
    v_bfe_i32 v160, v255, 2, 1
    v_and_b32 v160, 0x40, v160
    v_xor_b32 v167, v167, v160
    v_bfe_i32 v160, v255, 3, 1
    v_and_b32 v160, 0x80, v160
    v_xor_b32 v167, v167, v160
    v_bfe_i32 v160, v255, 4, 1
    v_and_b32 v160, 0x100, v160
    v_xor_b32 v167, v167, v160
    v_bfe_i32 v160, v255, 5, 1
    v_and_b32 v160, 0x40, v160
    v_xor_b32 v167, v167, v160
    v_add_u32 v166, v166, v167
    v_mov_b32 v167, 0x9000
    v_bfe_u32 v160, v255, 5, 1
    v_mul_u32_u24 v160, 0xc00, v160
    v_add_u32 v167, v167, v160
    v_bfe_u32 v160, v255, 6, 2
    v_mul_u32_u24 v160, 0xc000, v160
    v_add_u32 v167, v167, v160
    v_mov_b32 v168, 0x0
    v_bfe_i32 v160, v255, 0, 1
    v_and_b32 v160, 0x10, v160
    v_xor_b32 v168, v168, v160
    v_bfe_i32 v160, v255, 1, 1
    v_and_b32 v160, 0x20, v160
    v_xor_b32 v168, v168, v160
    v_bfe_i32 v160, v255, 2, 1
    v_and_b32 v160, 0x40, v160
    v_xor_b32 v168, v168, v160
    v_bfe_i32 v160, v255, 3, 1
    v_and_b32 v160, 0x80, v160
    v_xor_b32 v168, v168, v160
    v_bfe_i32 v160, v255, 4, 1
    v_and_b32 v160, 0x100, v160
    v_xor_b32 v168, v168, v160
    v_bfe_i32 v160, v255, 5, 1
    v_and_b32 v160, 0x40, v160
    v_xor_b32 v168, v168, v160
    v_add_u32 v167, v167, v168
    v_mov_b32 v168, 0xa800
    v_bfe_u32 v160, v255, 5, 1
    v_mul_u32_u24 v160, 0xc00, v160
    v_add_u32 v168, v168, v160
    v_bfe_u32 v160, v255, 6, 2
    v_mul_u32_u24 v160, 0xc000, v160
    v_add_u32 v168, v168, v160
    v_mov_b32 v169, 0x80
    v_bfe_i32 v160, v255, 0, 1
    v_and_b32 v160, 0x10, v160
    v_xor_b32 v169, v169, v160
    v_bfe_i32 v160, v255, 1, 1
    v_and_b32 v160, 0x20, v160
    v_xor_b32 v169, v169, v160
    v_bfe_i32 v160, v255, 2, 1
    v_and_b32 v160, 0x40, v160
    v_xor_b32 v169, v169, v160
    v_bfe_i32 v160, v255, 3, 1
    v_and_b32 v160, 0x80, v160
    v_xor_b32 v169, v169, v160
    v_bfe_i32 v160, v255, 4, 1
    v_and_b32 v160, 0x100, v160
    v_xor_b32 v169, v169, v160
    v_bfe_i32 v160, v255, 5, 1
    v_and_b32 v160, 0x40, v160
    v_xor_b32 v169, v169, v160
    v_add_u32 v168, v168, v169
    v_mov_b32 v170, 0x0
    v_bfe_i32 v160, v255, 0, 1
    v_and_b32 v160, 0x10, v160
    v_xor_b32 v170, v170, v160
    v_bfe_i32 v160, v255, 1, 1
    v_and_b32 v160, 0x20, v160
    v_xor_b32 v170, v170, v160
    v_bfe_i32 v160, v255, 2, 1
    v_and_b32 v160, 0x240, v160
    v_xor_b32 v170, v170, v160
    v_bfe_i32 v160, v255, 3, 1
    v_and_b32 v160, 0x480, v160
    v_xor_b32 v170, v170, v160
    v_bfe_i32 v160, v255, 4, 1
    v_and_b32 v160, 0x1000, v160
    v_xor_b32 v170, v170, v160
    v_bfe_i32 v160, v255, 5, 1
    v_and_b32 v160, 0x2000, v160
    v_xor_b32 v170, v170, v160
    v_bfe_i32 v160, v255, 6, 1
    v_and_b32 v160, 0x80, v160
    v_xor_b32 v170, v170, v160
    v_bfe_i32 v160, v255, 7, 1
    v_and_b32 v160, 0x100, v160
    v_xor_b32 v170, v170, v160
    v_mov_b32 v171, 0x40
    v_bfe_i32 v160, v255, 0, 1
    v_and_b32 v160, 0x10, v160
    v_xor_b32 v171, v171, v160
    v_bfe_i32 v160, v255, 1, 1
    v_and_b32 v160, 0x20, v160
    v_xor_b32 v171, v171, v160
    v_bfe_i32 v160, v255, 2, 1
    v_and_b32 v160, 0x240, v160
    v_xor_b32 v171, v171, v160
    v_bfe_i32 v160, v255, 3, 1
    v_and_b32 v160, 0x480, v160
    v_xor_b32 v171, v171, v160
    v_bfe_i32 v160, v255, 4, 1
    v_and_b32 v160, 0x1000, v160
    v_xor_b32 v171, v171, v160
    v_bfe_i32 v160, v255, 5, 1
    v_and_b32 v160, 0x2000, v160
    v_xor_b32 v171, v171, v160
    v_bfe_i32 v160, v255, 6, 1
    v_and_b32 v160, 0x80, v160
    v_xor_b32 v171, v171, v160
    v_bfe_i32 v160, v255, 7, 1
    v_and_b32 v160, 0x100, v160
    v_xor_b32 v171, v171, v160
    s_lshl_b32 s64, s31, 13
    s_add_u32 s66, s70, 0x0
    s_addc_u32 s67, s71, 0
    s_add_u32 m0, s64, 0x0
    s_nop 0
    global_load_lds_dwordx4 v161, s[66:67]
    s_add_u32 m0, s64, 0x400
    s_nop 0
    global_load_lds_dwordx4 v162, s[66:67]
    s_add_u32 m0, s64, 0x800
    s_nop 0
    global_load_lds_dwordx4 v163, s[66:67]
    s_add_u32 m0, s64, 0xc00
    s_nop 0
    global_load_lds_dwordx4 v164, s[66:67]
    s_add_u32 m0, s64, 0x1000
    s_nop 0
    global_load_lds_dwordx4 v165, s[66:67]
    s_add_u32 m0, s64, 0x1400
    s_nop 0
    global_load_lds_dwordx4 v166, s[66:67]
    s_add_u32 m0, s64, 0x1800
    s_nop 0
    global_load_lds_dwordx4 v167, s[66:67]
    s_add_u32 m0, s64, 0x1c00
    s_nop 0
    global_load_lds_dwordx4 v168, s[66:67]
    s_add_u32 s66, s70, 0x30000
    s_addc_u32 s67, s71, 0
    s_add_u32 m0, s64, 0x8000
    s_nop 0
    global_load_lds_dwordx4 v161, s[66:67]
    s_add_u32 m0, s64, 0x8400
    s_nop 0
    global_load_lds_dwordx4 v162, s[66:67]
    s_add_u32 m0, s64, 0x8800
    s_nop 0
    global_load_lds_dwordx4 v163, s[66:67]
    s_add_u32 m0, s64, 0x8c00
    s_nop 0
    global_load_lds_dwordx4 v164, s[66:67]
    s_add_u32 m0, s64, 0x9000
    s_nop 0
    global_load_lds_dwordx4 v165, s[66:67]
    s_add_u32 m0, s64, 0x9400
    s_nop 0
    global_load_lds_dwordx4 v166, s[66:67]
    s_add_u32 m0, s64, 0x9800
    s_nop 0
    global_load_lds_dwordx4 v167, s[66:67]
    s_add_u32 m0, s64, 0x9c00
    s_nop 0
    global_load_lds_dwordx4 v168, s[66:67]
    s_add_u32 s66, s70, 0x60000
    s_addc_u32 s67, s71, 0
    s_add_u32 m0, s64, 0x10000
    s_nop 0
    global_load_lds_dwordx4 v161, s[66:67]
    s_add_u32 m0, s64, 0x10400
    s_nop 0
    global_load_lds_dwordx4 v162, s[66:67]
    s_add_u32 m0, s64, 0x10800
    s_nop 0
    global_load_lds_dwordx4 v163, s[66:67]
    s_add_u32 m0, s64, 0x10c00
    s_nop 0
    global_load_lds_dwordx4 v164, s[66:67]
    s_add_u32 m0, s64, 0x11000
    s_nop 0
    global_load_lds_dwordx4 v165, s[66:67]
    s_add_u32 m0, s64, 0x11400
    s_nop 0
    global_load_lds_dwordx4 v166, s[66:67]
    s_add_u32 m0, s64, 0x11800
    s_nop 0
    global_load_lds_dwordx4 v167, s[66:67]
    s_add_u32 m0, s64, 0x11c00
    s_nop 0
    global_load_lds_dwordx4 v168, s[66:67]
    s_add_u32 s66, s70, 0x90000
    s_addc_u32 s67, s71, 0
    s_add_u32 m0, s64, 0x18000
    s_nop 0
    global_load_lds_dwordx4 v161, s[66:67]
    s_add_u32 m0, s64, 0x18400
    s_nop 0
    global_load_lds_dwordx4 v162, s[66:67]
    s_add_u32 m0, s64, 0x18800
    s_nop 0
    global_load_lds_dwordx4 v163, s[66:67]
    s_add_u32 m0, s64, 0x18c00
    s_nop 0
    global_load_lds_dwordx4 v164, s[66:67]
    s_add_u32 m0, s64, 0x19000
    s_nop 0
    global_load_lds_dwordx4 v165, s[66:67]
    s_add_u32 m0, s64, 0x19400
    s_nop 0
    global_load_lds_dwordx4 v166, s[66:67]
    s_add_u32 m0, s64, 0x19800
    s_nop 0
    global_load_lds_dwordx4 v167, s[66:67]
    s_add_u32 m0, s64, 0x19c00
    s_nop 0
    global_load_lds_dwordx4 v168, s[66:67]
    s_waitcnt vmcnt(24)
    s_barrier
    s_add_u32 s66, s70, 0xc0000
    s_addc_u32 s67, s71, 0
    s_add_u32 m0, s64, 0x20000
    s_nop 0
    global_load_lds_dwordx4 v161, s[66:67]
    s_add_u32 m0, s64, 0x20400
    s_nop 0
    global_load_lds_dwordx4 v162, s[66:67]
    s_add_u32 m0, s64, 0x20800
    s_nop 0
    global_load_lds_dwordx4 v163, s[66:67]
    s_add_u32 m0, s64, 0x20c00
    s_nop 0
    global_load_lds_dwordx4 v164, s[66:67]
    s_add_u32 m0, s64, 0x21000
    s_nop 0
    global_load_lds_dwordx4 v165, s[66:67]
    s_add_u32 m0, s64, 0x21400
    s_nop 0
    global_load_lds_dwordx4 v166, s[66:67]
    s_add_u32 m0, s64, 0x21800
    s_nop 0
    global_load_lds_dwordx4 v167, s[66:67]
    s_add_u32 m0, s64, 0x21c00
    s_nop 0
    global_load_lds_dwordx4 v168, s[66:67]
    v_add_u32 v186, 0x0, v170
    v_add_u32 v187, 0x0, v171
    ds_read_b64_tr_b16 a[0:1], v186 offset:0
    ds_read_b64_tr_b16 a[2:3], v186 offset:2048
    ds_read_b64_tr_b16 a[4:5], v186 offset:8
    ds_read_b64_tr_b16 a[6:7], v186 offset:2056
    ds_read_b64_tr_b16 a[8:9], v187 offset:0
    ds_read_b64_tr_b16 a[10:11], v187 offset:2048
    ds_read_b64_tr_b16 a[12:13], v187 offset:8
    ds_read_b64_tr_b16 a[14:15], v187 offset:2056
    ds_read_b64_tr_b16 a[16:17], v186 offset:16384
    ds_read_b64_tr_b16 a[18:19], v186 offset:18432
    ds_read_b64_tr_b16 a[20:21], v186 offset:16392
    ds_read_b64_tr_b16 a[22:23], v186 offset:18440
    ds_read_b64_tr_b16 a[24:25], v187 offset:16384
    ds_read_b64_tr_b16 a[26:27], v187 offset:18432
    ds_read_b64_tr_b16 a[28:29], v187 offset:16392
    ds_read_b64_tr_b16 a[30:31], v187 offset:18440
L_lw_29:
    s_waitcnt lgkmcnt(0)
    s_waitcnt vmcnt(24)
    s_barrier
    s_add_u32 s66, s70, 0xf0000
    s_addc_u32 s67, s71, 0
    s_add_u32 m0, s64, 0x0
    s_nop 0
    global_load_lds_dwordx4 v161, s[66:67]
    s_add_u32 m0, s64, 0x400
    s_nop 0
    global_load_lds_dwordx4 v162, s[66:67]
    s_add_u32 m0, s64, 0x800
    s_nop 0
    global_load_lds_dwordx4 v163, s[66:67]
    s_add_u32 m0, s64, 0xc00
    s_nop 0
    global_load_lds_dwordx4 v164, s[66:67]
    s_add_u32 m0, s64, 0x1000
    s_nop 0
    global_load_lds_dwordx4 v165, s[66:67]
    s_add_u32 m0, s64, 0x1400
    s_nop 0
    global_load_lds_dwordx4 v166, s[66:67]
    s_add_u32 m0, s64, 0x1800
    s_nop 0
    global_load_lds_dwordx4 v167, s[66:67]
    s_add_u32 m0, s64, 0x1c00
    s_nop 0
    global_load_lds_dwordx4 v168, s[66:67]
    v_add_u32 v186, 0x8000, v170
    v_add_u32 v187, 0x8000, v171
    ds_read_b64_tr_b16 a[32:33], v186 offset:0
    ds_read_b64_tr_b16 a[34:35], v186 offset:2048
    ds_read_b64_tr_b16 a[36:37], v186 offset:8
    ds_read_b64_tr_b16 a[38:39], v186 offset:2056
    ds_read_b64_tr_b16 a[40:41], v187 offset:0
    ds_read_b64_tr_b16 a[42:43], v187 offset:2048
    ds_read_b64_tr_b16 a[44:45], v187 offset:8
    ds_read_b64_tr_b16 a[46:47], v187 offset:2056
    ds_read_b64_tr_b16 a[48:49], v186 offset:16384
    ds_read_b64_tr_b16 a[50:51], v186 offset:18432
    ds_read_b64_tr_b16 a[52:53], v186 offset:16392
    ds_read_b64_tr_b16 a[54:55], v186 offset:18440
    ds_read_b64_tr_b16 a[56:57], v187 offset:16384
    ds_read_b64_tr_b16 a[58:59], v187 offset:18432
    ds_read_b64_tr_b16 a[60:61], v187 offset:16392
    ds_read_b64_tr_b16 a[62:63], v187 offset:18440
L_lw_30:
    s_waitcnt lgkmcnt(0)
    s_waitcnt vmcnt(24)
    s_barrier
    s_add_u32 s66, s70, 0x120000
    s_addc_u32 s67, s71, 0
    s_add_u32 m0, s64, 0x8000
    s_nop 0
    global_load_lds_dwordx4 v161, s[66:67]
    s_add_u32 m0, s64, 0x8400
    s_nop 0
    global_load_lds_dwordx4 v162, s[66:67]
    s_add_u32 m0, s64, 0x8800
    s_nop 0
    global_load_lds_dwordx4 v163, s[66:67]
    s_add_u32 m0, s64, 0x8c00
    s_nop 0
    global_load_lds_dwordx4 v164, s[66:67]
    s_add_u32 m0, s64, 0x9000
    s_nop 0
    global_load_lds_dwordx4 v165, s[66:67]
    s_add_u32 m0, s64, 0x9400
    s_nop 0
    global_load_lds_dwordx4 v166, s[66:67]
    s_add_u32 m0, s64, 0x9800
    s_nop 0
    global_load_lds_dwordx4 v167, s[66:67]
    s_add_u32 m0, s64, 0x9c00
    s_nop 0
    global_load_lds_dwordx4 v168, s[66:67]
    v_add_u32 v186, 0x10000, v170
    v_add_u32 v187, 0x10000, v171
    ds_read_b64_tr_b16 a[64:65], v186 offset:0
    ds_read_b64_tr_b16 a[66:67], v186 offset:2048
    ds_read_b64_tr_b16 a[68:69], v186 offset:8
    ds_read_b64_tr_b16 a[70:71], v186 offset:2056
    ds_read_b64_tr_b16 a[72:73], v187 offset:0
    ds_read_b64_tr_b16 a[74:75], v187 offset:2048
    ds_read_b64_tr_b16 a[76:77], v187 offset:8
    ds_read_b64_tr_b16 a[78:79], v187 offset:2056
    ds_read_b64_tr_b16 a[80:81], v186 offset:16384
    ds_read_b64_tr_b16 a[82:83], v186 offset:18432
    ds_read_b64_tr_b16 a[84:85], v186 offset:16392
    ds_read_b64_tr_b16 a[86:87], v186 offset:18440
    ds_read_b64_tr_b16 a[88:89], v187 offset:16384
    ds_read_b64_tr_b16 a[90:91], v187 offset:18432
    ds_read_b64_tr_b16 a[92:93], v187 offset:16392
    ds_read_b64_tr_b16 a[94:95], v187 offset:18440
L_lw_31:
    s_waitcnt lgkmcnt(0)
    s_waitcnt vmcnt(24)
    s_barrier
    s_add_u32 s66, s70, 0x150000
    s_addc_u32 s67, s71, 0
    s_add_u32 m0, s64, 0x10000
    s_nop 0
    global_load_lds_dwordx4 v161, s[66:67]
    s_add_u32 m0, s64, 0x10400
    s_nop 0
    global_load_lds_dwordx4 v162, s[66:67]
    s_add_u32 m0, s64, 0x10800
    s_nop 0
    global_load_lds_dwordx4 v163, s[66:67]
    s_add_u32 m0, s64, 0x10c00
    s_nop 0
    global_load_lds_dwordx4 v164, s[66:67]
    s_add_u32 m0, s64, 0x11000
    s_nop 0
    global_load_lds_dwordx4 v165, s[66:67]
    s_add_u32 m0, s64, 0x11400
    s_nop 0
    global_load_lds_dwordx4 v166, s[66:67]
    s_add_u32 m0, s64, 0x11800
    s_nop 0
    global_load_lds_dwordx4 v167, s[66:67]
    s_add_u32 m0, s64, 0x11c00
    s_nop 0
    global_load_lds_dwordx4 v168, s[66:67]
    v_add_u32 v186, 0x18000, v170
    v_add_u32 v187, 0x18000, v171
    ds_read_b64_tr_b16 a[96:97], v186 offset:0
    ds_read_b64_tr_b16 a[98:99], v186 offset:2048
    ds_read_b64_tr_b16 a[100:101], v186 offset:8
    ds_read_b64_tr_b16 a[102:103], v186 offset:2056
    ds_read_b64_tr_b16 a[104:105], v187 offset:0
    ds_read_b64_tr_b16 a[106:107], v187 offset:2048
    ds_read_b64_tr_b16 a[108:109], v187 offset:8
    ds_read_b64_tr_b16 a[110:111], v187 offset:2056
    ds_read_b64_tr_b16 a[112:113], v186 offset:16384
    ds_read_b64_tr_b16 a[114:115], v186 offset:18432
    ds_read_b64_tr_b16 a[116:117], v186 offset:16392
    ds_read_b64_tr_b16 a[118:119], v186 offset:18440
    ds_read_b64_tr_b16 a[120:121], v187 offset:16384
    ds_read_b64_tr_b16 a[122:123], v187 offset:18432
    ds_read_b64_tr_b16 a[124:125], v187 offset:16392
    ds_read_b64_tr_b16 a[126:127], v187 offset:18440
L_lw_32:
    s_waitcnt lgkmcnt(0)
    s_waitcnt vmcnt(24)
    s_barrier
    v_add_u32 v186, 0x20000, v170
    v_add_u32 v187, 0x20000, v171
    ds_read_b64_tr_b16 a[128:129], v186 offset:0
    ds_read_b64_tr_b16 a[130:131], v186 offset:2048
    ds_read_b64_tr_b16 a[132:133], v186 offset:8
    ds_read_b64_tr_b16 a[134:135], v186 offset:2056
    ds_read_b64_tr_b16 a[136:137], v187 offset:0
    ds_read_b64_tr_b16 a[138:139], v187 offset:2048
    ds_read_b64_tr_b16 a[140:141], v187 offset:8
    ds_read_b64_tr_b16 a[142:143], v187 offset:2056
    ds_read_b64_tr_b16 a[144:145], v186 offset:16384
    ds_read_b64_tr_b16 a[146:147], v186 offset:18432
    ds_read_b64_tr_b16 a[148:149], v186 offset:16392
    ds_read_b64_tr_b16 a[150:151], v186 offset:18440
    ds_read_b64_tr_b16 a[152:153], v187 offset:16384
    ds_read_b64_tr_b16 a[154:155], v187 offset:18432
    ds_read_b64_tr_b16 a[156:157], v187 offset:16392
    ds_read_b64_tr_b16 a[158:159], v187 offset:18440
L_lw_33:
    s_waitcnt lgkmcnt(0)
    s_waitcnt vmcnt(16)
    s_barrier
    v_add_u32 v186, 0x0, v170
    v_add_u32 v187, 0x0, v171
    ds_read_b64_tr_b16 a[160:161], v186 offset:0
    ds_read_b64_tr_b16 a[162:163], v186 offset:2048
    ds_read_b64_tr_b16 a[164:165], v186 offset:8
    ds_read_b64_tr_b16 a[166:167], v186 offset:2056
    ds_read_b64_tr_b16 a[168:169], v187 offset:0
    ds_read_b64_tr_b16 a[170:171], v187 offset:2048
    ds_read_b64_tr_b16 a[172:173], v187 offset:8
    ds_read_b64_tr_b16 a[174:175], v187 offset:2056
    ds_read_b64_tr_b16 a[176:177], v186 offset:16384
    ds_read_b64_tr_b16 a[178:179], v186 offset:18432
    ds_read_b64_tr_b16 a[180:181], v186 offset:16392
    ds_read_b64_tr_b16 a[182:183], v186 offset:18440
    ds_read_b64_tr_b16 a[184:185], v187 offset:16384
    ds_read_b64_tr_b16 a[186:187], v187 offset:18432
    ds_read_b64_tr_b16 a[188:189], v187 offset:16392
    ds_read_b64_tr_b16 a[190:191], v187 offset:18440
L_lw_34:
    s_waitcnt lgkmcnt(0)
    s_waitcnt vmcnt(8)
    s_barrier
    v_add_u32 v186, 0x8000, v170
    v_add_u32 v187, 0x8000, v171
    ds_read_b64_tr_b16 a[192:193], v186 offset:0
    ds_read_b64_tr_b16 a[194:195], v186 offset:2048
    ds_read_b64_tr_b16 a[196:197], v186 offset:8
    ds_read_b64_tr_b16 a[198:199], v186 offset:2056
    ds_read_b64_tr_b16 a[200:201], v187 offset:0
    ds_read_b64_tr_b16 a[202:203], v187 offset:2048
    ds_read_b64_tr_b16 a[204:205], v187 offset:8
    ds_read_b64_tr_b16 a[206:207], v187 offset:2056
    ds_read_b64_tr_b16 a[208:209], v186 offset:16384
    ds_read_b64_tr_b16 a[210:211], v186 offset:18432
    ds_read_b64_tr_b16 a[212:213], v186 offset:16392
    ds_read_b64_tr_b16 a[214:215], v186 offset:18440
    ds_read_b64_tr_b16 a[216:217], v187 offset:16384
    ds_read_b64_tr_b16 a[218:219], v187 offset:18432
    ds_read_b64_tr_b16 a[220:221], v187 offset:16392
    ds_read_b64_tr_b16 a[222:223], v187 offset:18440
L_lw_35:
    s_waitcnt lgkmcnt(0)
    s_waitcnt vmcnt(0)
    s_barrier
    v_add_u32 v186, 0x10000, v170
    v_add_u32 v187, 0x10000, v171
    ds_read_b64_tr_b16 a[224:225], v186 offset:0
    ds_read_b64_tr_b16 a[226:227], v186 offset:2048
    ds_read_b64_tr_b16 a[228:229], v186 offset:8
    ds_read_b64_tr_b16 a[230:231], v186 offset:2056
    ds_read_b64_tr_b16 a[232:233], v187 offset:0
    ds_read_b64_tr_b16 a[234:235], v187 offset:2048
    ds_read_b64_tr_b16 a[236:237], v187 offset:8
    ds_read_b64_tr_b16 a[238:239], v187 offset:2056
    ds_read_b64_tr_b16 a[240:241], v186 offset:16384
    ds_read_b64_tr_b16 a[242:243], v186 offset:18432
    ds_read_b64_tr_b16 a[244:245], v186 offset:16392
    ds_read_b64_tr_b16 a[246:247], v186 offset:18440
    ds_read_b64_tr_b16 a[248:249], v187 offset:16384
    ds_read_b64_tr_b16 a[250:251], v187 offset:18432
    ds_read_b64_tr_b16 a[252:253], v187 offset:16392
    ds_read_b64_tr_b16 a[254:255], v187 offset:18440
L_lw_36:
    s_waitcnt lgkmcnt(0)
    v_mov_b32 v157, 0x0
    v_bfe_u32 v160, v255, 0, 4
    v_lshl_add_u32 v157, v160, 4, v157
    v_bfe_u32 v160, v255, 4, 2
    v_lshl_add_u32 v157, v160, 9, v157
    s_lshl_b32 s80, s34, 8
    s_branch L_qa_wd
L_qa_wv:
    v_mov_b32 v161, 0x0
    v_bfe_u32 v160, v255, 5, 1
    v_mul_u32_u24 v160, 0xc00, v160
    v_add_u32 v161, v161, v160
    v_bfe_u32 v160, v255, 6, 2
    v_mul_u32_u24 v160, 0xc000, v160
    v_add_u32 v161, v161, v160
    v_mov_b32 v162, 0x0
    v_bfe_i32 v160, v255, 0, 1
    v_and_b32 v160, 0x10, v160
    v_xor_b32 v162, v162, v160
    v_bfe_i32 v160, v255, 1, 1
    v_and_b32 v160, 0x20, v160
    v_xor_b32 v162, v162, v160
    v_bfe_i32 v160, v255, 2, 1
    v_and_b32 v160, 0x40, v160
    v_xor_b32 v162, v162, v160
    v_bfe_i32 v160, v255, 3, 1
    v_and_b32 v160, 0x80, v160
    v_xor_b32 v162, v162, v160
    v_bfe_i32 v160, v255, 4, 1
    v_and_b32 v160, 0x100, v160
    v_xor_b32 v162, v162, v160
    v_bfe_i32 v160, v255, 5, 1
    v_and_b32 v160, 0x40, v160
    v_xor_b32 v162, v162, v160
    v_add_u32 v161, v161, v162
    v_mov_b32 v162, 0x1800
    v_bfe_u32 v160, v255, 5, 1
    v_mul_u32_u24 v160, 0xc00, v160
    v_add_u32 v162, v162, v160
    v_bfe_u32 v160, v255, 6, 2
    v_mul_u32_u24 v160, 0xc000, v160
    v_add_u32 v162, v162, v160
    v_mov_b32 v163, 0x80
    v_bfe_i32 v160, v255, 0, 1
    v_and_b32 v160, 0x10, v160
    v_xor_b32 v163, v163, v160
    v_bfe_i32 v160, v255, 1, 1
    v_and_b32 v160, 0x20, v160
    v_xor_b32 v163, v163, v160
    v_bfe_i32 v160, v255, 2, 1
    v_and_b32 v160, 0x40, v160
    v_xor_b32 v163, v163, v160
    v_bfe_i32 v160, v255, 3, 1
    v_and_b32 v160, 0x80, v160
    v_xor_b32 v163, v163, v160
    v_bfe_i32 v160, v255, 4, 1
    v_and_b32 v160, 0x100, v160
    v_xor_b32 v163, v163, v160
    v_bfe_i32 v160, v255, 5, 1
    v_and_b32 v160, 0x40, v160
    v_xor_b32 v163, v163, v160
    v_add_u32 v162, v162, v163
    v_mov_b32 v163, 0x3000
    v_bfe_u32 v160, v255, 5, 1
    v_mul_u32_u24 v160, 0xc00, v160
    v_add_u32 v163, v163, v160
    v_bfe_u32 v160, v255, 6, 2
    v_mul_u32_u24 v160, 0xc000, v160
    v_add_u32 v163, v163, v160
    v_mov_b32 v164, 0x0
    v_bfe_i32 v160, v255, 0, 1
    v_and_b32 v160, 0x10, v160
    v_xor_b32 v164, v164, v160
    v_bfe_i32 v160, v255, 1, 1
    v_and_b32 v160, 0x20, v160
    v_xor_b32 v164, v164, v160
    v_bfe_i32 v160, v255, 2, 1
    v_and_b32 v160, 0x40, v160
    v_xor_b32 v164, v164, v160
    v_bfe_i32 v160, v255, 3, 1
    v_and_b32 v160, 0x80, v160
    v_xor_b32 v164, v164, v160
    v_bfe_i32 v160, v255, 4, 1
    v_and_b32 v160, 0x100, v160
    v_xor_b32 v164, v164, v160
    v_bfe_i32 v160, v255, 5, 1
    v_and_b32 v160, 0x40, v160
    v_xor_b32 v164, v164, v160
    v_add_u32 v163, v163, v164
    v_mov_b32 v164, 0x4800
    v_bfe_u32 v160, v255, 5, 1
    v_mul_u32_u24 v160, 0xc00, v160
    v_add_u32 v164, v164, v160
    v_bfe_u32 v160, v255, 6, 2
    v_mul_u32_u24 v160, 0xc000, v160
    v_add_u32 v164, v164, v160
    v_mov_b32 v165, 0x80
    v_bfe_i32 v160, v255, 0, 1
    v_and_b32 v160, 0x10, v160
    v_xor_b32 v165, v165, v160
    v_bfe_i32 v160, v255, 1, 1
    v_and_b32 v160, 0x20, v160
    v_xor_b32 v165, v165, v160
    v_bfe_i32 v160, v255, 2, 1
    v_and_b32 v160, 0x40, v160
    v_xor_b32 v165, v165, v160
    v_bfe_i32 v160, v255, 3, 1
    v_and_b32 v160, 0x80, v160
    v_xor_b32 v165, v165, v160
    v_bfe_i32 v160, v255, 4, 1
    v_and_b32 v160, 0x100, v160
    v_xor_b32 v165, v165, v160
    v_bfe_i32 v160, v255, 5, 1
    v_and_b32 v160, 0x40, v160
    v_xor_b32 v165, v165, v160
    v_add_u32 v164, v164, v165
    v_mov_b32 v165, 0x6000
    v_bfe_u32 v160, v255, 5, 1
    v_mul_u32_u24 v160, 0xc00, v160
    v_add_u32 v165, v165, v160
    v_bfe_u32 v160, v255, 6, 2
    v_mul_u32_u24 v160, 0xc000, v160
    v_add_u32 v165, v165, v160
    v_mov_b32 v166, 0x0
    v_bfe_i32 v160, v255, 0, 1
    v_and_b32 v160, 0x10, v160
    v_xor_b32 v166, v166, v160
    v_bfe_i32 v160, v255, 1, 1
    v_and_b32 v160, 0x20, v160
    v_xor_b32 v166, v166, v160
    v_bfe_i32 v160, v255, 2, 1
    v_and_b32 v160, 0x40, v160
    v_xor_b32 v166, v166, v160
    v_bfe_i32 v160, v255, 3, 1
    v_and_b32 v160, 0x80, v160
    v_xor_b32 v166, v166, v160
    v_bfe_i32 v160, v255, 4, 1
    v_and_b32 v160, 0x100, v160
    v_xor_b32 v166, v166, v160
    v_bfe_i32 v160, v255, 5, 1
    v_and_b32 v160, 0x40, v160
    v_xor_b32 v166, v166, v160
    v_add_u32 v165, v165, v166
    v_mov_b32 v166, 0x7800
    v_bfe_u32 v160, v255, 5, 1
    v_mul_u32_u24 v160, 0xc00, v160
    v_add_u32 v166, v166, v160
    v_bfe_u32 v160, v255, 6, 2
    v_mul_u32_u24 v160, 0xc000, v160
    v_add_u32 v166, v166, v160
    v_mov_b32 v167, 0x80
    v_bfe_i32 v160, v255, 0, 1
    v_and_b32 v160, 0x10, v160
    v_xor_b32 v167, v167, v160
    v_bfe_i32 v160, v255, 1, 1
    v_and_b32 v160, 0x20, v160
    v_xor_b32 v167, v167, v160
    v_bfe_i32 v160, v255, 2, 1
    v_and_b32 v160, 0x40, v160
    v_xor_b32 v167, v167, v160
    v_bfe_i32 v160, v255, 3, 1
    v_and_b32 v160, 0x80, v160
    v_xor_b32 v167, v167, v160
    v_bfe_i32 v160, v255, 4, 1
    v_and_b32 v160, 0x100, v160
    v_xor_b32 v167, v167, v160
    v_bfe_i32 v160, v255, 5, 1
    v_and_b32 v160, 0x40, v160
    v_xor_b32 v167, v167, v160
    v_add_u32 v166, v166, v167
    v_mov_b32 v167, 0x9000
    v_bfe_u32 v160, v255, 5, 1
    v_mul_u32_u24 v160, 0xc00, v160
    v_add_u32 v167, v167, v160
    v_bfe_u32 v160, v255, 6, 2
    v_mul_u32_u24 v160, 0xc000, v160
    v_add_u32 v167, v167, v160
    v_mov_b32 v168, 0x0
    v_bfe_i32 v160, v255, 0, 1
    v_and_b32 v160, 0x10, v160
    v_xor_b32 v168, v168, v160
    v_bfe_i32 v160, v255, 1, 1
    v_and_b32 v160, 0x20, v160
    v_xor_b32 v168, v168, v160
    v_bfe_i32 v160, v255, 2, 1
    v_and_b32 v160, 0x40, v160
    v_xor_b32 v168, v168, v160
    v_bfe_i32 v160, v255, 3, 1
    v_and_b32 v160, 0x80, v160
    v_xor_b32 v168, v168, v160
    v_bfe_i32 v160, v255, 4, 1
    v_and_b32 v160, 0x100, v160
    v_xor_b32 v168, v168, v160
    v_bfe_i32 v160, v255, 5, 1
    v_and_b32 v160, 0x40, v160
    v_xor_b32 v168, v168, v160
    v_add_u32 v167, v167, v168
    v_mov_b32 v168, 0xa800
    v_bfe_u32 v160, v255, 5, 1
    v_mul_u32_u24 v160, 0xc00, v160
    v_add_u32 v168, v168, v160
    v_bfe_u32 v160, v255, 6, 2
    v_mul_u32_u24 v160, 0xc000, v160
    v_add_u32 v168, v168, v160
    v_mov_b32 v169, 0x80
    v_bfe_i32 v160, v255, 0, 1
    v_and_b32 v160, 0x10, v160
    v_xor_b32 v169, v169, v160
    v_bfe_i32 v160, v255, 1, 1
    v_and_b32 v160, 0x20, v160
    v_xor_b32 v169, v169, v160
    v_bfe_i32 v160, v255, 2, 1
    v_and_b32 v160, 0x40, v160
    v_xor_b32 v169, v169, v160
    v_bfe_i32 v160, v255, 3, 1
    v_and_b32 v160, 0x80, v160
    v_xor_b32 v169, v169, v160
    v_bfe_i32 v160, v255, 4, 1
    v_and_b32 v160, 0x100, v160
    v_xor_b32 v169, v169, v160
    v_bfe_i32 v160, v255, 5, 1
    v_and_b32 v160, 0x40, v160
    v_xor_b32 v169, v169, v160
    v_add_u32 v168, v168, v169
    v_mov_b32 v170, 0x0
    v_bfe_i32 v160, v255, 0, 1
    v_and_b32 v160, 0x10, v160
    v_xor_b32 v170, v170, v160
    v_bfe_i32 v160, v255, 1, 1
    v_and_b32 v160, 0x8, v160
    v_xor_b32 v170, v170, v160
    v_bfe_i32 v160, v255, 2, 1
    v_and_b32 v160, 0x240, v160
    v_xor_b32 v170, v170, v160
    v_bfe_i32 v160, v255, 3, 1
    v_and_b32 v160, 0x480, v160
    v_xor_b32 v170, v170, v160
    v_bfe_i32 v160, v255, 4, 1
    v_and_b32 v160, 0x1000, v160
    v_xor_b32 v170, v170, v160
    v_bfe_i32 v160, v255, 5, 1
    v_and_b32 v160, 0x2000, v160
    v_xor_b32 v170, v170, v160
    v_bfe_i32 v160, v255, 6, 1
    v_and_b32 v160, 0x80, v160
    v_xor_b32 v170, v170, v160
    v_bfe_i32 v160, v255, 7, 1
    v_and_b32 v160, 0x100, v160
    v_xor_b32 v170, v170, v160
    v_mov_b32 v171, 0x40
    v_bfe_i32 v160, v255, 0, 1
    v_and_b32 v160, 0x10, v160
    v_xor_b32 v171, v171, v160
    v_bfe_i32 v160, v255, 1, 1
    v_and_b32 v160, 0x8, v160
    v_xor_b32 v171, v171, v160
    v_bfe_i32 v160, v255, 2, 1
    v_and_b32 v160, 0x240, v160
    v_xor_b32 v171, v171, v160
    v_bfe_i32 v160, v255, 3, 1
    v_and_b32 v160, 0x480, v160
    v_xor_b32 v171, v171, v160
    v_bfe_i32 v160, v255, 4, 1
    v_and_b32 v160, 0x1000, v160
    v_xor_b32 v171, v171, v160
    v_bfe_i32 v160, v255, 5, 1
    v_and_b32 v160, 0x2000, v160
    v_xor_b32 v171, v171, v160
    v_bfe_i32 v160, v255, 6, 1
    v_and_b32 v160, 0x80, v160
    v_xor_b32 v171, v171, v160
    v_bfe_i32 v160, v255, 7, 1
    v_and_b32 v160, 0x100, v160
    v_xor_b32 v171, v171, v160
    s_lshl_b32 s64, s31, 13
    s_add_u32 s66, s70, 0x0
    s_addc_u32 s67, s71, 0
    s_add_u32 m0, s64, 0x0
    s_nop 0
    global_load_lds_dwordx4 v161, s[66:67]
    s_add_u32 m0, s64, 0x400
    s_nop 0
    global_load_lds_dwordx4 v162, s[66:67]
    s_add_u32 m0, s64, 0x800
    s_nop 0
    global_load_lds_dwordx4 v163, s[66:67]
    s_add_u32 m0, s64, 0xc00
    s_nop 0
    global_load_lds_dwordx4 v164, s[66:67]
    s_add_u32 m0, s64, 0x1000
    s_nop 0
    global_load_lds_dwordx4 v165, s[66:67]
    s_add_u32 m0, s64, 0x1400
    s_nop 0
    global_load_lds_dwordx4 v166, s[66:67]
    s_add_u32 m0, s64, 0x1800
    s_nop 0
    global_load_lds_dwordx4 v167, s[66:67]
    s_add_u32 m0, s64, 0x1c00
    s_nop 0
    global_load_lds_dwordx4 v168, s[66:67]
    s_add_u32 s66, s70, 0x30000
    s_addc_u32 s67, s71, 0
    s_add_u32 m0, s64, 0x8000
    s_nop 0
    global_load_lds_dwordx4 v161, s[66:67]
    s_add_u32 m0, s64, 0x8400
    s_nop 0
    global_load_lds_dwordx4 v162, s[66:67]
    s_add_u32 m0, s64, 0x8800
    s_nop 0
    global_load_lds_dwordx4 v163, s[66:67]
    s_add_u32 m0, s64, 0x8c00
    s_nop 0
    global_load_lds_dwordx4 v164, s[66:67]
    s_add_u32 m0, s64, 0x9000
    s_nop 0
    global_load_lds_dwordx4 v165, s[66:67]
    s_add_u32 m0, s64, 0x9400
    s_nop 0
    global_load_lds_dwordx4 v166, s[66:67]
    s_add_u32 m0, s64, 0x9800
    s_nop 0
    global_load_lds_dwordx4 v167, s[66:67]
    s_add_u32 m0, s64, 0x9c00
    s_nop 0
    global_load_lds_dwordx4 v168, s[66:67]
    s_add_u32 s66, s70, 0x60000
    s_addc_u32 s67, s71, 0
    s_add_u32 m0, s64, 0x10000
    s_nop 0
    global_load_lds_dwordx4 v161, s[66:67]
    s_add_u32 m0, s64, 0x10400
    s_nop 0
    global_load_lds_dwordx4 v162, s[66:67]
    s_add_u32 m0, s64, 0x10800
    s_nop 0
    global_load_lds_dwordx4 v163, s[66:67]
    s_add_u32 m0, s64, 0x10c00
    s_nop 0
    global_load_lds_dwordx4 v164, s[66:67]
    s_add_u32 m0, s64, 0x11000
    s_nop 0
    global_load_lds_dwordx4 v165, s[66:67]
    s_add_u32 m0, s64, 0x11400
    s_nop 0
    global_load_lds_dwordx4 v166, s[66:67]
    s_add_u32 m0, s64, 0x11800
    s_nop 0
    global_load_lds_dwordx4 v167, s[66:67]
    s_add_u32 m0, s64, 0x11c00
    s_nop 0
    global_load_lds_dwordx4 v168, s[66:67]
    s_add_u32 s66, s70, 0x90000
    s_addc_u32 s67, s71, 0
    s_add_u32 m0, s64, 0x18000
    s_nop 0
    global_load_lds_dwordx4 v161, s[66:67]
    s_add_u32 m0, s64, 0x18400
    s_nop 0
    global_load_lds_dwordx4 v162, s[66:67]
    s_add_u32 m0, s64, 0x18800
    s_nop 0
    global_load_lds_dwordx4 v163, s[66:67]
    s_add_u32 m0, s64, 0x18c00
    s_nop 0
    global_load_lds_dwordx4 v164, s[66:67]
    s_add_u32 m0, s64, 0x19000
    s_nop 0
    global_load_lds_dwordx4 v165, s[66:67]
    s_add_u32 m0, s64, 0x19400
    s_nop 0
    global_load_lds_dwordx4 v166, s[66:67]
    s_add_u32 m0, s64, 0x19800
    s_nop 0
    global_load_lds_dwordx4 v167, s[66:67]
    s_add_u32 m0, s64, 0x19c00
    s_nop 0
    global_load_lds_dwordx4 v168, s[66:67]
    s_waitcnt vmcnt(24)
    s_barrier
    s_add_u32 s66, s70, 0xc0000
    s_addc_u32 s67, s71, 0
    s_add_u32 m0, s64, 0x20000
    s_nop 0
    global_load_lds_dwordx4 v161, s[66:67]
    s_add_u32 m0, s64, 0x20400
    s_nop 0
    global_load_lds_dwordx4 v162, s[66:67]
    s_add_u32 m0, s64, 0x20800
    s_nop 0
    global_load_lds_dwordx4 v163, s[66:67]
    s_add_u32 m0, s64, 0x20c00
    s_nop 0
    global_load_lds_dwordx4 v164, s[66:67]
    s_add_u32 m0, s64, 0x21000
    s_nop 0
    global_load_lds_dwordx4 v165, s[66:67]
    s_add_u32 m0, s64, 0x21400
    s_nop 0
    global_load_lds_dwordx4 v166, s[66:67]
    s_add_u32 m0, s64, 0x21800
    s_nop 0
    global_load_lds_dwordx4 v167, s[66:67]
    s_add_u32 m0, s64, 0x21c00
    s_nop 0
    global_load_lds_dwordx4 v168, s[66:67]
    v_add_u32 v186, 0x0, v170
    v_add_u32 v187, 0x0, v171
    ds_read_b64_tr_b16 a[0:1], v186 offset:0
    ds_read_b64_tr_b16 a[2:3], v186 offset:2048
    ds_read_b64_tr_b16 a[4:5], v186 offset:32
    ds_read_b64_tr_b16 a[6:7], v186 offset:2080
    ds_read_b64_tr_b16 a[8:9], v187 offset:0
    ds_read_b64_tr_b16 a[10:11], v187 offset:2048
    ds_read_b64_tr_b16 a[12:13], v187 offset:32
    ds_read_b64_tr_b16 a[14:15], v187 offset:2080
    ds_read_b64_tr_b16 a[16:17], v186 offset:16384
    ds_read_b64_tr_b16 a[18:19], v186 offset:18432
    ds_read_b64_tr_b16 a[20:21], v186 offset:16416
    ds_read_b64_tr_b16 a[22:23], v186 offset:18464
    ds_read_b64_tr_b16 a[24:25], v187 offset:16384
    ds_read_b64_tr_b16 a[26:27], v187 offset:18432
    ds_read_b64_tr_b16 a[28:29], v187 offset:16416
    ds_read_b64_tr_b16 a[30:31], v187 offset:18464
L_lw_37:
    s_waitcnt lgkmcnt(0)
    s_waitcnt vmcnt(24)
    s_barrier
    s_add_u32 s66, s70, 0xf0000
    s_addc_u32 s67, s71, 0
    s_add_u32 m0, s64, 0x0
    s_nop 0
    global_load_lds_dwordx4 v161, s[66:67]
    s_add_u32 m0, s64, 0x400
    s_nop 0
    global_load_lds_dwordx4 v162, s[66:67]
    s_add_u32 m0, s64, 0x800
    s_nop 0
    global_load_lds_dwordx4 v163, s[66:67]
    s_add_u32 m0, s64, 0xc00
    s_nop 0
    global_load_lds_dwordx4 v164, s[66:67]
    s_add_u32 m0, s64, 0x1000
    s_nop 0
    global_load_lds_dwordx4 v165, s[66:67]
    s_add_u32 m0, s64, 0x1400
    s_nop 0
    global_load_lds_dwordx4 v166, s[66:67]
    s_add_u32 m0, s64, 0x1800
    s_nop 0
    global_load_lds_dwordx4 v167, s[66:67]
    s_add_u32 m0, s64, 0x1c00
    s_nop 0
    global_load_lds_dwordx4 v168, s[66:67]
    v_add_u32 v186, 0x8000, v170
    v_add_u32 v187, 0x8000, v171
    ds_read_b64_tr_b16 a[32:33], v186 offset:0
    ds_read_b64_tr_b16 a[34:35], v186 offset:2048
    ds_read_b64_tr_b16 a[36:37], v186 offset:32
    ds_read_b64_tr_b16 a[38:39], v186 offset:2080
    ds_read_b64_tr_b16 a[40:41], v187 offset:0
    ds_read_b64_tr_b16 a[42:43], v187 offset:2048
    ds_read_b64_tr_b16 a[44:45], v187 offset:32
    ds_read_b64_tr_b16 a[46:47], v187 offset:2080
    ds_read_b64_tr_b16 a[48:49], v186 offset:16384
    ds_read_b64_tr_b16 a[50:51], v186 offset:18432
    ds_read_b64_tr_b16 a[52:53], v186 offset:16416
    ds_read_b64_tr_b16 a[54:55], v186 offset:18464
    ds_read_b64_tr_b16 a[56:57], v187 offset:16384
    ds_read_b64_tr_b16 a[58:59], v187 offset:18432
    ds_read_b64_tr_b16 a[60:61], v187 offset:16416
    ds_read_b64_tr_b16 a[62:63], v187 offset:18464
L_lw_38:
    s_waitcnt lgkmcnt(0)
    s_waitcnt vmcnt(24)
    s_barrier
    s_add_u32 s66, s70, 0x120000
    s_addc_u32 s67, s71, 0
    s_add_u32 m0, s64, 0x8000
    s_nop 0
    global_load_lds_dwordx4 v161, s[66:67]
    s_add_u32 m0, s64, 0x8400
    s_nop 0
    global_load_lds_dwordx4 v162, s[66:67]
    s_add_u32 m0, s64, 0x8800
    s_nop 0
    global_load_lds_dwordx4 v163, s[66:67]
    s_add_u32 m0, s64, 0x8c00
    s_nop 0
    global_load_lds_dwordx4 v164, s[66:67]
    s_add_u32 m0, s64, 0x9000
    s_nop 0
    global_load_lds_dwordx4 v165, s[66:67]
    s_add_u32 m0, s64, 0x9400
    s_nop 0
    global_load_lds_dwordx4 v166, s[66:67]
    s_add_u32 m0, s64, 0x9800
    s_nop 0
    global_load_lds_dwordx4 v167, s[66:67]
    s_add_u32 m0, s64, 0x9c00
    s_nop 0
    global_load_lds_dwordx4 v168, s[66:67]
    v_add_u32 v186, 0x10000, v170
    v_add_u32 v187, 0x10000, v171
    ds_read_b64_tr_b16 a[64:65], v186 offset:0
    ds_read_b64_tr_b16 a[66:67], v186 offset:2048
    ds_read_b64_tr_b16 a[68:69], v186 offset:32
    ds_read_b64_tr_b16 a[70:71], v186 offset:2080
    ds_read_b64_tr_b16 a[72:73], v187 offset:0
    ds_read_b64_tr_b16 a[74:75], v187 offset:2048
    ds_read_b64_tr_b16 a[76:77], v187 offset:32
    ds_read_b64_tr_b16 a[78:79], v187 offset:2080
    ds_read_b64_tr_b16 a[80:81], v186 offset:16384
    ds_read_b64_tr_b16 a[82:83], v186 offset:18432
    ds_read_b64_tr_b16 a[84:85], v186 offset:16416
    ds_read_b64_tr_b16 a[86:87], v186 offset:18464
    ds_read_b64_tr_b16 a[88:89], v187 offset:16384
    ds_read_b64_tr_b16 a[90:91], v187 offset:18432
    ds_read_b64_tr_b16 a[92:93], v187 offset:16416
    ds_read_b64_tr_b16 a[94:95], v187 offset:18464
L_lw_39:
    s_waitcnt lgkmcnt(0)
    s_waitcnt vmcnt(24)
    s_barrier
    s_add_u32 s66, s70, 0x150000
    s_addc_u32 s67, s71, 0
    s_add_u32 m0, s64, 0x10000
    s_nop 0
    global_load_lds_dwordx4 v161, s[66:67]
    s_add_u32 m0, s64, 0x10400
    s_nop 0
    global_load_lds_dwordx4 v162, s[66:67]
    s_add_u32 m0, s64, 0x10800
    s_nop 0
    global_load_lds_dwordx4 v163, s[66:67]
    s_add_u32 m0, s64, 0x10c00
    s_nop 0
    global_load_lds_dwordx4 v164, s[66:67]
    s_add_u32 m0, s64, 0x11000
    s_nop 0
    global_load_lds_dwordx4 v165, s[66:67]
    s_add_u32 m0, s64, 0x11400
    s_nop 0
    global_load_lds_dwordx4 v166, s[66:67]
    s_add_u32 m0, s64, 0x11800
    s_nop 0
    global_load_lds_dwordx4 v167, s[66:67]
    s_add_u32 m0, s64, 0x11c00
    s_nop 0
    global_load_lds_dwordx4 v168, s[66:67]
    v_add_u32 v186, 0x18000, v170
    v_add_u32 v187, 0x18000, v171
    ds_read_b64_tr_b16 a[96:97], v186 offset:0
    ds_read_b64_tr_b16 a[98:99], v186 offset:2048
    ds_read_b64_tr_b16 a[100:101], v186 offset:32
    ds_read_b64_tr_b16 a[102:103], v186 offset:2080
    ds_read_b64_tr_b16 a[104:105], v187 offset:0
    ds_read_b64_tr_b16 a[106:107], v187 offset:2048
    ds_read_b64_tr_b16 a[108:109], v187 offset:32
    ds_read_b64_tr_b16 a[110:111], v187 offset:2080
    ds_read_b64_tr_b16 a[112:113], v186 offset:16384
    ds_read_b64_tr_b16 a[114:115], v186 offset:18432
    ds_read_b64_tr_b16 a[116:117], v186 offset:16416
    ds_read_b64_tr_b16 a[118:119], v186 offset:18464
    ds_read_b64_tr_b16 a[120:121], v187 offset:16384
    ds_read_b64_tr_b16 a[122:123], v187 offset:18432
    ds_read_b64_tr_b16 a[124:125], v187 offset:16416
    ds_read_b64_tr_b16 a[126:127], v187 offset:18464
L_lw_40:
    s_waitcnt lgkmcnt(0)
    s_waitcnt vmcnt(24)
    s_barrier
    v_add_u32 v186, 0x20000, v170
    v_add_u32 v187, 0x20000, v171
    ds_read_b64_tr_b16 a[128:129], v186 offset:0
    ds_read_b64_tr_b16 a[130:131], v186 offset:2048
    ds_read_b64_tr_b16 a[132:133], v186 offset:32
    ds_read_b64_tr_b16 a[134:135], v186 offset:2080
    ds_read_b64_tr_b16 a[136:137], v187 offset:0
    ds_read_b64_tr_b16 a[138:139], v187 offset:2048
    ds_read_b64_tr_b16 a[140:141], v187 offset:32
    ds_read_b64_tr_b16 a[142:143], v187 offset:2080
    ds_read_b64_tr_b16 a[144:145], v186 offset:16384
    ds_read_b64_tr_b16 a[146:147], v186 offset:18432
    ds_read_b64_tr_b16 a[148:149], v186 offset:16416
    ds_read_b64_tr_b16 a[150:151], v186 offset:18464
    ds_read_b64_tr_b16 a[152:153], v187 offset:16384
    ds_read_b64_tr_b16 a[154:155], v187 offset:18432
    ds_read_b64_tr_b16 a[156:157], v187 offset:16416
    ds_read_b64_tr_b16 a[158:159], v187 offset:18464
L_lw_41:
    s_waitcnt lgkmcnt(0)
    s_waitcnt vmcnt(16)
    s_barrier
    v_add_u32 v186, 0x0, v170
    v_add_u32 v187, 0x0, v171
    ds_read_b64_tr_b16 a[160:161], v186 offset:0
    ds_read_b64_tr_b16 a[162:163], v186 offset:2048
    ds_read_b64_tr_b16 a[164:165], v186 offset:32
    ds_read_b64_tr_b16 a[166:167], v186 offset:2080
    ds_read_b64_tr_b16 a[168:169], v187 offset:0
    ds_read_b64_tr_b16 a[170:171], v187 offset:2048
    ds_read_b64_tr_b16 a[172:173], v187 offset:32
    ds_read_b64_tr_b16 a[174:175], v187 offset:2080
    ds_read_b64_tr_b16 a[176:177], v186 offset:16384
    ds_read_b64_tr_b16 a[178:179], v186 offset:18432
    ds_read_b64_tr_b16 a[180:181], v186 offset:16416
    ds_read_b64_tr_b16 a[182:183], v186 offset:18464
    ds_read_b64_tr_b16 a[184:185], v187 offset:16384
    ds_read_b64_tr_b16 a[186:187], v187 offset:18432
    ds_read_b64_tr_b16 a[188:189], v187 offset:16416
    ds_read_b64_tr_b16 a[190:191], v187 offset:18464
L_lw_42:
    s_waitcnt lgkmcnt(0)
    s_waitcnt vmcnt(8)
    s_barrier
    v_add_u32 v186, 0x8000, v170
    v_add_u32 v187, 0x8000, v171
    ds_read_b64_tr_b16 a[192:193], v186 offset:0
    ds_read_b64_tr_b16 a[194:195], v186 offset:2048
    ds_read_b64_tr_b16 a[196:197], v186 offset:32
    ds_read_b64_tr_b16 a[198:199], v186 offset:2080
    ds_read_b64_tr_b16 a[200:201], v187 offset:0
    ds_read_b64_tr_b16 a[202:203], v187 offset:2048
    ds_read_b64_tr_b16 a[204:205], v187 offset:32
    ds_read_b64_tr_b16 a[206:207], v187 offset:2080
    ds_read_b64_tr_b16 a[208:209], v186 offset:16384
    ds_read_b64_tr_b16 a[210:211], v186 offset:18432
    ds_read_b64_tr_b16 a[212:213], v186 offset:16416
    ds_read_b64_tr_b16 a[214:215], v186 offset:18464
    ds_read_b64_tr_b16 a[216:217], v187 offset:16384
    ds_read_b64_tr_b16 a[218:219], v187 offset:18432
    ds_read_b64_tr_b16 a[220:221], v187 offset:16416
    ds_read_b64_tr_b16 a[222:223], v187 offset:18464
L_lw_43:
    s_waitcnt lgkmcnt(0)
    s_waitcnt vmcnt(0)
    s_barrier
    v_add_u32 v186, 0x10000, v170
    v_add_u32 v187, 0x10000, v171
    ds_read_b64_tr_b16 a[224:225], v186 offset:0
    ds_read_b64_tr_b16 a[226:227], v186 offset:2048
    ds_read_b64_tr_b16 a[228:229], v186 offset:32
    ds_read_b64_tr_b16 a[230:231], v186 offset:2080
    ds_read_b64_tr_b16 a[232:233], v187 offset:0
    ds_read_b64_tr_b16 a[234:235], v187 offset:2048
    ds_read_b64_tr_b16 a[236:237], v187 offset:32
    ds_read_b64_tr_b16 a[238:239], v187 offset:2080
    ds_read_b64_tr_b16 a[240:241], v186 offset:16384
    ds_read_b64_tr_b16 a[242:243], v186 offset:18432
    ds_read_b64_tr_b16 a[244:245], v186 offset:16416
    ds_read_b64_tr_b16 a[246:247], v186 offset:18464
    ds_read_b64_tr_b16 a[248:249], v187 offset:16384
    ds_read_b64_tr_b16 a[250:251], v187 offset:18432
    ds_read_b64_tr_b16 a[252:253], v187 offset:16416
    ds_read_b64_tr_b16 a[254:255], v187 offset:18464
L_lw_44:
    s_waitcnt lgkmcnt(0)
    v_mov_b32 v157, 0x0
    v_bfe_u32 v160, v255, 0, 4
    v_lshl_add_u32 v157, v160, 4, v157
    v_bfe_u32 v160, v255, 4, 1
    v_lshl_add_u32 v157, v160, 9, v157
    v_bfe_u32 v160, v255, 5, 1
    v_lshl_add_u32 v157, v160, 8, v157
    s_lshl_b32 s80, s34, 10
L_qa_wd:
    v_add_u32 v157, s80, v157
    s_cmp_lt_u32 s32, 2
    s_cselect_b32 s50, 0x3eb8aa3b, 1.0
    s_mov_b32 s51, s50
    v_mov_b32 v146, 0x0
    v_bfe_u32 v160, v255, 0, 6
    v_lshl_add_u32 v146, v160, 4, v146
    v_mov_b32 v147, 0x0
    v_bfe_u32 v160, v255, 0, 6
    v_lshl_add_u32 v147, v160, 2, v147
    v_mov_b32 v148, 0x0
    v_bfe_u32 v160, v255, 0, 5
    v_lshl_add_u32 v148, v160, 10, v148
    v_bfe_u32 v160, v255, 5, 1
    v_lshl_add_u32 v148, v160, 4, v148
    v_mov_b32 v200, 0x0
    v_bfe_u32 v160, v255, 0, 5
    v_lshl_add_u32 v200, v160, 7, v200
    v_mov_b32 v149, 0x0
    v_bfe_u32 v160, v255, 0, 6
    v_lshl_add_u32 v149, v160, 4, v149
    v_bfe_u32 v160, v255, 6, 2
    v_lshl_add_u32 v149, v160, 12, v149
    v_mov_b32 v150, 0x8000
    v_bfe_u32 v160, v255, 0, 4
    v_lshl_add_u32 v150, v160, 4, v150
    v_bfe_u32 v160, v255, 5, 1
    v_lshl_add_u32 v150, v160, 8, v150
    v_bfe_u32 v160, v255, 6, 2
    v_lshl_add_u32 v150, v160, 2, v150
    v_mov_b32 v151, 0x8000
    v_bfe_u32 v160, v255, 0, 4
    v_lshl_add_u32 v151, v160, 4, v151
    v_mov_b32 v155, 0x0
    v_bfe_u32 v160, v255, 0, 4
    v_lshl_add_u32 v155, v160, 4, v155
    v_bfe_u32 v160, v255, 4, 2
    v_lshl_add_u32 v155, v160, 9, v155
    v_mov_b32 v156, 0x0
    v_bfe_u32 v160, v255, 0, 4
    v_lshl_add_u32 v156, v160, 2, v156
    v_bfe_u32 v160, v255, 4, 1
    v_lshl_add_u32 v156, v160, 7, v156
    v_bfe_u32 v160, v255, 5, 1
    v_lshl_add_u32 v156, v160, 11, v156
    v_mov_b32 v158, 0x0
    v_bfe_u32 v160, v255, 0, 1
    v_lshl_add_u32 v158, v160, 8, v158
    s_lshl_b32 s80, s34, 8
    v_add_u32 v155, s80, v155
    s_lshl_b32 s80, s34, 6
    v_add_u32 v156, s80, v156
    v_mov_b32 v152, 0
    v_mov_b32 v153, 1
    s_cmp_lg_u32 s31, 0
    s_cbranch_scc1 L_qa_init_ok
    v_mov_b32 v160, 12
L_qa_init:
    global_load_dword v161, v160, s[26:27] sc1
    s_waitcnt vmcnt(0)
    v_readfirstlane_b32 s80, v161
    s_cmp_ge_u32 s80, 32
    s_cbranch_scc1 L_qa_init_ok
    s_sleep 4
    s_sub_u32 s62, s62, 1
    s_cbranch_scc0 L_qa_init
    s_movk_i32 s63, 10
    s_branch L_fail_far
L_qa_init_ok:
    s_cmp_lg_u32 s31, 0
    s_cbranch_scc1 L_qa_init2_ok
    v_mov_b32 v160, 64
L_qa_init2:
    global_load_dword v161, v160, s[26:27] sc1
    s_waitcnt vmcnt(0)
    v_readfirstlane_b32 s80, v161
    s_cmp_ge_u32 s80, 32
    s_cbranch_scc1 L_qa_init2_ok
    s_sleep 4
    s_sub_u32 s62, s62, 1
    s_cbranch_scc0 L_qa_init2
    s_movk_i32 s63, 10
    s_branch L_fail_far
L_qa_init2_ok:
    s_barrier
    s_mov_b32 s90, 0x00003f80
    s_mov_b32 s91, 0x3f800000
    s_mov_b32 s92, 0x3f803f80
L_qa_loop:
    s_lshl_b32 s83, s33, 15
    s_lshl_b32 s84, s31, 13
    s_add_u32 s83, s83, s84
    s_add_u32 s84, s83, 0xb01000
    s_add_u32 s40, s28, s84
    s_addc_u32 s41, s29, 0
    s_lshl_b32 s83, s83, 1
    s_add_u32 s83, s83, 0xf01000
    s_add_u32 s38, s28, s83
    s_addc_u32 s39, s29, 0
    s_and_b32 s84, s33, 3
    s_lshl_b32 s84, s84, 11
    s_add_u32 s84, s84, 0x0
    s_add_u32 s48, s28, s84
    s_addc_u32 s49, s29, 0
    s_lshr_b32 s54, s33, 2
    s_add_u32 s54, s54, 1
    s_cmp_eq_u32 s33, 63
    s_cselect_b32 s85, -1, 0x7ff
    v_and_b32 v154, s85, v200
L_qa_wx:
    global_load_dword v159, v154, s[48:49] offset:0 sc1
    s_waitcnt vmcnt(0)
    v_cmp_gt_u32 vcc, s54, v159
    s_cbranch_vccz L_qa_wx_ok
    s_sleep 1
    s_sub_u32 s62, s62, 1
    s_cbranch_scc0 L_qa_wx
    s_movk_i32 s63, 11
    s_branch L_fail_far
L_qa_wx_ok:
    global_load_dwordx4 v[64:67], v155, s[40:41] offset:-4096 sc1
    global_load_dword v0, v156, s[38:39] offset:-4096 sc1
    global_load_dword v1, v156, s[38:39] offset:-3840 sc1
    global_load_dword v2, v156, s[38:39] offset:-3584 sc1
    global_load_dword v3, v156, s[38:39] offset:-3328 sc1
    global_load_dword v4, v156, s[38:39] offset:-3072 sc1
    global_load_dword v5, v156, s[38:39] offset:-2816 sc1
    global_load_dword v6, v156, s[38:39] offset:-2560 sc1
    global_load_dword v7, v156, s[38:39] offset:-2304 sc1
    global_load_dwordx4 v[68:71], v155, s[40:41] offset:-2048 sc1
    global_load_dword v8, v156, s[38:39] offset:0 sc1
    global_load_dword v9, v156, s[38:39] offset:256 sc1
    global_load_dword v10, v156, s[38:39] offset:512 sc1
    global_load_dword v11, v156, s[38:39] offset:768 sc1
    global_load_dword v12, v156, s[38:39] offset:1024 sc1
    global_load_dword v13, v156, s[38:39] offset:1280 sc1
    global_load_dword v14, v156, s[38:39] offset:1536 sc1
    global_load_dword v15, v156, s[38:39] offset:1792 sc1
    s_add_u32 s38, s38, 0x2000
    s_addc_u32 s39, s39, 0
    global_load_dwordx4 v[72:75], v155, s[40:41] offset:0 sc1
    global_load_dword v16, v156, s[38:39] offset:-4096 sc1
    global_load_dword v17, v156, s[38:39] offset:-3840 sc1
    global_load_dword v18, v156, s[38:39] offset:-3584 sc1
    global_load_dword v19, v156, s[38:39] offset:-3328 sc1
    global_load_dword v20, v156, s[38:39] offset:-3072 sc1
    global_load_dword v21, v156, s[38:39] offset:-2816 sc1
    global_load_dword v22, v156, s[38:39] offset:-2560 sc1
    global_load_dword v23, v156, s[38:39] offset:-2304 sc1
    global_load_dwordx4 v[76:79], v155, s[40:41] offset:2048 sc1
    global_load_dword v24, v156, s[38:39] offset:0 sc1
    global_load_dword v25, v156, s[38:39] offset:256 sc1
    global_load_dword v26, v156, s[38:39] offset:512 sc1
    global_load_dword v27, v156, s[38:39] offset:768 sc1
    global_load_dword v28, v156, s[38:39] offset:1024 sc1
    global_load_dword v29, v156, s[38:39] offset:1280 sc1
    global_load_dword v30, v156, s[38:39] offset:1536 sc1
    global_load_dword v31, v156, s[38:39] offset:1792 sc1
L_qa_loop2:
    s_lshl_b32 s82, s33, 15
    s_lshr_b32 s84, s32, 1
    s_lshl_b32 s84, s84, 21
    s_add_u32 s84, s84, s82
    s_and_b32 s85, s32, 1
    s_lshl_b32 s85, s85, 2
    s_add_u32 s85, s85, s31
    s_lshl_b32 s85, s85, 12
    s_add_u32 s84, s84, s85
    s_add_u32 s84, s84, 0x5500000
    s_add_u32 s42, s28, s84
    s_addc_u32 s43, s29, 0
    s_lshl_b32 s84, s32, 2
    s_add_u32 s84, s84, s31
    s_lshl_b32 s84, s84, 7
    s_add_u32 s84, s84, s33
    s_lshl_b32 s84, s84, 2
    s_add_u32 s84, s84, s34
    s_add_u32 s84, s84, 0x24000
    s_add_u32 s46, s28, s84
    s_addc_u32 s47, s29, 0
    s_lshl_b32 s83, s31, 13
    s_add_u32 s83, s83, s82
    s_add_u32 s84, s83, 0x5301000
    s_add_u32 s44, s28, s84
    s_addc_u32 s45, s29, 0
    s_add_u32 s33, s33, s52
    s_lshl_b32 s83, s33, 15
    s_lshl_b32 s84, s31, 13
    s_add_u32 s83, s83, s84
    s_add_u32 s84, s83, 0xb01000
    s_add_u32 s40, s28, s84
    s_addc_u32 s41, s29, 0
    s_lshl_b32 s83, s83, 1
    s_add_u32 s83, s83, 0xf01000
    s_add_u32 s38, s28, s83
    s_addc_u32 s39, s29, 0
    s_and_b32 s84, s33, 3
    s_lshl_b32 s84, s84, 11
    s_add_u32 s84, s84, 0x0
    s_add_u32 s48, s28, s84
    s_addc_u32 s49, s29, 0
    s_lshr_b32 s54, s33, 2
    s_add_u32 s54, s54, 1
    s_cmp_eq_u32 s33, 63
    s_cselect_b32 s85, -1, 0x7ff
    v_and_b32 v154, s85, v200
    global_load_dword v159, v154, s[48:49] sc1
    s_waitcnt vmcnt(28)
    v_dot2_f32_bf16 v0, v64, s90, v0
    v_dot2_f32_bf16 v1, v64, s91, v1
    v_dot2_f32_bf16 v2, v65, s90, v2
    v_dot2_f32_bf16 v3, v65, s91, v3
    v_dot2_f32_bf16 v4, v66, s90, v4
    v_dot2_f32_bf16 v5, v66, s91, v5
    v_dot2_f32_bf16 v6, v67, s90, v6
    v_dot2_f32_bf16 v7, v67, s91, v7
    v_cvt_pk_bf16_f32 v64, v0, v1
    v_cvt_pk_bf16_f32 v65, v2, v3
    v_cvt_pk_bf16_f32 v66, v4, v5
    v_cvt_pk_bf16_f32 v67, v6, v7
    v_dot2_f32_bf16 v144, v64, s92, 0
    v_dot2_f32_bf16 v145, v64, v64, 0
    v_dot2_f32_bf16 v144, v65, s92, v144
    v_dot2_f32_bf16 v145, v65, v65, v145
    v_dot2_f32_bf16 v144, v66, s92, v144
    v_dot2_f32_bf16 v145, v66, v66, v145
    v_dot2_f32_bf16 v144, v67, s92, v144
    v_dot2_f32_bf16 v145, v67, v67, v145
    s_waitcnt vmcnt(19)
    v_dot2_f32_bf16 v8, v68, s90, v8
    v_dot2_f32_bf16 v9, v68, s91, v9
    v_dot2_f32_bf16 v10, v69, s90, v10
    v_dot2_f32_bf16 v11, v69, s91, v11
    v_dot2_f32_bf16 v12, v70, s90, v12
    v_dot2_f32_bf16 v13, v70, s91, v13
    v_dot2_f32_bf16 v14, v71, s90, v14
    v_dot2_f32_bf16 v15, v71, s91, v15
    v_cvt_pk_bf16_f32 v68, v8, v9
    v_cvt_pk_bf16_f32 v69, v10, v11
    v_cvt_pk_bf16_f32 v70, v12, v13
    v_cvt_pk_bf16_f32 v71, v14, v15
    v_dot2_f32_bf16 v144, v68, s92, v144
    v_dot2_f32_bf16 v145, v68, v68, v145
    v_dot2_f32_bf16 v144, v69, s92, v144
    v_dot2_f32_bf16 v145, v69, v69, v145
    v_dot2_f32_bf16 v144, v70, s92, v144
    v_dot2_f32_bf16 v145, v70, v70, v145
    v_dot2_f32_bf16 v144, v71, s92, v144
    v_dot2_f32_bf16 v145, v71, v71, v145
    s_waitcnt vmcnt(10)
    v_dot2_f32_bf16 v16, v72, s90, v16
    v_dot2_f32_bf16 v17, v72, s91, v17
    v_dot2_f32_bf16 v18, v73, s90, v18
    v_dot2_f32_bf16 v19, v73, s91, v19
    v_dot2_f32_bf16 v20, v74, s90, v20
    v_dot2_f32_bf16 v21, v74, s91, v21
    v_dot2_f32_bf16 v22, v75, s90, v22
    v_dot2_f32_bf16 v23, v75, s91, v23
    v_cvt_pk_bf16_f32 v72, v16, v17
    v_cvt_pk_bf16_f32 v73, v18, v19
    v_cvt_pk_bf16_f32 v74, v20, v21
    v_cvt_pk_bf16_f32 v75, v22, v23
    v_dot2_f32_bf16 v144, v72, s92, v144
    v_dot2_f32_bf16 v145, v72, v72, v145
    v_dot2_f32_bf16 v144, v73, s92, v144
    v_dot2_f32_bf16 v145, v73, v73, v145
    v_dot2_f32_bf16 v144, v74, s92, v144
    v_dot2_f32_bf16 v145, v74, v74, v145
    v_dot2_f32_bf16 v144, v75, s92, v144
    v_dot2_f32_bf16 v145, v75, v75, v145
    s_waitcnt vmcnt(1)
    v_dot2_f32_bf16 v24, v76, s90, v24
    v_dot2_f32_bf16 v25, v76, s91, v25
    v_dot2_f32_bf16 v26, v77, s90, v26
    v_dot2_f32_bf16 v27, v77, s91, v27
    v_dot2_f32_bf16 v28, v78, s90, v28
    v_dot2_f32_bf16 v29, v78, s91, v29
    v_dot2_f32_bf16 v30, v79, s90, v30
    v_dot2_f32_bf16 v31, v79, s91, v31
    v_cvt_pk_bf16_f32 v76, v24, v25
    v_cvt_pk_bf16_f32 v77, v26, v27
    v_cvt_pk_bf16_f32 v78, v28, v29
    v_cvt_pk_bf16_f32 v79, v30, v31
    v_dot2_f32_bf16 v144, v76, s92, v144
    v_dot2_f32_bf16 v145, v76, v76, v145
    v_dot2_f32_bf16 v144, v77, s92, v144
    v_dot2_f32_bf16 v145, v77, v77, v145
    v_dot2_f32_bf16 v144, v78, s92, v144
    v_dot2_f32_bf16 v145, v78, v78, v145
    v_dot2_f32_bf16 v144, v79, s92, v144
    v_dot2_f32_bf16 v145, v79, v79, v145
    s_nop 2
    v_permlane32_swap_b32 v144, v145
    v_add_f32 v144, v144, v145
    v_mov_b32 v145, v144
    s_nop 1
    v_permlane16_swap_b32 v144, v145
    v_add_f32 v144, v144, v145
    ds_write_b32 v150, v144
    s_cmp_lg_u32 s32, 1
    s_cbranch_scc1 L_qa_noxf
    global_store_dwordx4 v155, v[64:67], s[44:45] offset:-4096 sc1
    global_store_dwordx4 v155, v[68:71], s[44:45] offset:-2048 sc1
    global_store_dwordx4 v155, v[72:75], s[44:45] offset:0 sc1
    global_store_dwordx4 v155, v[76:79], s[44:45] offset:2048 sc1
L_qa_noxf:
    s_waitcnt lgkmcnt(0)
    s_barrier
    ds_read_b128 v[112:115], v151 offset:0
    ds_read_b128 v[116:119], v151 offset:256
    s_waitcnt lgkmcnt(0)
    v_pk_add_f32 v[112:113], v[112:113], v[114:115]
    v_pk_add_f32 v[116:117], v[116:117], v[118:119]
    v_add_f32 v144, v112, v113
    v_add_f32 v145, v116, v117
    v_mul_f32 v144, 0x3b000000, v144
    v_mul_f32 v145, 0x3b000000, v145
    v_fma_f32 v145, -v144, v144, v145
    v_max_f32 v145, 0, v145
    v_add_f32 v145, 0x3727c5ac, v145
    v_rsq_f32 v145, v145
    s_nop 0
    v_mul_f32 v144, v144, v145
    v_pk_fma_f32 v[0:1], v[0:1], v[144:145], v[144:145] op_sel:[0,1,0] op_sel_hi:[1,1,0] neg_lo:[0,0,1] neg_hi:[0,0,1]
    v_pk_fma_f32 v[2:3], v[2:3], v[144:145], v[144:145] op_sel:[0,1,0] op_sel_hi:[1,1,0] neg_lo:[0,0,1] neg_hi:[0,0,1]
    v_pk_fma_f32 v[4:5], v[4:5], v[144:145], v[144:145] op_sel:[0,1,0] op_sel_hi:[1,1,0] neg_lo:[0,0,1] neg_hi:[0,0,1]
    v_pk_fma_f32 v[6:7], v[6:7], v[144:145], v[144:145] op_sel:[0,1,0] op_sel_hi:[1,1,0] neg_lo:[0,0,1] neg_hi:[0,0,1]
    v_cvt_pk_bf16_f32 v80, v0, v1
    v_cvt_pk_bf16_f32 v81, v2, v3
    v_cvt_pk_bf16_f32 v82, v4, v5
    v_cvt_pk_bf16_f32 v83, v6, v7
    ds_write_b128 v149, v[80:83] offset:0
    v_pk_fma_f32 v[8:9], v[8:9], v[144:145], v[144:145] op_sel:[0,1,0] op_sel_hi:[1,1,0] neg_lo:[0,0,1] neg_hi:[0,0,1]
    v_pk_fma_f32 v[10:11], v[10:11], v[144:145], v[144:145] op_sel:[0,1,0] op_sel_hi:[1,1,0] neg_lo:[0,0,1] neg_hi:[0,0,1]
    v_pk_fma_f32 v[12:13], v[12:13], v[144:145], v[144:145] op_sel:[0,1,0] op_sel_hi:[1,1,0] neg_lo:[0,0,1] neg_hi:[0,0,1]
    v_pk_fma_f32 v[14:15], v[14:15], v[144:145], v[144:145] op_sel:[0,1,0] op_sel_hi:[1,1,0] neg_lo:[0,0,1] neg_hi:[0,0,1]
    v_cvt_pk_bf16_f32 v84, v8, v9
    v_cvt_pk_bf16_f32 v85, v10, v11
    v_cvt_pk_bf16_f32 v86, v12, v13
    v_cvt_pk_bf16_f32 v87, v14, v15
    ds_write_b128 v149, v[84:87] offset:1024
    v_pk_fma_f32 v[16:17], v[16:17], v[144:145], v[144:145] op_sel:[0,1,0] op_sel_hi:[1,1,0] neg_lo:[0,0,1] neg_hi:[0,0,1]
    v_pk_fma_f32 v[18:19], v[18:19], v[144:145], v[144:145] op_sel:[0,1,0] op_sel_hi:[1,1,0] neg_lo:[0,0,1] neg_hi:[0,0,1]
    v_pk_fma_f32 v[20:21], v[20:21], v[144:145], v[144:145] op_sel:[0,1,0] op_sel_hi:[1,1,0] neg_lo:[0,0,1] neg_hi:[0,0,1]
    v_pk_fma_f32 v[22:23], v[22:23], v[144:145], v[144:145] op_sel:[0,1,0] op_sel_hi:[1,1,0] neg_lo:[0,0,1] neg_hi:[0,0,1]
    v_cvt_pk_bf16_f32 v88, v16, v17
    v_cvt_pk_bf16_f32 v89, v18, v19
    v_cvt_pk_bf16_f32 v90, v20, v21
    v_cvt_pk_bf16_f32 v91, v22, v23
    ds_write_b128 v149, v[88:91] offset:2048
    v_pk_fma_f32 v[24:25], v[24:25], v[144:145], v[144:145] op_sel:[0,1,0] op_sel_hi:[1,1,0] neg_lo:[0,0,1] neg_hi:[0,0,1]
    v_pk_fma_f32 v[26:27], v[26:27], v[144:145], v[144:145] op_sel:[0,1,0] op_sel_hi:[1,1,0] neg_lo:[0,0,1] neg_hi:[0,0,1]
    v_pk_fma_f32 v[28:29], v[28:29], v[144:145], v[144:145] op_sel:[0,1,0] op_sel_hi:[1,1,0] neg_lo:[0,0,1] neg_hi:[0,0,1]
    v_pk_fma_f32 v[30:31], v[30:31], v[144:145], v[144:145] op_sel:[0,1,0] op_sel_hi:[1,1,0] neg_lo:[0,0,1] neg_hi:[0,0,1]
    v_cvt_pk_bf16_f32 v92, v24, v25
    v_cvt_pk_bf16_f32 v93, v26, v27
    v_cvt_pk_bf16_f32 v94, v28, v29
    v_cvt_pk_bf16_f32 v95, v30, v31
    ds_write_b128 v149, v[92:95] offset:3072
    s_mov_b32 s55, 0
    s_cmp_ge_u32 s33, s53
    s_cbranch_scc1 L_qa_np
    s_waitcnt vmcnt(0)
    v_cmp_gt_u32 vcc, s54, v159
    s_cbranch_vccnz L_qa_np
    s_mov_b32 s55, 1
    global_load_dwordx4 v[64:67], v155, s[40:41] offset:-4096 sc1
    global_load_dword v0, v156, s[38:39] offset:-4096 sc1
    global_load_dword v1, v156, s[38:39] offset:-3840 sc1
    global_load_dword v2, v156, s[38:39] offset:-3584 sc1
    global_load_dword v3, v156, s[38:39] offset:-3328 sc1
    global_load_dword v4, v156, s[38:39] offset:-3072 sc1
    global_load_dword v5, v156, s[38:39] offset:-2816 sc1
    global_load_dword v6, v156, s[38:39] offset:-2560 sc1
    global_load_dword v7, v156, s[38:39] offset:-2304 sc1
    global_load_dwordx4 v[68:71], v155, s[40:41] offset:-2048 sc1
    global_load_dword v8, v156, s[38:39] offset:0 sc1
    global_load_dword v9, v156, s[38:39] offset:256 sc1
    global_load_dword v10, v156, s[38:39] offset:512 sc1
    global_load_dword v11, v156, s[38:39] offset:768 sc1
    global_load_dword v12, v156, s[38:39] offset:1024 sc1
    global_load_dword v13, v156, s[38:39] offset:1280 sc1
    global_load_dword v14, v156, s[38:39] offset:1536 sc1
    global_load_dword v15, v156, s[38:39] offset:1792 sc1
    s_add_u32 s38, s38, 0x2000
    s_addc_u32 s39, s39, 0
    global_load_dwordx4 v[72:75], v155, s[40:41] offset:0 sc1
    global_load_dword v16, v156, s[38:39] offset:-4096 sc1
    global_load_dword v17, v156, s[38:39] offset:-3840 sc1
    global_load_dword v18, v156, s[38:39] offset:-3584 sc1
    global_load_dword v19, v156, s[38:39] offset:-3328 sc1
    global_load_dword v20, v156, s[38:39] offset:-3072 sc1
    global_load_dword v21, v156, s[38:39] offset:-2816 sc1
    global_load_dword v22, v156, s[38:39] offset:-2560 sc1
    global_load_dword v23, v156, s[38:39] offset:-2304 sc1
    global_load_dwordx4 v[76:79], v155, s[40:41] offset:2048 sc1
    global_load_dword v24, v156, s[38:39] offset:0 sc1
    global_load_dword v25, v156, s[38:39] offset:256 sc1
    global_load_dword v26, v156, s[38:39] offset:512 sc1
    global_load_dword v27, v156, s[38:39] offset:768 sc1
    global_load_dword v28, v156, s[38:39] offset:1024 sc1
    global_load_dword v29, v156, s[38:39] offset:1280 sc1
    global_load_dword v30, v156, s[38:39] offset:1536 sc1
    global_load_dword v31, v156, s[38:39] offset:1792 sc1
L_qa_np:
    s_waitcnt lgkmcnt(0)
    s_barrier
    s_cmp_ge_u32 s32, 4
    s_cbranch_scc1 L_qa_gv
    ds_read_b128 v[112:115], v146 offset:0
    ds_read_b128 v[116:119], v146 offset:1024
    ds_read_b128 v[120:123], v146 offset:2048
    ds_read_b128 v[124:127], v146 offset:3072
    ds_read_b128 v[128:131], v146 offset:4096
    ds_read_b128 v[132:135], v146 offset:5120
    ds_read_b128 v[136:139], v146 offset:6144
    ds_read_b128 v[140:143], v146 offset:7168
    s_waitcnt lgkmcnt(7)
    v_mfma_f32_16x16x32_bf16 v[96:99], a[0:3], v[112:115], 0
    v_mfma_f32_16x16x32_bf16 v[100:103], a[4:7], v[112:115], 0
    v_mfma_f32_16x16x32_bf16 v[104:107], a[8:11], v[112:115], 0
    v_mfma_f32_16x16x32_bf16 v[108:111], a[12:15], v[112:115], 0
    ds_read_b128 v[112:115], v146 offset:8192
    s_waitcnt lgkmcnt(7)
    v_mfma_f32_16x16x32_bf16 v[96:99], a[16:19], v[116:119], v[96:99]
    v_mfma_f32_16x16x32_bf16 v[100:103], a[20:23], v[116:119], v[100:103]
    v_mfma_f32_16x16x32_bf16 v[104:107], a[24:27], v[116:119], v[104:107]
    v_mfma_f32_16x16x32_bf16 v[108:111], a[28:31], v[116:119], v[108:111]
    ds_read_b128 v[116:119], v146 offset:9216
    s_waitcnt lgkmcnt(7)
    v_mfma_f32_16x16x32_bf16 v[96:99], a[32:35], v[120:123], v[96:99]
    v_mfma_f32_16x16x32_bf16 v[100:103], a[36:39], v[120:123], v[100:103]
    v_mfma_f32_16x16x32_bf16 v[104:107], a[40:43], v[120:123], v[104:107]
    v_mfma_f32_16x16x32_bf16 v[108:111], a[44:47], v[120:123], v[108:111]
    ds_read_b128 v[120:123], v146 offset:10240
    s_waitcnt lgkmcnt(7)
    v_mfma_f32_16x16x32_bf16 v[96:99], a[48:51], v[124:127], v[96:99]
    v_mfma_f32_16x16x32_bf16 v[100:103], a[52:55], v[124:127], v[100:103]
    v_mfma_f32_16x16x32_bf16 v[104:107], a[56:59], v[124:127], v[104:107]
    v_mfma_f32_16x16x32_bf16 v[108:111], a[60:63], v[124:127], v[108:111]
    ds_read_b128 v[124:127], v146 offset:11264
    s_waitcnt lgkmcnt(7)
    v_mfma_f32_16x16x32_bf16 v[96:99], a[64:67], v[128:131], v[96:99]
    v_mfma_f32_16x16x32_bf16 v[100:103], a[68:71], v[128:131], v[100:103]
    v_mfma_f32_16x16x32_bf16 v[104:107], a[72:75], v[128:131], v[104:107]
    v_mfma_f32_16x16x32_bf16 v[108:111], a[76:79], v[128:131], v[108:111]
    ds_read_b128 v[128:131], v146 offset:12288
    s_waitcnt lgkmcnt(7)
    v_mfma_f32_16x16x32_bf16 v[96:99], a[80:83], v[132:135], v[96:99]
    v_mfma_f32_16x16x32_bf16 v[100:103], a[84:87], v[132:135], v[100:103]
    v_mfma_f32_16x16x32_bf16 v[104:107], a[88:91], v[132:135], v[104:107]
    v_mfma_f32_16x16x32_bf16 v[108:111], a[92:95], v[132:135], v[108:111]
    ds_read_b128 v[132:135], v146 offset:13312
    s_waitcnt lgkmcnt(7)
    v_mfma_f32_16x16x32_bf16 v[96:99], a[96:99], v[136:139], v[96:99]
    v_mfma_f32_16x16x32_bf16 v[100:103], a[100:103], v[136:139], v[100:103]
    v_mfma_f32_16x16x32_bf16 v[104:107], a[104:107], v[136:139], v[104:107]
    v_mfma_f32_16x16x32_bf16 v[108:111], a[108:111], v[136:139], v[108:111]
    ds_read_b128 v[136:139], v146 offset:14336
    s_waitcnt lgkmcnt(7)
    v_mfma_f32_16x16x32_bf16 v[96:99], a[112:115], v[140:143], v[96:99]
    v_mfma_f32_16x16x32_bf16 v[100:103], a[116:119], v[140:143], v[100:103]
    v_mfma_f32_16x16x32_bf16 v[104:107], a[120:123], v[140:143], v[104:107]
    v_mfma_f32_16x16x32_bf16 v[108:111], a[124:127], v[140:143], v[108:111]
    ds_read_b128 v[140:143], v146 offset:15360
    s_waitcnt lgkmcnt(7)
    v_mfma_f32_16x16x32_bf16 v[96:99], a[128:131], v[112:115], v[96:99]
    v_mfma_f32_16x16x32_bf16 v[100:103], a[132:135], v[112:115], v[100:103]
    v_mfma_f32_16x16x32_bf16 v[104:107], a[136:139], v[112:115], v[104:107]
    v_mfma_f32_16x16x32_bf16 v[108:111], a[140:143], v[112:115], v[108:111]
    s_waitcnt lgkmcnt(6)
    v_mfma_f32_16x16x32_bf16 v[96:99], a[144:147], v[116:119], v[96:99]
    v_mfma_f32_16x16x32_bf16 v[100:103], a[148:151], v[116:119], v[100:103]
    v_mfma_f32_16x16x32_bf16 v[104:107], a[152:155], v[116:119], v[104:107]
    v_mfma_f32_16x16x32_bf16 v[108:111], a[156:159], v[116:119], v[108:111]
    s_waitcnt lgkmcnt(5)
    v_mfma_f32_16x16x32_bf16 v[96:99], a[160:163], v[120:123], v[96:99]
    v_mfma_f32_16x16x32_bf16 v[100:103], a[164:167], v[120:123], v[100:103]
    v_mfma_f32_16x16x32_bf16 v[104:107], a[168:171], v[120:123], v[104:107]
    v_mfma_f32_16x16x32_bf16 v[108:111], a[172:175], v[120:123], v[108:111]
    s_waitcnt lgkmcnt(4)
    v_mfma_f32_16x16x32_bf16 v[96:99], a[176:179], v[124:127], v[96:99]
    v_mfma_f32_16x16x32_bf16 v[100:103], a[180:183], v[124:127], v[100:103]
    v_mfma_f32_16x16x32_bf16 v[104:107], a[184:187], v[124:127], v[104:107]
    v_mfma_f32_16x16x32_bf16 v[108:111], a[188:191], v[124:127], v[108:111]
    s_waitcnt lgkmcnt(3)
    v_mfma_f32_16x16x32_bf16 v[96:99], a[192:195], v[128:131], v[96:99]
    v_mfma_f32_16x16x32_bf16 v[100:103], a[196:199], v[128:131], v[100:103]
    v_mfma_f32_16x16x32_bf16 v[104:107], a[200:203], v[128:131], v[104:107]
    v_mfma_f32_16x16x32_bf16 v[108:111], a[204:207], v[128:131], v[108:111]
    s_waitcnt lgkmcnt(2)
    v_mfma_f32_16x16x32_bf16 v[96:99], a[208:211], v[132:135], v[96:99]
    v_mfma_f32_16x16x32_bf16 v[100:103], a[212:215], v[132:135], v[100:103]
    v_mfma_f32_16x16x32_bf16 v[104:107], a[216:219], v[132:135], v[104:107]
    v_mfma_f32_16x16x32_bf16 v[108:111], a[220:223], v[132:135], v[108:111]
    s_waitcnt lgkmcnt(1)
    v_mfma_f32_16x16x32_bf16 v[96:99], a[224:227], v[136:139], v[96:99]
    v_mfma_f32_16x16x32_bf16 v[100:103], a[228:231], v[136:139], v[100:103]
    v_mfma_f32_16x16x32_bf16 v[104:107], a[232:235], v[136:139], v[104:107]
    v_mfma_f32_16x16x32_bf16 v[108:111], a[236:239], v[136:139], v[108:111]
    s_waitcnt lgkmcnt(0)
    v_mfma_f32_16x16x32_bf16 v[96:99], a[240:243], v[140:143], v[96:99]
    v_mfma_f32_16x16x32_bf16 v[100:103], a[244:247], v[140:143], v[100:103]
    v_mfma_f32_16x16x32_bf16 v[104:107], a[248:251], v[140:143], v[104:107]
    v_mfma_f32_16x16x32_bf16 v[108:111], a[252:255], v[140:143], v[108:111]
    s_nop 4
    v_pk_mul_f32 v[96:97], v[96:97], s[50:51]
    v_pk_mul_f32 v[98:99], v[98:99], s[50:51]
    v_pk_mul_f32 v[100:101], v[100:101], s[50:51]
    v_pk_mul_f32 v[102:103], v[102:103], s[50:51]
    v_pk_mul_f32 v[104:105], v[104:105], s[50:51]
    v_pk_mul_f32 v[106:107], v[106:107], s[50:51]
    v_pk_mul_f32 v[108:109], v[108:109], s[50:51]
    v_pk_mul_f32 v[110:111], v[110:111], s[50:51]
    v_cvt_pk_bf16_f32 v112, v96, v97
    v_cvt_pk_bf16_f32 v113, v98, v99
    v_cvt_pk_bf16_f32 v114, v100, v101
    v_cvt_pk_bf16_f32 v115, v102, v103
    v_cvt_pk_bf16_f32 v116, v104, v105
    v_cvt_pk_bf16_f32 v117, v106, v107
    v_cvt_pk_bf16_f32 v118, v108, v109
    v_cvt_pk_bf16_f32 v119, v110, v111
    s_branch L_qa_epi
L_qa_gv:
    ds_read_b128 v[112:115], v146 offset:0
    ds_read_b128 v[116:119], v146 offset:1024
    ds_read_b128 v[120:123], v146 offset:2048
    ds_read_b128 v[124:127], v146 offset:3072
    ds_read_b128 v[128:131], v146 offset:4096
    ds_read_b128 v[132:135], v146 offset:5120
    ds_read_b128 v[136:139], v146 offset:6144
    ds_read_b128 v[140:143], v146 offset:7168
    s_waitcnt lgkmcnt(7)
    v_mfma_f32_16x16x32_bf16 v[96:99], v[112:115], a[0:3], 0
    v_mfma_f32_16x16x32_bf16 v[100:103], v[112:115], a[4:7], 0
    v_mfma_f32_16x16x32_bf16 v[104:107], v[112:115], a[8:11], 0
    v_mfma_f32_16x16x32_bf16 v[108:111], v[112:115], a[12:15], 0
    ds_read_b128 v[112:115], v146 offset:8192
    s_waitcnt lgkmcnt(7)
    v_mfma_f32_16x16x32_bf16 v[96:99], v[116:119], a[16:19], v[96:99]
    v_mfma_f32_16x16x32_bf16 v[100:103], v[116:119], a[20:23], v[100:103]
    v_mfma_f32_16x16x32_bf16 v[104:107], v[116:119], a[24:27], v[104:107]
    v_mfma_f32_16x16x32_bf16 v[108:111], v[116:119], a[28:31], v[108:111]
    ds_read_b128 v[116:119], v146 offset:9216
    s_waitcnt lgkmcnt(7)
    v_mfma_f32_16x16x32_bf16 v[96:99], v[120:123], a[32:35], v[96:99]
    v_mfma_f32_16x16x32_bf16 v[100:103], v[120:123], a[36:39], v[100:103]
    v_mfma_f32_16x16x32_bf16 v[104:107], v[120:123], a[40:43], v[104:107]
    v_mfma_f32_16x16x32_bf16 v[108:111], v[120:123], a[44:47], v[108:111]
    ds_read_b128 v[120:123], v146 offset:10240
    s_waitcnt lgkmcnt(7)
    v_mfma_f32_16x16x32_bf16 v[96:99], v[124:127], a[48:51], v[96:99]
    v_mfma_f32_16x16x32_bf16 v[100:103], v[124:127], a[52:55], v[100:103]
    v_mfma_f32_16x16x32_bf16 v[104:107], v[124:127], a[56:59], v[104:107]
    v_mfma_f32_16x16x32_bf16 v[108:111], v[124:127], a[60:63], v[108:111]
    ds_read_b128 v[124:127], v146 offset:11264
    s_waitcnt lgkmcnt(7)
    v_mfma_f32_16x16x32_bf16 v[96:99], v[128:131], a[64:67], v[96:99]
    v_mfma_f32_16x16x32_bf16 v[100:103], v[128:131], a[68:71], v[100:103]
    v_mfma_f32_16x16x32_bf16 v[104:107], v[128:131], a[72:75], v[104:107]
    v_mfma_f32_16x16x32_bf16 v[108:111], v[128:131], a[76:79], v[108:111]
    ds_read_b128 v[128:131], v146 offset:12288
    s_waitcnt lgkmcnt(7)
    v_mfma_f32_16x16x32_bf16 v[96:99], v[132:135], a[80:83], v[96:99]
    v_mfma_f32_16x16x32_bf16 v[100:103], v[132:135], a[84:87], v[100:103]
    v_mfma_f32_16x16x32_bf16 v[104:107], v[132:135], a[88:91], v[104:107]
    v_mfma_f32_16x16x32_bf16 v[108:111], v[132:135], a[92:95], v[108:111]
    ds_read_b128 v[132:135], v146 offset:13312
    s_waitcnt lgkmcnt(7)
    v_mfma_f32_16x16x32_bf16 v[96:99], v[136:139], a[96:99], v[96:99]
    v_mfma_f32_16x16x32_bf16 v[100:103], v[136:139], a[100:103], v[100:103]
    v_mfma_f32_16x16x32_bf16 v[104:107], v[136:139], a[104:107], v[104:107]
    v_mfma_f32_16x16x32_bf16 v[108:111], v[136:139], a[108:111], v[108:111]
    ds_read_b128 v[136:139], v146 offset:14336
    s_waitcnt lgkmcnt(7)
    v_mfma_f32_16x16x32_bf16 v[96:99], v[140:143], a[112:115], v[96:99]
    v_mfma_f32_16x16x32_bf16 v[100:103], v[140:143], a[116:119], v[100:103]
    v_mfma_f32_16x16x32_bf16 v[104:107], v[140:143], a[120:123], v[104:107]
    v_mfma_f32_16x16x32_bf16 v[108:111], v[140:143], a[124:127], v[108:111]
    ds_read_b128 v[140:143], v146 offset:15360
    s_waitcnt lgkmcnt(7)
    v_mfma_f32_16x16x32_bf16 v[96:99], v[112:115], a[128:131], v[96:99]
    v_mfma_f32_16x16x32_bf16 v[100:103], v[112:115], a[132:135], v[100:103]
    v_mfma_f32_16x16x32_bf16 v[104:107], v[112:115], a[136:139], v[104:107]
    v_mfma_f32_16x16x32_bf16 v[108:111], v[112:115], a[140:143], v[108:111]
    s_waitcnt lgkmcnt(6)
    v_mfma_f32_16x16x32_bf16 v[96:99], v[116:119], a[144:147], v[96:99]
    v_mfma_f32_16x16x32_bf16 v[100:103], v[116:119], a[148:151], v[100:103]
    v_mfma_f32_16x16x32_bf16 v[104:107], v[116:119], a[152:155], v[104:107]
    v_mfma_f32_16x16x32_bf16 v[108:111], v[116:119], a[156:159], v[108:111]
    s_waitcnt lgkmcnt(5)
    v_mfma_f32_16x16x32_bf16 v[96:99], v[120:123], a[160:163], v[96:99]
    v_mfma_f32_16x16x32_bf16 v[100:103], v[120:123], a[164:167], v[100:103]
    v_mfma_f32_16x16x32_bf16 v[104:107], v[120:123], a[168:171], v[104:107]
    v_mfma_f32_16x16x32_bf16 v[108:111], v[120:123], a[172:175], v[108:111]
    s_waitcnt lgkmcnt(4)
    v_mfma_f32_16x16x32_bf16 v[96:99], v[124:127], a[176:179], v[96:99]
    v_mfma_f32_16x16x32_bf16 v[100:103], v[124:127], a[180:183], v[100:103]
    v_mfma_f32_16x16x32_bf16 v[104:107], v[124:127], a[184:187], v[104:107]
    v_mfma_f32_16x16x32_bf16 v[108:111], v[124:127], a[188:191], v[108:111]
    s_waitcnt lgkmcnt(3)
    v_mfma_f32_16x16x32_bf16 v[96:99], v[128:131], a[192:195], v[96:99]
    v_mfma_f32_16x16x32_bf16 v[100:103], v[128:131], a[196:199], v[100:103]
    v_mfma_f32_16x16x32_bf16 v[104:107], v[128:131], a[200:203], v[104:107]
    v_mfma_f32_16x16x32_bf16 v[108:111], v[128:131], a[204:207], v[108:111]
    s_waitcnt lgkmcnt(2)
    v_mfma_f32_16x16x32_bf16 v[96:99], v[132:135], a[208:211], v[96:99]
    v_mfma_f32_16x16x32_bf16 v[100:103], v[132:135], a[212:215], v[100:103]
    v_mfma_f32_16x16x32_bf16 v[104:107], v[132:135], a[216:219], v[104:107]
    v_mfma_f32_16x16x32_bf16 v[108:111], v[132:135], a[220:223], v[108:111]
    s_waitcnt lgkmcnt(1)
    v_mfma_f32_16x16x32_bf16 v[96:99], v[136:139], a[224:227], v[96:99]
    v_mfma_f32_16x16x32_bf16 v[100:103], v[136:139], a[228:231], v[100:103]
    v_mfma_f32_16x16x32_bf16 v[104:107], v[136:139], a[232:235], v[104:107]
    v_mfma_f32_16x16x32_bf16 v[108:111], v[136:139], a[236:239], v[108:111]
    s_waitcnt lgkmcnt(0)
    v_mfma_f32_16x16x32_bf16 v[96:99], v[140:143], a[240:243], v[96:99]
    v_mfma_f32_16x16x32_bf16 v[100:103], v[140:143], a[244:247], v[100:103]
    v_mfma_f32_16x16x32_bf16 v[104:107], v[140:143], a[248:251], v[104:107]
    v_mfma_f32_16x16x32_bf16 v[108:111], v[140:143], a[252:255], v[108:111]
    s_nop 4
    v_cvt_pk_bf16_f32 v112, v96, v97
    v_cvt_pk_bf16_f32 v113, v98, v99
    v_cvt_pk_bf16_f32 v114, v100, v101
    v_cvt_pk_bf16_f32 v115, v102, v103
    v_cvt_pk_bf16_f32 v116, v104, v105
    v_cvt_pk_bf16_f32 v117, v106, v107
    v_cvt_pk_bf16_f32 v118, v108, v109
    v_cvt_pk_bf16_f32 v119, v110, v111
    v_permlane32_swap_b32 v112, v114
    v_permlane32_swap_b32 v113, v115
    v_permlane32_swap_b32 v116, v118
    v_permlane32_swap_b32 v117, v119
L_qa_epi:
    v_min_u32 v112, -2, v112
    v_min_u32 v113, -2, v113
    v_min_u32 v114, -2, v114
    v_min_u32 v115, -2, v115
    v_min_u32 v116, -2, v116
    v_min_u32 v117, -2, v117
    v_min_u32 v118, -2, v118
    v_min_u32 v119, -2, v119
    global_store_dwordx4 v157, v[112:115], s[42:43] offset:0 sc1
    global_store_dwordx4 v157, v[116:119], s[42:43] offset:2048 sc1
    s_waitcnt vmcnt(0)
    s_mov_b64 exec, 3
    global_store_byte v158, v153, s[46:47] sc1
    s_mov_b64 exec, -1
    s_cmp_lg_u32 s55, 0
    s_cbranch_scc1 L_qa_loop2
    s_cmp_lt_u32 s33, s53
    s_cbranch_scc1 L_qa_loop
    s_cmp_eq_u32 s53, 64
    s_cbranch_scc1 L_qa_done
    s_cmp_ge_u32 s33, 32
    s_cbranch_scc1 L_attn_back
    s_mov_b32 s52, 2
    s_mov_b32 s53, 38
    s_branch L_qa_loop
L_qa_done:
    s_lshr_b32 s33, s30, 3
    s_and_b32 s36, s30, 7
    s_lshl_b32 s36, s36, 2
    s_add_u32 s36, s36, s31
L_qa_fin:
    s_lshl_b32 s82, s33, 15
    s_lshl_b32 s83, s36, 10
    s_add_u32 s83, s83, s82
    s_add_u32 s84, s83, 0x5d00000
    s_add_u32 s40, s28, s84
    s_addc_u32 s41, s29, 0
    s_lshl_b32 s83, s83, 1
    s_add_u32 s83, s83, 0x6100000
    s_add_u32 s38, s28, s83
    s_addc_u32 s39, s29, 0
    s_lshl_b32 s83, s36, 5
    s_add_u32 s83, s83, s82
    s_add_u32 s42, s24, s83
    s_addc_u32 s43, s25, 0
    s_and_b32 s84, s33, 3
    s_lshl_b32 s84, s84, 11
    s_add_u32 s84, s84, 0x0
    s_add_u32 s48, s28, s84
    s_addc_u32 s49, s29, 0
    s_lshr_b32 s84, s33, 2
    s_add_u32 s84, s84, 17
    s_cmp_eq_u32 s33, 63
    s_cselect_b32 s85, -1, 0x7ff
    v_and_b32 v154, s85, v200
    s_cmp_lg_u32 s31, 0
    s_cbranch_scc1 L_qa_wf_ok
L_qa_wf:
    global_load_dword v144, v154, s[48:49] sc1
    s_waitcnt vmcnt(0)
    v_cmp_gt_u32 vcc, s84, v144
    s_cbranch_vccz L_qa_wf_ok
    s_sub_u32 s62, s62, 1
    s_cbranch_scc0 L_qa_wf
    s_movk_i32 s63, 19
    s_branch L_fail_far
L_qa_wf_ok:
    s_barrier
    global_load_dwordx4 v[64:67], v146, s[40:41] sc1
    global_load_dword v0, v147, s[38:39] offset:0 sc1
    global_load_dword v1, v147, s[38:39] offset:256 sc1
    global_load_dword v2, v147, s[38:39] offset:512 sc1
    global_load_dword v3, v147, s[38:39] offset:768 sc1
    global_load_dword v4, v147, s[38:39] offset:1024 sc1
    global_load_dword v5, v147, s[38:39] offset:1280 sc1
    global_load_dword v6, v147, s[38:39] offset:1536 sc1
    global_load_dword v7, v147, s[38:39] offset:1792 sc1
    s_waitcnt vmcnt(0)
    v_dot2_f32_bf16 v0, v64, s90, v0
    v_dot2_f32_bf16 v1, v64, s91, v1
    v_dot2_f32_bf16 v2, v65, s90, v2
    v_dot2_f32_bf16 v3, v65, s91, v3
    v_dot2_f32_bf16 v4, v66, s90, v4
    v_dot2_f32_bf16 v5, v66, s91, v5
    v_dot2_f32_bf16 v6, v67, s90, v6
    v_dot2_f32_bf16 v7, v67, s91, v7
    v_cvt_pk_bf16_f32 v64, v0, v1
    v_cvt_pk_bf16_f32 v65, v2, v3
    v_cvt_pk_bf16_f32 v66, v4, v5
    v_cvt_pk_bf16_f32 v67, v6, v7
    global_store_dwordx4 v148, v[64:67], s[42:43] sc1
    s_add_u32 s33, s33, 3
    s_cmp_lt_u32 s33, 64
    s_cbranch_scc1 L_qa_fin
    s_endpgm
L_attn_back:
    s_mov_b32 s60, 1
L_attn:
    v_mov_b32 v148, 0x3f803f80
    v_accvgpr_write_b32 a128, v148
    v_accvgpr_write_b32 a129, v148
    v_accvgpr_write_b32 a130, v148
    v_accvgpr_write_b32 a131, v148
    v_accvgpr_write_b32 a132, v148
    v_accvgpr_write_b32 a133, v148
    v_accvgpr_write_b32 a134, v148
    v_accvgpr_write_b32 a135, v148
    v_accvgpr_write_b32 a136, v148
    v_accvgpr_write_b32 a137, v148
    v_accvgpr_write_b32 a138, v148
    v_accvgpr_write_b32 a139, v148
    v_accvgpr_write_b32 a140, v148
    v_accvgpr_write_b32 a141, v148
    v_accvgpr_write_b32 a142, v148
    v_accvgpr_write_b32 a143, v148
    v_accvgpr_write_b32 a144, v148
    v_accvgpr_write_b32 a145, v148
    v_accvgpr_write_b32 a146, v148
    v_accvgpr_write_b32 a147, v148
    v_accvgpr_write_b32 a148, v148
    v_accvgpr_write_b32 a149, v148
    v_accvgpr_write_b32 a150, v148
    v_accvgpr_write_b32 a151, v148
    v_accvgpr_write_b32 a152, v148
    v_accvgpr_write_b32 a153, v148
    v_accvgpr_write_b32 a154, v148
    v_accvgpr_write_b32 a155, v148
    v_accvgpr_write_b32 a156, v148
    v_accvgpr_write_b32 a157, v148
    v_accvgpr_write_b32 a158, v148
    v_accvgpr_write_b32 a159, v148
    v_accvgpr_write_b32 a160, v148
    v_accvgpr_write_b32 a161, v148
    v_accvgpr_write_b32 a162, v148
    v_accvgpr_write_b32 a163, v148
    v_accvgpr_write_b32 a164, v148
    v_accvgpr_write_b32 a165, v148
    v_accvgpr_write_b32 a166, v148
    v_accvgpr_write_b32 a167, v148
    v_accvgpr_write_b32 a168, v148
    v_accvgpr_write_b32 a169, v148
    v_accvgpr_write_b32 a170, v148
    v_accvgpr_write_b32 a171, v148
    v_accvgpr_write_b32 a172, v148
    v_accvgpr_write_b32 a173, v148
    v_accvgpr_write_b32 a174, v148
    v_accvgpr_write_b32 a175, v148
    v_accvgpr_write_b32 a176, v148
    v_accvgpr_write_b32 a177, v148
    v_accvgpr_write_b32 a178, v148
    v_accvgpr_write_b32 a179, v148
    v_accvgpr_write_b32 a180, v148
    v_accvgpr_write_b32 a181, v148
    v_accvgpr_write_b32 a182, v148
    v_accvgpr_write_b32 a183, v148
    v_accvgpr_write_b32 a184, v148
    v_accvgpr_write_b32 a185, v148
    v_accvgpr_write_b32 a186, v148
    v_accvgpr_write_b32 a187, v148
    v_accvgpr_write_b32 a188, v148
    v_accvgpr_write_b32 a189, v148
    v_accvgpr_write_b32 a190, v148
    v_accvgpr_write_b32 a191, v148
    v_accvgpr_write_b32 a192, v148
    v_accvgpr_write_b32 a193, v148
    v_accvgpr_write_b32 a194, v148
    v_accvgpr_write_b32 a195, v148
    v_accvgpr_write_b32 a196, v148
    v_accvgpr_write_b32 a197, v148
    v_accvgpr_write_b32 a198, v148
    v_accvgpr_write_b32 a199, v148
    v_accvgpr_write_b32 a200, v148
    v_accvgpr_write_b32 a201, v148
    v_accvgpr_write_b32 a202, v148
    v_accvgpr_write_b32 a203, v148
    v_accvgpr_write_b32 a204, v148
    v_accvgpr_write_b32 a205, v148
    v_accvgpr_write_b32 a206, v148
    v_accvgpr_write_b32 a207, v148
    v_accvgpr_write_b32 a208, v148
    v_accvgpr_write_b32 a209, v148
    v_accvgpr_write_b32 a210, v148
    v_accvgpr_write_b32 a211, v148
    v_accvgpr_write_b32 a212, v148
    v_accvgpr_write_b32 a213, v148
    v_accvgpr_write_b32 a214, v148
    v_accvgpr_write_b32 a215, v148
    v_accvgpr_write_b32 a216, v148
    v_accvgpr_write_b32 a217, v148
    v_accvgpr_write_b32 a218, v148
    v_accvgpr_write_b32 a219, v148
    v_accvgpr_write_b32 a220, v148
    v_accvgpr_write_b32 a221, v148
    v_accvgpr_write_b32 a222, v148
    v_accvgpr_write_b32 a223, v148
    v_accvgpr_write_b32 a224, v148
    v_accvgpr_write_b32 a225, v148
    v_accvgpr_write_b32 a226, v148
    v_accvgpr_write_b32 a227, v148
    v_accvgpr_write_b32 a228, v148
    v_accvgpr_write_b32 a229, v148
    v_accvgpr_write_b32 a230, v148
    v_accvgpr_write_b32 a231, v148
    v_accvgpr_write_b32 a232, v148
    v_accvgpr_write_b32 a233, v148
    v_accvgpr_write_b32 a234, v148
    v_accvgpr_write_b32 a235, v148
    v_accvgpr_write_b32 a236, v148
    v_accvgpr_write_b32 a237, v148
    v_accvgpr_write_b32 a238, v148
    v_accvgpr_write_b32 a239, v148
    v_accvgpr_write_b32 a240, v148
    v_accvgpr_write_b32 a241, v148
    v_accvgpr_write_b32 a242, v148
    v_accvgpr_write_b32 a243, v148
    v_accvgpr_write_b32 a244, v148
    v_accvgpr_write_b32 a245, v148
    v_accvgpr_write_b32 a246, v148
    v_accvgpr_write_b32 a247, v148
    v_accvgpr_write_b32 a248, v148
    v_accvgpr_write_b32 a249, v148
    v_accvgpr_write_b32 a250, v148
    v_accvgpr_write_b32 a251, v148
    v_accvgpr_write_b32 a252, v148
    v_accvgpr_write_b32 a253, v148
    v_accvgpr_write_b32 a254, v148
    v_accvgpr_write_b32 a255, v148
    s_barrier
    s_lshl_b32 s32, s37, 4
    s_lshr_b32 s80, s30, 1
    s_add_u32 s32, s32, s80
    s_and_b32 s36, s30, 1
    v_mov_b32 v150, 0x0
    v_bfe_u32 v170, v255, 0, 6
    v_lshl_add_u32 v150, v170, 4, v150
    v_mov_b32 v151, 0x0
    v_bfe_u32 v170, v255, 0, 6
    v_lshl_add_u32 v151, v170, 2, v151
    v_mov_b32 v152, 0x0
    v_bfe_u32 v170, v255, 0, 4
    v_lshl_add_u32 v152, v170, 4, v152
    v_bfe_u32 v170, v255, 5, 1
    v_lshl_add_u32 v152, v170, 9, v152
    v_mov_b32 v153, 0x0
    v_bfe_u32 v170, v255, 0, 6
    v_lshl_add_u32 v153, v170, 4, v153
    v_bfe_u32 v170, v255, 6, 2
    v_mul_u32_u24 v170, 0xc00, v170
    v_add_u32 v153, v153, v170
    v_mov_b32 v155, 0
    v_mov_b32 v156, 1
    s_mov_b32 s54, 0x0000ffff
    s_mov_b32 s55, 0x0000ffff
    s_mov_b32 s34, s60
    s_lshl_b32 s35, s60, 5
    s_lshl_b32 s83, s36, 12
    s_lshl_b32 s84, s32, 7
    s_add_u32 s83, s83, s84
    s_add_u32 s83, s83, 0x8000
    s_add_u32 s52, s28, s83
    s_addc_u32 s53, s29, 0
L_at_layer:
    s_mul_i32 s80, s34, 0x5200000
    s_lshl_b32 s81, s32, 10
    s_add_u32 s81, s81, s80
    s_lshl_b32 s82, s31, 15
    s_add_u32 s83, s81, s82
    s_add_u32 s83, s83, 0x500000
    s_add_u32 s38, s28, s83
    s_addc_u32 s39, s29, 0
    s_lshl_b32 s83, s36, 15
    s_add_u32 s83, s83, s81
    s_add_u32 s84, s83, 0x300000
    s_add_u32 s42, s28, s84
    s_addc_u32 s43, s29, 0
    s_add_u32 s84, s83, 0x900000
    s_add_u32 s44, s28, s84
    s_addc_u32 s45, s29, 0
    s_lshr_b32 s83, s32, 1
    s_lshl_b32 s84, s83, 11
    s_add_u32 s84, s84, s80
    s_add_u32 s84, s84, s82
    s_and_b32 s85, s32, 1
    s_lshl_b32 s85, s85, 8
    s_add_u32 s84, s84, s85
    s_add_u32 s84, s84, 0x700000
    s_add_u32 s40, s28, s84
    s_addc_u32 s41, s29, 0
    s_lshl_b32 s80, s34, 17
    s_lshl_b32 s83, s83, 8
    s_add_u32 s83, s83, s80
    s_add_u32 s83, s83, 0x5000
    s_add_u32 s46, s28, s83
    s_addc_u32 s47, s29, 0
    s_mov_b64 s[50:51], 0
    s_mov_b64 s[48:49], 0
    v_add_u32 v160, 4096, v151
    s_add_u32 s82, s36, 0
    s_min_u32 s82, s82, 63
L_at_kw_45:
    s_bitcmp1_b64 s[48:49], s82
    s_cbranch_scc1 L_at_kw_45_ok
    s_getpc_b64 s[58:59]
    s_branch L_at_poll
    s_branch L_at_kw_45
L_at_kw_45_ok:
    global_load_dwordx4 v[96:99], v150, s[42:43] sc1
    s_add_u32 s82, s36, 2
    s_min_u32 s82, s82, 63
L_at_kw_46:
    s_bitcmp1_b64 s[48:49], s82
    s_cbranch_scc1 L_at_kw_46_ok
    s_getpc_b64 s[58:59]
    s_branch L_at_poll
    s_branch L_at_kw_46
L_at_kw_46_ok:
    s_add_u32 s42, s42, 0x10000
    s_addc_u32 s43, s43, 0
    global_load_dwordx4 v[100:103], v150, s[42:43] sc1
    s_mov_b32 s33, s36
    s_mov_b32 s56, 0
    v_mov_b64 v[80:81], 0
    v_mov_b64 v[82:83], 0
    v_mov_b64 v[84:85], 0
    v_mov_b64 v[86:87], 0
    v_mov_b64 v[88:89], 0
    v_mov_b64 v[90:91], 0
    v_mov_b64 v[92:93], 0
    v_mov_b64 v[94:95], 0
    v_mov_b64 v[120:121], 0
    v_mov_b64 v[122:123], 0
    v_mov_b64 v[124:125], 0
    v_mov_b64 v[126:127], 0
    v_mov_b64 v[128:129], 0
    v_mov_b32 v48, 0x7f000000
    v_mov_b32 v129, 0x7f000000
    s_add_u32 s82, s31, 0
L_at_kw_47:
    s_bitcmp1_b64 s[50:51], s82
    s_cbranch_scc1 L_at_kw_47_ok
    s_getpc_b64 s[58:59]
    s_branch L_at_poll
    s_branch L_at_kw_47
L_at_kw_47_ok:
    global_load_dwordx4 a[0:3], v150, s[38:39] sc1
    s_add_u32 s38, s38, 0x20000
    s_addc_u32 s39, s39, 0
    s_mov_b64 exec, s[54:55]
    global_load_dwordx4 a[128:131], v152, s[40:41] offset:0 sc1
    global_load_dwordx4 a[132:135], v152, s[40:41] offset:1024 sc1
    s_add_u32 s40, s40, 0x20000
    s_addc_u32 s41, s41, 0
    s_mov_b64 exec, -1
    s_add_u32 s82, s31, 4
L_at_kw_48:
    s_bitcmp1_b64 s[50:51], s82
    s_cbranch_scc1 L_at_kw_48_ok
    s_getpc_b64 s[58:59]
    s_branch L_at_poll
    s_branch L_at_kw_48
L_at_kw_48_ok:
    global_load_dwordx4 a[4:7], v150, s[38:39] sc1
    s_add_u32 s38, s38, 0x20000
    s_addc_u32 s39, s39, 0
    s_mov_b64 exec, s[54:55]
    global_load_dwordx4 a[136:139], v152, s[40:41] offset:0 sc1
    global_load_dwordx4 a[140:143], v152, s[40:41] offset:1024 sc1
    s_add_u32 s40, s40, 0x20000
    s_addc_u32 s41, s41, 0
    s_mov_b64 exec, -1
    s_add_u32 s82, s31, 8
L_at_kw_49:
    s_bitcmp1_b64 s[50:51], s82
    s_cbranch_scc1 L_at_kw_49_ok
    s_getpc_b64 s[58:59]
    s_branch L_at_poll
    s_branch L_at_kw_49
L_at_kw_49_ok:
    global_load_dwordx4 a[8:11], v150, s[38:39] sc1
    s_add_u32 s38, s38, 0x20000
    s_addc_u32 s39, s39, 0
    s_mov_b64 exec, s[54:55]
    global_load_dwordx4 a[144:147], v152, s[40:41] offset:0 sc1
    global_load_dwordx4 a[148:151], v152, s[40:41] offset:1024 sc1
    s_add_u32 s40, s40, 0x20000
    s_addc_u32 s41, s41, 0
    s_mov_b64 exec, -1
    s_add_u32 s82, s31, 12
L_at_kw_50:
    s_bitcmp1_b64 s[50:51], s82
    s_cbranch_scc1 L_at_kw_50_ok
    s_getpc_b64 s[58:59]
    s_branch L_at_poll
    s_branch L_at_kw_50
L_at_kw_50_ok:
    global_load_dwordx4 a[12:15], v150, s[38:39] sc1
    s_add_u32 s38, s38, 0x20000
    s_addc_u32 s39, s39, 0
    s_mov_b64 exec, s[54:55]
    global_load_dwordx4 a[152:155], v152, s[40:41] offset:0 sc1
    global_load_dwordx4 a[156:159], v152, s[40:41] offset:1024 sc1
    s_add_u32 s40, s40, 0x20000
    s_addc_u32 s41, s41, 0
    s_mov_b64 exec, -1
    s_add_u32 s82, s31, 16
L_at_kw_51:
    s_bitcmp1_b64 s[50:51], s82
    s_cbranch_scc1 L_at_kw_51_ok
    s_getpc_b64 s[58:59]
    s_branch L_at_poll
    s_branch L_at_kw_51
L_at_kw_51_ok:
    global_load_dwordx4 a[16:19], v150, s[38:39] sc1
    s_add_u32 s38, s38, 0x20000
    s_addc_u32 s39, s39, 0
    s_mov_b64 exec, s[54:55]
    global_load_dwordx4 a[160:163], v152, s[40:41] offset:0 sc1
    global_load_dwordx4 a[164:167], v152, s[40:41] offset:1024 sc1
    s_add_u32 s40, s40, 0x20000
    s_addc_u32 s41, s41, 0
    s_mov_b64 exec, -1
    s_add_u32 s82, s31, 20
L_at_kw_52:
    s_bitcmp1_b64 s[50:51], s82
    s_cbranch_scc1 L_at_kw_52_ok
    s_getpc_b64 s[58:59]
    s_branch L_at_poll
    s_branch L_at_kw_52
L_at_kw_52_ok:
    global_load_dwordx4 a[20:23], v150, s[38:39] sc1
    s_add_u32 s38, s38, 0x20000
    s_addc_u32 s39, s39, 0
    s_mov_b64 exec, s[54:55]
    global_load_dwordx4 a[168:171], v152, s[40:41] offset:0 sc1
    global_load_dwordx4 a[172:175], v152, s[40:41] offset:1024 sc1
    s_add_u32 s40, s40, 0x20000
    s_addc_u32 s41, s41, 0
    s_mov_b64 exec, -1
    s_add_u32 s82, s31, 24
L_at_kw_53:
    s_bitcmp1_b64 s[50:51], s82
    s_cbranch_scc1 L_at_kw_53_ok
    s_getpc_b64 s[58:59]
    s_branch L_at_poll
    s_branch L_at_kw_53
L_at_kw_53_ok:
    global_load_dwordx4 a[24:27], v150, s[38:39] sc1
    s_add_u32 s38, s38, 0x20000
    s_addc_u32 s39, s39, 0
    s_mov_b64 exec, s[54:55]
    global_load_dwordx4 a[176:179], v152, s[40:41] offset:0 sc1
    global_load_dwordx4 a[180:183], v152, s[40:41] offset:1024 sc1
    s_add_u32 s40, s40, 0x20000
    s_addc_u32 s41, s41, 0
    s_mov_b64 exec, -1
    s_add_u32 s82, s31, 28
L_at_kw_54:
    s_bitcmp1_b64 s[50:51], s82
    s_cbranch_scc1 L_at_kw_54_ok
    s_getpc_b64 s[58:59]
    s_branch L_at_poll
    s_branch L_at_kw_54
L_at_kw_54_ok:
    global_load_dwordx4 a[28:31], v150, s[38:39] sc1
    s_add_u32 s38, s38, 0x20000
    s_addc_u32 s39, s39, 0
    s_mov_b64 exec, s[54:55]
    global_load_dwordx4 a[184:187], v152, s[40:41] offset:0 sc1
    global_load_dwordx4 a[188:191], v152, s[40:41] offset:1024 sc1
    s_add_u32 s40, s40, 0x20000
    s_addc_u32 s41, s41, 0
    s_mov_b64 exec, -1
    s_mov_b32 s57, 0
    s_waitcnt vmcnt(12)
L_at_c0:
    v_mfma_f32_32x32x16_bf16 v[0:15], a[0:3], v[96:99], 0
    v_mfma_f32_32x32x16_bf16 v[16:31], a[4:7], v[96:99], 0
    v_sub_f32 v158, 0, v48
    v_mov_b32 v159, v158
    v_mfma_f32_32x32x16_bf16 v[32:47], a[8:11], v[96:99], 0
    s_nop 7
    v_max3_f32 v158, v158, v0, v1
    v_max3_f32 v159, v159, v2, v3
    v_max3_f32 v158, v158, v4, v5
    v_max3_f32 v159, v159, v6, v7
    v_max3_f32 v158, v158, v8, v9
    v_max3_f32 v159, v159, v10, v11
    v_max3_f32 v158, v158, v12, v13
    v_max3_f32 v159, v159, v14, v15
    v_mfma_f32_32x32x16_bf16 v[0:15], a[12:15], v[96:99], 0
    v_max3_f32 v158, v158, v16, v17
    v_max3_f32 v159, v159, v18, v19
    v_max3_f32 v158, v158, v20, v21
    v_max3_f32 v159, v159, v22, v23
    v_max3_f32 v158, v158, v24, v25
    v_max3_f32 v159, v159, v26, v27
    v_max3_f32 v158, v158, v28, v29
    v_max3_f32 v159, v159, v30, v31
    v_max3_f32 v158, v158, v32, v33
    v_max3_f32 v159, v159, v34, v35
    v_max3_f32 v158, v158, v36, v37
    v_max3_f32 v159, v159, v38, v39
    v_max3_f32 v158, v158, v40, v41
    v_max3_f32 v159, v159, v42, v43
    v_max3_f32 v158, v158, v44, v45
    v_max3_f32 v159, v159, v46, v47
    v_max3_f32 v158, v158, v0, v1
    v_max3_f32 v159, v159, v2, v3
    v_max3_f32 v158, v158, v4, v5
    v_max3_f32 v159, v159, v6, v7
    v_max3_f32 v158, v158, v8, v9
    v_max3_f32 v159, v159, v10, v11
    v_max3_f32 v158, v158, v12, v13
    v_max3_f32 v159, v159, v14, v15
    v_max_f32 v158, v158, v159
    v_mov_b32 v159, v158
    s_nop 1
    v_permlane32_swap_b32 v158, v159
    v_max_f32 v158, v158, v159
    v_add_f32 v159, v48, v158
    v_exp_f32 v159, -v159
    v_sub_f32 v48, 0, v158
    v_mov_b32 v49, v48
    v_mov_b64 v[50:51], v[48:49]
    v_mov_b64 v[52:53], v[48:49]
    v_mov_b64 v[54:55], v[48:49]
    v_mov_b64 v[56:57], v[48:49]
    v_mov_b64 v[58:59], v[48:49]
    v_mov_b64 v[60:61], v[48:49]
    v_mov_b64 v[62:63], v[48:49]
    s_nop 1
    v_mfma_f32_32x32x16_bf16 v[0:15], a[0:3], v[96:99], v[48:63]
    v_mfma_f32_32x32x16_bf16 v[16:31], a[4:7], v[96:99], v[48:63]
    v_mul_f32 v80, v80, v159
    v_mul_f32 v81, v81, v159
    v_mul_f32 v82, v82, v159
    v_mul_f32 v83, v83, v159
    v_mul_f32 v84, v84, v159
    v_mul_f32 v85, v85, v159
    v_mul_f32 v86, v86, v159
    v_mul_f32 v87, v87, v159
    v_mul_f32 v88, v88, v159
    s_nop 1
    v_exp_f32 v0, v0
    v_exp_f32 v1, v1
    v_exp_f32 v2, v2
    v_exp_f32 v3, v3
    v_exp_f32 v4, v4
    v_exp_f32 v5, v5
    v_mfma_f32_32x32x16_bf16 v[32:47], a[8:11], v[96:99], v[48:63]
    v_exp_f32 v6, v6
    v_exp_f32 v7, v7
    v_exp_f32 v8, v8
    v_exp_f32 v9, v9
    v_cvt_pk_bf16_f32 v64, v0, v1
    v_cvt_pk_bf16_f32 v65, v2, v3
    v_cvt_pk_bf16_f32 v66, v4, v5
    v_cvt_pk_bf16_f32 v67, v6, v7
    v_exp_f32 v10, v10
    v_exp_f32 v11, v11
    v_mfma_f32_32x32x16_bf16 v[80:95], a[128:131], v[64:67], v[80:95]
    v_exp_f32 v12, v12
    v_exp_f32 v13, v13
    v_exp_f32 v14, v14
    v_exp_f32 v15, v15
    v_cvt_pk_bf16_f32 v68, v8, v9
    v_cvt_pk_bf16_f32 v69, v10, v11
    v_cvt_pk_bf16_f32 v70, v12, v13
    v_cvt_pk_bf16_f32 v71, v14, v15
    v_exp_f32 v16, v16
    v_exp_f32 v17, v17
    v_mfma_f32_32x32x16_bf16 v[80:95], a[132:135], v[68:71], v[80:95]
    v_exp_f32 v18, v18
    v_exp_f32 v19, v19
    v_exp_f32 v20, v20
    v_exp_f32 v21, v21
    v_mfma_f32_32x32x16_bf16 v[0:15], a[12:15], v[96:99], v[48:63]
    v_exp_f32 v22, v22
    v_exp_f32 v23, v23
    v_exp_f32 v24, v24
    v_exp_f32 v25, v25
    v_cvt_pk_bf16_f32 v72, v16, v17
    v_cvt_pk_bf16_f32 v73, v18, v19
    v_cvt_pk_bf16_f32 v74, v20, v21
    v_cvt_pk_bf16_f32 v75, v22, v23
    v_exp_f32 v26, v26
    v_exp_f32 v27, v27
    v_mfma_f32_32x32x16_bf16 v[80:95], a[136:139], v[72:75], v[80:95]
    v_exp_f32 v28, v28
    v_exp_f32 v29, v29
    v_exp_f32 v30, v30
    v_exp_f32 v31, v31
    v_cvt_pk_bf16_f32 v76, v24, v25
    v_cvt_pk_bf16_f32 v77, v26, v27
    v_cvt_pk_bf16_f32 v78, v28, v29
    v_cvt_pk_bf16_f32 v79, v30, v31
    v_exp_f32 v32, v32
    v_exp_f32 v33, v33
    v_mfma_f32_32x32x16_bf16 v[80:95], a[140:143], v[76:79], v[80:95]
    v_exp_f32 v34, v34
    v_exp_f32 v35, v35
    v_exp_f32 v36, v36
    v_exp_f32 v37, v37
    v_exp_f32 v38, v38
    v_exp_f32 v39, v39
    v_exp_f32 v40, v40
    v_exp_f32 v41, v41
    v_cvt_pk_bf16_f32 v64, v32, v33
    v_cvt_pk_bf16_f32 v65, v34, v35
    v_cvt_pk_bf16_f32 v66, v36, v37
    v_cvt_pk_bf16_f32 v67, v38, v39
    v_exp_f32 v42, v42
    v_exp_f32 v43, v43
    v_mfma_f32_32x32x16_bf16 v[80:95], a[144:147], v[64:67], v[80:95]
    v_exp_f32 v44, v44
    v_exp_f32 v45, v45
    v_exp_f32 v46, v46
    v_exp_f32 v47, v47
    v_cvt_pk_bf16_f32 v68, v40, v41
    v_cvt_pk_bf16_f32 v69, v42, v43
    v_cvt_pk_bf16_f32 v70, v44, v45
    v_cvt_pk_bf16_f32 v71, v46, v47
    v_exp_f32 v0, v0
    v_exp_f32 v1, v1
    v_mfma_f32_32x32x16_bf16 v[80:95], a[148:151], v[68:71], v[80:95]
    v_exp_f32 v2, v2
    v_exp_f32 v3, v3
    v_exp_f32 v4, v4
    v_exp_f32 v5, v5
    v_exp_f32 v6, v6
    v_exp_f32 v7, v7
    v_exp_f32 v8, v8
    v_exp_f32 v9, v9
    v_cvt_pk_bf16_f32 v72, v0, v1
    v_cvt_pk_bf16_f32 v73, v2, v3
    v_cvt_pk_bf16_f32 v74, v4, v5
    v_cvt_pk_bf16_f32 v75, v6, v7
    v_exp_f32 v10, v10
    v_exp_f32 v11, v11
    v_mfma_f32_32x32x16_bf16 v[80:95], a[152:155], v[72:75], v[80:95]
    v_exp_f32 v12, v12
    v_exp_f32 v13, v13
    v_exp_f32 v14, v14
    v_exp_f32 v15, v15
    v_cvt_pk_bf16_f32 v76, v8, v9
    v_cvt_pk_bf16_f32 v77, v10, v11
    v_cvt_pk_bf16_f32 v78, v12, v13
    v_cvt_pk_bf16_f32 v79, v14, v15
    s_nop 1
    v_mfma_f32_32x32x16_bf16 v[80:95], a[156:159], v[76:79], v[80:95]
    s_cmp_eq_u32 s34, 0
    s_cbranch_scc1 L_at_n0
    s_nop 9
    v_swap_b32 v80, v120
    v_swap_b32 v81, v121
    v_swap_b32 v82, v122
    v_swap_b32 v83, v123
    v_swap_b32 v84, v124
    v_swap_b32 v85, v125
    v_swap_b32 v86, v126
    v_swap_b32 v87, v127
    v_swap_b32 v88, v128
    v_swap_b32 v48, v129
    v_swap_b32 v96, v100
    v_swap_b32 v97, v101
    v_swap_b32 v98, v102
    v_swap_b32 v99, v103
    s_add_u32 s57, s57, 1
    s_cmp_lt_u32 s57, 2
    s_cbranch_scc1 L_at_c0
L_at_n0:
    s_add_u32 s82, s31, 32
L_at_kw_55:
    s_bitcmp1_b64 s[50:51], s82
    s_cbranch_scc1 L_at_kw_55_ok
    s_getpc_b64 s[58:59]
    s_branch L_at_poll
    s_branch L_at_kw_55
L_at_kw_55_ok:
    global_load_dwordx4 a[32:35], v150, s[38:39] sc1
    s_add_u32 s38, s38, 0x20000
    s_addc_u32 s39, s39, 0
    s_mov_b64 exec, s[54:55]
    global_load_dwordx4 a[192:195], v152, s[40:41] offset:0 sc1
    global_load_dwordx4 a[196:199], v152, s[40:41] offset:1024 sc1
    s_add_u32 s40, s40, 0x20000
    s_addc_u32 s41, s41, 0
    s_mov_b64 exec, -1
    s_add_u32 s82, s31, 36
L_at_kw_56:
    s_bitcmp1_b64 s[50:51], s82
    s_cbranch_scc1 L_at_kw_56_ok
    s_getpc_b64 s[58:59]
    s_branch L_at_poll
    s_branch L_at_kw_56
L_at_kw_56_ok:
    global_load_dwordx4 a[36:39], v150, s[38:39] sc1
    s_add_u32 s38, s38, 0x20000
    s_addc_u32 s39, s39, 0
    s_mov_b64 exec, s[54:55]
    global_load_dwordx4 a[200:203], v152, s[40:41] offset:0 sc1
    global_load_dwordx4 a[204:207], v152, s[40:41] offset:1024 sc1
    s_add_u32 s40, s40, 0x20000
    s_addc_u32 s41, s41, 0
    s_mov_b64 exec, -1
    s_add_u32 s82, s31, 40
L_at_kw_57:
    s_bitcmp1_b64 s[50:51], s82
    s_cbranch_scc1 L_at_kw_57_ok
    s_getpc_b64 s[58:59]
    s_branch L_at_poll
    s_branch L_at_kw_57
L_at_kw_57_ok:
    global_load_dwordx4 a[40:43], v150, s[38:39] sc1
    s_add_u32 s38, s38, 0x20000
    s_addc_u32 s39, s39, 0
    s_mov_b64 exec, s[54:55]
    global_load_dwordx4 a[208:211], v152, s[40:41] offset:0 sc1
    global_load_dwordx4 a[212:215], v152, s[40:41] offset:1024 sc1
    s_add_u32 s40, s40, 0x20000
    s_addc_u32 s41, s41, 0
    s_mov_b64 exec, -1
    s_add_u32 s82, s31, 44
L_at_kw_58:
    s_bitcmp1_b64 s[50:51], s82
    s_cbranch_scc1 L_at_kw_58_ok
    s_getpc_b64 s[58:59]
    s_branch L_at_poll
    s_branch L_at_kw_58
L_at_kw_58_ok:
    global_load_dwordx4 a[44:47], v150, s[38:39] sc1
    s_add_u32 s38, s38, 0x20000
    s_addc_u32 s39, s39, 0
    s_mov_b64 exec, s[54:55]
    global_load_dwordx4 a[216:219], v152, s[40:41] offset:0 sc1
    global_load_dwordx4 a[220:223], v152, s[40:41] offset:1024 sc1
    s_add_u32 s40, s40, 0x20000
    s_addc_u32 s41, s41, 0
    s_mov_b64 exec, -1
    s_mov_b32 s57, 0
    s_waitcnt vmcnt(12)
L_at_c4:
    v_mfma_f32_32x32x16_bf16 v[16:31], a[16:19], v[96:99], 0
    v_mfma_f32_32x32x16_bf16 v[32:47], a[20:23], v[96:99], 0
    v_sub_f32 v158, 0, v48
    v_mov_b32 v159, v158
    v_mfma_f32_32x32x16_bf16 v[0:15], a[24:27], v[96:99], 0
    s_nop 7
    v_max3_f32 v158, v158, v16, v17
    v_max3_f32 v159, v159, v18, v19
    v_max3_f32 v158, v158, v20, v21
    v_max3_f32 v159, v159, v22, v23
    v_max3_f32 v158, v158, v24, v25
    v_max3_f32 v159, v159, v26, v27
    v_max3_f32 v158, v158, v28, v29
    v_max3_f32 v159, v159, v30, v31
    v_mfma_f32_32x32x16_bf16 v[16:31], a[28:31], v[96:99], 0
    v_max3_f32 v158, v158, v32, v33
    v_max3_f32 v159, v159, v34, v35
    v_max3_f32 v158, v158, v36, v37
    v_max3_f32 v159, v159, v38, v39
    v_max3_f32 v158, v158, v40, v41
    v_max3_f32 v159, v159, v42, v43
    v_max3_f32 v158, v158, v44, v45
    v_max3_f32 v159, v159, v46, v47
    v_max3_f32 v158, v158, v0, v1
    v_max3_f32 v159, v159, v2, v3
    v_max3_f32 v158, v158, v4, v5
    v_max3_f32 v159, v159, v6, v7
    v_max3_f32 v158, v158, v8, v9
    v_max3_f32 v159, v159, v10, v11
    v_max3_f32 v158, v158, v12, v13
    v_max3_f32 v159, v159, v14, v15
    v_max3_f32 v158, v158, v16, v17
    v_max3_f32 v159, v159, v18, v19
    v_max3_f32 v158, v158, v20, v21
    v_max3_f32 v159, v159, v22, v23
    v_max3_f32 v158, v158, v24, v25
    v_max3_f32 v159, v159, v26, v27
    v_max3_f32 v158, v158, v28, v29
    v_max3_f32 v159, v159, v30, v31
    v_max_f32 v158, v158, v159
    v_mov_b32 v159, v158
    s_nop 1
    v_permlane32_swap_b32 v158, v159
    v_max_f32 v158, v158, v159
    v_add_f32 v159, v48, v158
    v_exp_f32 v159, -v159
    v_sub_f32 v48, 0, v158
    v_mov_b32 v49, v48
    v_mov_b64 v[50:51], v[48:49]
    v_mov_b64 v[52:53], v[48:49]
    v_mov_b64 v[54:55], v[48:49]
    v_mov_b64 v[56:57], v[48:49]
    v_mov_b64 v[58:59], v[48:49]
    v_mov_b64 v[60:61], v[48:49]
    v_mov_b64 v[62:63], v[48:49]
    s_nop 1
    v_mfma_f32_32x32x16_bf16 v[16:31], a[16:19], v[96:99], v[48:63]
    v_mfma_f32_32x32x16_bf16 v[32:47], a[20:23], v[96:99], v[48:63]
    v_mul_f32 v80, v80, v159
    v_mul_f32 v81, v81, v159
    v_mul_f32 v82, v82, v159
    v_mul_f32 v83, v83, v159
    v_mul_f32 v84, v84, v159
    v_mul_f32 v85, v85, v159
    v_mul_f32 v86, v86, v159
    v_mul_f32 v87, v87, v159
    v_mul_f32 v88, v88, v159
    s_nop 1
    v_exp_f32 v16, v16
    v_exp_f32 v17, v17
    v_exp_f32 v18, v18
    v_exp_f32 v19, v19
    v_exp_f32 v20, v20
    v_exp_f32 v21, v21
    v_mfma_f32_32x32x16_bf16 v[0:15], a[24:27], v[96:99], v[48:63]
    v_exp_f32 v22, v22
    v_exp_f32 v23, v23
    v_exp_f32 v24, v24
    v_exp_f32 v25, v25
    v_cvt_pk_bf16_f32 v64, v16, v17
    v_cvt_pk_bf16_f32 v65, v18, v19
    v_cvt_pk_bf16_f32 v66, v20, v21
    v_cvt_pk_bf16_f32 v67, v22, v23
    v_exp_f32 v26, v26
    v_exp_f32 v27, v27
    v_mfma_f32_32x32x16_bf16 v[80:95], a[160:163], v[64:67], v[80:95]
    v_exp_f32 v28, v28
    v_exp_f32 v29, v29
    v_exp_f32 v30, v30
    v_exp_f32 v31, v31
    v_cvt_pk_bf16_f32 v68, v24, v25
    v_cvt_pk_bf16_f32 v69, v26, v27
    v_cvt_pk_bf16_f32 v70, v28, v29
    v_cvt_pk_bf16_f32 v71, v30, v31
    v_exp_f32 v32, v32
    v_exp_f32 v33, v33
    v_mfma_f32_32x32x16_bf16 v[80:95], a[164:167], v[68:71], v[80:95]
    v_exp_f32 v34, v34
    v_exp_f32 v35, v35
    v_exp_f32 v36, v36
    v_exp_f32 v37, v37
    v_mfma_f32_32x32x16_bf16 v[16:31], a[28:31], v[96:99], v[48:63]
    v_exp_f32 v38, v38
    v_exp_f32 v39, v39
    v_exp_f32 v40, v40
    v_exp_f32 v41, v41
    v_cvt_pk_bf16_f32 v72, v32, v33
    v_cvt_pk_bf16_f32 v73, v34, v35
    v_cvt_pk_bf16_f32 v74, v36, v37
    v_cvt_pk_bf16_f32 v75, v38, v39
    v_exp_f32 v42, v42
    v_exp_f32 v43, v43
    v_mfma_f32_32x32x16_bf16 v[80:95], a[168:171], v[72:75], v[80:95]
    v_exp_f32 v44, v44
    v_exp_f32 v45, v45
    v_exp_f32 v46, v46
    v_exp_f32 v47, v47
    v_cvt_pk_bf16_f32 v76, v40, v41
    v_cvt_pk_bf16_f32 v77, v42, v43
    v_cvt_pk_bf16_f32 v78, v44, v45
    v_cvt_pk_bf16_f32 v79, v46, v47
    v_exp_f32 v0, v0
    v_exp_f32 v1, v1
    v_mfma_f32_32x32x16_bf16 v[80:95], a[172:175], v[76:79], v[80:95]
    v_exp_f32 v2, v2
    v_exp_f32 v3, v3
    v_exp_f32 v4, v4
    v_exp_f32 v5, v5
    v_exp_f32 v6, v6
    v_exp_f32 v7, v7
    v_exp_f32 v8, v8
    v_exp_f32 v9, v9
    v_cvt_pk_bf16_f32 v64, v0, v1
    v_cvt_pk_bf16_f32 v65, v2, v3
    v_cvt_pk_bf16_f32 v66, v4, v5
    v_cvt_pk_bf16_f32 v67, v6, v7
    v_exp_f32 v10, v10
    v_exp_f32 v11, v11
    v_mfma_f32_32x32x16_bf16 v[80:95], a[176:179], v[64:67], v[80:95]
    v_exp_f32 v12, v12
    v_exp_f32 v13, v13
    v_exp_f32 v14, v14
    v_exp_f32 v15, v15
    v_cvt_pk_bf16_f32 v68, v8, v9
    v_cvt_pk_bf16_f32 v69, v10, v11
    v_cvt_pk_bf16_f32 v70, v12, v13
    v_cvt_pk_bf16_f32 v71, v14, v15
    v_exp_f32 v16, v16
    v_exp_f32 v17, v17
    v_mfma_f32_32x32x16_bf16 v[80:95], a[180:183], v[68:71], v[80:95]
    v_exp_f32 v18, v18
    v_exp_f32 v19, v19
    v_exp_f32 v20, v20
    v_exp_f32 v21, v21
    v_exp_f32 v22, v22
    v_exp_f32 v23, v23
    v_exp_f32 v24, v24
    v_exp_f32 v25, v25
    v_cvt_pk_bf16_f32 v72, v16, v17
    v_cvt_pk_bf16_f32 v73, v18, v19
    v_cvt_pk_bf16_f32 v74, v20, v21
    v_cvt_pk_bf16_f32 v75, v22, v23
    v_exp_f32 v26, v26
    v_exp_f32 v27, v27
    v_mfma_f32_32x32x16_bf16 v[80:95], a[184:187], v[72:75], v[80:95]
    v_exp_f32 v28, v28
    v_exp_f32 v29, v29
    v_exp_f32 v30, v30
    v_exp_f32 v31, v31
    v_cvt_pk_bf16_f32 v76, v24, v25
    v_cvt_pk_bf16_f32 v77, v26, v27
    v_cvt_pk_bf16_f32 v78, v28, v29
    v_cvt_pk_bf16_f32 v79, v30, v31
    s_nop 1
    v_mfma_f32_32x32x16_bf16 v[80:95], a[188:191], v[76:79], v[80:95]
    s_cmp_eq_u32 s34, 0
    s_cbranch_scc1 L_at_n4
    s_nop 9
    v_swap_b32 v80, v120
    v_swap_b32 v81, v121
    v_swap_b32 v82, v122
    v_swap_b32 v83, v123
    v_swap_b32 v84, v124
    v_swap_b32 v85, v125
    v_swap_b32 v86, v126
    v_swap_b32 v87, v127
    v_swap_b32 v88, v128
    v_swap_b32 v48, v129
    v_swap_b32 v96, v100
    v_swap_b32 v97, v101
    v_swap_b32 v98, v102
    v_swap_b32 v99, v103
    s_add_u32 s57, s57, 1
    s_cmp_lt_u32 s57, 2
    s_cbranch_scc1 L_at_c4
L_at_n4:
    s_add_u32 s82, s31, 48
L_at_kw_59:
    s_bitcmp1_b64 s[50:51], s82
    s_cbranch_scc1 L_at_kw_59_ok
    s_getpc_b64 s[58:59]
    s_branch L_at_poll
    s_branch L_at_kw_59
L_at_kw_59_ok:
    global_load_dwordx4 a[48:51], v150, s[38:39] sc1
    s_add_u32 s38, s38, 0x20000
    s_addc_u32 s39, s39, 0
    s_mov_b64 exec, s[54:55]
    global_load_dwordx4 a[224:227], v152, s[40:41] offset:0 sc1
    global_load_dwordx4 a[228:231], v152, s[40:41] offset:1024 sc1
    s_add_u32 s40, s40, 0x20000
    s_addc_u32 s41, s41, 0
    s_mov_b64 exec, -1
    s_add_u32 s82, s31, 52
L_at_kw_60:
    s_bitcmp1_b64 s[50:51], s82
    s_cbranch_scc1 L_at_kw_60_ok
    s_getpc_b64 s[58:59]
    s_branch L_at_poll
    s_branch L_at_kw_60
L_at_kw_60_ok:
    global_load_dwordx4 a[52:55], v150, s[38:39] sc1
    s_add_u32 s38, s38, 0x20000
    s_addc_u32 s39, s39, 0
    s_mov_b64 exec, s[54:55]
    global_load_dwordx4 a[232:235], v152, s[40:41] offset:0 sc1
    global_load_dwordx4 a[236:239], v152, s[40:41] offset:1024 sc1
    s_add_u32 s40, s40, 0x20000
    s_addc_u32 s41, s41, 0
    s_mov_b64 exec, -1
    s_add_u32 s82, s31, 56
L_at_kw_61:
    s_bitcmp1_b64 s[50:51], s82
    s_cbranch_scc1 L_at_kw_61_ok
    s_getpc_b64 s[58:59]
    s_branch L_at_poll
    s_branch L_at_kw_61
L_at_kw_61_ok:
    global_load_dwordx4 a[56:59], v150, s[38:39] sc1
    s_add_u32 s38, s38, 0x20000
    s_addc_u32 s39, s39, 0
    s_mov_b64 exec, s[54:55]
    global_load_dwordx4 a[240:243], v152, s[40:41] offset:0 sc1
    global_load_dwordx4 a[244:247], v152, s[40:41] offset:1024 sc1
    s_add_u32 s40, s40, 0x20000
    s_addc_u32 s41, s41, 0
    s_mov_b64 exec, -1
    s_mov_b32 s57, 0
    s_waitcnt vmcnt(9)
    s_cmp_lg_u32 s34, 0
    s_cbranch_scc1 L_at_c8
    s_add_u32 s82, s31, 60
L_at_kw_62:
    s_bitcmp1_b64 s[50:51], s82
    s_cbranch_scc1 L_at_kw_62_ok
    s_getpc_b64 s[58:59]
    s_branch L_at_poll
    s_branch L_at_kw_62
L_at_kw_62_ok:
    global_load_dwordx4 a[60:63], v150, s[38:39] sc1
    s_add_u32 s38, s38, 0x20000
    s_addc_u32 s39, s39, 0
    s_mov_b64 exec, s[54:55]
    global_load_dwordx4 a[248:251], v152, s[40:41] offset:0 sc1
    global_load_dwordx4 a[252:255], v152, s[40:41] offset:1024 sc1
    s_add_u32 s40, s40, 0x20000
    s_addc_u32 s41, s41, 0
    s_mov_b64 exec, -1
L_at_c8:
    v_mfma_f32_32x32x16_bf16 v[32:47], a[32:35], v[96:99], 0
    v_mfma_f32_32x32x16_bf16 v[0:15], a[36:39], v[96:99], 0
    v_sub_f32 v158, 0, v48
    v_mov_b32 v159, v158
    v_mfma_f32_32x32x16_bf16 v[16:31], a[40:43], v[96:99], 0
    s_nop 7
    v_max3_f32 v158, v158, v32, v33
    v_max3_f32 v159, v159, v34, v35
    v_max3_f32 v158, v158, v36, v37
    v_max3_f32 v159, v159, v38, v39
    v_max3_f32 v158, v158, v40, v41
    v_max3_f32 v159, v159, v42, v43
    v_max3_f32 v158, v158, v44, v45
    v_max3_f32 v159, v159, v46, v47
    v_mfma_f32_32x32x16_bf16 v[32:47], a[44:47], v[96:99], 0
    v_max3_f32 v158, v158, v0, v1
    v_max3_f32 v159, v159, v2, v3
    v_max3_f32 v158, v158, v4, v5
    v_max3_f32 v159, v159, v6, v7
    v_max3_f32 v158, v158, v8, v9
    v_max3_f32 v159, v159, v10, v11
    v_max3_f32 v158, v158, v12, v13
    v_max3_f32 v159, v159, v14, v15
    v_max3_f32 v158, v158, v16, v17
    v_max3_f32 v159, v159, v18, v19
    v_max3_f32 v158, v158, v20, v21
    v_max3_f32 v159, v159, v22, v23
    v_max3_f32 v158, v158, v24, v25
    v_max3_f32 v159, v159, v26, v27
    v_max3_f32 v158, v158, v28, v29
    v_max3_f32 v159, v159, v30, v31
    v_max3_f32 v158, v158, v32, v33
    v_max3_f32 v159, v159, v34, v35
    v_max3_f32 v158, v158, v36, v37
    v_max3_f32 v159, v159, v38, v39
    v_max3_f32 v158, v158, v40, v41
    v_max3_f32 v159, v159, v42, v43
    v_max3_f32 v158, v158, v44, v45
    v_max3_f32 v159, v159, v46, v47
    v_max_f32 v158, v158, v159
    v_mov_b32 v159, v158
    s_nop 1
    v_permlane32_swap_b32 v158, v159
    v_max_f32 v158, v158, v159
    v_add_f32 v159, v48, v158
    v_exp_f32 v159, -v159
    v_sub_f32 v48, 0, v158
    v_mov_b32 v49, v48
    v_mov_b64 v[50:51], v[48:49]
    v_mov_b64 v[52:53], v[48:49]
    v_mov_b64 v[54:55], v[48:49]
    v_mov_b64 v[56:57], v[48:49]
    v_mov_b64 v[58:59], v[48:49]
    v_mov_b64 v[60:61], v[48:49]
    v_mov_b64 v[62:63], v[48:49]
    s_nop 1
    v_mfma_f32_32x32x16_bf16 v[32:47], a[32:35], v[96:99], v[48:63]
    v_mfma_f32_32x32x16_bf16 v[0:15], a[36:39], v[96:99], v[48:63]
    v_mul_f32 v80, v80, v159
    v_mul_f32 v81, v81, v159
    v_mul_f32 v82, v82, v159
    v_mul_f32 v83, v83, v159
    v_mul_f32 v84, v84, v159
    v_mul_f32 v85, v85, v159
    v_mul_f32 v86, v86, v159
    v_mul_f32 v87, v87, v159
    v_mul_f32 v88, v88, v159
    s_nop 1
    v_exp_f32 v32, v32
    v_exp_f32 v33, v33
    v_exp_f32 v34, v34
    v_exp_f32 v35, v35
    v_exp_f32 v36, v36
    v_exp_f32 v37, v37
    v_mfma_f32_32x32x16_bf16 v[16:31], a[40:43], v[96:99], v[48:63]
    v_exp_f32 v38, v38
    v_exp_f32 v39, v39
    v_exp_f32 v40, v40
    v_exp_f32 v41, v41
    v_cvt_pk_bf16_f32 v64, v32, v33
    v_cvt_pk_bf16_f32 v65, v34, v35
    v_cvt_pk_bf16_f32 v66, v36, v37
    v_cvt_pk_bf16_f32 v67, v38, v39
    v_exp_f32 v42, v42
    v_exp_f32 v43, v43
    v_mfma_f32_32x32x16_bf16 v[80:95], a[192:195], v[64:67], v[80:95]
    v_exp_f32 v44, v44
    v_exp_f32 v45, v45
    v_exp_f32 v46, v46
    v_exp_f32 v47, v47
    v_cvt_pk_bf16_f32 v68, v40, v41
    v_cvt_pk_bf16_f32 v69, v42, v43
    v_cvt_pk_bf16_f32 v70, v44, v45
    v_cvt_pk_bf16_f32 v71, v46, v47
    v_exp_f32 v0, v0
    v_exp_f32 v1, v1
    v_mfma_f32_32x32x16_bf16 v[80:95], a[196:199], v[68:71], v[80:95]
    v_exp_f32 v2, v2
    v_exp_f32 v3, v3
    v_exp_f32 v4, v4
    v_exp_f32 v5, v5
    v_mfma_f32_32x32x16_bf16 v[32:47], a[44:47], v[96:99], v[48:63]
    v_exp_f32 v6, v6
    v_exp_f32 v7, v7
    v_exp_f32 v8, v8
    v_exp_f32 v9, v9
    v_cvt_pk_bf16_f32 v72, v0, v1
    v_cvt_pk_bf16_f32 v73, v2, v3
    v_cvt_pk_bf16_f32 v74, v4, v5
    v_cvt_pk_bf16_f32 v75, v6, v7
    v_exp_f32 v10, v10
    v_exp_f32 v11, v11
    v_mfma_f32_32x32x16_bf16 v[80:95], a[200:203], v[72:75], v[80:95]
    v_exp_f32 v12, v12
    v_exp_f32 v13, v13
    v_exp_f32 v14, v14
    v_exp_f32 v15, v15
    v_cvt_pk_bf16_f32 v76, v8, v9
    v_cvt_pk_bf16_f32 v77, v10, v11
    v_cvt_pk_bf16_f32 v78, v12, v13
    v_cvt_pk_bf16_f32 v79, v14, v15
    v_exp_f32 v16, v16
    v_exp_f32 v17, v17
    v_mfma_f32_32x32x16_bf16 v[80:95], a[204:207], v[76:79], v[80:95]
    v_exp_f32 v18, v18
    v_exp_f32 v19, v19
    v_exp_f32 v20, v20
    v_exp_f32 v21, v21
    v_exp_f32 v22, v22
    v_exp_f32 v23, v23
    v_exp_f32 v24, v24
    v_exp_f32 v25, v25
    v_cvt_pk_bf16_f32 v64, v16, v17
    v_cvt_pk_bf16_f32 v65, v18, v19
    v_cvt_pk_bf16_f32 v66, v20, v21
    v_cvt_pk_bf16_f32 v67, v22, v23
    v_exp_f32 v26, v26
    v_exp_f32 v27, v27
    v_mfma_f32_32x32x16_bf16 v[80:95], a[208:211], v[64:67], v[80:95]
    v_exp_f32 v28, v28
    v_exp_f32 v29, v29
    v_exp_f32 v30, v30
    v_exp_f32 v31, v31
    v_cvt_pk_bf16_f32 v68, v24, v25
    v_cvt_pk_bf16_f32 v69, v26, v27
    v_cvt_pk_bf16_f32 v70, v28, v29
    v_cvt_pk_bf16_f32 v71, v30, v31
    v_exp_f32 v32, v32
    v_exp_f32 v33, v33
    v_mfma_f32_32x32x16_bf16 v[80:95], a[212:215], v[68:71], v[80:95]
    v_exp_f32 v34, v34
    v_exp_f32 v35, v35
    v_exp_f32 v36, v36
    v_exp_f32 v37, v37
    v_exp_f32 v38, v38
    v_exp_f32 v39, v39
    v_exp_f32 v40, v40
    v_exp_f32 v41, v41
    v_cvt_pk_bf16_f32 v72, v32, v33
    v_cvt_pk_bf16_f32 v73, v34, v35
    v_cvt_pk_bf16_f32 v74, v36, v37
    v_cvt_pk_bf16_f32 v75, v38, v39
    v_exp_f32 v42, v42
    v_exp_f32 v43, v43
    v_mfma_f32_32x32x16_bf16 v[80:95], a[216:219], v[72:75], v[80:95]
    v_exp_f32 v44, v44
    v_exp_f32 v45, v45
    v_exp_f32 v46, v46
    v_exp_f32 v47, v47
    v_cvt_pk_bf16_f32 v76, v40, v41
    v_cvt_pk_bf16_f32 v77, v42, v43
    v_cvt_pk_bf16_f32 v78, v44, v45
    v_cvt_pk_bf16_f32 v79, v46, v47
    s_nop 1
    v_mfma_f32_32x32x16_bf16 v[80:95], a[220:223], v[76:79], v[80:95]
    s_cmp_eq_u32 s34, 0
    s_cbranch_scc1 L_at_n8
    s_nop 9
    v_swap_b32 v80, v120
    v_swap_b32 v81, v121
    v_swap_b32 v82, v122
    v_swap_b32 v83, v123
    v_swap_b32 v84, v124
    v_swap_b32 v85, v125
    v_swap_b32 v86, v126
    v_swap_b32 v87, v127
    v_swap_b32 v88, v128
    v_swap_b32 v48, v129
    v_swap_b32 v96, v100
    v_swap_b32 v97, v101
    v_swap_b32 v98, v102
    v_swap_b32 v99, v103
    s_add_u32 s57, s57, 1
    s_cmp_lt_u32 s57, 2
    s_cbranch_scc1 L_at_c8
L_at_n8:
    s_cmp_eq_u32 s34, 0
    s_cselect_b32 s57, 3, 0
    s_waitcnt vmcnt(0)
L_at_c12:
    v_mfma_f32_32x32x16_bf16 v[0:15], a[48:51], v[96:99], 0
    v_mfma_f32_32x32x16_bf16 v[16:31], a[52:55], v[96:99], 0
    v_sub_f32 v158, 0, v48
    v_mov_b32 v159, v158
    v_mfma_f32_32x32x16_bf16 v[32:47], a[56:59], v[96:99], 0
    s_nop 7
    v_max3_f32 v158, v158, v0, v1
    v_max3_f32 v159, v159, v2, v3
    v_max3_f32 v158, v158, v4, v5
    v_max3_f32 v159, v159, v6, v7
    v_max3_f32 v158, v158, v8, v9
    v_max3_f32 v159, v159, v10, v11
    v_max3_f32 v158, v158, v12, v13
    v_max3_f32 v159, v159, v14, v15
    v_max3_f32 v158, v158, v16, v17
    v_max3_f32 v159, v159, v18, v19
    v_max3_f32 v158, v158, v20, v21
    v_max3_f32 v159, v159, v22, v23
    v_max3_f32 v158, v158, v24, v25
    v_max3_f32 v159, v159, v26, v27
    v_max3_f32 v158, v158, v28, v29
    v_max3_f32 v159, v159, v30, v31
    v_max3_f32 v158, v158, v32, v33
    v_max3_f32 v159, v159, v34, v35
    v_max3_f32 v158, v158, v36, v37
    v_max3_f32 v159, v159, v38, v39
    v_max3_f32 v158, v158, v40, v41
    v_max3_f32 v159, v159, v42, v43
    v_max3_f32 v158, v158, v44, v45
    v_max3_f32 v159, v159, v46, v47
    v_max_f32 v158, v158, v159
    v_mov_b32 v159, v158
    s_nop 1
    v_permlane32_swap_b32 v158, v159
    v_max_f32 v158, v158, v159
    v_add_f32 v159, v48, v158
    v_exp_f32 v159, -v159
    v_sub_f32 v48, 0, v158
    v_mov_b32 v49, v48
    v_mov_b64 v[50:51], v[48:49]
    v_mov_b64 v[52:53], v[48:49]
    v_mov_b64 v[54:55], v[48:49]
    v_mov_b64 v[56:57], v[48:49]
    v_mov_b64 v[58:59], v[48:49]
    v_mov_b64 v[60:61], v[48:49]
    v_mov_b64 v[62:63], v[48:49]
    s_nop 1
    v_mfma_f32_32x32x16_bf16 v[0:15], a[48:51], v[96:99], v[48:63]
    v_mfma_f32_32x32x16_bf16 v[16:31], a[52:55], v[96:99], v[48:63]
    v_mul_f32 v80, v80, v159
    v_mul_f32 v81, v81, v159
    v_mul_f32 v82, v82, v159
    v_mul_f32 v83, v83, v159
    v_mul_f32 v84, v84, v159
    v_mul_f32 v85, v85, v159
    v_mul_f32 v86, v86, v159
    v_mul_f32 v87, v87, v159
    v_mul_f32 v88, v88, v159
    s_nop 1
    v_exp_f32 v0, v0
    v_exp_f32 v1, v1
    v_exp_f32 v2, v2
    v_exp_f32 v3, v3
    v_exp_f32 v4, v4
    v_exp_f32 v5, v5
    v_mfma_f32_32x32x16_bf16 v[32:47], a[56:59], v[96:99], v[48:63]
    v_exp_f32 v6, v6
    v_exp_f32 v7, v7
    v_exp_f32 v8, v8
    v_exp_f32 v9, v9
    v_cvt_pk_bf16_f32 v64, v0, v1
    v_cvt_pk_bf16_f32 v65, v2, v3
    v_cvt_pk_bf16_f32 v66, v4, v5
    v_cvt_pk_bf16_f32 v67, v6, v7
    v_exp_f32 v10, v10
    v_exp_f32 v11, v11
    v_mfma_f32_32x32x16_bf16 v[80:95], a[224:227], v[64:67], v[80:95]
    v_exp_f32 v12, v12
    v_exp_f32 v13, v13
    v_exp_f32 v14, v14
    v_exp_f32 v15, v15
    v_cvt_pk_bf16_f32 v68, v8, v9
    v_cvt_pk_bf16_f32 v69, v10, v11
    v_cvt_pk_bf16_f32 v70, v12, v13
    v_cvt_pk_bf16_f32 v71, v14, v15
    v_exp_f32 v16, v16
    v_exp_f32 v17, v17
    v_mfma_f32_32x32x16_bf16 v[80:95], a[228:231], v[68:71], v[80:95]
    v_exp_f32 v18, v18
    v_exp_f32 v19, v19
    v_exp_f32 v20, v20
    v_exp_f32 v21, v21
    v_exp_f32 v22, v22
    v_exp_f32 v23, v23
    v_exp_f32 v24, v24
    v_exp_f32 v25, v25
    v_cvt_pk_bf16_f32 v72, v16, v17
    v_cvt_pk_bf16_f32 v73, v18, v19
    v_cvt_pk_bf16_f32 v74, v20, v21
    v_cvt_pk_bf16_f32 v75, v22, v23
    v_exp_f32 v26, v26
    v_exp_f32 v27, v27
    v_mfma_f32_32x32x16_bf16 v[80:95], a[232:235], v[72:75], v[80:95]
    v_exp_f32 v28, v28
    v_exp_f32 v29, v29
    v_exp_f32 v30, v30
    v_exp_f32 v31, v31
    v_cvt_pk_bf16_f32 v76, v24, v25
    v_cvt_pk_bf16_f32 v77, v26, v27
    v_cvt_pk_bf16_f32 v78, v28, v29
    v_cvt_pk_bf16_f32 v79, v30, v31
    v_exp_f32 v32, v32
    v_exp_f32 v33, v33
    v_mfma_f32_32x32x16_bf16 v[80:95], a[236:239], v[76:79], v[80:95]
    v_exp_f32 v34, v34
    v_exp_f32 v35, v35
    v_exp_f32 v36, v36
    v_exp_f32 v37, v37
    v_exp_f32 v38, v38
    v_exp_f32 v39, v39
    v_exp_f32 v40, v40
    v_exp_f32 v41, v41
    v_cvt_pk_bf16_f32 v64, v32, v33
    v_cvt_pk_bf16_f32 v65, v34, v35
    v_cvt_pk_bf16_f32 v66, v36, v37
    v_cvt_pk_bf16_f32 v67, v38, v39
    v_exp_f32 v42, v42
    v_exp_f32 v43, v43
    v_mfma_f32_32x32x16_bf16 v[80:95], a[240:243], v[64:67], v[80:95]
    v_exp_f32 v44, v44
    v_exp_f32 v45, v45
    v_exp_f32 v46, v46
    v_exp_f32 v47, v47
    v_cvt_pk_bf16_f32 v68, v40, v41
    v_cvt_pk_bf16_f32 v69, v42, v43
    v_cvt_pk_bf16_f32 v70, v44, v45
    v_cvt_pk_bf16_f32 v71, v46, v47
    s_nop 1
    v_mfma_f32_32x32x16_bf16 v[80:95], a[244:247], v[68:71], v[80:95]
    s_cmp_eq_u32 s34, 0
    s_cbranch_scc1 L_at_dp_ok
    s_nop 9
    v_swap_b32 v80, v120
    v_swap_b32 v81, v121
    v_swap_b32 v82, v122
    v_swap_b32 v83, v123
    v_swap_b32 v84, v124
    v_swap_b32 v85, v125
    v_swap_b32 v86, v126
    v_swap_b32 v87, v127
    v_swap_b32 v88, v128
    v_swap_b32 v48, v129
    v_swap_b32 v96, v100
    v_swap_b32 v97, v101
    v_swap_b32 v98, v102
    v_swap_b32 v99, v103
    s_add_u32 s57, s57, 1
    s_cmp_lt_u32 s57, 2
    s_cbranch_scc1 L_at_c12
L_at_dp:
    global_load_dwordx4 a[60:63], v150, s[38:39] sc1
    s_mov_b64 exec, s[54:55]
    global_load_dwordx4 a[248:251], v152, s[40:41] offset:0 sc1
    global_load_dwordx4 a[252:255], v152, s[40:41] offset:1024 sc1
    s_mov_b64 exec, -1
    s_waitcnt vmcnt(0)
    v_accvgpr_read_b32 v104, a60
    v_accvgpr_read_b32 v105, a61
    v_accvgpr_read_b32 v106, a62
    v_accvgpr_read_b32 v107, a63
    v_accvgpr_read_b32 v108, a248
    v_accvgpr_read_b32 v109, a249
    v_accvgpr_read_b32 v110, a250
    v_accvgpr_read_b32 v111, a251
    v_accvgpr_read_b32 v112, a252
    v_accvgpr_read_b32 v113, a253
    v_accvgpr_read_b32 v114, a254
    v_accvgpr_read_b32 v115, a255
    v_max_u32 v157, v104, v105
    v_max3_u32 v157, v157, v106, v107
    v_max3_u32 v157, v157, v108, v109
    v_max3_u32 v157, v157, v110, v111
    v_max3_u32 v157, v157, v112, v113
    v_max3_u32 v157, v157, v114, v115
    v_cmp_eq_u32 vcc, -1, v157
    s_cbranch_vccz L_at_dp_ok
    s_sub_u32 s62, s62, 1
    s_cbranch_scc0 L_at_dp
    s_movk_i32 s63, 22
    s_branch L_fail_far
L_at_loop:
    s_add_u32 s82, s33, 2
    s_min_u32 s82, s82, 63
L_at_kw_63:
    s_bitcmp1_b64 s[48:49], s82
    s_cbranch_scc1 L_at_kw_63_ok
    s_getpc_b64 s[58:59]
    s_branch L_at_poll
    s_branch L_at_kw_63
L_at_kw_63_ok:
    s_cmp_ge_u32 s33, 62
    s_cselect_b32 s80, 0, 0x10000
    s_add_u32 s42, s42, s80
    s_addc_u32 s43, s43, 0
    global_load_dwordx4 v[100:103], v150, s[42:43] sc1
    s_cmp_lg_u32 s57, 3
    s_cbranch_scc1 L_at_second
    v_mfma_f32_32x32x16_bf16 v[0:15], a[0:3], v[96:99], 0
    v_mfma_f32_32x32x16_bf16 v[16:31], a[4:7], v[96:99], 0
    v_mfma_f32_32x32x16_bf16 v[32:47], a[8:11], v[96:99], 0
    s_nop 9
    v_max_f32 v158, v0, v1
    v_max_f32 v159, v2, v3
    v_max3_f32 v158, v158, v4, v5
    v_max3_f32 v159, v159, v6, v7
    v_max3_f32 v158, v158, v8, v9
    v_max3_f32 v159, v159, v10, v11
    v_max3_f32 v158, v158, v12, v13
    v_max3_f32 v159, v159, v14, v15
    v_mfma_f32_32x32x16_bf16 v[0:15], a[12:15], v[96:99], 0
    v_max3_f32 v158, v158, v16, v17
    v_max3_f32 v159, v159, v18, v19
    v_max3_f32 v158, v158, v20, v21
    v_max3_f32 v159, v159, v22, v23
    v_max3_f32 v158, v158, v24, v25
    v_max3_f32 v159, v159, v26, v27
    v_max3_f32 v158, v158, v28, v29
    v_max3_f32 v159, v159, v30, v31
    v_mfma_f32_32x32x16_bf16 v[16:31], a[16:19], v[96:99], 0
    v_max3_f32 v158, v158, v32, v33
    v_max3_f32 v159, v159, v34, v35
    v_max3_f32 v158, v158, v36, v37
    v_max3_f32 v159, v159, v38, v39
    v_max3_f32 v158, v158, v40, v41
    v_max3_f32 v159, v159, v42, v43
    v_max3_f32 v158, v158, v44, v45
    v_max3_f32 v159, v159, v46, v47
    v_mfma_f32_32x32x16_bf16 v[32:47], a[20:23], v[96:99], 0
    v_max3_f32 v158, v158, v0, v1
    v_max3_f32 v159, v159, v2, v3
    v_max3_f32 v158, v158, v4, v5
    v_max3_f32 v159, v159, v6, v7
    v_max3_f32 v158, v158, v8, v9
    v_max3_f32 v159, v159, v10, v11
    v_max3_f32 v158, v158, v12, v13
    v_max3_f32 v159, v159, v14, v15
    v_mfma_f32_32x32x16_bf16 v[0:15], a[24:27], v[96:99], 0
    v_max3_f32 v158, v158, v16, v17
    v_max3_f32 v159, v159, v18, v19
    v_max3_f32 v158, v158, v20, v21
    v_max3_f32 v159, v159, v22, v23
    v_max3_f32 v158, v158, v24, v25
    v_max3_f32 v159, v159, v26, v27
    v_max3_f32 v158, v158, v28, v29
    v_max3_f32 v159, v159, v30, v31
    v_mfma_f32_32x32x16_bf16 v[16:31], a[28:31], v[96:99], 0
    v_max3_f32 v158, v158, v32, v33
    v_max3_f32 v159, v159, v34, v35
    v_max3_f32 v158, v158, v36, v37
    v_max3_f32 v159, v159, v38, v39
    v_max3_f32 v158, v158, v40, v41
    v_max3_f32 v159, v159, v42, v43
    v_max3_f32 v158, v158, v44, v45
    v_max3_f32 v159, v159, v46, v47
    v_mfma_f32_32x32x16_bf16 v[32:47], a[32:35], v[96:99], 0
    v_max3_f32 v158, v158, v0, v1
    v_max3_f32 v159, v159, v2, v3
    v_max3_f32 v158, v158, v4, v5
    v_max3_f32 v159, v159, v6, v7
    v_max3_f32 v158, v158, v8, v9
    v_max3_f32 v159, v159, v10, v11
    v_max3_f32 v158, v158, v12, v13
    v_max3_f32 v159, v159, v14, v15
    v_mfma_f32_32x32x16_bf16 v[0:15], a[36:39], v[96:99], 0
    v_max3_f32 v158, v158, v16, v17
    v_max3_f32 v159, v159, v18, v19
    v_max3_f32 v158, v158, v20, v21
    v_max3_f32 v159, v159, v22, v23
    v_max3_f32 v158, v158, v24, v25
    v_max3_f32 v159, v159, v26, v27
    v_max3_f32 v158, v158, v28, v29
    v_max3_f32 v159, v159, v30, v31
    v_mfma_f32_32x32x16_bf16 v[16:31], a[40:43], v[96:99], 0
    v_max3_f32 v158, v158, v32, v33
    v_max3_f32 v159, v159, v34, v35
    v_max3_f32 v158, v158, v36, v37
    v_max3_f32 v159, v159, v38, v39
    v_max3_f32 v158, v158, v40, v41
    v_max3_f32 v159, v159, v42, v43
    v_max3_f32 v158, v158, v44, v45
    v_max3_f32 v159, v159, v46, v47
    v_mfma_f32_32x32x16_bf16 v[32:47], a[44:47], v[96:99], 0
    v_max3_f32 v158, v158, v0, v1
    v_max3_f32 v159, v159, v2, v3
    v_max3_f32 v158, v158, v4, v5
    v_max3_f32 v159, v159, v6, v7
    v_max3_f32 v158, v158, v8, v9
    v_max3_f32 v159, v159, v10, v11
    v_max3_f32 v158, v158, v12, v13
    v_max3_f32 v159, v159, v14, v15
    v_mfma_f32_32x32x16_bf16 v[0:15], a[48:51], v[96:99], 0
    v_max3_f32 v158, v158, v16, v17
    v_max3_f32 v159, v159, v18, v19
    v_max3_f32 v158, v158, v20, v21
    v_max3_f32 v159, v159, v22, v23
    v_max3_f32 v158, v158, v24, v25
    v_max3_f32 v159, v159, v26, v27
    v_max3_f32 v158, v158, v28, v29
    v_max3_f32 v159, v159, v30, v31
    v_mfma_f32_32x32x16_bf16 v[16:31], a[52:55], v[96:99], 0
    v_max3_f32 v158, v158, v32, v33
    v_max3_f32 v159, v159, v34, v35
    v_max3_f32 v158, v158, v36, v37
    v_max3_f32 v159, v159, v38, v39
    v_max3_f32 v158, v158, v40, v41
    v_max3_f32 v159, v159, v42, v43
    v_max3_f32 v158, v158, v44, v45
    v_max3_f32 v159, v159, v46, v47
    v_mfma_f32_32x32x16_bf16 v[32:47], a[56:59], v[96:99], 0
    v_max3_f32 v158, v158, v0, v1
    v_max3_f32 v159, v159, v2, v3
    v_max3_f32 v158, v158, v4, v5
    v_max3_f32 v159, v159, v6, v7
    v_max3_f32 v158, v158, v8, v9
    v_max3_f32 v159, v159, v10, v11
    v_max3_f32 v158, v158, v12, v13
    v_max3_f32 v159, v159, v14, v15
    v_mfma_f32_32x32x16_bf16 v[0:15], a[60:63], v[96:99], 0
    v_max3_f32 v158, v158, v16, v17
    v_max3_f32 v159, v159, v18, v19
    v_max3_f32 v158, v158, v20, v21
    v_max3_f32 v159, v159, v22, v23
    v_max3_f32 v158, v158, v24, v25
    v_max3_f32 v159, v159, v26, v27
    v_max3_f32 v158, v158, v28, v29
    v_max3_f32 v159, v159, v30, v31
    v_max3_f32 v158, v158, v32, v33
    v_max3_f32 v159, v159, v34, v35
    v_max3_f32 v158, v158, v36, v37
    v_max3_f32 v159, v159, v38, v39
    v_max3_f32 v158, v158, v40, v41
    v_max3_f32 v159, v159, v42, v43
    v_max3_f32 v158, v158, v44, v45
    v_max3_f32 v159, v159, v46, v47
    v_max3_f32 v158, v158, v0, v1
    v_max3_f32 v159, v159, v2, v3
    v_max3_f32 v158, v158, v4, v5
    v_max3_f32 v159, v159, v6, v7
    v_max3_f32 v158, v158, v8, v9
    v_max3_f32 v159, v159, v10, v11
    v_max3_f32 v158, v158, v12, v13
    v_max3_f32 v159, v159, v14, v15
    v_max_f32 v158, v158, v159
    v_mov_b32 v159, v158
    s_nop 1
    v_permlane32_swap_b32 v158, v159
    v_max_f32 v158, v158, v159
    v_sub_f32 v48, 0, v158
    v_mov_b32 v49, v48
    v_mov_b64 v[50:51], v[48:49]
    v_mov_b64 v[52:53], v[48:49]
    v_mov_b64 v[54:55], v[48:49]
    v_mov_b64 v[56:57], v[48:49]
    v_mov_b64 v[58:59], v[48:49]
    v_mov_b64 v[60:61], v[48:49]
    v_mov_b64 v[62:63], v[48:49]
    s_nop 1
    v_mfma_f32_32x32x16_bf16 v[0:15], a[0:3], v[96:99], v[48:63]
    v_mfma_f32_32x32x16_bf16 v[16:31], a[4:7], v[96:99], v[48:63]
    s_cmp_eq_u32 s56, 0
    s_cbranch_scc1 L_at_np
    s_waitcnt vmcnt(1)
    v_mov_b32 v156, s35
    s_mov_b64 exec, 1
    global_store_dword v155, v156, s[52:53] sc1
    s_mov_b64 exec, -1
    s_mov_b32 s56, 0
L_at_np:
    s_nop 8
    v_exp_f32 v0, v0
    v_exp_f32 v1, v1
    v_exp_f32 v2, v2
    v_exp_f32 v3, v3
    v_exp_f32 v4, v4
    v_exp_f32 v5, v5
    v_mfma_f32_32x32x16_bf16 v[32:47], a[8:11], v[96:99], v[48:63]
    v_exp_f32 v6, v6
    v_exp_f32 v7, v7
    v_exp_f32 v8, v8
    v_exp_f32 v9, v9
    v_cvt_pk_bf16_f32 v64, v0, v1
    v_cvt_pk_bf16_f32 v65, v2, v3
    v_cvt_pk_bf16_f32 v66, v4, v5
    v_cvt_pk_bf16_f32 v67, v6, v7
    v_exp_f32 v10, v10
    v_exp_f32 v11, v11
    v_mfma_f32_32x32x16_bf16 v[80:95], a[128:131], v[64:67], 0
    v_exp_f32 v12, v12
    v_exp_f32 v13, v13
    v_exp_f32 v14, v14
    v_exp_f32 v15, v15
    v_cvt_pk_bf16_f32 v68, v8, v9
    v_cvt_pk_bf16_f32 v69, v10, v11
    v_cvt_pk_bf16_f32 v70, v12, v13
    v_cvt_pk_bf16_f32 v71, v14, v15
    v_exp_f32 v16, v16
    v_exp_f32 v17, v17
    v_mfma_f32_32x32x16_bf16 v[80:95], a[132:135], v[68:71], v[80:95]
    v_exp_f32 v18, v18
    v_exp_f32 v19, v19
    v_exp_f32 v20, v20
    v_exp_f32 v21, v21
    v_mfma_f32_32x32x16_bf16 v[0:15], a[12:15], v[96:99], v[48:63]
    v_exp_f32 v22, v22
    v_exp_f32 v23, v23
    v_exp_f32 v24, v24
    v_exp_f32 v25, v25
    v_cvt_pk_bf16_f32 v72, v16, v17
    v_cvt_pk_bf16_f32 v73, v18, v19
    v_cvt_pk_bf16_f32 v74, v20, v21
    v_cvt_pk_bf16_f32 v75, v22, v23
    v_exp_f32 v26, v26
    v_exp_f32 v27, v27
    v_mfma_f32_32x32x16_bf16 v[80:95], a[136:139], v[72:75], v[80:95]
    v_exp_f32 v28, v28
    v_exp_f32 v29, v29
    v_exp_f32 v30, v30
    v_exp_f32 v31, v31
    v_cvt_pk_bf16_f32 v76, v24, v25
    v_cvt_pk_bf16_f32 v77, v26, v27
    v_cvt_pk_bf16_f32 v78, v28, v29
    v_cvt_pk_bf16_f32 v79, v30, v31
    v_exp_f32 v32, v32
    v_exp_f32 v33, v33
    v_mfma_f32_32x32x16_bf16 v[80:95], a[140:143], v[76:79], v[80:95]
    v_exp_f32 v34, v34
    v_exp_f32 v35, v35
    v_exp_f32 v36, v36
    v_exp_f32 v37, v37
    v_mfma_f32_32x32x16_bf16 v[16:31], a[16:19], v[96:99], v[48:63]
    v_exp_f32 v38, v38
    v_exp_f32 v39, v39
    v_exp_f32 v40, v40
    v_exp_f32 v41, v41
    v_cvt_pk_bf16_f32 v64, v32, v33
    v_cvt_pk_bf16_f32 v65, v34, v35
    v_cvt_pk_bf16_f32 v66, v36, v37
    v_cvt_pk_bf16_f32 v67, v38, v39
    v_exp_f32 v42, v42
    v_exp_f32 v43, v43
    v_mfma_f32_32x32x16_bf16 v[80:95], a[144:147], v[64:67], v[80:95]
    v_exp_f32 v44, v44
    v_exp_f32 v45, v45
    v_exp_f32 v46, v46
    v_exp_f32 v47, v47
    v_cvt_pk_bf16_f32 v68, v40, v41
    v_cvt_pk_bf16_f32 v69, v42, v43
    v_cvt_pk_bf16_f32 v70, v44, v45
    v_cvt_pk_bf16_f32 v71, v46, v47
    v_exp_f32 v0, v0
    v_exp_f32 v1, v1
    v_mfma_f32_32x32x16_bf16 v[80:95], a[148:151], v[68:71], v[80:95]
    v_exp_f32 v2, v2
    v_exp_f32 v3, v3
    v_exp_f32 v4, v4
    v_exp_f32 v5, v5
    v_mfma_f32_32x32x16_bf16 v[32:47], a[20:23], v[96:99], v[48:63]
    v_exp_f32 v6, v6
    v_exp_f32 v7, v7
    v_exp_f32 v8, v8
    v_exp_f32 v9, v9
    v_cvt_pk_bf16_f32 v72, v0, v1
    v_cvt_pk_bf16_f32 v73, v2, v3
    v_cvt_pk_bf16_f32 v74, v4, v5
    v_cvt_pk_bf16_f32 v75, v6, v7
    v_exp_f32 v10, v10
    v_exp_f32 v11, v11
    v_mfma_f32_32x32x16_bf16 v[80:95], a[152:155], v[72:75], v[80:95]
    v_exp_f32 v12, v12
    v_exp_f32 v13, v13
    v_exp_f32 v14, v14
    v_exp_f32 v15, v15
    v_cvt_pk_bf16_f32 v76, v8, v9
    v_cvt_pk_bf16_f32 v77, v10, v11
    v_cvt_pk_bf16_f32 v78, v12, v13
    v_cvt_pk_bf16_f32 v79, v14, v15
    v_exp_f32 v16, v16
    v_exp_f32 v17, v17
    v_mfma_f32_32x32x16_bf16 v[80:95], a[156:159], v[76:79], v[80:95]
    v_exp_f32 v18, v18
    v_exp_f32 v19, v19
    v_exp_f32 v20, v20
    v_exp_f32 v21, v21
    v_mfma_f32_32x32x16_bf16 v[0:15], a[24:27], v[96:99], v[48:63]
    v_exp_f32 v22, v22
    v_exp_f32 v23, v23
    v_exp_f32 v24, v24
    v_exp_f32 v25, v25
    v_cvt_pk_bf16_f32 v64, v16, v17
    v_cvt_pk_bf16_f32 v65, v18, v19
    v_cvt_pk_bf16_f32 v66, v20, v21
    v_cvt_pk_bf16_f32 v67, v22, v23
    v_exp_f32 v26, v26
    v_exp_f32 v27, v27
    v_mfma_f32_32x32x16_bf16 v[80:95], a[160:163], v[64:67], v[80:95]
    v_exp_f32 v28, v28
    v_exp_f32 v29, v29
    v_exp_f32 v30, v30
    v_exp_f32 v31, v31
    v_cvt_pk_bf16_f32 v68, v24, v25
    v_cvt_pk_bf16_f32 v69, v26, v27
    v_cvt_pk_bf16_f32 v70, v28, v29
    v_cvt_pk_bf16_f32 v71, v30, v31
    v_exp_f32 v32, v32
    v_exp_f32 v33, v33
    v_mfma_f32_32x32x16_bf16 v[80:95], a[164:167], v[68:71], v[80:95]
    v_exp_f32 v34, v34
    v_exp_f32 v35, v35
    v_exp_f32 v36, v36
    v_exp_f32 v37, v37
    v_mfma_f32_32x32x16_bf16 v[16:31], a[28:31], v[96:99], v[48:63]
    v_exp_f32 v38, v38
    v_exp_f32 v39, v39
    v_exp_f32 v40, v40
    v_exp_f32 v41, v41
    v_cvt_pk_bf16_f32 v72, v32, v33
    v_cvt_pk_bf16_f32 v73, v34, v35
    v_cvt_pk_bf16_f32 v74, v36, v37
    v_cvt_pk_bf16_f32 v75, v38, v39
    v_exp_f32 v42, v42
    v_exp_f32 v43, v43
    v_mfma_f32_32x32x16_bf16 v[80:95], a[168:171], v[72:75], v[80:95]
    v_exp_f32 v44, v44
    v_exp_f32 v45, v45
    v_exp_f32 v46, v46
    v_exp_f32 v47, v47
    v_cvt_pk_bf16_f32 v76, v40, v41
    v_cvt_pk_bf16_f32 v77, v42, v43
    v_cvt_pk_bf16_f32 v78, v44, v45
    v_cvt_pk_bf16_f32 v79, v46, v47
    v_exp_f32 v0, v0
    v_exp_f32 v1, v1
    v_mfma_f32_32x32x16_bf16 v[80:95], a[172:175], v[76:79], v[80:95]
    v_exp_f32 v2, v2
    v_exp_f32 v3, v3
    v_exp_f32 v4, v4
    v_exp_f32 v5, v5
    v_mfma_f32_32x32x16_bf16 v[32:47], a[32:35], v[96:99], v[48:63]
    v_exp_f32 v6, v6
    v_exp_f32 v7, v7
    v_exp_f32 v8, v8
    v_exp_f32 v9, v9
    v_cvt_pk_bf16_f32 v64, v0, v1
    v_cvt_pk_bf16_f32 v65, v2, v3
    v_cvt_pk_bf16_f32 v66, v4, v5
    v_cvt_pk_bf16_f32 v67, v6, v7
    v_exp_f32 v10, v10
    v_exp_f32 v11, v11
    v_mfma_f32_32x32x16_bf16 v[80:95], a[176:179], v[64:67], v[80:95]
    v_exp_f32 v12, v12
    v_exp_f32 v13, v13
    v_exp_f32 v14, v14
    v_exp_f32 v15, v15
    v_cvt_pk_bf16_f32 v68, v8, v9
    v_cvt_pk_bf16_f32 v69, v10, v11
    v_cvt_pk_bf16_f32 v70, v12, v13
    v_cvt_pk_bf16_f32 v71, v14, v15
    v_exp_f32 v16, v16
    v_exp_f32 v17, v17
    v_mfma_f32_32x32x16_bf16 v[80:95], a[180:183], v[68:71], v[80:95]
    v_exp_f32 v18, v18
    v_exp_f32 v19, v19
    v_exp_f32 v20, v20
    v_exp_f32 v21, v21
    v_mfma_f32_32x32x16_bf16 v[0:15], a[36:39], v[96:99], v[48:63]
    v_exp_f32 v22, v22
    v_exp_f32 v23, v23
    v_exp_f32 v24, v24
    v_exp_f32 v25, v25
    v_cvt_pk_bf16_f32 v72, v16, v17
    v_cvt_pk_bf16_f32 v73, v18, v19
    v_cvt_pk_bf16_f32 v74, v20, v21
    v_cvt_pk_bf16_f32 v75, v22, v23
    v_exp_f32 v26, v26
    v_exp_f32 v27, v27
    v_mfma_f32_32x32x16_bf16 v[80:95], a[184:187], v[72:75], v[80:95]
    v_exp_f32 v28, v28
    v_exp_f32 v29, v29
    v_exp_f32 v30, v30
    v_exp_f32 v31, v31
    v_cvt_pk_bf16_f32 v76, v24, v25
    v_cvt_pk_bf16_f32 v77, v26, v27
    v_cvt_pk_bf16_f32 v78, v28, v29
    v_cvt_pk_bf16_f32 v79, v30, v31
    v_exp_f32 v32, v32
    v_exp_f32 v33, v33
    v_mfma_f32_32x32x16_bf16 v[80:95], a[188:191], v[76:79], v[80:95]
    v_exp_f32 v34, v34
    v_exp_f32 v35, v35
    v_exp_f32 v36, v36
    v_exp_f32 v37, v37
    v_mfma_f32_32x32x16_bf16 v[16:31], a[40:43], v[96:99], v[48:63]
    v_exp_f32 v38, v38
    v_exp_f32 v39, v39
    v_exp_f32 v40, v40
    v_exp_f32 v41, v41
    v_cvt_pk_bf16_f32 v64, v32, v33
    v_cvt_pk_bf16_f32 v65, v34, v35
    v_cvt_pk_bf16_f32 v66, v36, v37
    v_cvt_pk_bf16_f32 v67, v38, v39
    v_exp_f32 v42, v42
    v_exp_f32 v43, v43
    v_mfma_f32_32x32x16_bf16 v[80:95], a[192:195], v[64:67], v[80:95]
    v_exp_f32 v44, v44
    v_exp_f32 v45, v45
    v_exp_f32 v46, v46
    v_exp_f32 v47, v47
    v_cvt_pk_bf16_f32 v68, v40, v41
    v_cvt_pk_bf16_f32 v69, v42, v43
    v_cvt_pk_bf16_f32 v70, v44, v45
    v_cvt_pk_bf16_f32 v71, v46, v47
    v_exp_f32 v0, v0
    v_exp_f32 v1, v1
    v_mfma_f32_32x32x16_bf16 v[80:95], a[196:199], v[68:71], v[80:95]
    v_exp_f32 v2, v2
    v_exp_f32 v3, v3
    v_exp_f32 v4, v4
    v_exp_f32 v5, v5
    v_mfma_f32_32x32x16_bf16 v[32:47], a[44:47], v[96:99], v[48:63]
    v_exp_f32 v6, v6
    v_exp_f32 v7, v7
    v_exp_f32 v8, v8
    v_exp_f32 v9, v9
    v_cvt_pk_bf16_f32 v72, v0, v1
    v_cvt_pk_bf16_f32 v73, v2, v3
    v_cvt_pk_bf16_f32 v74, v4, v5
    v_cvt_pk_bf16_f32 v75, v6, v7
    v_exp_f32 v10, v10
    v_exp_f32 v11, v11
    v_mfma_f32_32x32x16_bf16 v[80:95], a[200:203], v[72:75], v[80:95]
    v_exp_f32 v12, v12
    v_exp_f32 v13, v13
    v_exp_f32 v14, v14
    v_exp_f32 v15, v15
    v_cvt_pk_bf16_f32 v76, v8, v9
    v_cvt_pk_bf16_f32 v77, v10, v11
    v_cvt_pk_bf16_f32 v78, v12, v13
    v_cvt_pk_bf16_f32 v79, v14, v15
    v_exp_f32 v16, v16
    v_exp_f32 v17, v17
    v_mfma_f32_32x32x16_bf16 v[80:95], a[204:207], v[76:79], v[80:95]
    v_exp_f32 v18, v18
    v_exp_f32 v19, v19
    v_exp_f32 v20, v20
    v_exp_f32 v21, v21
    v_mfma_f32_32x32x16_bf16 v[0:15], a[48:51], v[96:99], v[48:63]
    v_exp_f32 v22, v22
    v_exp_f32 v23, v23
    v_exp_f32 v24, v24
    v_exp_f32 v25, v25
    v_cvt_pk_bf16_f32 v64, v16, v17
    v_cvt_pk_bf16_f32 v65, v18, v19
    v_cvt_pk_bf16_f32 v66, v20, v21
    v_cvt_pk_bf16_f32 v67, v22, v23
    v_exp_f32 v26, v26
    v_exp_f32 v27, v27
    v_mfma_f32_32x32x16_bf16 v[80:95], a[208:211], v[64:67], v[80:95]
    v_exp_f32 v28, v28
    v_exp_f32 v29, v29
    v_exp_f32 v30, v30
    v_exp_f32 v31, v31
    v_cvt_pk_bf16_f32 v68, v24, v25
    v_cvt_pk_bf16_f32 v69, v26, v27
    v_cvt_pk_bf16_f32 v70, v28, v29
    v_cvt_pk_bf16_f32 v71, v30, v31
    v_exp_f32 v32, v32
    v_exp_f32 v33, v33
    v_mfma_f32_32x32x16_bf16 v[80:95], a[212:215], v[68:71], v[80:95]
    v_exp_f32 v34, v34
    v_exp_f32 v35, v35
    v_exp_f32 v36, v36
    v_exp_f32 v37, v37
    v_mfma_f32_32x32x16_bf16 v[16:31], a[52:55], v[96:99], v[48:63]
    v_exp_f32 v38, v38
    v_exp_f32 v39, v39
    v_exp_f32 v40, v40
    v_exp_f32 v41, v41
    v_cvt_pk_bf16_f32 v72, v32, v33
    v_cvt_pk_bf16_f32 v73, v34, v35
    v_cvt_pk_bf16_f32 v74, v36, v37
    v_cvt_pk_bf16_f32 v75, v38, v39
    v_exp_f32 v42, v42
    v_exp_f32 v43, v43
    v_mfma_f32_32x32x16_bf16 v[80:95], a[216:219], v[72:75], v[80:95]
    v_exp_f32 v44, v44
    v_exp_f32 v45, v45
    v_exp_f32 v46, v46
    v_exp_f32 v47, v47
    v_cvt_pk_bf16_f32 v76, v40, v41
    v_cvt_pk_bf16_f32 v77, v42, v43
    v_cvt_pk_bf16_f32 v78, v44, v45
    v_cvt_pk_bf16_f32 v79, v46, v47
    v_exp_f32 v0, v0
    v_exp_f32 v1, v1
    v_mfma_f32_32x32x16_bf16 v[80:95], a[220:223], v[76:79], v[80:95]
    v_exp_f32 v2, v2
    v_exp_f32 v3, v3
    v_exp_f32 v4, v4
    v_exp_f32 v5, v5
    v_mfma_f32_32x32x16_bf16 v[32:47], a[56:59], v[96:99], v[48:63]
    v_exp_f32 v6, v6
    v_exp_f32 v7, v7
    v_exp_f32 v8, v8
    v_exp_f32 v9, v9
    v_cvt_pk_bf16_f32 v64, v0, v1
    v_cvt_pk_bf16_f32 v65, v2, v3
    v_cvt_pk_bf16_f32 v66, v4, v5
    v_cvt_pk_bf16_f32 v67, v6, v7
    v_exp_f32 v10, v10
    v_exp_f32 v11, v11
    v_mfma_f32_32x32x16_bf16 v[80:95], a[224:227], v[64:67], v[80:95]
    v_exp_f32 v12, v12
    v_exp_f32 v13, v13
    v_exp_f32 v14, v14
    v_exp_f32 v15, v15
    v_cvt_pk_bf16_f32 v68, v8, v9
    v_cvt_pk_bf16_f32 v69, v10, v11
    v_cvt_pk_bf16_f32 v70, v12, v13
    v_cvt_pk_bf16_f32 v71, v14, v15
    v_exp_f32 v16, v16
    v_exp_f32 v17, v17
    v_mfma_f32_32x32x16_bf16 v[80:95], a[228:231], v[68:71], v[80:95]
    v_exp_f32 v18, v18
    v_exp_f32 v19, v19
    v_exp_f32 v20, v20
    v_exp_f32 v21, v21
    v_mfma_f32_32x32x16_bf16 v[0:15], a[60:63], v[96:99], v[48:63]
    v_exp_f32 v22, v22
    v_exp_f32 v23, v23
    v_exp_f32 v24, v24
    v_exp_f32 v25, v25
    v_cvt_pk_bf16_f32 v72, v16, v17
    v_cvt_pk_bf16_f32 v73, v18, v19
    v_cvt_pk_bf16_f32 v74, v20, v21
    v_cvt_pk_bf16_f32 v75, v22, v23
    v_exp_f32 v26, v26
    v_exp_f32 v27, v27
    v_mfma_f32_32x32x16_bf16 v[80:95], a[232:235], v[72:75], v[80:95]
    v_exp_f32 v28, v28
    v_exp_f32 v29, v29
    v_exp_f32 v30, v30
    v_exp_f32 v31, v31
    v_cvt_pk_bf16_f32 v76, v24, v25
    v_cvt_pk_bf16_f32 v77, v26, v27
    v_cvt_pk_bf16_f32 v78, v28, v29
    v_cvt_pk_bf16_f32 v79, v30, v31
    v_exp_f32 v32, v32
    v_exp_f32 v33, v33
    v_mfma_f32_32x32x16_bf16 v[80:95], a[236:239], v[76:79], v[80:95]
    v_exp_f32 v34, v34
    v_exp_f32 v35, v35
    v_exp_f32 v36, v36
    v_exp_f32 v37, v37
    v_exp_f32 v38, v38
    v_exp_f32 v39, v39
    v_exp_f32 v40, v40
    v_exp_f32 v41, v41
    v_cvt_pk_bf16_f32 v64, v32, v33
    v_cvt_pk_bf16_f32 v65, v34, v35
    v_cvt_pk_bf16_f32 v66, v36, v37
    v_cvt_pk_bf16_f32 v67, v38, v39
    v_exp_f32 v42, v42
    v_exp_f32 v43, v43
    v_mfma_f32_32x32x16_bf16 v[80:95], a[240:243], v[64:67], v[80:95]
    v_exp_f32 v44, v44
    v_exp_f32 v45, v45
    v_exp_f32 v46, v46
    v_exp_f32 v47, v47
    v_cvt_pk_bf16_f32 v68, v40, v41
    v_cvt_pk_bf16_f32 v69, v42, v43
    v_cvt_pk_bf16_f32 v70, v44, v45
    v_cvt_pk_bf16_f32 v71, v46, v47
    v_exp_f32 v0, v0
    v_exp_f32 v1, v1
    v_mfma_f32_32x32x16_bf16 v[80:95], a[244:247], v[68:71], v[80:95]
    v_exp_f32 v2, v2
    v_exp_f32 v3, v3
    v_exp_f32 v4, v4
    v_exp_f32 v5, v5
    v_exp_f32 v6, v6
    v_exp_f32 v7, v7
    v_exp_f32 v8, v8
    v_exp_f32 v9, v9
    v_cvt_pk_bf16_f32 v72, v0, v1
    v_cvt_pk_bf16_f32 v73, v2, v3
    v_cvt_pk_bf16_f32 v74, v4, v5
    v_cvt_pk_bf16_f32 v75, v6, v7
    v_exp_f32 v10, v10
    v_exp_f32 v11, v11
    v_mfma_f32_32x32x16_bf16 v[80:95], a[248:251], v[72:75], v[80:95]
    v_exp_f32 v12, v12
    v_exp_f32 v13, v13
    v_exp_f32 v14, v14
    v_exp_f32 v15, v15
    v_cvt_pk_bf16_f32 v76, v8, v9
    v_cvt_pk_bf16_f32 v77, v10, v11
    v_cvt_pk_bf16_f32 v78, v12, v13
    v_cvt_pk_bf16_f32 v79, v14, v15
    s_nop 1
    v_mfma_f32_32x32x16_bf16 v[80:95], a[252:255], v[76:79], v[80:95]
    s_branch L_at_merge
L_at_second:
    v_mov_b32 v80, v120
    v_mov_b32 v81, v121
    v_mov_b32 v82, v122
    v_mov_b32 v83, v123
    v_mov_b32 v84, v124
    v_mov_b32 v85, v125
    v_mov_b32 v86, v126
    v_mov_b32 v87, v127
    v_mov_b32 v88, v128
    v_mov_b32 v48, v129
    s_mov_b32 s56, 0
    s_mov_b32 s57, 3
L_at_dp_ok:
    v_mfma_f32_32x32x16_bf16 v[0:15], a[60:63], v[96:99], 0
    v_sub_f32 v158, 0, v48
    v_mov_b32 v159, v158
    s_nop 9
    v_max3_f32 v158, v158, v0, v1
    v_max3_f32 v159, v159, v2, v3
    v_max3_f32 v158, v158, v4, v5
    v_max3_f32 v159, v159, v6, v7
    v_max3_f32 v158, v158, v8, v9
    v_max3_f32 v159, v159, v10, v11
    v_max3_f32 v158, v158, v12, v13
    v_max3_f32 v159, v159, v14, v15
    v_max_f32 v158, v158, v159
    v_mov_b32 v159, v158
    s_nop 1
    v_permlane32_swap_b32 v158, v159
    v_max_f32 v158, v158, v159
    v_add_f32 v159, v48, v158
    v_sub_f32 v0, v0, v158
    v_sub_f32 v1, v1, v158
    v_sub_f32 v2, v2, v158
    v_sub_f32 v3, v3, v158
    v_sub_f32 v4, v4, v158
    v_sub_f32 v5, v5, v158
    v_sub_f32 v6, v6, v158
    v_sub_f32 v7, v7, v158
    v_sub_f32 v8, v8, v158
    v_sub_f32 v9, v9, v158
    v_sub_f32 v10, v10, v158
    v_sub_f32 v11, v11, v158
    v_sub_f32 v12, v12, v158
    v_sub_f32 v13, v13, v158
    v_sub_f32 v14, v14, v158
    v_sub_f32 v15, v15, v158
    v_exp_f32 v159, -v159
    v_exp_f32 v0, v0
    v_exp_f32 v1, v1
    v_exp_f32 v2, v2
    v_exp_f32 v3, v3
    v_exp_f32 v4, v4
    v_exp_f32 v5, v5
    v_exp_f32 v6, v6
    v_exp_f32 v7, v7
    v_exp_f32 v8, v8
    v_exp_f32 v9, v9
    v_exp_f32 v10, v10
    v_exp_f32 v11, v11
    v_exp_f32 v12, v12
    v_exp_f32 v13, v13
    v_exp_f32 v14, v14
    v_exp_f32 v15, v15
    v_mul_f32 v80, v80, v159
    v_mul_f32 v81, v81, v159
    v_mul_f32 v82, v82, v159
    v_mul_f32 v83, v83, v159
    v_mul_f32 v84, v84, v159
    v_mul_f32 v85, v85, v159
    v_mul_f32 v86, v86, v159
    v_mul_f32 v87, v87, v159
    v_mul_f32 v88, v88, v159
    v_cvt_pk_bf16_f32 v72, v0, v1
    v_cvt_pk_bf16_f32 v73, v2, v3
    v_cvt_pk_bf16_f32 v74, v4, v5
    v_cvt_pk_bf16_f32 v75, v6, v7
    v_cvt_pk_bf16_f32 v76, v8, v9
    v_cvt_pk_bf16_f32 v77, v10, v11
    v_cvt_pk_bf16_f32 v78, v12, v13
    v_cvt_pk_bf16_f32 v79, v14, v15
    v_mfma_f32_32x32x16_bf16 v[80:95], a[248:251], v[72:75], v[80:95]
    s_nop 0
    v_mfma_f32_32x32x16_bf16 v[80:95], a[252:255], v[76:79], v[80:95]
L_at_merge:
    s_and_b32 s80, s35, 1
    s_mul_i32 s80, s80, 12288
    v_add_u32 v157, s80, v153
    v_add_u32 v154, s80, v150
    s_nop 7
    v_mov_b32 v89, v158
    ds_write_b128 v157, v[80:83] offset:0
    ds_write_b128 v157, v[84:87] offset:1024
    ds_write_b128 v157, v[88:91] offset:2048
    s_waitcnt vmcnt(0)
    v_mov_b64 v[96:97], v[100:101]
    v_mov_b64 v[98:99], v[102:103]
    s_waitcnt lgkmcnt(0)
    s_barrier
    s_and_b32 s80, s35, 3
    s_cmp_lg_u32 s80, s31
    s_cbranch_scc1 L_at_nomg
    ds_read_b128 v[0:3], v154 offset:0
    ds_read_b128 v[4:7], v154 offset:1024
    ds_read_b128 v[8:11], v154 offset:2048
    ds_read_b128 v[12:15], v154 offset:3072
    ds_read_b128 v[16:19], v154 offset:4096
    ds_read_b128 v[20:23], v154 offset:5120
    ds_read_b128 v[24:27], v154 offset:6144
    ds_read_b128 v[28:31], v154 offset:7168
    ds_read_b128 v[32:35], v154 offset:8192
    ds_read_b128 v[36:39], v154 offset:9216
    ds_read_b128 v[40:43], v154 offset:10240
    ds_read_b128 v[44:47], v154 offset:11264
    s_waitcnt lgkmcnt(0)
    v_max3_f32 v158, v9, v21, v33
    v_max_f32 v158, v158, v45
    v_sub_f32 v9, v9, v158
    v_sub_f32 v21, v21, v158
    v_sub_f32 v33, v33, v158
    v_sub_f32 v45, v45, v158
    v_exp_f32 v9, v9
    v_exp_f32 v21, v21
    v_exp_f32 v33, v33
    v_exp_f32 v45, v45
    v_mul_f32 v8, v8, v9
    v_fmac_f32 v8, v20, v21
    v_fmac_f32 v8, v32, v33
    v_fmac_f32 v8, v44, v45
    v_rcp_f32 v158, v8
    v_pk_mul_f32 v[0:1], v[0:1], v[8:9] op_sel:[0,1] op_sel_hi:[1,1]
    v_pk_mul_f32 v[2:3], v[2:3], v[8:9] op_sel:[0,1] op_sel_hi:[1,1]
    v_pk_mul_f32 v[4:5], v[4:5], v[8:9] op_sel:[0,1] op_sel_hi:[1,1]
    v_pk_mul_f32 v[6:7], v[6:7], v[8:9] op_sel:[0,1] op_sel_hi:[1,1]
    v_pk_fma_f32 v[0:1], v[12:13], v[20:21], v[0:1] op_sel:[0,1,0] op_sel_hi:[1,1,1]
    v_pk_fma_f32 v[2:3], v[14:15], v[20:21], v[2:3] op_sel:[0,1,0] op_sel_hi:[1,1,1]
    v_pk_fma_f32 v[4:5], v[16:17], v[20:21], v[4:5] op_sel:[0,1,0] op_sel_hi:[1,1,1]
    v_pk_fma_f32 v[6:7], v[18:19], v[20:21], v[6:7] op_sel:[0,1,0] op_sel_hi:[1,1,1]
    v_pk_fma_f32 v[0:1], v[24:25], v[32:33], v[0:1] op_sel:[0,1,0] op_sel_hi:[1,1,1]
    v_pk_fma_f32 v[2:3], v[26:27], v[32:33], v[2:3] op_sel:[0,1,0] op_sel_hi:[1,1,1]
    v_pk_fma_f32 v[4:5], v[28:29], v[32:33], v[4:5] op_sel:[0,1,0] op_sel_hi:[1,1,1]
    v_pk_fma_f32 v[6:7], v[30:31], v[32:33], v[6:7] op_sel:[0,1,0] op_sel_hi:[1,1,1]
    v_pk_fma_f32 v[0:1], v[36:37], v[44:45], v[0:1] op_sel:[0,1,0] op_sel_hi:[1,1,1]
    v_pk_fma_f32 v[2:3], v[38:39], v[44:45], v[2:3] op_sel:[0,1,0] op_sel_hi:[1,1,1]
    v_pk_fma_f32 v[4:5], v[40:41], v[44:45], v[4:5] op_sel:[0,1,0] op_sel_hi:[1,1,1]
    v_pk_fma_f32 v[6:7], v[42:43], v[44:45], v[6:7] op_sel:[0,1,0] op_sel_hi:[1,1,1]
    v_pk_mul_f32 v[0:1], v[0:1], v[158:159] op_sel_hi:[1,0]
    v_pk_mul_f32 v[2:3], v[2:3], v[158:159] op_sel_hi:[1,0]
    v_pk_mul_f32 v[4:5], v[4:5], v[158:159] op_sel_hi:[1,0]
    v_pk_mul_f32 v[6:7], v[6:7], v[158:159] op_sel_hi:[1,0]
    v_cvt_pk_bf16_f32 v64, v0, v1
    v_cvt_pk_bf16_f32 v65, v2, v3
    v_cvt_pk_bf16_f32 v66, v4, v5
    v_cvt_pk_bf16_f32 v67, v6, v7
    v_min_u32 v64, -2, v64
    v_min_u32 v65, -2, v65
    v_min_u32 v66, -2, v66
    v_min_u32 v67, -2, v67
    global_store_dwordx4 v150, v[64:67], s[44:45] sc1
    s_mov_b32 s56, 1
L_at_nomg:
    s_add_u32 s44, s44, 0x10000
    s_addc_u32 s45, s45, 0
    s_add_u32 s35, s35, 1
    s_add_u32 s33, s33, 2
    s_cmp_lt_u32 s33, 64
    s_cbranch_scc1 L_at_loop
    s_cmp_eq_u32 s56, 0
    s_cbranch_scc1 L_at_np2
    s_waitcnt vmcnt(0)
    v_mov_b32 v156, s35
    s_mov_b64 exec, 1
    global_store_dword v155, v156, s[52:53] sc1
    s_mov_b64 exec, -1
    s_mov_b32 s56, 0
L_at_np2:
    s_cmp_lg_u32 s34, 0
    s_cbranch_scc1 L_at_end
    s_mov_b32 s34, 1
    s_lshl_b32 s80, s37, 5
    s_add_u32 s80, s80, s30
    s_cmp_ge_u32 s80, 60
    s_cbranch_scc1 L_at_layer
    s_mul_i32 s33, s80, 43
    s_lshr_b32 s33, s33, 9
    s_mul_i32 s81, s33, 12
    s_sub_u32 s80, s80, s81
    s_mov_b32 s52, 5
    s_mov_b32 s53, 30
    s_waitcnt vmcnt(0)
    s_barrier
    s_branch L_qkva2
L_at_end:
    s_endpgm
L_at_poll:
    global_load_dword v158, v151, s[46:47] sc1
    global_load_dword v159, v160, s[46:47] sc1
    global_load_dword v157, v151, s[46:47] offset:-4096 sc1
    s_add_u32 s58, s58, 4
    s_addc_u32 s59, s59, 0
    s_waitcnt vmcnt(0)
    v_and_b32 v158, v158, v159
    s_movk_i32 s83, 0x0101
    v_cmp_eq_u32 s[48:49], s83, v157
    v_cmp_eq_u32 s[50:51], s83, v158
    s_sub_u32 s62, s62, 1
    s_cbranch_scc0 L_at_ret
    s_movk_i32 s63, 13
    s_branch L_fail_far
L_at_ret:
    s_setpc_b64 s[58:59]
L_xp:
    s_lshr_b32 s35, s30, 3
    s_bfe_u32 s81, s30, 0x20001
    s_lshl_b32 s80, s37, 2
    s_add_u32 s81, s81, s80
    s_lshl_b32 s36, s81, 2
    s_and_b32 s54, s30, 1
    s_lshl_b32 s55, s81, 1
    s_add_u32 s55, s55, s54
    s_add_u32 s36, s36, s31
    s_lshl_b32 s81, s81, 19
    s_lshl_b32 s82, s54, 9
    s_add_u32 s81, s81, s82
    s_add_u32 s70, s20, s81
    s_addc_u32 s71, s21, 0
    v_mov_b32 v161, 0x0
    v_bfe_u32 v160, v255, 5, 1
    v_lshl_add_u32 v161, v160, 10, v161
    v_bfe_u32 v160, v255, 6, 2
    v_lshl_add_u32 v161, v160, 14, v161
    v_mov_b32 v162, 0x0
    v_bfe_i32 v160, v255, 0, 1
    v_and_b32 v160, 0x10, v160
    v_xor_b32 v162, v162, v160
    v_bfe_i32 v160, v255, 1, 1
    v_and_b32 v160, 0x20, v160
    v_xor_b32 v162, v162, v160
    v_bfe_i32 v160, v255, 2, 1
    v_and_b32 v160, 0x40, v160
    v_xor_b32 v162, v162, v160
    v_bfe_i32 v160, v255, 3, 1
    v_and_b32 v160, 0x80, v160
    v_xor_b32 v162, v162, v160
    v_bfe_i32 v160, v255, 4, 1
    v_and_b32 v160, 0x100, v160
    v_xor_b32 v162, v162, v160
    v_bfe_i32 v160, v255, 5, 1
    v_and_b32 v160, 0x40, v160
    v_xor_b32 v162, v162, v160
    v_add_u32 v161, v161, v162
    v_mov_b32 v162, 0x800
    v_bfe_u32 v160, v255, 5, 1
    v_lshl_add_u32 v162, v160, 10, v162
    v_bfe_u32 v160, v255, 6, 2
    v_lshl_add_u32 v162, v160, 14, v162
    v_mov_b32 v163, 0x80
    v_bfe_i32 v160, v255, 0, 1
    v_and_b32 v160, 0x10, v160
    v_xor_b32 v163, v163, v160
    v_bfe_i32 v160, v255, 1, 1
    v_and_b32 v160, 0x20, v160
    v_xor_b32 v163, v163, v160
    v_bfe_i32 v160, v255, 2, 1
    v_and_b32 v160, 0x40, v160
    v_xor_b32 v163, v163, v160
    v_bfe_i32 v160, v255, 3, 1
    v_and_b32 v160, 0x80, v160
    v_xor_b32 v163, v163, v160
    v_bfe_i32 v160, v255, 4, 1
    v_and_b32 v160, 0x100, v160
    v_xor_b32 v163, v163, v160
    v_bfe_i32 v160, v255, 5, 1
    v_and_b32 v160, 0x40, v160
    v_xor_b32 v163, v163, v160
    v_add_u32 v162, v162, v163
    v_mov_b32 v163, 0x1000
    v_bfe_u32 v160, v255, 5, 1
    v_lshl_add_u32 v163, v160, 10, v163
    v_bfe_u32 v160, v255, 6, 2
    v_lshl_add_u32 v163, v160, 14, v163
    v_mov_b32 v164, 0x0
    v_bfe_i32 v160, v255, 0, 1
    v_and_b32 v160, 0x10, v160
    v_xor_b32 v164, v164, v160
    v_bfe_i32 v160, v255, 1, 1
    v_and_b32 v160, 0x20, v160
    v_xor_b32 v164, v164, v160
    v_bfe_i32 v160, v255, 2, 1
    v_and_b32 v160, 0x40, v160
    v_xor_b32 v164, v164, v160
    v_bfe_i32 v160, v255, 3, 1
    v_and_b32 v160, 0x80, v160
    v_xor_b32 v164, v164, v160
    v_bfe_i32 v160, v255, 4, 1
    v_and_b32 v160, 0x100, v160
    v_xor_b32 v164, v164, v160
    v_bfe_i32 v160, v255, 5, 1
    v_and_b32 v160, 0x40, v160
    v_xor_b32 v164, v164, v160
    v_add_u32 v163, v163, v164
    v_mov_b32 v164, 0x1800
    v_bfe_u32 v160, v255, 5, 1
    v_lshl_add_u32 v164, v160, 10, v164
    v_bfe_u32 v160, v255, 6, 2
    v_lshl_add_u32 v164, v160, 14, v164
    v_mov_b32 v165, 0x80
    v_bfe_i32 v160, v255, 0, 1
    v_and_b32 v160, 0x10, v160
    v_xor_b32 v165, v165, v160
    v_bfe_i32 v160, v255, 1, 1
    v_and_b32 v160, 0x20, v160
    v_xor_b32 v165, v165, v160
    v_bfe_i32 v160, v255, 2, 1
    v_and_b32 v160, 0x40, v160
    v_xor_b32 v165, v165, v160
    v_bfe_i32 v160, v255, 3, 1
    v_and_b32 v160, 0x80, v160
    v_xor_b32 v165, v165, v160
    v_bfe_i32 v160, v255, 4, 1
    v_and_b32 v160, 0x100, v160
    v_xor_b32 v165, v165, v160
    v_bfe_i32 v160, v255, 5, 1
    v_and_b32 v160, 0x40, v160
    v_xor_b32 v165, v165, v160
    v_add_u32 v164, v164, v165
    v_mov_b32 v165, 0x2000
    v_bfe_u32 v160, v255, 5, 1
    v_lshl_add_u32 v165, v160, 10, v165
    v_bfe_u32 v160, v255, 6, 2
    v_lshl_add_u32 v165, v160, 14, v165
    v_mov_b32 v166, 0x0
    v_bfe_i32 v160, v255, 0, 1
    v_and_b32 v160, 0x10, v160
    v_xor_b32 v166, v166, v160
    v_bfe_i32 v160, v255, 1, 1
    v_and_b32 v160, 0x20, v160
    v_xor_b32 v166, v166, v160
    v_bfe_i32 v160, v255, 2, 1
    v_and_b32 v160, 0x40, v160
    v_xor_b32 v166, v166, v160
    v_bfe_i32 v160, v255, 3, 1
    v_and_b32 v160, 0x80, v160
    v_xor_b32 v166, v166, v160
    v_bfe_i32 v160, v255, 4, 1
    v_and_b32 v160, 0x100, v160
    v_xor_b32 v166, v166, v160
    v_bfe_i32 v160, v255, 5, 1
    v_and_b32 v160, 0x40, v160
    v_xor_b32 v166, v166, v160
    v_add_u32 v165, v165, v166
    v_mov_b32 v166, 0x2800
    v_bfe_u32 v160, v255, 5, 1
    v_lshl_add_u32 v166, v160, 10, v166
    v_bfe_u32 v160, v255, 6, 2
    v_lshl_add_u32 v166, v160, 14, v166
    v_mov_b32 v167, 0x80
    v_bfe_i32 v160, v255, 0, 1
    v_and_b32 v160, 0x10, v160
    v_xor_b32 v167, v167, v160
    v_bfe_i32 v160, v255, 1, 1
    v_and_b32 v160, 0x20, v160
    v_xor_b32 v167, v167, v160
    v_bfe_i32 v160, v255, 2, 1
    v_and_b32 v160, 0x40, v160
    v_xor_b32 v167, v167, v160
    v_bfe_i32 v160, v255, 3, 1
    v_and_b32 v160, 0x80, v160
    v_xor_b32 v167, v167, v160
    v_bfe_i32 v160, v255, 4, 1
    v_and_b32 v160, 0x100, v160
    v_xor_b32 v167, v167, v160
    v_bfe_i32 v160, v255, 5, 1
    v_and_b32 v160, 0x40, v160
    v_xor_b32 v167, v167, v160
    v_add_u32 v166, v166, v167
    v_mov_b32 v167, 0x3000
    v_bfe_u32 v160, v255, 5, 1
    v_lshl_add_u32 v167, v160, 10, v167
    v_bfe_u32 v160, v255, 6, 2
    v_lshl_add_u32 v167, v160, 14, v167
    v_mov_b32 v168, 0x0
    v_bfe_i32 v160, v255, 0, 1
    v_and_b32 v160, 0x10, v160
    v_xor_b32 v168, v168, v160
    v_bfe_i32 v160, v255, 1, 1
    v_and_b32 v160, 0x20, v160
    v_xor_b32 v168, v168, v160
    v_bfe_i32 v160, v255, 2, 1
    v_and_b32 v160, 0x40, v160
    v_xor_b32 v168, v168, v160
    v_bfe_i32 v160, v255, 3, 1
    v_and_b32 v160, 0x80, v160
    v_xor_b32 v168, v168, v160
    v_bfe_i32 v160, v255, 4, 1
    v_and_b32 v160, 0x100, v160
    v_xor_b32 v168, v168, v160
    v_bfe_i32 v160, v255, 5, 1
    v_and_b32 v160, 0x40, v160
    v_xor_b32 v168, v168, v160
    v_add_u32 v167, v167, v168
    v_mov_b32 v168, 0x3800
    v_bfe_u32 v160, v255, 5, 1
    v_lshl_add_u32 v168, v160, 10, v168
    v_bfe_u32 v160, v255, 6, 2
    v_lshl_add_u32 v168, v160, 14, v168
    v_mov_b32 v169, 0x80
    v_bfe_i32 v160, v255, 0, 1
    v_and_b32 v160, 0x10, v160
    v_xor_b32 v169, v169, v160
    v_bfe_i32 v160, v255, 1, 1
    v_and_b32 v160, 0x20, v160
    v_xor_b32 v169, v169, v160
    v_bfe_i32 v160, v255, 2, 1
    v_and_b32 v160, 0x40, v160
    v_xor_b32 v169, v169, v160
    v_bfe_i32 v160, v255, 3, 1
    v_and_b32 v160, 0x80, v160
    v_xor_b32 v169, v169, v160
    v_bfe_i32 v160, v255, 4, 1
    v_and_b32 v160, 0x100, v160
    v_xor_b32 v169, v169, v160
    v_bfe_i32 v160, v255, 5, 1
    v_and_b32 v160, 0x40, v160
    v_xor_b32 v169, v169, v160
    v_add_u32 v168, v168, v169
    v_mov_b32 v170, 0x0
    v_bfe_i32 v160, v255, 0, 1
    v_and_b32 v160, 0x10, v160
    v_xor_b32 v170, v170, v160
    v_bfe_i32 v160, v255, 1, 1
    v_and_b32 v160, 0x8, v160
    v_xor_b32 v170, v170, v160
    v_bfe_i32 v160, v255, 2, 1
    v_and_b32 v160, 0x240, v160
    v_xor_b32 v170, v170, v160
    v_bfe_i32 v160, v255, 3, 1
    v_and_b32 v160, 0x480, v160
    v_xor_b32 v170, v170, v160
    v_bfe_i32 v160, v255, 4, 1
    v_and_b32 v160, 0x20, v160
    v_xor_b32 v170, v170, v160
    v_bfe_i32 v160, v255, 5, 1
    v_and_b32 v160, 0x1000, v160
    v_xor_b32 v170, v170, v160
    v_bfe_i32 v160, v255, 6, 1
    v_and_b32 v160, 0x80, v160
    v_xor_b32 v170, v170, v160
    v_bfe_i32 v160, v255, 7, 1
    v_and_b32 v160, 0x100, v160
    v_xor_b32 v170, v170, v160
    v_mov_b32 v171, 0x40
    v_bfe_i32 v160, v255, 0, 1
    v_and_b32 v160, 0x10, v160
    v_xor_b32 v171, v171, v160
    v_bfe_i32 v160, v255, 1, 1
    v_and_b32 v160, 0x8, v160
    v_xor_b32 v171, v171, v160
    v_bfe_i32 v160, v255, 2, 1
    v_and_b32 v160, 0x240, v160
    v_xor_b32 v171, v171, v160
    v_bfe_i32 v160, v255, 3, 1
    v_and_b32 v160, 0x480, v160
    v_xor_b32 v171, v171, v160
    v_bfe_i32 v160, v255, 4, 1
    v_and_b32 v160, 0x20, v160
    v_xor_b32 v171, v171, v160
    v_bfe_i32 v160, v255, 5, 1
    v_and_b32 v160, 0x1000, v160
    v_xor_b32 v171, v171, v160
    v_bfe_i32 v160, v255, 6, 1
    v_and_b32 v160, 0x80, v160
    v_xor_b32 v171, v171, v160
    v_bfe_i32 v160, v255, 7, 1
    v_and_b32 v160, 0x100, v160
    v_xor_b32 v171, v171, v160
    s_lshl_b32 s64, s31, 13
    s_add_u32 s66, s70, 0x0
    s_addc_u32 s67, s71, 0
    s_add_u32 m0, s64, 0x0
    s_nop 0
    global_load_lds_dwordx4 v161, s[66:67]
    s_add_u32 m0, s64, 0x400
    s_nop 0
    global_load_lds_dwordx4 v162, s[66:67]
    s_add_u32 m0, s64, 0x800
    s_nop 0
    global_load_lds_dwordx4 v163, s[66:67]
    s_add_u32 m0, s64, 0xc00
    s_nop 0
    global_load_lds_dwordx4 v164, s[66:67]
    s_add_u32 m0, s64, 0x1000
    s_nop 0
    global_load_lds_dwordx4 v165, s[66:67]
    s_add_u32 m0, s64, 0x1400
    s_nop 0
    global_load_lds_dwordx4 v166, s[66:67]
    s_add_u32 m0, s64, 0x1800
    s_nop 0
    global_load_lds_dwordx4 v167, s[66:67]
    s_add_u32 m0, s64, 0x1c00
    s_nop 0
    global_load_lds_dwordx4 v168, s[66:67]
    s_add_u32 s66, s70, 0x10000
    s_addc_u32 s67, s71, 0
    s_add_u32 m0, s64, 0x8000
    s_nop 0
    global_load_lds_dwordx4 v161, s[66:67]
    s_add_u32 m0, s64, 0x8400
    s_nop 0
    global_load_lds_dwordx4 v162, s[66:67]
    s_add_u32 m0, s64, 0x8800
    s_nop 0
    global_load_lds_dwordx4 v163, s[66:67]
    s_add_u32 m0, s64, 0x8c00
    s_nop 0
    global_load_lds_dwordx4 v164, s[66:67]
    s_add_u32 m0, s64, 0x9000
    s_nop 0
    global_load_lds_dwordx4 v165, s[66:67]
    s_add_u32 m0, s64, 0x9400
    s_nop 0
    global_load_lds_dwordx4 v166, s[66:67]
    s_add_u32 m0, s64, 0x9800
    s_nop 0
    global_load_lds_dwordx4 v167, s[66:67]
    s_add_u32 m0, s64, 0x9c00
    s_nop 0
    global_load_lds_dwordx4 v168, s[66:67]
    s_add_u32 s66, s70, 0x20000
    s_addc_u32 s67, s71, 0
    s_add_u32 m0, s64, 0x10000
    s_nop 0
    global_load_lds_dwordx4 v161, s[66:67]
    s_add_u32 m0, s64, 0x10400
    s_nop 0
    global_load_lds_dwordx4 v162, s[66:67]
    s_add_u32 m0, s64, 0x10800
    s_nop 0
    global_load_lds_dwordx4 v163, s[66:67]
    s_add_u32 m0, s64, 0x10c00
    s_nop 0
    global_load_lds_dwordx4 v164, s[66:67]
    s_add_u32 m0, s64, 0x11000
    s_nop 0
    global_load_lds_dwordx4 v165, s[66:67]
    s_add_u32 m0, s64, 0x11400
    s_nop 0
    global_load_lds_dwordx4 v166, s[66:67]
    s_add_u32 m0, s64, 0x11800
    s_nop 0
    global_load_lds_dwordx4 v167, s[66:67]
    s_add_u32 m0, s64, 0x11c00
    s_nop 0
    global_load_lds_dwordx4 v168, s[66:67]
    s_add_u32 s66, s70, 0x30000
    s_addc_u32 s67, s71, 0
    s_add_u32 m0, s64, 0x18000
    s_nop 0
    global_load_lds_dwordx4 v161, s[66:67]
    s_add_u32 m0, s64, 0x18400
    s_nop 0
    global_load_lds_dwordx4 v162, s[66:67]
    s_add_u32 m0, s64, 0x18800
    s_nop 0
    global_load_lds_dwordx4 v163, s[66:67]
    s_add_u32 m0, s64, 0x18c00
    s_nop 0
    global_load_lds_dwordx4 v164, s[66:67]
    s_add_u32 m0, s64, 0x19000
    s_nop 0
    global_load_lds_dwordx4 v165, s[66:67]
    s_add_u32 m0, s64, 0x19400
    s_nop 0
    global_load_lds_dwordx4 v166, s[66:67]
    s_add_u32 m0, s64, 0x19800
    s_nop 0
    global_load_lds_dwordx4 v167, s[66:67]
    s_add_u32 m0, s64, 0x19c00
    s_nop 0
    global_load_lds_dwordx4 v168, s[66:67]
    s_waitcnt vmcnt(24)
    s_barrier
    s_add_u32 s66, s70, 0x40000
    s_addc_u32 s67, s71, 0
    s_add_u32 m0, s64, 0x20000
    s_nop 0
    global_load_lds_dwordx4 v161, s[66:67]
    s_add_u32 m0, s64, 0x20400
    s_nop 0
    global_load_lds_dwordx4 v162, s[66:67]
    s_add_u32 m0, s64, 0x20800
    s_nop 0
    global_load_lds_dwordx4 v163, s[66:67]
    s_add_u32 m0, s64, 0x20c00
    s_nop 0
    global_load_lds_dwordx4 v164, s[66:67]
    s_add_u32 m0, s64, 0x21000
    s_nop 0
    global_load_lds_dwordx4 v165, s[66:67]
    s_add_u32 m0, s64, 0x21400
    s_nop 0
    global_load_lds_dwordx4 v166, s[66:67]
    s_add_u32 m0, s64, 0x21800
    s_nop 0
    global_load_lds_dwordx4 v167, s[66:67]
    s_add_u32 m0, s64, 0x21c00
    s_nop 0
    global_load_lds_dwordx4 v168, s[66:67]
    v_add_u32 v186, 0x0, v170
    v_add_u32 v187, 0x0, v171
    ds_read_b64_tr_b16 a[0:1], v186 offset:0
    ds_read_b64_tr_b16 a[2:3], v186 offset:2048
    ds_read_b64_tr_b16 a[4:5], v186 offset:8192
    ds_read_b64_tr_b16 a[6:7], v186 offset:10240
    ds_read_b64_tr_b16 a[8:9], v186 offset:16384
    ds_read_b64_tr_b16 a[10:11], v186 offset:18432
    ds_read_b64_tr_b16 a[12:13], v186 offset:24576
    ds_read_b64_tr_b16 a[14:15], v186 offset:26624
    ds_read_b64_tr_b16 a[128:129], v187 offset:0
    ds_read_b64_tr_b16 a[130:131], v187 offset:2048
    ds_read_b64_tr_b16 a[132:133], v187 offset:8192
    ds_read_b64_tr_b16 a[134:135], v187 offset:10240
    ds_read_b64_tr_b16 a[136:137], v187 offset:16384
    ds_read_b64_tr_b16 a[138:139], v187 offset:18432
    ds_read_b64_tr_b16 a[140:141], v187 offset:24576
    ds_read_b64_tr_b16 a[142:143], v187 offset:26624
L_lw_64:
    s_waitcnt lgkmcnt(0)
    s_waitcnt vmcnt(24)
    s_barrier
    s_add_u32 s66, s70, 0x50000
    s_addc_u32 s67, s71, 0
    s_add_u32 m0, s64, 0x0
    s_nop 0
    global_load_lds_dwordx4 v161, s[66:67]
    s_add_u32 m0, s64, 0x400
    s_nop 0
    global_load_lds_dwordx4 v162, s[66:67]
    s_add_u32 m0, s64, 0x800
    s_nop 0
    global_load_lds_dwordx4 v163, s[66:67]
    s_add_u32 m0, s64, 0xc00
    s_nop 0
    global_load_lds_dwordx4 v164, s[66:67]
    s_add_u32 m0, s64, 0x1000
    s_nop 0
    global_load_lds_dwordx4 v165, s[66:67]
    s_add_u32 m0, s64, 0x1400
    s_nop 0
    global_load_lds_dwordx4 v166, s[66:67]
    s_add_u32 m0, s64, 0x1800
    s_nop 0
    global_load_lds_dwordx4 v167, s[66:67]
    s_add_u32 m0, s64, 0x1c00
    s_nop 0
    global_load_lds_dwordx4 v168, s[66:67]
    v_add_u32 v186, 0x8000, v170
    v_add_u32 v187, 0x8000, v171
    ds_read_b64_tr_b16 a[16:17], v186 offset:0
    ds_read_b64_tr_b16 a[18:19], v186 offset:2048
    ds_read_b64_tr_b16 a[20:21], v186 offset:8192
    ds_read_b64_tr_b16 a[22:23], v186 offset:10240
    ds_read_b64_tr_b16 a[24:25], v186 offset:16384
    ds_read_b64_tr_b16 a[26:27], v186 offset:18432
    ds_read_b64_tr_b16 a[28:29], v186 offset:24576
    ds_read_b64_tr_b16 a[30:31], v186 offset:26624
    ds_read_b64_tr_b16 a[144:145], v187 offset:0
    ds_read_b64_tr_b16 a[146:147], v187 offset:2048
    ds_read_b64_tr_b16 a[148:149], v187 offset:8192
    ds_read_b64_tr_b16 a[150:151], v187 offset:10240
    ds_read_b64_tr_b16 a[152:153], v187 offset:16384
    ds_read_b64_tr_b16 a[154:155], v187 offset:18432
    ds_read_b64_tr_b16 a[156:157], v187 offset:24576
    ds_read_b64_tr_b16 a[158:159], v187 offset:26624
L_lw_65:
    s_waitcnt lgkmcnt(0)
    s_waitcnt vmcnt(24)
    s_barrier
    s_add_u32 s66, s70, 0x60000
    s_addc_u32 s67, s71, 0
    s_add_u32 m0, s64, 0x8000
    s_nop 0
    global_load_lds_dwordx4 v161, s[66:67]
    s_add_u32 m0, s64, 0x8400
    s_nop 0
    global_load_lds_dwordx4 v162, s[66:67]
    s_add_u32 m0, s64, 0x8800
    s_nop 0
    global_load_lds_dwordx4 v163, s[66:67]
    s_add_u32 m0, s64, 0x8c00
    s_nop 0
    global_load_lds_dwordx4 v164, s[66:67]
    s_add_u32 m0, s64, 0x9000
    s_nop 0
    global_load_lds_dwordx4 v165, s[66:67]
    s_add_u32 m0, s64, 0x9400
    s_nop 0
    global_load_lds_dwordx4 v166, s[66:67]
    s_add_u32 m0, s64, 0x9800
    s_nop 0
    global_load_lds_dwordx4 v167, s[66:67]
    s_add_u32 m0, s64, 0x9c00
    s_nop 0
    global_load_lds_dwordx4 v168, s[66:67]
    v_add_u32 v186, 0x10000, v170
    v_add_u32 v187, 0x10000, v171
    ds_read_b64_tr_b16 a[32:33], v186 offset:0
    ds_read_b64_tr_b16 a[34:35], v186 offset:2048
    ds_read_b64_tr_b16 a[36:37], v186 offset:8192
    ds_read_b64_tr_b16 a[38:39], v186 offset:10240
    ds_read_b64_tr_b16 a[40:41], v186 offset:16384
    ds_read_b64_tr_b16 a[42:43], v186 offset:18432
    ds_read_b64_tr_b16 a[44:45], v186 offset:24576
    ds_read_b64_tr_b16 a[46:47], v186 offset:26624
    ds_read_b64_tr_b16 a[160:161], v187 offset:0
    ds_read_b64_tr_b16 a[162:163], v187 offset:2048
    ds_read_b64_tr_b16 a[164:165], v187 offset:8192
    ds_read_b64_tr_b16 a[166:167], v187 offset:10240
    ds_read_b64_tr_b16 a[168:169], v187 offset:16384
    ds_read_b64_tr_b16 a[170:171], v187 offset:18432
    ds_read_b64_tr_b16 a[172:173], v187 offset:24576
    ds_read_b64_tr_b16 a[174:175], v187 offset:26624
L_lw_66:
    s_waitcnt lgkmcnt(0)
    s_waitcnt vmcnt(24)
    s_barrier
    s_add_u32 s66, s70, 0x70000
    s_addc_u32 s67, s71, 0
    s_add_u32 m0, s64, 0x10000
    s_nop 0
    global_load_lds_dwordx4 v161, s[66:67]
    s_add_u32 m0, s64, 0x10400
    s_nop 0
    global_load_lds_dwordx4 v162, s[66:67]
    s_add_u32 m0, s64, 0x10800
    s_nop 0
    global_load_lds_dwordx4 v163, s[66:67]
    s_add_u32 m0, s64, 0x10c00
    s_nop 0
    global_load_lds_dwordx4 v164, s[66:67]
    s_add_u32 m0, s64, 0x11000
    s_nop 0
    global_load_lds_dwordx4 v165, s[66:67]
    s_add_u32 m0, s64, 0x11400
    s_nop 0
    global_load_lds_dwordx4 v166, s[66:67]
    s_add_u32 m0, s64, 0x11800
    s_nop 0
    global_load_lds_dwordx4 v167, s[66:67]
    s_add_u32 m0, s64, 0x11c00
    s_nop 0
    global_load_lds_dwordx4 v168, s[66:67]
    v_add_u32 v186, 0x18000, v170
    v_add_u32 v187, 0x18000, v171
    ds_read_b64_tr_b16 a[48:49], v186 offset:0
    ds_read_b64_tr_b16 a[50:51], v186 offset:2048
    ds_read_b64_tr_b16 a[52:53], v186 offset:8192
    ds_read_b64_tr_b16 a[54:55], v186 offset:10240
    ds_read_b64_tr_b16 a[56:57], v186 offset:16384
    ds_read_b64_tr_b16 a[58:59], v186 offset:18432
    ds_read_b64_tr_b16 a[60:61], v186 offset:24576
    ds_read_b64_tr_b16 a[62:63], v186 offset:26624
    ds_read_b64_tr_b16 a[176:177], v187 offset:0
    ds_read_b64_tr_b16 a[178:179], v187 offset:2048
    ds_read_b64_tr_b16 a[180:181], v187 offset:8192
    ds_read_b64_tr_b16 a[182:183], v187 offset:10240
    ds_read_b64_tr_b16 a[184:185], v187 offset:16384
    ds_read_b64_tr_b16 a[186:187], v187 offset:18432
    ds_read_b64_tr_b16 a[188:189], v187 offset:24576
    ds_read_b64_tr_b16 a[190:191], v187 offset:26624
L_lw_67:
    s_waitcnt lgkmcnt(0)
    s_waitcnt vmcnt(24)
    s_barrier
    v_add_u32 v186, 0x20000, v170
    v_add_u32 v187, 0x20000, v171
    ds_read_b64_tr_b16 a[64:65], v186 offset:0
    ds_read_b64_tr_b16 a[66:67], v186 offset:2048
    ds_read_b64_tr_b16 a[68:69], v186 offset:8192
    ds_read_b64_tr_b16 a[70:71], v186 offset:10240
    ds_read_b64_tr_b16 a[72:73], v186 offset:16384
    ds_read_b64_tr_b16 a[74:75], v186 offset:18432
    ds_read_b64_tr_b16 a[76:77], v186 offset:24576
    ds_read_b64_tr_b16 a[78:79], v186 offset:26624
    ds_read_b64_tr_b16 a[192:193], v187 offset:0
    ds_read_b64_tr_b16 a[194:195], v187 offset:2048
    ds_read_b64_tr_b16 a[196:197], v187 offset:8192
    ds_read_b64_tr_b16 a[198:199], v187 offset:10240
    ds_read_b64_tr_b16 a[200:201], v187 offset:16384
    ds_read_b64_tr_b16 a[202:203], v187 offset:18432
    ds_read_b64_tr_b16 a[204:205], v187 offset:24576
    ds_read_b64_tr_b16 a[206:207], v187 offset:26624
L_lw_68:
    s_waitcnt lgkmcnt(0)
    s_waitcnt vmcnt(16)
    s_barrier
    v_add_u32 v186, 0x0, v170
    v_add_u32 v187, 0x0, v171
    ds_read_b64_tr_b16 a[80:81], v186 offset:0
    ds_read_b64_tr_b16 a[82:83], v186 offset:2048
    ds_read_b64_tr_b16 a[84:85], v186 offset:8192
    ds_read_b64_tr_b16 a[86:87], v186 offset:10240
    ds_read_b64_tr_b16 a[88:89], v186 offset:16384
    ds_read_b64_tr_b16 a[90:91], v186 offset:18432
    ds_read_b64_tr_b16 a[92:93], v186 offset:24576
    ds_read_b64_tr_b16 a[94:95], v186 offset:26624
    ds_read_b64_tr_b16 a[208:209], v187 offset:0
    ds_read_b64_tr_b16 a[210:211], v187 offset:2048
    ds_read_b64_tr_b16 a[212:213], v187 offset:8192
    ds_read_b64_tr_b16 a[214:215], v187 offset:10240
    ds_read_b64_tr_b16 a[216:217], v187 offset:16384
    ds_read_b64_tr_b16 a[218:219], v187 offset:18432
    ds_read_b64_tr_b16 a[220:221], v187 offset:24576
    ds_read_b64_tr_b16 a[222:223], v187 offset:26624
L_lw_69:
    s_waitcnt lgkmcnt(0)
    s_waitcnt vmcnt(8)
    s_barrier
    v_add_u32 v186, 0x8000, v170
    v_add_u32 v187, 0x8000, v171
    ds_read_b64_tr_b16 a[96:97], v186 offset:0
    ds_read_b64_tr_b16 a[98:99], v186 offset:2048
    ds_read_b64_tr_b16 a[100:101], v186 offset:8192
    ds_read_b64_tr_b16 a[102:103], v186 offset:10240
    ds_read_b64_tr_b16 a[104:105], v186 offset:16384
    ds_read_b64_tr_b16 a[106:107], v186 offset:18432
    ds_read_b64_tr_b16 a[108:109], v186 offset:24576
    ds_read_b64_tr_b16 a[110:111], v186 offset:26624
    ds_read_b64_tr_b16 a[224:225], v187 offset:0
    ds_read_b64_tr_b16 a[226:227], v187 offset:2048
    ds_read_b64_tr_b16 a[228:229], v187 offset:8192
    ds_read_b64_tr_b16 a[230:231], v187 offset:10240
    ds_read_b64_tr_b16 a[232:233], v187 offset:16384
    ds_read_b64_tr_b16 a[234:235], v187 offset:18432
    ds_read_b64_tr_b16 a[236:237], v187 offset:24576
    ds_read_b64_tr_b16 a[238:239], v187 offset:26624
L_lw_70:
    s_waitcnt lgkmcnt(0)
    s_waitcnt vmcnt(0)
    s_barrier
    v_add_u32 v186, 0x10000, v170
    v_add_u32 v187, 0x10000, v171
    ds_read_b64_tr_b16 a[112:113], v186 offset:0
    ds_read_b64_tr_b16 a[114:115], v186 offset:2048
    ds_read_b64_tr_b16 a[116:117], v186 offset:8192
    ds_read_b64_tr_b16 a[118:119], v186 offset:10240
    ds_read_b64_tr_b16 a[120:121], v186 offset:16384
    ds_read_b64_tr_b16 a[122:123], v186 offset:18432
    ds_read_b64_tr_b16 a[124:125], v186 offset:24576
    ds_read_b64_tr_b16 a[126:127], v186 offset:26624
    ds_read_b64_tr_b16 a[240:241], v187 offset:0
    ds_read_b64_tr_b16 a[242:243], v187 offset:2048
    ds_read_b64_tr_b16 a[244:245], v187 offset:8192
    ds_read_b64_tr_b16 a[246:247], v187 offset:10240
    ds_read_b64_tr_b16 a[248:249], v187 offset:16384
    ds_read_b64_tr_b16 a[250:251], v187 offset:18432
    ds_read_b64_tr_b16 a[252:253], v187 offset:24576
    ds_read_b64_tr_b16 a[254:255], v187 offset:26624
L_lw_71:
    s_waitcnt lgkmcnt(0)
    v_mov_b32 v228, 0x0
    v_bfe_u32 v160, v255, 0, 6
    v_lshl_add_u32 v228, v160, 4, v228
    v_mov_b32 v229, 0x0
    v_bfe_u32 v160, v255, 0, 6
    v_lshl_add_u32 v229, v160, 2, v229
    v_mov_b32 v237, 0x0
    v_bfe_u32 v160, v255, 0, 2
    v_lshl_add_u32 v237, v160, 2, v237
    v_min_u32 v237, 8, v237
    v_mov_b32 v230, 0x0
    v_bfe_u32 v160, v255, 0, 1
    v_lshl_add_u32 v230, v160, 4, v230
    v_bfe_u32 v160, v255, 1, 2
    v_lshl_add_u32 v230, v160, 6, v230
    v_bfe_u32 v160, v255, 5, 1
    v_lshl_add_u32 v230, v160, 8, v230
    v_mov_b32 v231, 0x28
    v_bfe_i32 v160, v255, 0, 1
    v_and_b32 v160, 0x10, v160
    v_xor_b32 v231, v231, v160
    v_bfe_i32 v160, v255, 1, 1
    v_and_b32 v160, 0x8, v160
    v_xor_b32 v231, v231, v160
    v_bfe_i32 v160, v255, 2, 1
    v_and_b32 v160, 0x40, v160
    v_xor_b32 v231, v231, v160
    v_bfe_i32 v160, v255, 3, 1
    v_and_b32 v160, 0x80, v160
    v_xor_b32 v231, v231, v160
    v_bfe_i32 v160, v255, 4, 1
    v_and_b32 v160, 0x4, v160
    v_xor_b32 v231, v231, v160
    v_bfe_i32 v160, v255, 5, 1
    v_and_b32 v160, 0x200, v160
    v_xor_b32 v231, v231, v160
    v_mov_b32 v232, 0x0
    v_bfe_u32 v160, v255, 0, 6
    v_lshl_add_u32 v232, v160, 4, v232
    v_bfe_u32 v160, v255, 6, 2
    v_lshl_add_u32 v232, v160, 13, v232
    v_mov_b32 v234, 0
    v_mov_b32 v235, 1
    v_mov_b32 v236, 0x40
    v_bfe_u32 v160, v255, 0, 5
    v_lshl_add_u32 v236, v160, 0, v236
    v_mov_b32 v239, 0x0
    v_bfe_u32 v160, v255, 5, 1
    v_lshl_add_u32 v239, v160, 2, v239
    v_sub_u32 v236, v236, v239
    v_mov_b32 v238, 0xff000000
    v_cmp_gt_u32 vcc, 64, v236
    s_nop 1
    v_cndmask_b32 v128, 0, v238, vcc
    v_cmp_gt_u32 vcc, 65, v236
    s_nop 1
    v_cndmask_b32 v129, 0, v238, vcc
    v_cmp_gt_u32 vcc, 66, v236
    s_nop 1
    v_cndmask_b32 v130, 0, v238, vcc
    v_cmp_gt_u32 vcc, 67, v236
    s_nop 1
    v_cndmask_b32 v131, 0, v238, vcc
    v_cmp_gt_u32 vcc, 72, v236
    s_nop 1
    v_cndmask_b32 v132, 0, v238, vcc
    v_cmp_gt_u32 vcc, 73, v236
    s_nop 1
    v_cndmask_b32 v133, 0, v238, vcc
    v_cmp_gt_u32 vcc, 74, v236
    s_nop 1
    v_cndmask_b32 v134, 0, v238, vcc
    v_cmp_gt_u32 vcc, 75, v236
    s_nop 1
    v_cndmask_b32 v135, 0, v238, vcc
    v_cmp_gt_u32 vcc, 80, v236
    s_nop 1
    v_cndmask_b32 v136, 0, v238, vcc
    v_cmp_gt_u32 vcc, 81, v236
    s_nop 1
    v_cndmask_b32 v137, 0, v238, vcc
    v_cmp_gt_u32 vcc, 82, v236
    s_nop 1
    v_cndmask_b32 v138, 0, v238, vcc
    v_cmp_gt_u32 vcc, 83, v236
    s_nop 1
    v_cndmask_b32 v139, 0, v238, vcc
    v_cmp_gt_u32 vcc, 88, v236
    s_nop 1
    v_cndmask_b32 v140, 0, v238, vcc
    v_cmp_gt_u32 vcc, 89, v236
    s_nop 1
    v_cndmask_b32 v141, 0, v238, vcc
    v_cmp_gt_u32 vcc, 90, v236
    s_nop 1
    v_cndmask_b32 v142, 0, v238, vcc
    v_cmp_gt_u32 vcc, 91, v236
    s_nop 1
    v_cndmask_b32 v143, 0, v238, vcc
    s_mov_b32 s34, 0
    s_mov_b32 s32, 0
    s_mov_b32 s56, 0
    s_lshl_b32 s81, s35, 4
    s_add_u32 s81, s81, s55
    s_lshl_b32 s81, s81, 7
    s_add_u32 s81, s81, 0x0
    s_add_u32 s52, s28, s81
    s_addc_u32 s53, s29, 0
    s_cmp_lg_u32 s31, 0
    s_cbranch_scc1 L_xp_arm_ok
    v_mov_b32 v160, 64
L_xp_arm:
    global_load_dword v161, v160, s[26:27] sc1
    s_waitcnt vmcnt(0)
    v_readfirstlane_b32 s80, v161
    s_cmp_ge_u32 s80, 32
    s_cbranch_scc1 L_xp_arm_ok
    s_sleep 4
    s_sub_u32 s62, s62, 1
    s_cbranch_scc0 L_xp_arm
    s_movk_i32 s63, 10
    s_branch L_fail_far
L_xp_arm_ok:
    s_barrier
L_xp_layer:
    s_mov_b32 s33, s35
    s_mul_i32 s80, s34, 0x5200000
    s_lshl_b32 s81, s35, 5
    s_add_u32 s81, s81, s36
    s_lshl_b32 s82, s81, 13
    s_add_u32 s82, s82, s80
    s_add_u32 s83, s82, 0x2301000
    s_add_u32 s38, s28, s83
    s_addc_u32 s39, s29, 0
    s_add_u32 s83, s82, 0x1300000
    s_add_u32 s44, s28, s83
    s_addc_u32 s45, s29, 0
    s_lshl_b32 s82, s81, 14
    s_add_u32 s82, s82, s80
    s_add_u32 s82, s82, 0x3301000
    s_add_u32 s40, s28, s82
    s_addc_u32 s41, s29, 0
    s_add_u32 s42, s40, 0x2000
    s_addc_u32 s43, s41, 0
    s_lshl_b32 s82, s35, 16
    s_lshl_b32 s83, s54, 15
    s_add_u32 s82, s82, s83
    s_lshl_b32 s83, s31, 13
    s_add_u32 s82, s82, s83
    s_add_u32 s82, s82, s80
    s_add_u32 s82, s82, 0xf01000
    s_add_u32 s46, s28, s82
    s_addc_u32 s47, s29, 0
    s_lshl_b32 s80, s34, 17
    s_lshl_b32 s81, s36, 10
    s_lshl_b32 s82, s35, 4
    s_add_u32 s81, s81, s82
    s_add_u32 s81, s81, s80
    s_add_u32 s82, s81, 0xc000
    s_add_u32 s48, s28, s82
    s_addc_u32 s49, s29, 0
    s_lshl_b32 s83, s35, 3
    s_sub_u32 s82, s81, s83
    s_add_u32 s82, s82, 0x14008
    s_add_u32 s50, s28, s82
    s_addc_u32 s51, s29, 0
L_xp_loop:
L_xp_wk:
    global_load_dword v236, v237, s[48:49] offset:0 sc1
    s_waitcnt vmcnt(0)
    v_cmp_ne_u32 vcc, 0x01010101, v236
    s_cbranch_vccz L_xp_wk_ok
    s_sleep 1
    s_sub_u32 s62, s62, 1
    s_cbranch_scc0 L_xp_wk
    s_movk_i32 s63, 16
    s_branch L_fail_far
L_xp_wk_ok:
    global_load_dwordx4 v[32:35], v228, s[40:41] offset:-4096 sc1
    global_load_dwordx4 v[36:39], v228, s[40:41] offset:-3072 sc1
    global_load_dwordx4 v[40:43], v228, s[40:41] offset:-2048 sc1
    global_load_dwordx4 v[44:47], v228, s[40:41] offset:-1024 sc1
    global_load_dwordx4 v[48:51], v228, s[40:41] offset:0 sc1
    global_load_dwordx4 v[52:55], v228, s[40:41] offset:1024 sc1
    global_load_dwordx4 v[56:59], v228, s[40:41] offset:2048 sc1
    global_load_dwordx4 v[60:63], v228, s[40:41] offset:3072 sc1
    global_load_dwordx4 v[0:3], v228, s[38:39] offset:-4096 sc1
    global_load_dwordx4 v[4:7], v228, s[38:39] offset:-3072 sc1
    global_load_dwordx4 v[8:11], v228, s[38:39] offset:-2048 sc1
    global_load_dwordx4 v[12:15], v228, s[38:39] offset:-1024 sc1
    global_load_dwordx4 v[16:19], v228, s[38:39] offset:0 sc1
    global_load_dwordx4 v[20:23], v228, s[38:39] offset:1024 sc1
    global_load_dwordx4 v[24:27], v228, s[38:39] offset:2048 sc1
    global_load_dwordx4 v[28:31], v228, s[38:39] offset:3072 sc1
    global_load_dwordx4 v[64:67], v228, s[42:43] offset:-4096 sc1
    global_load_dwordx4 v[68:71], v228, s[42:43] offset:-3072 sc1
    global_load_dwordx4 v[72:75], v228, s[42:43] offset:-2048 sc1
    global_load_dwordx4 v[76:79], v228, s[42:43] offset:-1024 sc1
    global_load_dwordx4 v[80:83], v228, s[42:43] offset:0 sc1
    global_load_dwordx4 v[84:87], v228, s[42:43] offset:1024 sc1
    global_load_dwordx4 v[88:91], v228, s[42:43] offset:2048 sc1
    global_load_dwordx4 v[92:95], v228, s[42:43] offset:3072 sc1
    s_waitcnt vmcnt(15)
    v_mfma_f32_32x32x16_bf16 v[96:111], v[32:35], v[0:3], v[128:143]
    s_waitcnt vmcnt(14)
    v_mfma_f32_32x32x16_bf16 v[96:111], v[36:39], v[4:7], v[96:111]
    s_waitcnt vmcnt(13)
    v_mfma_f32_32x32x16_bf16 v[96:111], v[40:43], v[8:11], v[96:111]
    s_waitcnt vmcnt(12)
    v_mfma_f32_32x32x16_bf16 v[96:111], v[44:47], v[12:15], v[96:111]
    s_waitcnt vmcnt(11)
    v_mfma_f32_32x32x16_bf16 v[96:111], v[48:51], v[16:19], v[96:111]
    s_waitcnt vmcnt(10)
    v_mfma_f32_32x32x16_bf16 v[96:111], v[52:55], v[20:23], v[96:111]
    s_waitcnt vmcnt(9)
    v_mfma_f32_32x32x16_bf16 v[96:111], v[56:59], v[24:27], v[96:111]
    s_waitcnt vmcnt(8)
    v_mfma_f32_32x32x16_bf16 v[96:111], v[60:63], v[28:31], v[96:111]
    s_add_u32 s38, s38, 0x100000
    s_addc_u32 s39, s39, 0
    s_add_u32 s40, s40, 0x200000
    s_addc_u32 s41, s41, 0
    s_add_u32 s42, s42, 0x200000
    s_addc_u32 s43, s43, 0
    s_add_u32 s48, s48, 0x40
    s_addc_u32 s49, s49, 0
    s_add_u32 s33, s33, 4
    s_cmp_ge_u32 s33, 60
    s_cbranch_scc1 L_xp_dp
L_xp_wm:
    global_load_dword v236, v234, s[50:51] offset:0 sc1
    s_waitcnt vmcnt(0)
    v_cmp_ne_u32 vcc, 0x44444444, v236
    s_cbranch_vccz L_xp_wm_ok
    s_sleep 1
    s_sub_u32 s62, s62, 1
    s_cbranch_scc0 L_xp_wm
    s_movk_i32 s63, 17
    s_branch L_fail_far
L_xp_wm_ok:
    global_load_dwordx4 v[32:35], v230, s[44:45] offset:0 sc1
    global_load_dwordx4 v[36:39], v230, s[44:45] offset:512 sc1
    global_load_dwordx4 v[40:43], v230, s[44:45] offset:1024 sc1
    global_load_dwordx4 v[44:47], v230, s[44:45] offset:1536 sc1
    global_load_dwordx4 v[48:51], v230, s[44:45] offset:2048 sc1
    global_load_dwordx4 v[52:55], v230, s[44:45] offset:2560 sc1
    global_load_dwordx4 v[56:59], v230, s[44:45] offset:3072 sc1
    global_load_dwordx4 v[60:63], v230, s[44:45] offset:3584 sc1
    global_load_dword v208, v231, s[44:45] offset:0 sc1
    global_load_dword v209, v231, s[44:45] offset:256 sc1
    global_load_dword v210, v231, s[44:45] offset:1024 sc1
    global_load_dword v211, v231, s[44:45] offset:1280 sc1
    global_load_dword v212, v231, s[44:45] offset:2048 sc1
    global_load_dword v213, v231, s[44:45] offset:2304 sc1
    global_load_dword v214, v231, s[44:45] offset:3072 sc1
    global_load_dword v215, v231, s[44:45] offset:3328 sc1
L_xp_dp_ok:
    s_add_u32 s44, s44, 0x100000
    s_addc_u32 s45, s45, 0
    s_add_u32 s50, s50, 0x20
    s_addc_u32 s51, s51, 0
    v_max_f32 v238, v96, v97
    v_max_f32 v239, v98, v99
    v_max3_f32 v238, v238, v100, v101
    v_max3_f32 v239, v239, v102, v103
    v_max3_f32 v238, v238, v104, v105
    v_max3_f32 v239, v239, v106, v107
    v_max3_f32 v238, v238, v108, v109
    v_max3_f32 v239, v239, v110, v111
    s_waitcnt vmcnt(15)
    v_mfma_f32_32x32x16_bf16 v[112:127], v[32:35], v[0:3], 0
    s_waitcnt vmcnt(14)
    v_mfma_f32_32x32x16_bf16 v[112:127], v[36:39], v[4:7], v[112:127]
    s_waitcnt vmcnt(13)
    v_mfma_f32_32x32x16_bf16 v[112:127], v[40:43], v[8:11], v[112:127]
    s_waitcnt vmcnt(12)
    v_mfma_f32_32x32x16_bf16 v[112:127], v[44:47], v[12:15], v[112:127]
    s_waitcnt vmcnt(11)
    v_mfma_f32_32x32x16_bf16 v[112:127], v[48:51], v[16:19], v[112:127]
    s_waitcnt vmcnt(10)
    v_mfma_f32_32x32x16_bf16 v[112:127], v[52:55], v[20:23], v[112:127]
    s_waitcnt vmcnt(9)
    v_mfma_f32_32x32x16_bf16 v[112:127], v[56:59], v[24:27], v[112:127]
    s_waitcnt vmcnt(8)
    v_mfma_f32_32x32x16_bf16 v[112:127], v[60:63], v[28:31], v[112:127]
    s_waitcnt vmcnt(0)
    s_nop 10
    v_max3_f32 v238, v238, v112, v113
    v_max3_f32 v239, v239, v114, v115
    v_max_f32 v238, v238, v239
    v_mov_b32 v239, v238
    s_nop 1
    v_permlane32_swap_b32 v238, v239
    v_max_f32 v238, v238, v239
    v_pk_add_f32 v[96:97], v[96:97], v[238:239] op_sel_hi:[1,0] neg_lo:[0,1] neg_hi:[0,1]
    v_pk_add_f32 v[98:99], v[98:99], v[238:239] op_sel_hi:[1,0] neg_lo:[0,1] neg_hi:[0,1]
    v_pk_add_f32 v[100:101], v[100:101], v[238:239] op_sel_hi:[1,0] neg_lo:[0,1] neg_hi:[0,1]
    v_pk_add_f32 v[102:103], v[102:103], v[238:239] op_sel_hi:[1,0] neg_lo:[0,1] neg_hi:[0,1]
    v_pk_add_f32 v[104:105], v[104:105], v[238:239] op_sel_hi:[1,0] neg_lo:[0,1] neg_hi:[0,1]
    v_pk_add_f32 v[106:107], v[106:107], v[238:239] op_sel_hi:[1,0] neg_lo:[0,1] neg_hi:[0,1]
    v_pk_add_f32 v[108:109], v[108:109], v[238:239] op_sel_hi:[1,0] neg_lo:[0,1] neg_hi:[0,1]
    v_pk_add_f32 v[110:111], v[110:111], v[238:239] op_sel_hi:[1,0] neg_lo:[0,1] neg_hi:[0,1]
    v_pk_add_f32 v[112:113], v[112:113], v[238:239] op_sel_hi:[1,0] neg_lo:[0,1] neg_hi:[0,1]
    v_pk_add_f32 v[114:115], v[114:115], v[238:239] op_sel_hi:[1,0] neg_lo:[0,1] neg_hi:[0,1]
    v_exp_f32 v96, v96
    v_exp_f32 v97, v97
    v_exp_f32 v98, v98
    v_exp_f32 v99, v99
    v_exp_f32 v100, v100
    v_exp_f32 v101, v101
    v_exp_f32 v102, v102
    v_exp_f32 v103, v103
    v_exp_f32 v104, v104
    v_exp_f32 v105, v105
    v_exp_f32 v106, v106
    v_exp_f32 v107, v107
    v_exp_f32 v108, v108
    v_exp_f32 v109, v109
    v_exp_f32 v110, v110
    v_exp_f32 v111, v111
    v_exp_f32 v112, v112
    v_exp_f32 v113, v113
    v_exp_f32 v114, v114
    v_exp_f32 v115, v115
    v_cvt_pk_bf16_f32 v216, v96, v97
    v_cvt_pk_bf16_f32 v217, v98, v99
    v_cvt_pk_bf16_f32 v218, v100, v101
    v_cvt_pk_bf16_f32 v219, v102, v103
    v_cvt_pk_bf16_f32 v220, v104, v105
    v_cvt_pk_bf16_f32 v221, v106, v107
    v_cvt_pk_bf16_f32 v222, v108, v109
    v_cvt_pk_bf16_f32 v223, v110, v111
    v_cvt_pk_bf16_f32 v224, v112, v113
    v_cvt_pk_bf16_f32 v225, v114, v115
    v_mfma_f32_32x32x16_bf16 v[144:159], v[64:67], v[216:219], 0
    v_add_f32 v96, v96, v98
    v_add_f32 v97, v97, v99
    v_add_f32 v96, v96, v100
    v_add_f32 v97, v97, v101
    v_add_f32 v96, v96, v102
    v_add_f32 v97, v97, v103
    v_mfma_f32_32x32x16_bf16 v[144:159], v[68:71], v[220:223], v[144:159]
    v_add_f32 v96, v96, v104
    v_add_f32 v97, v97, v105
    v_add_f32 v96, v96, v106
    v_add_f32 v97, v97, v107
    v_add_f32 v96, v96, v108
    v_add_f32 v97, v97, v109
    v_mfma_f32_32x32x8_bf16 v[144:159], v[208:209], v[224:225], v[144:159]
    v_add_f32 v96, v96, v110
    v_add_f32 v97, v97, v111
    v_add_f32 v96, v96, v112
    v_add_f32 v97, v97, v113
    v_add_f32 v96, v96, v114
    v_add_f32 v97, v97, v115
    v_mfma_f32_32x32x16_bf16 v[160:175], v[72:75], v[216:219], 0
    v_add_f32 v238, v96, v97
    v_mov_b32 v239, v238
    v_add_u32 v236, s32, v232
    v_add_u32 v233, s32, v228
    v_permlane32_swap_b32 v238, v239
    v_add_f32 v238, v238, v239
    v_mfma_f32_32x32x16_bf16 v[160:175], v[76:79], v[220:223], v[160:175]
    v_rcp_f32 v238, v238
    s_xor_b32 s32, s32, 0x8000
    v_mul_f32 v144, v144, v238
    v_mul_f32 v145, v145, v238
    v_mul_f32 v146, v146, v238
    v_mul_f32 v147, v147, v238
    v_mfma_f32_32x32x8_bf16 v[160:175], v[210:211], v[224:225], v[160:175]
    v_mul_f32 v148, v148, v238
    v_mul_f32 v149, v149, v238
    v_mul_f32 v150, v150, v238
    v_mul_f32 v151, v151, v238
    v_mul_f32 v152, v152, v238
    v_mul_f32 v153, v153, v238
    v_mfma_f32_32x32x16_bf16 v[176:191], v[80:83], v[216:219], 0
    v_mul_f32 v154, v154, v238
    v_mul_f32 v155, v155, v238
    v_mul_f32 v156, v156, v238
    v_mul_f32 v157, v157, v238
    v_mul_f32 v158, v158, v238
    v_mul_f32 v159, v159, v238
    v_mfma_f32_32x32x16_bf16 v[176:191], v[84:87], v[220:223], v[176:191]
    v_cvt_pk_bf16_f32 v96, v144, v145
    v_cvt_pk_bf16_f32 v97, v146, v147
    v_cvt_pk_bf16_f32 v98, v148, v149
    v_cvt_pk_bf16_f32 v99, v150, v151
    v_cvt_pk_bf16_f32 v100, v152, v153
    v_cvt_pk_bf16_f32 v101, v154, v155
    v_mfma_f32_32x32x8_bf16 v[176:191], v[212:213], v[224:225], v[176:191]
    v_cvt_pk_bf16_f32 v102, v156, v157
    v_cvt_pk_bf16_f32 v103, v158, v159
    ds_write_b128 v236, v[96:99] offset:0
    ds_write_b128 v236, v[100:103] offset:1024
    v_mul_f32 v160, v160, v238
    v_mul_f32 v161, v161, v238
    v_mfma_f32_32x32x16_bf16 v[192:207], v[88:91], v[216:219], 0
    v_mul_f32 v162, v162, v238
    v_mul_f32 v163, v163, v238
    v_mul_f32 v164, v164, v238
    v_mul_f32 v165, v165, v238
    v_mul_f32 v166, v166, v238
    v_mul_f32 v167, v167, v238
    v_mfma_f32_32x32x16_bf16 v[192:207], v[92:95], v[220:223], v[192:207]
    v_mul_f32 v168, v168, v238
    v_mul_f32 v169, v169, v238
    v_mul_f32 v170, v170, v238
    v_mul_f32 v171, v171, v238
    v_mul_f32 v172, v172, v238
    v_mul_f32 v173, v173, v238
    v_mfma_f32_32x32x8_bf16 v[192:207], v[214:215], v[224:225], v[192:207]
    v_mul_f32 v174, v174, v238
    v_mul_f32 v175, v175, v238
    v_cvt_pk_bf16_f32 v104, v160, v161
    v_cvt_pk_bf16_f32 v105, v162, v163
    v_cvt_pk_bf16_f32 v106, v164, v165
    v_cvt_pk_bf16_f32 v107, v166, v167
    v_cvt_pk_bf16_f32 v108, v168, v169
    v_cvt_pk_bf16_f32 v109, v170, v171
    v_cvt_pk_bf16_f32 v110, v172, v173
    v_cvt_pk_bf16_f32 v111, v174, v175
    ds_write_b128 v236, v[104:107] offset:2048
    ds_write_b128 v236, v[108:111] offset:3072
    v_mul_f32 v176, v176, v238
    v_mul_f32 v177, v177, v238
    v_mul_f32 v178, v178, v238
    v_mul_f32 v179, v179, v238
    v_mul_f32 v180, v180, v238
    v_mul_f32 v181, v181, v238
    v_mul_f32 v182, v182, v238
    v_mul_f32 v183, v183, v238
    v_mul_f32 v184, v184, v238
    v_mul_f32 v185, v185, v238
    v_mul_f32 v186, v186, v238
    v_mul_f32 v187, v187, v238
    v_mul_f32 v188, v188, v238
    v_mul_f32 v189, v189, v238
    v_mul_f32 v190, v190, v238
    v_mul_f32 v191, v191, v238
    v_cvt_pk_bf16_f32 v112, v176, v177
    v_cvt_pk_bf16_f32 v113, v178, v179
    v_cvt_pk_bf16_f32 v114, v180, v181
    v_cvt_pk_bf16_f32 v115, v182, v183
    v_cvt_pk_bf16_f32 v116, v184, v185
    v_cvt_pk_bf16_f32 v117, v186, v187
    v_cvt_pk_bf16_f32 v118, v188, v189
    v_cvt_pk_bf16_f32 v119, v190, v191
    ds_write_b128 v236, v[112:115] offset:4096
    ds_write_b128 v236, v[116:119] offset:5120
    v_mul_f32 v192, v192, v238
    v_mul_f32 v193, v193, v238
    v_mul_f32 v194, v194, v238
    v_mul_f32 v195, v195, v238
    v_mul_f32 v196, v196, v238
    v_mul_f32 v197, v197, v238
    v_mul_f32 v198, v198, v238
    v_mul_f32 v199, v199, v238
    v_mul_f32 v200, v200, v238
    v_mul_f32 v201, v201, v238
    v_mul_f32 v202, v202, v238
    v_mul_f32 v203, v203, v238
    v_mul_f32 v204, v204, v238
    v_mul_f32 v205, v205, v238
    v_mul_f32 v206, v206, v238
    v_mul_f32 v207, v207, v238
    v_cvt_pk_bf16_f32 v120, v192, v193
    v_cvt_pk_bf16_f32 v121, v194, v195
    v_cvt_pk_bf16_f32 v122, v196, v197
    v_cvt_pk_bf16_f32 v123, v198, v199
    v_cvt_pk_bf16_f32 v124, v200, v201
    v_cvt_pk_bf16_f32 v125, v202, v203
    v_cvt_pk_bf16_f32 v126, v204, v205
    v_cvt_pk_bf16_f32 v127, v206, v207
    ds_write_b128 v236, v[120:123] offset:6144
    ds_write_b128 v236, v[124:127] offset:7168
    s_waitcnt lgkmcnt(0)
    s_barrier
    ds_read_b128 v[32:35], v233 offset:0
    ds_read_b128 v[36:39], v233 offset:1024
    ds_read_b128 v[40:43], v233 offset:2048
    ds_read_b128 v[44:47], v233 offset:3072
    ds_read_b128 v[48:51], v233 offset:4096
    ds_read_b128 v[52:55], v233 offset:5120
    ds_read_b128 v[56:59], v233 offset:6144
    ds_read_b128 v[60:63], v233 offset:7168
    s_cmp_eq_u32 s33, 67
    s_cbranch_scc1 L_xp_half
    s_waitcnt lgkmcnt(6)
    v_mfma_f32_32x32x16_bf16 v[144:159], a[0:3], v[32:35], 0
    ds_read_b128 v[32:35], v233 offset:8192
    v_mfma_f32_32x32x16_bf16 v[144:159], a[4:7], v[36:39], v[144:159]
    ds_read_b128 v[36:39], v233 offset:9216
    s_waitcnt lgkmcnt(6)
    v_mfma_f32_32x32x16_bf16 v[144:159], a[8:11], v[40:43], v[144:159]
    ds_read_b128 v[40:43], v233 offset:10240
    v_mfma_f32_32x32x16_bf16 v[144:159], a[12:15], v[44:47], v[144:159]
    ds_read_b128 v[44:47], v233 offset:11264
    s_waitcnt lgkmcnt(6)
    v_mfma_f32_32x32x16_bf16 v[144:159], a[16:19], v[48:51], v[144:159]
    ds_read_b128 v[48:51], v233 offset:12288
    v_mfma_f32_32x32x16_bf16 v[144:159], a[20:23], v[52:55], v[144:159]
    ds_read_b128 v[52:55], v233 offset:13312
    s_waitcnt lgkmcnt(6)
    v_mfma_f32_32x32x16_bf16 v[144:159], a[24:27], v[56:59], v[144:159]
    ds_read_b128 v[56:59], v233 offset:14336
    v_mfma_f32_32x32x16_bf16 v[144:159], a[28:31], v[60:63], v[144:159]
    ds_read_b128 v[60:63], v233 offset:15360
    s_waitcnt lgkmcnt(6)
    v_mfma_f32_32x32x16_bf16 v[144:159], a[32:35], v[32:35], v[144:159]
    ds_read_b128 v[32:35], v233 offset:16384
    v_mfma_f32_32x32x16_bf16 v[144:159], a[36:39], v[36:39], v[144:159]
    ds_read_b128 v[36:39], v233 offset:17408
    s_waitcnt lgkmcnt(6)
    v_mfma_f32_32x32x16_bf16 v[144:159], a[40:43], v[40:43], v[144:159]
    ds_read_b128 v[40:43], v233 offset:18432
    v_mfma_f32_32x32x16_bf16 v[144:159], a[44:47], v[44:47], v[144:159]
    ds_read_b128 v[44:47], v233 offset:19456
    s_waitcnt lgkmcnt(6)
    v_mfma_f32_32x32x16_bf16 v[144:159], a[48:51], v[48:51], v[144:159]
    ds_read_b128 v[48:51], v233 offset:20480
    v_mfma_f32_32x32x16_bf16 v[144:159], a[52:55], v[52:55], v[144:159]
    ds_read_b128 v[52:55], v233 offset:21504
    s_waitcnt lgkmcnt(6)
    v_mfma_f32_32x32x16_bf16 v[144:159], a[56:59], v[56:59], v[144:159]
    ds_read_b128 v[56:59], v233 offset:22528
    v_mfma_f32_32x32x16_bf16 v[144:159], a[60:63], v[60:63], v[144:159]
    ds_read_b128 v[60:63], v233 offset:23552
    s_waitcnt lgkmcnt(6)
    v_mfma_f32_32x32x16_bf16 v[144:159], a[64:67], v[32:35], v[144:159]
    ds_read_b128 v[32:35], v233 offset:24576
    v_mfma_f32_32x32x16_bf16 v[144:159], a[68:71], v[36:39], v[144:159]
    ds_read_b128 v[36:39], v233 offset:25600
    s_waitcnt lgkmcnt(6)
    v_mfma_f32_32x32x16_bf16 v[144:159], a[72:75], v[40:43], v[144:159]
    ds_read_b128 v[40:43], v233 offset:26624
    v_mfma_f32_32x32x16_bf16 v[144:159], a[76:79], v[44:47], v[144:159]
    ds_read_b128 v[44:47], v233 offset:27648
    s_waitcnt lgkmcnt(6)
    v_mfma_f32_32x32x16_bf16 v[144:159], a[80:83], v[48:51], v[144:159]
    ds_read_b128 v[48:51], v233 offset:28672
    v_mfma_f32_32x32x16_bf16 v[144:159], a[84:87], v[52:55], v[144:159]
    ds_read_b128 v[52:55], v233 offset:29696
    s_waitcnt lgkmcnt(6)
    v_mfma_f32_32x32x16_bf16 v[144:159], a[88:91], v[56:59], v[144:159]
    ds_read_b128 v[56:59], v233 offset:30720
    v_mfma_f32_32x32x16_bf16 v[144:159], a[92:95], v[60:63], v[144:159]
    ds_read_b128 v[60:63], v233 offset:31744
    s_waitcnt lgkmcnt(6)
    v_mfma_f32_32x32x16_bf16 v[144:159], a[96:99], v[32:35], v[144:159]
    ds_read_b128 v[32:35], v233 offset:0
    v_mfma_f32_32x32x16_bf16 v[144:159], a[100:103], v[36:39], v[144:159]
    ds_read_b128 v[36:39], v233 offset:1024
    s_waitcnt lgkmcnt(6)
    v_mfma_f32_32x32x16_bf16 v[144:159], a[104:107], v[40:43], v[144:159]
    ds_read_b128 v[40:43], v233 offset:2048
    v_mfma_f32_32x32x16_bf16 v[144:159], a[108:111], v[44:47], v[144:159]
    ds_read_b128 v[44:47], v233 offset:3072
    s_waitcnt lgkmcnt(6)
    v_mfma_f32_32x32x16_bf16 v[144:159], a[112:115], v[48:51], v[144:159]
    ds_read_b128 v[48:51], v233 offset:4096
    v_mfma_f32_32x32x16_bf16 v[144:159], a[116:119], v[52:55], v[144:159]
    ds_read_b128 v[52:55], v233 offset:5120
    s_waitcnt lgkmcnt(6)
    v_mfma_f32_32x32x16_bf16 v[144:159], a[120:123], v[56:59], v[144:159]
    ds_read_b128 v[56:59], v233 offset:6144
    v_mfma_f32_32x32x16_bf16 v[144:159], a[124:127], v[60:63], v[144:159]
    ds_read_b128 v[60:63], v233 offset:7168
    s_waitcnt lgkmcnt(6)
    v_mfma_f32_32x32x16_bf16 v[160:175], a[128:131], v[32:35], 0
    ds_read_b128 v[32:35], v233 offset:8192
    v_mfma_f32_32x32x16_bf16 v[160:175], a[132:135], v[36:39], v[160:175]
    ds_read_b128 v[36:39], v233 offset:9216
    s_waitcnt lgkmcnt(6)
    v_mfma_f32_32x32x16_bf16 v[160:175], a[136:139], v[40:43], v[160:175]
    ds_read_b128 v[40:43], v233 offset:10240
    v_mfma_f32_32x32x16_bf16 v[160:175], a[140:143], v[44:47], v[160:175]
    ds_read_b128 v[44:47], v233 offset:11264
    s_waitcnt lgkmcnt(6)
    v_mfma_f32_32x32x16_bf16 v[160:175], a[144:147], v[48:51], v[160:175]
    ds_read_b128 v[48:51], v233 offset:12288
    global_atomic_add_f32 v229, v144, s[46:47] offset:-4096
    v_mfma_f32_32x32x16_bf16 v[160:175], a[148:151], v[52:55], v[160:175]
    ds_read_b128 v[52:55], v233 offset:13312
    global_atomic_add_f32 v229, v145, s[46:47] offset:-3840
    s_waitcnt lgkmcnt(6)
    v_mfma_f32_32x32x16_bf16 v[160:175], a[152:155], v[56:59], v[160:175]
    ds_read_b128 v[56:59], v233 offset:14336
    global_atomic_add_f32 v229, v146, s[46:47] offset:-3584
    v_mfma_f32_32x32x16_bf16 v[160:175], a[156:159], v[60:63], v[160:175]
    ds_read_b128 v[60:63], v233 offset:15360
    global_atomic_add_f32 v229, v147, s[46:47] offset:-3328
    s_waitcnt lgkmcnt(6)
    v_mfma_f32_32x32x16_bf16 v[160:175], a[160:163], v[32:35], v[160:175]
    ds_read_b128 v[32:35], v233 offset:16384
    global_atomic_add_f32 v229, v148, s[46:47] offset:-3072
    v_mfma_f32_32x32x16_bf16 v[160:175], a[164:167], v[36:39], v[160:175]
    ds_read_b128 v[36:39], v233 offset:17408
    global_atomic_add_f32 v229, v149, s[46:47] offset:-2816
    s_waitcnt lgkmcnt(6)
    v_mfma_f32_32x32x16_bf16 v[160:175], a[168:171], v[40:43], v[160:175]
    ds_read_b128 v[40:43], v233 offset:18432
    global_atomic_add_f32 v229, v150, s[46:47] offset:-2560
    v_mfma_f32_32x32x16_bf16 v[160:175], a[172:175], v[44:47], v[160:175]
    ds_read_b128 v[44:47], v233 offset:19456
    global_atomic_add_f32 v229, v151, s[46:47] offset:-2304
    s_waitcnt lgkmcnt(6)
    v_mfma_f32_32x32x16_bf16 v[160:175], a[176:179], v[48:51], v[160:175]
    ds_read_b128 v[48:51], v233 offset:20480
    global_atomic_add_f32 v229, v152, s[46:47] offset:-2048
    v_mfma_f32_32x32x16_bf16 v[160:175], a[180:183], v[52:55], v[160:175]
    ds_read_b128 v[52:55], v233 offset:21504
    global_atomic_add_f32 v229, v153, s[46:47] offset:-1792
    s_waitcnt lgkmcnt(6)
    v_mfma_f32_32x32x16_bf16 v[160:175], a[184:187], v[56:59], v[160:175]
    ds_read_b128 v[56:59], v233 offset:22528
    global_atomic_add_f32 v229, v154, s[46:47] offset:-1536
    v_mfma_f32_32x32x16_bf16 v[160:175], a[188:191], v[60:63], v[160:175]
    ds_read_b128 v[60:63], v233 offset:23552
    global_atomic_add_f32 v229, v155, s[46:47] offset:-1280
    s_waitcnt lgkmcnt(6)
    v_mfma_f32_32x32x16_bf16 v[160:175], a[192:195], v[32:35], v[160:175]
    ds_read_b128 v[32:35], v233 offset:24576
    global_atomic_add_f32 v229, v156, s[46:47] offset:-1024
    v_mfma_f32_32x32x16_bf16 v[160:175], a[196:199], v[36:39], v[160:175]
    ds_read_b128 v[36:39], v233 offset:25600
    global_atomic_add_f32 v229, v157, s[46:47] offset:-768
    s_waitcnt lgkmcnt(6)
    v_mfma_f32_32x32x16_bf16 v[160:175], a[200:203], v[40:43], v[160:175]
    ds_read_b128 v[40:43], v233 offset:26624
    global_atomic_add_f32 v229, v158, s[46:47] offset:-512
    v_mfma_f32_32x32x16_bf16 v[160:175], a[204:207], v[44:47], v[160:175]
    ds_read_b128 v[44:47], v233 offset:27648
    global_atomic_add_f32 v229, v159, s[46:47] offset:-256
    s_waitcnt lgkmcnt(6)
    v_mfma_f32_32x32x16_bf16 v[160:175], a[208:211], v[48:51], v[160:175]
    ds_read_b128 v[48:51], v233 offset:28672
    v_mfma_f32_32x32x16_bf16 v[160:175], a[212:215], v[52:55], v[160:175]
    ds_read_b128 v[52:55], v233 offset:29696
    s_waitcnt lgkmcnt(6)
    v_mfma_f32_32x32x16_bf16 v[160:175], a[216:219], v[56:59], v[160:175]
    ds_read_b128 v[56:59], v233 offset:30720
    v_mfma_f32_32x32x16_bf16 v[160:175], a[220:223], v[60:63], v[160:175]
    ds_read_b128 v[60:63], v233 offset:31744
    s_waitcnt lgkmcnt(6)
    v_mfma_f32_32x32x16_bf16 v[160:175], a[224:227], v[32:35], v[160:175]
    v_mfma_f32_32x32x16_bf16 v[160:175], a[228:231], v[36:39], v[160:175]
    s_waitcnt lgkmcnt(4)
    v_mfma_f32_32x32x16_bf16 v[160:175], a[232:235], v[40:43], v[160:175]
    v_mfma_f32_32x32x16_bf16 v[160:175], a[236:239], v[44:47], v[160:175]
    s_waitcnt lgkmcnt(2)
    v_mfma_f32_32x32x16_bf16 v[160:175], a[240:243], v[48:51], v[160:175]
    v_mfma_f32_32x32x16_bf16 v[160:175], a[244:247], v[52:55], v[160:175]
    s_waitcnt lgkmcnt(0)
    v_mfma_f32_32x32x16_bf16 v[160:175], a[248:251], v[56:59], v[160:175]
    v_mfma_f32_32x32x16_bf16 v[160:175], a[252:255], v[60:63], v[160:175]
    s_nop 11
    global_atomic_add_f32 v229, v160, s[46:47] offset:0
    global_atomic_add_f32 v229, v161, s[46:47] offset:256
    global_atomic_add_f32 v229, v162, s[46:47] offset:512
    global_atomic_add_f32 v229, v163, s[46:47] offset:768
    global_atomic_add_f32 v229, v164, s[46:47] offset:1024
    global_atomic_add_f32 v229, v165, s[46:47] offset:1280
    global_atomic_add_f32 v229, v166, s[46:47] offset:1536
    global_atomic_add_f32 v229, v167, s[46:47] offset:1792
    global_atomic_add_f32 v229, v168, s[46:47] offset:2048
    global_atomic_add_f32 v229, v169, s[46:47] offset:2304
    global_atomic_add_f32 v229, v170, s[46:47] offset:2560
    global_atomic_add_f32 v229, v171, s[46:47] offset:2816
    global_atomic_add_f32 v229, v172, s[46:47] offset:3072
    global_atomic_add_f32 v229, v173, s[46:47] offset:3328
    global_atomic_add_f32 v229, v174, s[46:47] offset:3584
    global_atomic_add_f32 v229, v175, s[46:47] offset:3840
L_xp_fin:
    s_add_u32 s46, s46, 0x40000
    s_addc_u32 s47, s47, 0
    s_waitcnt vmcnt(0)
    s_add_u32 s56, s56, 1
    s_barrier
    s_cmp_lg_u32 s31, 0
    s_cbranch_scc1 L_xp_pub
    v_mov_b32 v235, s56
    s_mov_b64 exec, 1
    global_store_dword v234, v235, s[52:53] sc1
    s_mov_b64 exec, -1
L_xp_pub:
    s_cmp_lt_u32 s33, 64
    s_cbranch_scc1 L_xp_loop
    s_cmp_lg_u32 s33, 64
    s_cbranch_scc1 L_xp_next
    s_sub_u32 s38, s38, 0x40000
    s_subb_u32 s39, s39, 0
    s_sub_u32 s44, s44, 0x40000
    s_subb_u32 s45, s45, 0
    s_sub_u32 s40, s40, 0x80000
    s_subb_u32 s41, s41, 0
    s_sub_u32 s42, s42, 0x80000
    s_subb_u32 s43, s43, 0
    s_sub_u32 s46, s46, 0x10000
    s_subb_u32 s47, s47, 0
    s_sub_u32 s48, s48, 0x10
    s_subb_u32 s49, s49, 0
    s_sub_u32 s50, s50, 0x8
    s_subb_u32 s51, s51, 0
    s_mov_b32 s33, 63
    s_branch L_xp_loop
L_xp_half:
    s_cmp_eq_u32 s35, 0
    s_cbranch_scc1 L_xp_h0
    s_waitcnt lgkmcnt(6)
    v_mfma_f32_32x32x16_bf16 v[160:175], a[128:131], v[32:35], 0
    ds_read_b128 v[32:35], v233 offset:8192
    v_mfma_f32_32x32x16_bf16 v[160:175], a[132:135], v[36:39], v[160:175]
    ds_read_b128 v[36:39], v233 offset:9216
    s_waitcnt lgkmcnt(6)
    v_mfma_f32_32x32x16_bf16 v[160:175], a[136:139], v[40:43], v[160:175]
    ds_read_b128 v[40:43], v233 offset:10240
    v_mfma_f32_32x32x16_bf16 v[160:175], a[140:143], v[44:47], v[160:175]
    ds_read_b128 v[44:47], v233 offset:11264
    s_waitcnt lgkmcnt(6)
    v_mfma_f32_32x32x16_bf16 v[160:175], a[144:147], v[48:51], v[160:175]
    ds_read_b128 v[48:51], v233 offset:12288
    v_mfma_f32_32x32x16_bf16 v[160:175], a[148:151], v[52:55], v[160:175]
    ds_read_b128 v[52:55], v233 offset:13312
    s_waitcnt lgkmcnt(6)
    v_mfma_f32_32x32x16_bf16 v[160:175], a[152:155], v[56:59], v[160:175]
    ds_read_b128 v[56:59], v233 offset:14336
    v_mfma_f32_32x32x16_bf16 v[160:175], a[156:159], v[60:63], v[160:175]
    ds_read_b128 v[60:63], v233 offset:15360
    s_waitcnt lgkmcnt(6)
    v_mfma_f32_32x32x16_bf16 v[160:175], a[160:163], v[32:35], v[160:175]
    ds_read_b128 v[32:35], v233 offset:16384
    v_mfma_f32_32x32x16_bf16 v[160:175], a[164:167], v[36:39], v[160:175]
    ds_read_b128 v[36:39], v233 offset:17408
    s_waitcnt lgkmcnt(6)
    v_mfma_f32_32x32x16_bf16 v[160:175], a[168:171], v[40:43], v[160:175]
    ds_read_b128 v[40:43], v233 offset:18432
    v_mfma_f32_32x32x16_bf16 v[160:175], a[172:175], v[44:47], v[160:175]
    ds_read_b128 v[44:47], v233 offset:19456
    s_waitcnt lgkmcnt(6)
    v_mfma_f32_32x32x16_bf16 v[160:175], a[176:179], v[48:51], v[160:175]
    ds_read_b128 v[48:51], v233 offset:20480
    v_mfma_f32_32x32x16_bf16 v[160:175], a[180:183], v[52:55], v[160:175]
    ds_read_b128 v[52:55], v233 offset:21504
    s_waitcnt lgkmcnt(6)
    v_mfma_f32_32x32x16_bf16 v[160:175], a[184:187], v[56:59], v[160:175]
    ds_read_b128 v[56:59], v233 offset:22528
    v_mfma_f32_32x32x16_bf16 v[160:175], a[188:191], v[60:63], v[160:175]
    ds_read_b128 v[60:63], v233 offset:23552
    s_waitcnt lgkmcnt(6)
    v_mfma_f32_32x32x16_bf16 v[160:175], a[192:195], v[32:35], v[160:175]
    ds_read_b128 v[32:35], v233 offset:24576
    v_mfma_f32_32x32x16_bf16 v[160:175], a[196:199], v[36:39], v[160:175]
    ds_read_b128 v[36:39], v233 offset:25600
    s_waitcnt lgkmcnt(6)
    v_mfma_f32_32x32x16_bf16 v[160:175], a[200:203], v[40:43], v[160:175]
    ds_read_b128 v[40:43], v233 offset:26624
    v_mfma_f32_32x32x16_bf16 v[160:175], a[204:207], v[44:47], v[160:175]
    ds_read_b128 v[44:47], v233 offset:27648
    s_waitcnt lgkmcnt(6)
    v_mfma_f32_32x32x16_bf16 v[160:175], a[208:211], v[48:51], v[160:175]
    ds_read_b128 v[48:51], v233 offset:28672
    v_mfma_f32_32x32x16_bf16 v[160:175], a[212:215], v[52:55], v[160:175]
    ds_read_b128 v[52:55], v233 offset:29696
    s_waitcnt lgkmcnt(6)
    v_mfma_f32_32x32x16_bf16 v[160:175], a[216:219], v[56:59], v[160:175]
    ds_read_b128 v[56:59], v233 offset:30720
    v_mfma_f32_32x32x16_bf16 v[160:175], a[220:223], v[60:63], v[160:175]
    ds_read_b128 v[60:63], v233 offset:31744
    s_waitcnt lgkmcnt(6)
    v_mfma_f32_32x32x16_bf16 v[160:175], a[224:227], v[32:35], v[160:175]
    v_mfma_f32_32x32x16_bf16 v[160:175], a[228:231], v[36:39], v[160:175]
    s_waitcnt lgkmcnt(4)
    v_mfma_f32_32x32x16_bf16 v[160:175], a[232:235], v[40:43], v[160:175]
    v_mfma_f32_32x32x16_bf16 v[160:175], a[236:239], v[44:47], v[160:175]
    s_waitcnt lgkmcnt(2)
    v_mfma_f32_32x32x16_bf16 v[160:175], a[240:243], v[48:51], v[160:175]
    v_mfma_f32_32x32x16_bf16 v[160:175], a[244:247], v[52:55], v[160:175]
    s_waitcnt lgkmcnt(0)
    v_mfma_f32_32x32x16_bf16 v[160:175], a[248:251], v[56:59], v[160:175]
    v_mfma_f32_32x32x16_bf16 v[160:175], a[252:255], v[60:63], v[160:175]
    s_nop 11
    global_atomic_add_f32 v229, v160, s[46:47] offset:0
    global_atomic_add_f32 v229, v161, s[46:47] offset:256
    global_atomic_add_f32 v229, v162, s[46:47] offset:512
    global_atomic_add_f32 v229, v163, s[46:47] offset:768
    global_atomic_add_f32 v229, v164, s[46:47] offset:1024
    global_atomic_add_f32 v229, v165, s[46:47] offset:1280
    global_atomic_add_f32 v229, v166, s[46:47] offset:1536
    global_atomic_add_f32 v229, v167, s[46:47] offset:1792
    global_atomic_add_f32 v229, v168, s[46:47] offset:2048
    global_atomic_add_f32 v229, v169, s[46:47] offset:2304
    global_atomic_add_f32 v229, v170, s[46:47] offset:2560
    global_atomic_add_f32 v229, v171, s[46:47] offset:2816
    global_atomic_add_f32 v229, v172, s[46:47] offset:3072
    global_atomic_add_f32 v229, v173, s[46:47] offset:3328
    global_atomic_add_f32 v229, v174, s[46:47] offset:3584
    global_atomic_add_f32 v229, v175, s[46:47] offset:3840
    s_branch L_xp_fin
L_xp_h0:
    s_waitcnt lgkmcnt(6)
    v_mfma_f32_32x32x16_bf16 v[144:159], a[0:3], v[32:35], 0
    ds_read_b128 v[32:35], v233 offset:8192
    v_mfma_f32_32x32x16_bf16 v[144:159], a[4:7], v[36:39], v[144:159]
    ds_read_b128 v[36:39], v233 offset:9216
    s_waitcnt lgkmcnt(6)
    v_mfma_f32_32x32x16_bf16 v[144:159], a[8:11], v[40:43], v[144:159]
    ds_read_b128 v[40:43], v233 offset:10240
    v_mfma_f32_32x32x16_bf16 v[144:159], a[12:15], v[44:47], v[144:159]
    ds_read_b128 v[44:47], v233 offset:11264
    s_waitcnt lgkmcnt(6)
    v_mfma_f32_32x32x16_bf16 v[144:159], a[16:19], v[48:51], v[144:159]
    ds_read_b128 v[48:51], v233 offset:12288
    v_mfma_f32_32x32x16_bf16 v[144:159], a[20:23], v[52:55], v[144:159]
    ds_read_b128 v[52:55], v233 offset:13312
    s_waitcnt lgkmcnt(6)
    v_mfma_f32_32x32x16_bf16 v[144:159], a[24:27], v[56:59], v[144:159]
    ds_read_b128 v[56:59], v233 offset:14336
    v_mfma_f32_32x32x16_bf16 v[144:159], a[28:31], v[60:63], v[144:159]
    ds_read_b128 v[60:63], v233 offset:15360
    s_waitcnt lgkmcnt(6)
    v_mfma_f32_32x32x16_bf16 v[144:159], a[32:35], v[32:35], v[144:159]
    ds_read_b128 v[32:35], v233 offset:16384
    v_mfma_f32_32x32x16_bf16 v[144:159], a[36:39], v[36:39], v[144:159]
    ds_read_b128 v[36:39], v233 offset:17408
    s_waitcnt lgkmcnt(6)
    v_mfma_f32_32x32x16_bf16 v[144:159], a[40:43], v[40:43], v[144:159]
    ds_read_b128 v[40:43], v233 offset:18432
    v_mfma_f32_32x32x16_bf16 v[144:159], a[44:47], v[44:47], v[144:159]
    ds_read_b128 v[44:47], v233 offset:19456
    s_waitcnt lgkmcnt(6)
    v_mfma_f32_32x32x16_bf16 v[144:159], a[48:51], v[48:51], v[144:159]
    ds_read_b128 v[48:51], v233 offset:20480
    v_mfma_f32_32x32x16_bf16 v[144:159], a[52:55], v[52:55], v[144:159]
    ds_read_b128 v[52:55], v233 offset:21504
    s_waitcnt lgkmcnt(6)
    v_mfma_f32_32x32x16_bf16 v[144:159], a[56:59], v[56:59], v[144:159]
    ds_read_b128 v[56:59], v233 offset:22528
    v_mfma_f32_32x32x16_bf16 v[144:159], a[60:63], v[60:63], v[144:159]
    ds_read_b128 v[60:63], v233 offset:23552
    s_waitcnt lgkmcnt(6)
    v_mfma_f32_32x32x16_bf16 v[144:159], a[64:67], v[32:35], v[144:159]
    ds_read_b128 v[32:35], v233 offset:24576
    v_mfma_f32_32x32x16_bf16 v[144:159], a[68:71], v[36:39], v[144:159]
    ds_read_b128 v[36:39], v233 offset:25600
    s_waitcnt lgkmcnt(6)
    v_mfma_f32_32x32x16_bf16 v[144:159], a[72:75], v[40:43], v[144:159]
    ds_read_b128 v[40:43], v233 offset:26624
    v_mfma_f32_32x32x16_bf16 v[144:159], a[76:79], v[44:47], v[144:159]
    ds_read_b128 v[44:47], v233 offset:27648
    s_waitcnt lgkmcnt(6)
    v_mfma_f32_32x32x16_bf16 v[144:159], a[80:83], v[48:51], v[144:159]
    ds_read_b128 v[48:51], v233 offset:28672
    v_mfma_f32_32x32x16_bf16 v[144:159], a[84:87], v[52:55], v[144:159]
    ds_read_b128 v[52:55], v233 offset:29696
    s_waitcnt lgkmcnt(6)
    v_mfma_f32_32x32x16_bf16 v[144:159], a[88:91], v[56:59], v[144:159]
    ds_read_b128 v[56:59], v233 offset:30720
    v_mfma_f32_32x32x16_bf16 v[144:159], a[92:95], v[60:63], v[144:159]
    ds_read_b128 v[60:63], v233 offset:31744
    s_waitcnt lgkmcnt(6)
    v_mfma_f32_32x32x16_bf16 v[144:159], a[96:99], v[32:35], v[144:159]
    v_mfma_f32_32x32x16_bf16 v[144:159], a[100:103], v[36:39], v[144:159]
    s_waitcnt lgkmcnt(4)
    v_mfma_f32_32x32x16_bf16 v[144:159], a[104:107], v[40:43], v[144:159]
    v_mfma_f32_32x32x16_bf16 v[144:159], a[108:111], v[44:47], v[144:159]
    s_waitcnt lgkmcnt(2)
    v_mfma_f32_32x32x16_bf16 v[144:159], a[112:115], v[48:51], v[144:159]
    v_mfma_f32_32x32x16_bf16 v[144:159], a[116:119], v[52:55], v[144:159]
    s_waitcnt lgkmcnt(0)
    v_mfma_f32_32x32x16_bf16 v[144:159], a[120:123], v[56:59], v[144:159]
    v_mfma_f32_32x32x16_bf16 v[144:159], a[124:127], v[60:63], v[144:159]
    s_nop 11
    global_atomic_add_f32 v229, v144, s[46:47] offset:-4096
    global_atomic_add_f32 v229, v145, s[46:47] offset:-3840
    global_atomic_add_f32 v229, v146, s[46:47] offset:-3584
    global_atomic_add_f32 v229, v147, s[46:47] offset:-3328
    global_atomic_add_f32 v229, v148, s[46:47] offset:-3072
    global_atomic_add_f32 v229, v149, s[46:47] offset:-2816
    global_atomic_add_f32 v229, v150, s[46:47] offset:-2560
    global_atomic_add_f32 v229, v151, s[46:47] offset:-2304
    global_atomic_add_f32 v229, v152, s[46:47] offset:-2048
    global_atomic_add_f32 v229, v153, s[46:47] offset:-1792
    global_atomic_add_f32 v229, v154, s[46:47] offset:-1536
    global_atomic_add_f32 v229, v155, s[46:47] offset:-1280
    global_atomic_add_f32 v229, v156, s[46:47] offset:-1024
    global_atomic_add_f32 v229, v157, s[46:47] offset:-768
    global_atomic_add_f32 v229, v158, s[46:47] offset:-512
    global_atomic_add_f32 v229, v159, s[46:47] offset:-256
    s_add_u32 s80, s52, 0x2000
    s_addc_u32 s81, s53, 0
    s_waitcnt vmcnt(0)
    s_barrier
    s_cmp_lg_u32 s31, 0
    s_cbranch_scc1 L_xp_pub2
    v_mov_b32 v235, s56
    s_mov_b64 exec, 1
    global_store_dword v234, v235, s[80:81] sc1
    s_mov_b64 exec, -1
L_xp_pub2:
L_xp_next:
    s_add_u32 s34, s34, 1
    s_cmp_lt_u32 s34, 2
    s_cbranch_scc1 L_xp_layer
    s_endpgm
L_xp_dp:
    global_load_dwordx4 v[32:35], v230, s[44:45] offset:0 sc1
    global_load_dwordx4 v[36:39], v230, s[44:45] offset:512 sc1
    global_load_dwordx4 v[40:43], v230, s[44:45] offset:1024 sc1
    global_load_dwordx4 v[44:47], v230, s[44:45] offset:1536 sc1
    global_load_dwordx4 v[48:51], v230, s[44:45] offset:2048 sc1
    global_load_dwordx4 v[52:55], v230, s[44:45] offset:2560 sc1
    global_load_dwordx4 v[56:59], v230, s[44:45] offset:3072 sc1
    global_load_dwordx4 v[60:63], v230, s[44:45] offset:3584 sc1
    global_load_dword v208, v231, s[44:45] offset:0 sc1
    global_load_dword v209, v231, s[44:45] offset:256 sc1
    global_load_dword v210, v231, s[44:45] offset:1024 sc1
    global_load_dword v211, v231, s[44:45] offset:1280 sc1
    global_load_dword v212, v231, s[44:45] offset:2048 sc1
    global_load_dword v213, v231, s[44:45] offset:2304 sc1
    global_load_dword v214, v231, s[44:45] offset:3072 sc1
    global_load_dword v215, v231, s[44:45] offset:3328 sc1
    global_load_dword v240, v234, s[50:51] sc1
    s_waitcnt vmcnt(0)
    v_max_u32 v236, v32, v33
    v_max3_u32 v236, v236, v34, v35
    v_max3_u32 v236, v236, v36, v37
    v_max3_u32 v236, v236, v38, v39
    v_max3_u32 v236, v236, v40, v41
    v_max3_u32 v236, v236, v42, v43
    v_max3_u32 v236, v236, v44, v45
    v_max3_u32 v236, v236, v46, v47
    v_max3_u32 v236, v236, v48, v49
    v_max3_u32 v236, v236, v50, v51
    v_max3_u32 v236, v236, v52, v53
    v_max3_u32 v236, v236, v54, v55
    v_max3_u32 v236, v236, v56, v57
    v_max3_u32 v236, v236, v58, v59
    v_max3_u32 v236, v236, v60, v61
    v_max3_u32 v236, v236, v62, v63
    v_max3_u32 v236, v236, v208, v209
    v_max3_u32 v236, v236, v210, v211
    v_max3_u32 v236, v236, v212, v213
    v_max3_u32 v236, v236, v214, v215
    v_cmp_eq_u32 vcc, -1, v236
    s_cbranch_vccz L_xp_dp_ok
    v_cmp_ne_u32 vcc, 0x44444444, v240
    s_cbranch_vccz L_xp_wm_ok
    s_sub_u32 s62, s62, 1
    s_cbranch_scc0 L_xp_dp
    s_movk_i32 s63, 21
    s_branch L_fail_far
L_qkvb:
    v_mov_b32 v127, v0
    v_lshlrev_b32 v1, 4, v0
    s_cmp_lg_u32 s32, 0
    s_cbranch_scc1 L_qb_arm
    s_lshl_b32 s80, s30, 13
    s_add_u32 s70, s28, s80
    s_addc_u32 s71, s29, 0
    v_mov_b64 v[4:5], 0
    v_mov_b64 v[6:7], 0
    v_add_u32 v2, 4096, v1
    global_store_dwordx4 v1, v[4:7], s[70:71] sc1
    global_store_dwordx4 v2, v[4:7], s[70:71] sc1
    s_movk_i32 s81, 12
    s_branch L_qb_cnt
L_qb_arm:
    v_mov_b64 v[4:5], -1
    v_mov_b64 v[6:7], -1
    s_lshl_b32 s80, s30, 12
    s_add_u32 s80, s80, 0x900000
    s_add_u32 s70, s28, s80
    s_addc_u32 s71, s29, 0
    global_store_dwordx4 v1, v[4:7], s[70:71] sc1
    s_lshl_b32 s80, s30, 12
    s_add_u32 s80, s80, 0xd00000
    s_add_u32 s70, s28, s80
    s_addc_u32 s71, s29, 0
    global_store_dwordx4 v1, v[4:7], s[70:71] sc1
    s_lshl_b32 s80, s30, 15
    s_add_u32 s80, s80, 0x3300000
    s_add_u32 s70, s28, s80
    s_addc_u32 s71, s29, 0
    global_store_dwordx4 v1, v[4:7], s[70:71] sc1
    s_lshl_b32 s80, s30, 15
    s_add_u32 s80, s80, 0x3301000
    s_add_u32 s70, s28, s80
    s_addc_u32 s71, s29, 0
    global_store_dwordx4 v1, v[4:7], s[70:71] sc1
    s_lshl_b32 s80, s30, 15
    s_add_u32 s80, s80, 0x3302000
    s_add_u32 s70, s28, s80
    s_addc_u32 s71, s29, 0
    global_store_dwordx4 v1, v[4:7], s[70:71] sc1
    s_lshl_b32 s80, s30, 15
    s_add_u32 s80, s80, 0x3303000
    s_add_u32 s70, s28, s80
    s_addc_u32 s71, s29, 0
    global_store_dwordx4 v1, v[4:7], s[70:71] sc1
    s_lshl_b32 s80, s30, 15
    s_add_u32 s80, s80, 0x3304000
    s_add_u32 s70, s28, s80
    s_addc_u32 s71, s29, 0
    global_store_dwordx4 v1, v[4:7], s[70:71] sc1
    s_lshl_b32 s80, s30, 15
    s_add_u32 s80, s80, 0x3305000
    s_add_u32 s70, s28, s80
    s_addc_u32 s71, s29, 0
    global_store_dwordx4 v1, v[4:7], s[70:71] sc1
    s_lshl_b32 s80, s30, 15
    s_add_u32 s80, s80, 0x3306000
    s_add_u32 s70, s28, s80
    s_addc_u32 s71, s29, 0
    global_store_dwordx4 v1, v[4:7], s[70:71] sc1
    s_lshl_b32 s80, s30, 15
    s_add_u32 s80, s80, 0x3307000
    s_add_u32 s70, s28, s80
    s_addc_u32 s71, s29, 0
    global_store_dwordx4 v1, v[4:7], s[70:71] sc1
    s_lshl_b32 s80, s30, 13
    s_add_u32 s80, s80, 0x2100000
    s_add_u32 s70, s28, s80
    s_addc_u32 s71, s29, 0
    global_store_dwordx4 v1, v[4:7], s[70:71] sc1
    s_lshl_b32 s80, s30, 13
    s_add_u32 s80, s80, 0x2140000
    s_add_u32 s70, s28, s80
    s_addc_u32 s71, s29, 0
    global_store_dwordx4 v1, v[4:7], s[70:71] sc1
    s_lshl_b32 s80, s30, 13
    s_add_u32 s80, s80, 0x2180000
    s_add_u32 s70, s28, s80
    s_addc_u32 s71, s29, 0
    global_store_dwordx4 v1, v[4:7], s[70:71] sc1
    s_lshl_b32 s80, s30, 13
    s_add_u32 s80, s80, 0x21c0000
    s_add_u32 s70, s28, s80
    s_addc_u32 s71, s29, 0
    global_store_dwordx4 v1, v[4:7], s[70:71] sc1
    s_lshl_b32 s80, s30, 13
    s_add_u32 s80, s80, 0x2200000
    s_add_u32 s70, s28, s80
    s_addc_u32 s71, s29, 0
    global_store_dwordx4 v1, v[4:7], s[70:71] sc1
    s_lshl_b32 s80, s30, 13
    s_add_u32 s80, s80, 0x2240000
    s_add_u32 s70, s28, s80
    s_addc_u32 s71, s29, 0
    global_store_dwordx4 v1, v[4:7], s[70:71] sc1
    s_lshl_b32 s80, s30, 13
    s_add_u32 s80, s80, 0x2280000
    s_add_u32 s70, s28, s80
    s_addc_u32 s71, s29, 0
    global_store_dwordx4 v1, v[4:7], s[70:71] sc1
    s_lshl_b32 s80, s30, 13
    s_add_u32 s80, s80, 0x22c0000
    s_add_u32 s70, s28, s80
    s_addc_u32 s71, s29, 0
    global_store_dwordx4 v1, v[4:7], s[70:71] sc1
    s_lshl_b32 s80, s30, 12
    s_add_u32 s80, s80, 0x5b00000
    s_add_u32 s70, s28, s80
    s_addc_u32 s71, s29, 0
    global_store_dwordx4 v1, v[4:7], s[70:71] sc1
    s_lshl_b32 s80, s30, 12
    s_add_u32 s80, s80, 0x5f00000
    s_add_u32 s70, s28, s80
    s_addc_u32 s71, s29, 0
    global_store_dwordx4 v1, v[4:7], s[70:71] sc1
    s_lshl_b32 s80, s30, 15
    s_add_u32 s80, s80, 0x8500000
    s_add_u32 s70, s28, s80
    s_addc_u32 s71, s29, 0
    global_store_dwordx4 v1, v[4:7], s[70:71] sc1
    s_lshl_b32 s80, s30, 15
    s_add_u32 s80, s80, 0x8501000
    s_add_u32 s70, s28, s80
    s_addc_u32 s71, s29, 0
    global_store_dwordx4 v1, v[4:7], s[70:71] sc1
    s_lshl_b32 s80, s30, 15
    s_add_u32 s80, s80, 0x8502000
    s_add_u32 s70, s28, s80
    s_addc_u32 s71, s29, 0
    global_store_dwordx4 v1, v[4:7], s[70:71] sc1
    s_lshl_b32 s80, s30, 15
    s_add_u32 s80, s80, 0x8503000
    s_add_u32 s70, s28, s80
    s_addc_u32 s71, s29, 0
    global_store_dwordx4 v1, v[4:7], s[70:71] sc1
    s_lshl_b32 s80, s30, 15
    s_add_u32 s80, s80, 0x8504000
    s_add_u32 s70, s28, s80
    s_addc_u32 s71, s29, 0
    global_store_dwordx4 v1, v[4:7], s[70:71] sc1
    s_lshl_b32 s80, s30, 15
    s_add_u32 s80, s80, 0x8505000
    s_add_u32 s70, s28, s80
    s_addc_u32 s71, s29, 0
    global_store_dwordx4 v1, v[4:7], s[70:71] sc1
    s_lshl_b32 s80, s30, 15
    s_add_u32 s80, s80, 0x8506000
    s_add_u32 s70, s28, s80
    s_addc_u32 s71, s29, 0
    global_store_dwordx4 v1, v[4:7], s[70:71] sc1
    s_lshl_b32 s80, s30, 15
    s_add_u32 s80, s80, 0x8507000
    s_add_u32 s70, s28, s80
    s_addc_u32 s71, s29, 0
    global_store_dwordx4 v1, v[4:7], s[70:71] sc1
    s_lshl_b32 s80, s30, 13
    s_add_u32 s80, s80, 0x7300000
    s_add_u32 s70, s28, s80
    s_addc_u32 s71, s29, 0
    global_store_dwordx4 v1, v[4:7], s[70:71] sc1
    s_lshl_b32 s80, s30, 13
    s_add_u32 s80, s80, 0x7340000
    s_add_u32 s70, s28, s80
    s_addc_u32 s71, s29, 0
    global_store_dwordx4 v1, v[4:7], s[70:71] sc1
    s_lshl_b32 s80, s30, 13
    s_add_u32 s80, s80, 0x7380000
    s_add_u32 s70, s28, s80
    s_addc_u32 s71, s29, 0
    global_store_dwordx4 v1, v[4:7], s[70:71] sc1
    s_lshl_b32 s80, s30, 13
    s_add_u32 s80, s80, 0x73c0000
    s_add_u32 s70, s28, s80
    s_addc_u32 s71, s29, 0
    global_store_dwordx4 v1, v[4:7], s[70:71] sc1
    s_lshl_b32 s80, s30, 13
    s_add_u32 s80, s80, 0x7400000
    s_add_u32 s70, s28, s80
    s_addc_u32 s71, s29, 0
    global_store_dwordx4 v1, v[4:7], s[70:71] sc1
    s_lshl_b32 s80, s30, 13
    s_add_u32 s80, s80, 0x7440000
    s_add_u32 s70, s28, s80
    s_addc_u32 s71, s29, 0
    global_store_dwordx4 v1, v[4:7], s[70:71] sc1
    s_lshl_b32 s80, s30, 13
    s_add_u32 s80, s80, 0x7480000
    s_add_u32 s70, s28, s80
    s_addc_u32 s71, s29, 0
    global_store_dwordx4 v1, v[4:7], s[70:71] sc1
    s_lshl_b32 s80, s30, 13
    s_add_u32 s80, s80, 0x74c0000
    s_add_u32 s70, s28, s80
    s_addc_u32 s71, s29, 0
    global_store_dwordx4 v1, v[4:7], s[70:71] sc1
    s_lshl_b32 s80, s30, 12
    s_add_u32 s80, s80, 0x58e0000
    s_add_u32 s70, s28, s80
    s_addc_u32 s71, s29, 0
    global_store_dwordx4 v1, v[4:7], s[70:71] sc1
    s_lshl_b32 s80, s30, 12
    s_add_u32 s80, s80, 0x5ae0000
    s_add_u32 s70, s28, s80
    s_addc_u32 s71, s29, 0
    global_store_dwordx4 v1, v[4:7], s[70:71] sc1
    s_movk_i32 s81, 64
L_qb_cnt:
    s_waitcnt vmcnt(0)
    s_barrier
    s_cmp_lg_u32 s31, 0
    s_cbranch_scc1 L_qb_noz
    v_mov_b32 v1, s81
    v_mov_b32 v2, 1
    s_mov_b64 exec, 1
    global_atomic_add v1, v2, s[26:27]
    s_mov_b64 exec, -1
    s_waitcnt vmcnt(0)
L_qb_noz:
    s_lshl_b32 s37, s32, 4
    s_lshr_b32 s80, s30, 1
    s_add_u32 s37, s37, s80
    s_and_b32 s32, s30, 1
    s_lshl_b32 s80, s37, 8
    s_cmp_eq_u32 s32, 0
    s_cselect_b64 s[74:75], s[16:17], s[18:19]
    s_add_u32 s70, s74, s80
    s_addc_u32 s71, s75, 0
    s_add_u32 s72, s14, s80
    s_addc_u32 s73, s15, 0
    v_mov_b32 v65, 0x0
    v_bfe_u32 v64, v127, 4, 2
    v_lshl_add_u32 v65, v64, 13, v65
    v_bfe_u32 v64, v127, 6, 2
    v_lshl_add_u32 v65, v64, 18, v65
    v_mov_b32 v66, 0x0
    v_bfe_i32 v64, v127, 0, 1
    v_and_b32 v64, 0x10, v64
    v_xor_b32 v66, v66, v64
    v_bfe_i32 v64, v127, 1, 1
    v_and_b32 v64, 0x20, v64
    v_xor_b32 v66, v66, v64
    v_bfe_i32 v64, v127, 2, 1
    v_and_b32 v64, 0x40, v64
    v_xor_b32 v66, v66, v64
    v_bfe_i32 v64, v127, 3, 1
    v_and_b32 v64, 0x80, v64
    v_xor_b32 v66, v66, v64
    v_bfe_i32 v64, v127, 4, 1
    v_and_b32 v64, 0x40, v64
    v_xor_b32 v66, v66, v64
    v_bfe_i32 v64, v127, 5, 1
    v_and_b32 v64, 0x80, v64
    v_xor_b32 v66, v66, v64
    v_add_u32 v65, v65, v66
    v_mov_b32 v66, 0x8000
    v_bfe_u32 v64, v127, 4, 2
    v_lshl_add_u32 v66, v64, 13, v66
    v_bfe_u32 v64, v127, 6, 2
    v_lshl_add_u32 v66, v64, 18, v66
    v_mov_b32 v67, 0x0
    v_bfe_i32 v64, v127, 0, 1
    v_and_b32 v64, 0x10, v64
    v_xor_b32 v67, v67, v64
    v_bfe_i32 v64, v127, 1, 1
    v_and_b32 v64, 0x20, v64
    v_xor_b32 v67, v67, v64
    v_bfe_i32 v64, v127, 2, 1
    v_and_b32 v64, 0x40, v64
    v_xor_b32 v67, v67, v64
    v_bfe_i32 v64, v127, 3, 1
    v_and_b32 v64, 0x80, v64
    v_xor_b32 v67, v67, v64
    v_bfe_i32 v64, v127, 4, 1
    v_and_b32 v64, 0x40, v64
    v_xor_b32 v67, v67, v64
    v_bfe_i32 v64, v127, 5, 1
    v_and_b32 v64, 0x80, v64
    v_xor_b32 v67, v67, v64
    v_add_u32 v66, v66, v67
    v_mov_b32 v67, 0x10000
    v_bfe_u32 v64, v127, 4, 2
    v_lshl_add_u32 v67, v64, 13, v67
    v_bfe_u32 v64, v127, 6, 2
    v_lshl_add_u32 v67, v64, 18, v67
    v_mov_b32 v68, 0x0
    v_bfe_i32 v64, v127, 0, 1
    v_and_b32 v64, 0x10, v64
    v_xor_b32 v68, v68, v64
    v_bfe_i32 v64, v127, 1, 1
    v_and_b32 v64, 0x20, v64
    v_xor_b32 v68, v68, v64
    v_bfe_i32 v64, v127, 2, 1
    v_and_b32 v64, 0x40, v64
    v_xor_b32 v68, v68, v64
    v_bfe_i32 v64, v127, 3, 1
    v_and_b32 v64, 0x80, v64
    v_xor_b32 v68, v68, v64
    v_bfe_i32 v64, v127, 4, 1
    v_and_b32 v64, 0x40, v64
    v_xor_b32 v68, v68, v64
    v_bfe_i32 v64, v127, 5, 1
    v_and_b32 v64, 0x80, v64
    v_xor_b32 v68, v68, v64
    v_add_u32 v67, v67, v68
    v_mov_b32 v68, 0x18000
    v_bfe_u32 v64, v127, 4, 2
    v_lshl_add_u32 v68, v64, 13, v68
    v_bfe_u32 v64, v127, 6, 2
    v_lshl_add_u32 v68, v64, 18, v68
    v_mov_b32 v69, 0x0
    v_bfe_i32 v64, v127, 0, 1
    v_and_b32 v64, 0x10, v64
    v_xor_b32 v69, v69, v64
    v_bfe_i32 v64, v127, 1, 1
    v_and_b32 v64, 0x20, v64
    v_xor_b32 v69, v69, v64
    v_bfe_i32 v64, v127, 2, 1
    v_and_b32 v64, 0x40, v64
    v_xor_b32 v69, v69, v64
    v_bfe_i32 v64, v127, 3, 1
    v_and_b32 v64, 0x80, v64
    v_xor_b32 v69, v69, v64
    v_bfe_i32 v64, v127, 4, 1
    v_and_b32 v64, 0x40, v64
    v_xor_b32 v69, v69, v64
    v_bfe_i32 v64, v127, 5, 1
    v_and_b32 v64, 0x80, v64
    v_xor_b32 v69, v69, v64
    v_add_u32 v68, v68, v69
    v_mov_b32 v69, 0x20000
    v_bfe_u32 v64, v127, 4, 2
    v_lshl_add_u32 v69, v64, 13, v69
    v_bfe_u32 v64, v127, 6, 2
    v_lshl_add_u32 v69, v64, 18, v69
    v_mov_b32 v70, 0x0
    v_bfe_i32 v64, v127, 0, 1
    v_and_b32 v64, 0x10, v64
    v_xor_b32 v70, v70, v64
    v_bfe_i32 v64, v127, 1, 1
    v_and_b32 v64, 0x20, v64
    v_xor_b32 v70, v70, v64
    v_bfe_i32 v64, v127, 2, 1
    v_and_b32 v64, 0x40, v64
    v_xor_b32 v70, v70, v64
    v_bfe_i32 v64, v127, 3, 1
    v_and_b32 v64, 0x80, v64
    v_xor_b32 v70, v70, v64
    v_bfe_i32 v64, v127, 4, 1
    v_and_b32 v64, 0x40, v64
    v_xor_b32 v70, v70, v64
    v_bfe_i32 v64, v127, 5, 1
    v_and_b32 v64, 0x80, v64
    v_xor_b32 v70, v70, v64
    v_add_u32 v69, v69, v70
    v_mov_b32 v70, 0x28000
    v_bfe_u32 v64, v127, 4, 2
    v_lshl_add_u32 v70, v64, 13, v70
    v_bfe_u32 v64, v127, 6, 2
    v_lshl_add_u32 v70, v64, 18, v70
    v_mov_b32 v71, 0x0
    v_bfe_i32 v64, v127, 0, 1
    v_and_b32 v64, 0x10, v64
    v_xor_b32 v71, v71, v64
    v_bfe_i32 v64, v127, 1, 1
    v_and_b32 v64, 0x20, v64
    v_xor_b32 v71, v71, v64
    v_bfe_i32 v64, v127, 2, 1
    v_and_b32 v64, 0x40, v64
    v_xor_b32 v71, v71, v64
    v_bfe_i32 v64, v127, 3, 1
    v_and_b32 v64, 0x80, v64
    v_xor_b32 v71, v71, v64
    v_bfe_i32 v64, v127, 4, 1
    v_and_b32 v64, 0x40, v64
    v_xor_b32 v71, v71, v64
    v_bfe_i32 v64, v127, 5, 1
    v_and_b32 v64, 0x80, v64
    v_xor_b32 v71, v71, v64
    v_add_u32 v70, v70, v71
    v_mov_b32 v71, 0x30000
    v_bfe_u32 v64, v127, 4, 2
    v_lshl_add_u32 v71, v64, 13, v71
    v_bfe_u32 v64, v127, 6, 2
    v_lshl_add_u32 v71, v64, 18, v71
    v_mov_b32 v72, 0x0
    v_bfe_i32 v64, v127, 0, 1
    v_and_b32 v64, 0x10, v64
    v_xor_b32 v72, v72, v64
    v_bfe_i32 v64, v127, 1, 1
    v_and_b32 v64, 0x20, v64
    v_xor_b32 v72, v72, v64
    v_bfe_i32 v64, v127, 2, 1
    v_and_b32 v64, 0x40, v64
    v_xor_b32 v72, v72, v64
    v_bfe_i32 v64, v127, 3, 1
    v_and_b32 v64, 0x80, v64
    v_xor_b32 v72, v72, v64
    v_bfe_i32 v64, v127, 4, 1
    v_and_b32 v64, 0x40, v64
    v_xor_b32 v72, v72, v64
    v_bfe_i32 v64, v127, 5, 1
    v_and_b32 v64, 0x80, v64
    v_xor_b32 v72, v72, v64
    v_add_u32 v71, v71, v72
    v_mov_b32 v72, 0x38000
    v_bfe_u32 v64, v127, 4, 2
    v_lshl_add_u32 v72, v64, 13, v72
    v_bfe_u32 v64, v127, 6, 2
    v_lshl_add_u32 v72, v64, 18, v72
    v_mov_b32 v73, 0x0
    v_bfe_i32 v64, v127, 0, 1
    v_and_b32 v64, 0x10, v64
    v_xor_b32 v73, v73, v64
    v_bfe_i32 v64, v127, 1, 1
    v_and_b32 v64, 0x20, v64
    v_xor_b32 v73, v73, v64
    v_bfe_i32 v64, v127, 2, 1
    v_and_b32 v64, 0x40, v64
    v_xor_b32 v73, v73, v64
    v_bfe_i32 v64, v127, 3, 1
    v_and_b32 v64, 0x80, v64
    v_xor_b32 v73, v73, v64
    v_bfe_i32 v64, v127, 4, 1
    v_and_b32 v64, 0x40, v64
    v_xor_b32 v73, v73, v64
    v_bfe_i32 v64, v127, 5, 1
    v_and_b32 v64, 0x80, v64
    v_xor_b32 v73, v73, v64
    v_add_u32 v72, v72, v73
    v_mov_b32 v74, 0x0
    v_bfe_i32 v64, v127, 0, 1
    v_and_b32 v64, 0x10, v64
    v_xor_b32 v74, v74, v64
    v_bfe_i32 v64, v127, 1, 1
    v_and_b32 v64, 0x8, v64
    v_xor_b32 v74, v74, v64
    v_bfe_i32 v64, v127, 2, 1
    v_and_b32 v64, 0x140, v64
    v_xor_b32 v74, v74, v64
    v_bfe_i32 v64, v127, 3, 1
    v_and_b32 v64, 0x280, v64
    v_xor_b32 v74, v74, v64
    v_bfe_i32 v64, v127, 4, 1
    v_and_b32 v64, 0x20, v64
    v_xor_b32 v74, v74, v64
    v_bfe_i32 v64, v127, 5, 1
    v_and_b32 v64, 0x800, v64
    v_xor_b32 v74, v74, v64
    v_bfe_i32 v64, v127, 6, 1
    v_and_b32 v64, 0x40, v64
    v_xor_b32 v74, v74, v64
    v_bfe_i32 v64, v127, 7, 1
    v_and_b32 v64, 0x80, v64
    v_xor_b32 v74, v74, v64
    s_lshl_b32 s64, s31, 13
    s_add_u32 s66, s70, 0x0
    s_addc_u32 s67, s71, 0
    s_add_u32 m0, s64, 0x0
    s_nop 0
    global_load_lds_dwordx4 v65, s[66:67]
    s_add_u32 m0, s64, 0x400
    s_nop 0
    global_load_lds_dwordx4 v66, s[66:67]
    s_add_u32 m0, s64, 0x800
    s_nop 0
    global_load_lds_dwordx4 v67, s[66:67]
    s_add_u32 m0, s64, 0xc00
    s_nop 0
    global_load_lds_dwordx4 v68, s[66:67]
    s_add_u32 m0, s64, 0x1000
    s_nop 0
    global_load_lds_dwordx4 v69, s[66:67]
    s_add_u32 m0, s64, 0x1400
    s_nop 0
    global_load_lds_dwordx4 v70, s[66:67]
    s_add_u32 m0, s64, 0x1800
    s_nop 0
    global_load_lds_dwordx4 v71, s[66:67]
    s_add_u32 m0, s64, 0x1c00
    s_nop 0
    global_load_lds_dwordx4 v72, s[66:67]
    s_add_u32 s66, s70, 0x100000
    s_addc_u32 s67, s71, 0
    s_add_u32 m0, s64, 0x8000
    s_nop 0
    global_load_lds_dwordx4 v65, s[66:67]
    s_add_u32 m0, s64, 0x8400
    s_nop 0
    global_load_lds_dwordx4 v66, s[66:67]
    s_add_u32 m0, s64, 0x8800
    s_nop 0
    global_load_lds_dwordx4 v67, s[66:67]
    s_add_u32 m0, s64, 0x8c00
    s_nop 0
    global_load_lds_dwordx4 v68, s[66:67]
    s_add_u32 m0, s64, 0x9000
    s_nop 0
    global_load_lds_dwordx4 v69, s[66:67]
    s_add_u32 m0, s64, 0x9400
    s_nop 0
    global_load_lds_dwordx4 v70, s[66:67]
    s_add_u32 m0, s64, 0x9800
    s_nop 0
    global_load_lds_dwordx4 v71, s[66:67]
    s_add_u32 m0, s64, 0x9c00
    s_nop 0
    global_load_lds_dwordx4 v72, s[66:67]
    s_add_u32 s66, s70, 0x200000
    s_addc_u32 s67, s71, 0
    s_add_u32 m0, s64, 0x10000
    s_nop 0
    global_load_lds_dwordx4 v65, s[66:67]
    s_add_u32 m0, s64, 0x10400
    s_nop 0
    global_load_lds_dwordx4 v66, s[66:67]
    s_add_u32 m0, s64, 0x10800
    s_nop 0
    global_load_lds_dwordx4 v67, s[66:67]
    s_add_u32 m0, s64, 0x10c00
    s_nop 0
    global_load_lds_dwordx4 v68, s[66:67]
    s_add_u32 m0, s64, 0x11000
    s_nop 0
    global_load_lds_dwordx4 v69, s[66:67]
    s_add_u32 m0, s64, 0x11400
    s_nop 0
    global_load_lds_dwordx4 v70, s[66:67]
    s_add_u32 m0, s64, 0x11800
    s_nop 0
    global_load_lds_dwordx4 v71, s[66:67]
    s_add_u32 m0, s64, 0x11c00
    s_nop 0
    global_load_lds_dwordx4 v72, s[66:67]
    s_add_u32 s66, s70, 0x300000
    s_addc_u32 s67, s71, 0
    s_add_u32 m0, s64, 0x18000
    s_nop 0
    global_load_lds_dwordx4 v65, s[66:67]
    s_add_u32 m0, s64, 0x18400
    s_nop 0
    global_load_lds_dwordx4 v66, s[66:67]
    s_add_u32 m0, s64, 0x18800
    s_nop 0
    global_load_lds_dwordx4 v67, s[66:67]
    s_add_u32 m0, s64, 0x18c00
    s_nop 0
    global_load_lds_dwordx4 v68, s[66:67]
    s_add_u32 m0, s64, 0x19000
    s_nop 0
    global_load_lds_dwordx4 v69, s[66:67]
    s_add_u32 m0, s64, 0x19400
    s_nop 0
    global_load_lds_dwordx4 v70, s[66:67]
    s_add_u32 m0, s64, 0x19800
    s_nop 0
    global_load_lds_dwordx4 v71, s[66:67]
    s_add_u32 m0, s64, 0x19c00
    s_nop 0
    global_load_lds_dwordx4 v72, s[66:67]
    s_waitcnt vmcnt(24)
    s_barrier
    s_add_u32 s66, s72, 0x0
    s_addc_u32 s67, s73, 0
    s_add_u32 m0, s64, 0x20000
    s_nop 0
    global_load_lds_dwordx4 v65, s[66:67]
    s_add_u32 m0, s64, 0x20400
    s_nop 0
    global_load_lds_dwordx4 v66, s[66:67]
    s_add_u32 m0, s64, 0x20800
    s_nop 0
    global_load_lds_dwordx4 v67, s[66:67]
    s_add_u32 m0, s64, 0x20c00
    s_nop 0
    global_load_lds_dwordx4 v68, s[66:67]
    s_add_u32 m0, s64, 0x21000
    s_nop 0
    global_load_lds_dwordx4 v69, s[66:67]
    s_add_u32 m0, s64, 0x21400
    s_nop 0
    global_load_lds_dwordx4 v70, s[66:67]
    s_add_u32 m0, s64, 0x21800
    s_nop 0
    global_load_lds_dwordx4 v71, s[66:67]
    s_add_u32 m0, s64, 0x21c00
    s_nop 0
    global_load_lds_dwordx4 v72, s[66:67]
    v_add_u32 v90, 0x0, v74
    ds_read_b64_tr_b16 a[0:1], v90 offset:0
    ds_read_b64_tr_b16 a[2:3], v90 offset:1024
    ds_read_b64_tr_b16 a[4:5], v90 offset:4096
    ds_read_b64_tr_b16 a[6:7], v90 offset:5120
    ds_read_b64_tr_b16 a[8:9], v90 offset:8192
    ds_read_b64_tr_b16 a[10:11], v90 offset:9216
    ds_read_b64_tr_b16 a[12:13], v90 offset:12288
    ds_read_b64_tr_b16 a[14:15], v90 offset:13312
    ds_read_b64_tr_b16 a[16:17], v90 offset:16384
    ds_read_b64_tr_b16 a[18:19], v90 offset:17408
    ds_read_b64_tr_b16 a[20:21], v90 offset:20480
    ds_read_b64_tr_b16 a[22:23], v90 offset:21504
    ds_read_b64_tr_b16 a[24:25], v90 offset:24576
    ds_read_b64_tr_b16 a[26:27], v90 offset:25600
    ds_read_b64_tr_b16 a[28:29], v90 offset:28672
    ds_read_b64_tr_b16 a[30:31], v90 offset:29696
L_lw_72:
    s_waitcnt lgkmcnt(0)
    s_waitcnt vmcnt(24)
    s_barrier
    s_add_u32 s66, s72, 0x100000
    s_addc_u32 s67, s73, 0
    s_add_u32 m0, s64, 0x0
    s_nop 0
    global_load_lds_dwordx4 v65, s[66:67]
    s_add_u32 m0, s64, 0x400
    s_nop 0
    global_load_lds_dwordx4 v66, s[66:67]
    s_add_u32 m0, s64, 0x800
    s_nop 0
    global_load_lds_dwordx4 v67, s[66:67]
    s_add_u32 m0, s64, 0xc00
    s_nop 0
    global_load_lds_dwordx4 v68, s[66:67]
    s_add_u32 m0, s64, 0x1000
    s_nop 0
    global_load_lds_dwordx4 v69, s[66:67]
    s_add_u32 m0, s64, 0x1400
    s_nop 0
    global_load_lds_dwordx4 v70, s[66:67]
    s_add_u32 m0, s64, 0x1800
    s_nop 0
    global_load_lds_dwordx4 v71, s[66:67]
    s_add_u32 m0, s64, 0x1c00
    s_nop 0
    global_load_lds_dwordx4 v72, s[66:67]
    v_add_u32 v90, 0x8000, v74
    ds_read_b64_tr_b16 a[32:33], v90 offset:0
    ds_read_b64_tr_b16 a[34:35], v90 offset:1024
    ds_read_b64_tr_b16 a[36:37], v90 offset:4096
    ds_read_b64_tr_b16 a[38:39], v90 offset:5120
    ds_read_b64_tr_b16 a[40:41], v90 offset:8192
    ds_read_b64_tr_b16 a[42:43], v90 offset:9216
    ds_read_b64_tr_b16 a[44:45], v90 offset:12288
    ds_read_b64_tr_b16 a[46:47], v90 offset:13312
    ds_read_b64_tr_b16 a[48:49], v90 offset:16384
    ds_read_b64_tr_b16 a[50:51], v90 offset:17408
    ds_read_b64_tr_b16 a[52:53], v90 offset:20480
    ds_read_b64_tr_b16 a[54:55], v90 offset:21504
    ds_read_b64_tr_b16 a[56:57], v90 offset:24576
    ds_read_b64_tr_b16 a[58:59], v90 offset:25600
    ds_read_b64_tr_b16 a[60:61], v90 offset:28672
    ds_read_b64_tr_b16 a[62:63], v90 offset:29696
L_lw_73:
    s_waitcnt lgkmcnt(0)
    s_waitcnt vmcnt(24)
    s_barrier
    s_add_u32 s66, s72, 0x200000
    s_addc_u32 s67, s73, 0
    s_add_u32 m0, s64, 0x8000
    s_nop 0
    global_load_lds_dwordx4 v65, s[66:67]
    s_add_u32 m0, s64, 0x8400
    s_nop 0
    global_load_lds_dwordx4 v66, s[66:67]
    s_add_u32 m0, s64, 0x8800
    s_nop 0
    global_load_lds_dwordx4 v67, s[66:67]
    s_add_u32 m0, s64, 0x8c00
    s_nop 0
    global_load_lds_dwordx4 v68, s[66:67]
    s_add_u32 m0, s64, 0x9000
    s_nop 0
    global_load_lds_dwordx4 v69, s[66:67]
    s_add_u32 m0, s64, 0x9400
    s_nop 0
    global_load_lds_dwordx4 v70, s[66:67]
    s_add_u32 m0, s64, 0x9800
    s_nop 0
    global_load_lds_dwordx4 v71, s[66:67]
    s_add_u32 m0, s64, 0x9c00
    s_nop 0
    global_load_lds_dwordx4 v72, s[66:67]
    v_add_u32 v90, 0x10000, v74
    ds_read_b64_tr_b16 a[64:65], v90 offset:0
    ds_read_b64_tr_b16 a[66:67], v90 offset:1024
    ds_read_b64_tr_b16 a[68:69], v90 offset:4096
    ds_read_b64_tr_b16 a[70:71], v90 offset:5120
    ds_read_b64_tr_b16 a[72:73], v90 offset:8192
    ds_read_b64_tr_b16 a[74:75], v90 offset:9216
    ds_read_b64_tr_b16 a[76:77], v90 offset:12288
    ds_read_b64_tr_b16 a[78:79], v90 offset:13312
    ds_read_b64_tr_b16 a[80:81], v90 offset:16384
    ds_read_b64_tr_b16 a[82:83], v90 offset:17408
    ds_read_b64_tr_b16 a[84:85], v90 offset:20480
    ds_read_b64_tr_b16 a[86:87], v90 offset:21504
    ds_read_b64_tr_b16 a[88:89], v90 offset:24576
    ds_read_b64_tr_b16 a[90:91], v90 offset:25600
    ds_read_b64_tr_b16 a[92:93], v90 offset:28672
    ds_read_b64_tr_b16 a[94:95], v90 offset:29696
L_lw_74:
    s_waitcnt lgkmcnt(0)
    s_waitcnt vmcnt(24)
    s_barrier
    s_add_u32 s66, s72, 0x300000
    s_addc_u32 s67, s73, 0
    s_add_u32 m0, s64, 0x10000
    s_nop 0
    global_load_lds_dwordx4 v65, s[66:67]
    s_add_u32 m0, s64, 0x10400
    s_nop 0
    global_load_lds_dwordx4 v66, s[66:67]
    s_add_u32 m0, s64, 0x10800
    s_nop 0
    global_load_lds_dwordx4 v67, s[66:67]
    s_add_u32 m0, s64, 0x10c00
    s_nop 0
    global_load_lds_dwordx4 v68, s[66:67]
    s_add_u32 m0, s64, 0x11000
    s_nop 0
    global_load_lds_dwordx4 v69, s[66:67]
    s_add_u32 m0, s64, 0x11400
    s_nop 0
    global_load_lds_dwordx4 v70, s[66:67]
    s_add_u32 m0, s64, 0x11800
    s_nop 0
    global_load_lds_dwordx4 v71, s[66:67]
    s_add_u32 m0, s64, 0x11c00
    s_nop 0
    global_load_lds_dwordx4 v72, s[66:67]
    v_add_u32 v90, 0x18000, v74
    ds_read_b64_tr_b16 a[96:97], v90 offset:0
    ds_read_b64_tr_b16 a[98:99], v90 offset:1024
    ds_read_b64_tr_b16 a[100:101], v90 offset:4096
    ds_read_b64_tr_b16 a[102:103], v90 offset:5120
    ds_read_b64_tr_b16 a[104:105], v90 offset:8192
    ds_read_b64_tr_b16 a[106:107], v90 offset:9216
    ds_read_b64_tr_b16 a[108:109], v90 offset:12288
    ds_read_b64_tr_b16 a[110:111], v90 offset:13312
    ds_read_b64_tr_b16 a[112:113], v90 offset:16384
    ds_read_b64_tr_b16 a[114:115], v90 offset:17408
    ds_read_b64_tr_b16 a[116:117], v90 offset:20480
    ds_read_b64_tr_b16 a[118:119], v90 offset:21504
    ds_read_b64_tr_b16 a[120:121], v90 offset:24576
    ds_read_b64_tr_b16 a[122:123], v90 offset:25600
    ds_read_b64_tr_b16 a[124:125], v90 offset:28672
    ds_read_b64_tr_b16 a[126:127], v90 offset:29696
L_lw_75:
    s_waitcnt lgkmcnt(0)
    s_waitcnt vmcnt(24)
    s_barrier
    v_add_u32 v90, 0x20000, v74
    ds_read_b64_tr_b16 a[128:129], v90 offset:0
    ds_read_b64_tr_b16 a[130:131], v90 offset:1024
    ds_read_b64_tr_b16 a[132:133], v90 offset:4096
    ds_read_b64_tr_b16 a[134:135], v90 offset:5120
    ds_read_b64_tr_b16 a[136:137], v90 offset:8192
    ds_read_b64_tr_b16 a[138:139], v90 offset:9216
    ds_read_b64_tr_b16 a[140:141], v90 offset:12288
    ds_read_b64_tr_b16 a[142:143], v90 offset:13312
    ds_read_b64_tr_b16 a[144:145], v90 offset:16384
    ds_read_b64_tr_b16 a[146:147], v90 offset:17408
    ds_read_b64_tr_b16 a[148:149], v90 offset:20480
    ds_read_b64_tr_b16 a[150:151], v90 offset:21504
    ds_read_b64_tr_b16 a[152:153], v90 offset:24576
    ds_read_b64_tr_b16 a[154:155], v90 offset:25600
    ds_read_b64_tr_b16 a[156:157], v90 offset:28672
    ds_read_b64_tr_b16 a[158:159], v90 offset:29696
L_lw_76:
    s_waitcnt lgkmcnt(0)
    s_waitcnt vmcnt(16)
    s_barrier
    v_add_u32 v90, 0x0, v74
    ds_read_b64_tr_b16 a[160:161], v90 offset:0
    ds_read_b64_tr_b16 a[162:163], v90 offset:1024
    ds_read_b64_tr_b16 a[164:165], v90 offset:4096
    ds_read_b64_tr_b16 a[166:167], v90 offset:5120
    ds_read_b64_tr_b16 a[168:169], v90 offset:8192
    ds_read_b64_tr_b16 a[170:171], v90 offset:9216
    ds_read_b64_tr_b16 a[172:173], v90 offset:12288
    ds_read_b64_tr_b16 a[174:175], v90 offset:13312
    ds_read_b64_tr_b16 a[176:177], v90 offset:16384
    ds_read_b64_tr_b16 a[178:179], v90 offset:17408
    ds_read_b64_tr_b16 a[180:181], v90 offset:20480
    ds_read_b64_tr_b16 a[182:183], v90 offset:21504
    ds_read_b64_tr_b16 a[184:185], v90 offset:24576
    ds_read_b64_tr_b16 a[186:187], v90 offset:25600
    ds_read_b64_tr_b16 a[188:189], v90 offset:28672
    ds_read_b64_tr_b16 a[190:191], v90 offset:29696
L_lw_77:
    s_waitcnt lgkmcnt(0)
    s_waitcnt vmcnt(8)
    s_barrier
    v_add_u32 v90, 0x8000, v74
    ds_read_b64_tr_b16 a[192:193], v90 offset:0
    ds_read_b64_tr_b16 a[194:195], v90 offset:1024
    ds_read_b64_tr_b16 a[196:197], v90 offset:4096
    ds_read_b64_tr_b16 a[198:199], v90 offset:5120
    ds_read_b64_tr_b16 a[200:201], v90 offset:8192
    ds_read_b64_tr_b16 a[202:203], v90 offset:9216
    ds_read_b64_tr_b16 a[204:205], v90 offset:12288
    ds_read_b64_tr_b16 a[206:207], v90 offset:13312
    ds_read_b64_tr_b16 a[208:209], v90 offset:16384
    ds_read_b64_tr_b16 a[210:211], v90 offset:17408
    ds_read_b64_tr_b16 a[212:213], v90 offset:20480
    ds_read_b64_tr_b16 a[214:215], v90 offset:21504
    ds_read_b64_tr_b16 a[216:217], v90 offset:24576
    ds_read_b64_tr_b16 a[218:219], v90 offset:25600
    ds_read_b64_tr_b16 a[220:221], v90 offset:28672
    ds_read_b64_tr_b16 a[222:223], v90 offset:29696
L_lw_78:
    s_waitcnt lgkmcnt(0)
    s_waitcnt vmcnt(0)
    s_barrier
    v_add_u32 v90, 0x10000, v74
    ds_read_b64_tr_b16 a[224:225], v90 offset:0
    ds_read_b64_tr_b16 a[226:227], v90 offset:1024
    ds_read_b64_tr_b16 a[228:229], v90 offset:4096
    ds_read_b64_tr_b16 a[230:231], v90 offset:5120
    ds_read_b64_tr_b16 a[232:233], v90 offset:8192
    ds_read_b64_tr_b16 a[234:235], v90 offset:9216
    ds_read_b64_tr_b16 a[236:237], v90 offset:12288
    ds_read_b64_tr_b16 a[238:239], v90 offset:13312
    ds_read_b64_tr_b16 a[240:241], v90 offset:16384
    ds_read_b64_tr_b16 a[242:243], v90 offset:17408
    ds_read_b64_tr_b16 a[244:245], v90 offset:20480
    ds_read_b64_tr_b16 a[246:247], v90 offset:21504
    ds_read_b64_tr_b16 a[248:249], v90 offset:24576
    ds_read_b64_tr_b16 a[250:251], v90 offset:25600
    ds_read_b64_tr_b16 a[252:253], v90 offset:28672
    ds_read_b64_tr_b16 a[254:255], v90 offset:29696
L_lw_79:
    s_waitcnt lgkmcnt(0)
    v_mov_b32 v110, 0x0
    v_bfe_u32 v64, v127, 0, 6
    v_lshl_add_u32 v110, v64, 4, v110
    v_mov_b32 v111, 0x0
    v_bfe_u32 v64, v127, 0, 2
    v_lshl_add_u32 v111, v64, 7, v111
    v_mov_b32 v112, 0
    v_mov_b32 v113, 1
    s_mov_b32 s48, 0x3e0293ee
    s_mov_b32 s49, s48
    s_mov_b32 s34, 0
    s_mov_b32 s56, 0x0
    s_mov_b32 s57, 0x8000
    s_mov_b32 s58, 0x10000
    s_mov_b32 s59, 0x18000
    s_mov_b32 s60, 0x20000
    s_add_u32 s40, s28, 0xa000
    s_addc_u32 s41, s29, 0
    s_mov_b32 s54, 2
    s_mov_b32 s55, 1
    s_lshl_b32 s36, s31, 13
    s_cmp_lg_u32 s31, 0
    s_cbranch_scc1 L_qb_init_ok
    v_mov_b32 v64, 12
L_qb_init:
    global_load_dword v65, v64, s[26:27] sc1
    s_waitcnt vmcnt(0)
    v_readfirstlane_b32 s80, v65
    s_cmp_ge_u32 s80, 32
    s_cbranch_scc1 L_qb_init_ok
    s_sleep 4
    s_sub_u32 s62, s62, 1
    s_cbranch_scc0 L_qb_init
    s_movk_i32 s63, 10
    s_branch L_fail_far
L_qb_init_ok:
    s_cmp_lg_u32 s31, 0
    s_cbranch_scc1 L_qb_init2_ok
    v_mov_b32 v64, 64
L_qb_init2:
    global_load_dword v65, v64, s[26:27] sc1
    s_waitcnt vmcnt(0)
    v_readfirstlane_b32 s80, v65
    s_cmp_ge_u32 s80, 32
    s_cbranch_scc1 L_qb_init2_ok
    s_sleep 4
    s_sub_u32 s62, s62, 1
    s_cbranch_scc0 L_qb_init2
    s_movk_i32 s63, 10
    s_branch L_fail_far
L_qb_init2_ok:
    s_barrier
L_qb_layer:
    s_mov_b32 s33, 0
    s_mul_i32 s80, s34, 0x5200000
    s_add_u32 s81, s36, s80
    s_add_u32 s81, s81, 0xd00000
    s_add_u32 s38, s28, s81
    s_addc_u32 s39, s29, 0
    s_lshl_b32 s82, s31, 11
    s_add_u32 s82, s82, s80
    s_lshl_b32 s83, s37, 13
    s_add_u32 s83, s83, s82
    s_lshl_b32 s84, s32, 18
    s_add_u32 s83, s83, s84
    s_add_u32 s83, s83, 0x2300000
    s_add_u32 s42, s28, s83
    s_addc_u32 s43, s29, 0
    s_lshl_b32 s83, s37, 14
    s_add_u32 s83, s83, s82
    s_lshl_b32 s84, s32, 13
    s_add_u32 s83, s83, s84
    s_add_u32 s83, s83, 0x3300000
    s_add_u32 s44, s28, s83
    s_addc_u32 s45, s29, 0
    s_lshl_b32 s80, s34, 17
    s_lshl_b32 s81, s37, 10
    s_add_u32 s81, s81, s80
    s_add_u32 s81, s81, 0xc000
    s_add_u32 s81, s81, s31
    s_lshl_b32 s82, s32, 2
    s_add_u32 s82, s82, s81
    s_add_u32 s46, s28, s82
    s_addc_u32 s47, s29, 0
    s_lshl_b32 s82, s32, 4
    s_add_u32 s82, s82, s81
    s_add_u32 s50, s28, s82
    s_addc_u32 s51, s29, 0
    s_mov_b32 s52, 0
    s_add_u32 s80, s38, 0x1000
    s_addc_u32 s81, s39, 0
    s_add_u32 s82, s38, 0x9000
    s_addc_u32 s83, s39, 0
L_qb_dp0:
    global_load_dwordx4 v[128:131], v110, s[80:81] offset:3072 sc1
    s_waitcnt vmcnt(0)
    v_max_u32 v114, v128, v129
    v_max3_u32 v114, v114, v130, v131
    v_cmp_eq_u32 vcc, -1, v114
    s_cbranch_vccz L_qb_dp1
    s_sub_u32 s62, s62, 1
    s_cbranch_scc0 L_qb_dp0
    s_movk_i32 s63, 24
    s_branch L_fail_far
L_qb_dp1:
    global_load_dwordx4 v[128:131], v110, s[80:81] offset:-4096 sc1
    global_load_dwordx4 v[132:135], v110, s[80:81] offset:-3072 sc1
    global_load_dwordx4 v[136:139], v110, s[80:81] offset:-2048 sc1
    global_load_dwordx4 v[140:143], v110, s[80:81] offset:-1024 sc1
    global_load_dwordx4 v[144:147], v110, s[80:81] offset:0 sc1
    global_load_dwordx4 v[148:151], v110, s[80:81] offset:1024 sc1
    global_load_dwordx4 v[152:155], v110, s[80:81] offset:2048 sc1
    global_load_dwordx4 v[156:159], v110, s[80:81] offset:3072 sc1
    global_load_dwordx4 v[160:163], v110, s[82:83] offset:-4096 sc1
    global_load_dwordx4 v[164:167], v110, s[82:83] offset:-3072 sc1
    global_load_dwordx4 v[168:171], v110, s[82:83] offset:-2048 sc1
    global_load_dwordx4 v[172:175], v110, s[82:83] offset:-1024 sc1
    global_load_dwordx4 v[176:179], v110, s[82:83] offset:0 sc1
    global_load_dwordx4 v[180:183], v110, s[82:83] offset:1024 sc1
    global_load_dwordx4 v[184:187], v110, s[82:83] offset:2048 sc1
    global_load_dwordx4 v[188:191], v110, s[82:83] offset:3072 sc1
    v_add_u32 v115, s56, v110
    v_add_u32 v116, s57, v110
    v_add_u32 v117, s58, v110
    v_add_u32 v112, s36, v115
    s_waitcnt vmcnt(15)
    ds_write_b128 v112, v[128:131] offset:0
    s_waitcnt vmcnt(14)
    ds_write_b128 v112, v[132:135] offset:1024
    s_waitcnt vmcnt(13)
    ds_write_b128 v112, v[136:139] offset:2048
    s_waitcnt vmcnt(12)
    ds_write_b128 v112, v[140:143] offset:3072
    s_waitcnt vmcnt(11)
    ds_write_b128 v112, v[144:147] offset:4096
    s_waitcnt vmcnt(10)
    ds_write_b128 v112, v[148:151] offset:5120
    s_waitcnt vmcnt(9)
    ds_write_b128 v112, v[152:155] offset:6144
    s_waitcnt vmcnt(8)
    ds_write_b128 v112, v[156:159] offset:7168
    v_add_u32 v112, s36, v116
    s_waitcnt vmcnt(7)
    ds_write_b128 v112, v[160:163] offset:0
    s_waitcnt vmcnt(6)
    ds_write_b128 v112, v[164:167] offset:1024
    s_waitcnt vmcnt(5)
    ds_write_b128 v112, v[168:171] offset:2048
    s_waitcnt vmcnt(4)
    ds_write_b128 v112, v[172:175] offset:3072
    s_waitcnt vmcnt(3)
    ds_write_b128 v112, v[176:179] offset:4096
    s_waitcnt vmcnt(2)
    ds_write_b128 v112, v[180:183] offset:5120
    s_waitcnt vmcnt(1)
    ds_write_b128 v112, v[184:187] offset:6144
    s_waitcnt vmcnt(0)
    ds_write_b128 v112, v[188:191] offset:7168
    v_max_u32 v114, v128, v129
    v_max3_u32 v114, v114, v130, v131
    v_max3_u32 v114, v114, v132, v133
    v_max3_u32 v114, v114, v134, v135
    v_max3_u32 v114, v114, v136, v137
    v_max3_u32 v114, v114, v138, v139
    v_max3_u32 v114, v114, v140, v141
    v_max3_u32 v114, v114, v142, v143
    v_max3_u32 v114, v114, v144, v145
    v_max3_u32 v114, v114, v146, v147
    v_max3_u32 v114, v114, v148, v149
    v_max3_u32 v114, v114, v150, v151
    v_max3_u32 v114, v114, v152, v153
    v_max3_u32 v114, v114, v154, v155
    v_max3_u32 v114, v114, v156, v157
    v_max3_u32 v114, v114, v158, v159
    v_max3_u32 v114, v114, v160, v161
    v_max3_u32 v114, v114, v162, v163
    v_max3_u32 v114, v114, v164, v165
    v_max3_u32 v114, v114, v166, v167
    v_max3_u32 v114, v114, v168, v169
    v_max3_u32 v114, v114, v170, v171
    v_max3_u32 v114, v114, v172, v173
    v_max3_u32 v114, v114, v174, v175
    v_max3_u32 v114, v114, v176, v177
    v_max3_u32 v114, v114, v178, v179
    v_max3_u32 v114, v114, v180, v181
    v_max3_u32 v114, v114, v182, v183
    v_max3_u32 v114, v114, v184, v185
    v_max3_u32 v114, v114, v186, v187
    v_max3_u32 v114, v114, v188, v189
    v_max3_u32 v114, v114, v190, v191
    v_cmp_eq_u32 vcc, -1, v114
    s_waitcnt lgkmcnt(0)
    s_cbranch_vccz L_qb_dp2
    s_sub_u32 s62, s62, 1
    s_cbranch_scc0 L_qb_dp1
    s_movk_i32 s63, 25
    s_branch L_fail_far
L_qb_dp2:
    s_add_u32 s38, s38, 0x10000
    s_addc_u32 s39, s39, 0
    v_xor_b32 v111, 512, v111
    s_add_u32 s54, s54, 1
    s_lshr_b32 s55, s54, 1
    s_branch L_qb_have
L_qb_loop:
    s_cmp_lg_u32 s35, 0
    s_cbranch_scc1 L_qb_have
    global_load_dword v114, v111, s[40:41] sc1
    s_waitcnt vmcnt(0)
    s_mov_b64 exec, 3
    global_store_byte v110, v113, s[46:47] offset:-32 sc1
    s_mov_b64 exec, -1
    v_cmp_gt_u32 vcc, s55, v114
    s_cbranch_vccz L_qb_wy_ok
L_qb_wy:
    global_load_dword v114, v111, s[40:41] offset:0 sc1
    s_waitcnt vmcnt(0)
    v_cmp_gt_u32 vcc, s55, v114
    s_cbranch_vccz L_qb_wy_ok
    s_sleep 1
    s_sub_u32 s62, s62, 1
    s_cbranch_scc0 L_qb_wy
    s_movk_i32 s63, 12
    s_branch L_fail_far
L_qb_wy_ok:
    s_cmp_lg_u32 s52, 1
    s_cbranch_scc1 L_qb_q0
    s_mov_b64 exec, 1
    global_store_byte v110, v113, s[50:51] offset:8 sc1
    s_mov_b64 exec, -1
    s_add_u32 s50, s50, 0x20
    s_addc_u32 s51, s51, 0
L_qb_q0:
    s_mov_b32 s52, 0
    s_add_u32 m0, s56, s36
    s_nop 0
    global_load_lds_dwordx4 v110, s[38:39] offset:0 sc1
    global_load_lds_dwordx4 v110, s[38:39] offset:1024 sc1
    global_load_lds_dwordx4 v110, s[38:39] offset:2048 sc1
    global_load_lds_dwordx4 v110, s[38:39] offset:3072 sc1
    s_add_u32 s38, s38, 0x1000
    s_addc_u32 s39, s39, 0
    s_add_u32 m0, m0, 4096
    s_nop 0
    global_load_lds_dwordx4 v110, s[38:39] offset:0 sc1
    global_load_lds_dwordx4 v110, s[38:39] offset:1024 sc1
    global_load_lds_dwordx4 v110, s[38:39] offset:2048 sc1
    global_load_lds_dwordx4 v110, s[38:39] offset:3072 sc1
    s_add_u32 s38, s38, 0x7000
    s_addc_u32 s39, s39, 0
    s_add_u32 m0, s57, s36
    s_nop 0
    global_load_lds_dwordx4 v110, s[38:39] offset:0 sc1
    global_load_lds_dwordx4 v110, s[38:39] offset:1024 sc1
    global_load_lds_dwordx4 v110, s[38:39] offset:2048 sc1
    global_load_lds_dwordx4 v110, s[38:39] offset:3072 sc1
    s_add_u32 s38, s38, 0x1000
    s_addc_u32 s39, s39, 0
    s_add_u32 m0, m0, 4096
    s_nop 0
    global_load_lds_dwordx4 v110, s[38:39] offset:0 sc1
    global_load_lds_dwordx4 v110, s[38:39] offset:1024 sc1
    global_load_lds_dwordx4 v110, s[38:39] offset:2048 sc1
    global_load_lds_dwordx4 v110, s[38:39] offset:3072 sc1
    s_add_u32 s38, s38, 0x7000
    s_addc_u32 s39, s39, 0
    v_xor_b32 v111, 512, v111
    s_add_u32 s54, s54, 1
    s_lshr_b32 s55, s54, 1
    s_waitcnt vmcnt(8)
L_qb_have:
    s_waitcnt vmcnt(10)
    s_barrier
    v_add_u32 v115, s56, v110
    v_add_u32 v116, s57, v110
    v_add_u32 v117, s58, v110
    ds_read_b128 v[48:51], v115 offset:0
    ds_read_b128 v[52:55], v115 offset:1024
    ds_read_b128 v[56:59], v115 offset:2048
    ds_read_b128 v[60:63], v115 offset:3072
    ds_read_b128 v[64:67], v115 offset:4096
    ds_read_b128 v[68:71], v115 offset:5120
    ds_read_b128 v[72:75], v115 offset:6144
    ds_read_b128 v[76:79], v115 offset:7168
    s_cmp_lg_u32 s32, 0
    s_cbranch_scc1 L_qb_gv
    s_waitcnt lgkmcnt(6)
    v_mfma_f32_32x32x16_bf16 v[0:15], a[0:3], v[48:51], 0
    ds_read_b128 v[48:51], v115 offset:8192
    v_mfma_f32_32x32x16_bf16 v[0:15], a[4:7], v[52:55], v[0:15]
    ds_read_b128 v[52:55], v115 offset:9216
    s_waitcnt lgkmcnt(6)
    v_mfma_f32_32x32x16_bf16 v[0:15], a[8:11], v[56:59], v[0:15]
    ds_read_b128 v[56:59], v115 offset:10240
    v_mfma_f32_32x32x16_bf16 v[0:15], a[12:15], v[60:63], v[0:15]
    ds_read_b128 v[60:63], v115 offset:11264
    s_waitcnt lgkmcnt(6)
    v_mfma_f32_32x32x16_bf16 v[0:15], a[16:19], v[64:67], v[0:15]
    ds_read_b128 v[64:67], v115 offset:12288
    v_mfma_f32_32x32x16_bf16 v[0:15], a[20:23], v[68:71], v[0:15]
    ds_read_b128 v[68:71], v115 offset:13312
    s_waitcnt lgkmcnt(6)
    v_mfma_f32_32x32x16_bf16 v[0:15], a[24:27], v[72:75], v[0:15]
    ds_read_b128 v[72:75], v115 offset:14336
    v_mfma_f32_32x32x16_bf16 v[0:15], a[28:31], v[76:79], v[0:15]
    ds_read_b128 v[76:79], v115 offset:15360
    s_waitcnt lgkmcnt(6)
    v_mfma_f32_32x32x16_bf16 v[0:15], a[32:35], v[48:51], v[0:15]
    ds_read_b128 v[48:51], v115 offset:16384
    v_mfma_f32_32x32x16_bf16 v[0:15], a[36:39], v[52:55], v[0:15]
    ds_read_b128 v[52:55], v115 offset:17408
    s_waitcnt lgkmcnt(6)
    v_mfma_f32_32x32x16_bf16 v[0:15], a[40:43], v[56:59], v[0:15]
    ds_read_b128 v[56:59], v115 offset:18432
    v_mfma_f32_32x32x16_bf16 v[0:15], a[44:47], v[60:63], v[0:15]
    ds_read_b128 v[60:63], v115 offset:19456
    s_waitcnt lgkmcnt(6)
    v_mfma_f32_32x32x16_bf16 v[0:15], a[48:51], v[64:67], v[0:15]
    ds_read_b128 v[64:67], v115 offset:20480
    v_mfma_f32_32x32x16_bf16 v[0:15], a[52:55], v[68:71], v[0:15]
    ds_read_b128 v[68:71], v115 offset:21504
    s_waitcnt lgkmcnt(6)
    v_mfma_f32_32x32x16_bf16 v[0:15], a[56:59], v[72:75], v[0:15]
    ds_read_b128 v[72:75], v115 offset:22528
    v_mfma_f32_32x32x16_bf16 v[0:15], a[60:63], v[76:79], v[0:15]
    ds_read_b128 v[76:79], v115 offset:23552
    s_waitcnt lgkmcnt(6)
    v_mfma_f32_32x32x16_bf16 v[0:15], a[64:67], v[48:51], v[0:15]
    ds_read_b128 v[48:51], v115 offset:24576
    v_mfma_f32_32x32x16_bf16 v[0:15], a[68:71], v[52:55], v[0:15]
    ds_read_b128 v[52:55], v115 offset:25600
    s_waitcnt lgkmcnt(6)
    v_mfma_f32_32x32x16_bf16 v[0:15], a[72:75], v[56:59], v[0:15]
    ds_read_b128 v[56:59], v115 offset:26624
    v_mfma_f32_32x32x16_bf16 v[0:15], a[76:79], v[60:63], v[0:15]
    ds_read_b128 v[60:63], v115 offset:27648
    s_waitcnt lgkmcnt(6)
    v_mfma_f32_32x32x16_bf16 v[0:15], a[80:83], v[64:67], v[0:15]
    ds_read_b128 v[64:67], v115 offset:28672
    v_mfma_f32_32x32x16_bf16 v[0:15], a[84:87], v[68:71], v[0:15]
    ds_read_b128 v[68:71], v115 offset:29696
    s_cmp_eq_u32 s52, 1
    s_cbranch_scc1 L_qb_k_a
    s_waitcnt vmcnt(0)
L_qb_k_a:
    s_waitcnt vmcnt(3)
    s_cmp_eq_u32 s52, 0
    s_cbranch_scc1 L_qb_k_b
    s_mov_b64 exec, 3
    global_store_byte v110, v113, s[46:47] offset:-32 sc1
    s_mov_b64 exec, -1
L_qb_k_b:
    s_barrier
    s_waitcnt lgkmcnt(6)
    v_mfma_f32_32x32x16_bf16 v[0:15], a[88:91], v[72:75], v[0:15]
    ds_read_b128 v[72:75], v115 offset:30720
    v_mfma_f32_32x32x16_bf16 v[0:15], a[92:95], v[76:79], v[0:15]
    ds_read_b128 v[76:79], v115 offset:31744
    s_waitcnt lgkmcnt(6)
    v_mfma_f32_32x32x16_bf16 v[0:15], a[96:99], v[48:51], v[0:15]
    ds_read_b128 v[48:51], v116 offset:0
    v_mfma_f32_32x32x16_bf16 v[0:15], a[100:103], v[52:55], v[0:15]
    ds_read_b128 v[52:55], v116 offset:1024
    s_waitcnt lgkmcnt(6)
    v_mfma_f32_32x32x16_bf16 v[0:15], a[104:107], v[56:59], v[0:15]
    ds_read_b128 v[56:59], v116 offset:2048
    v_mfma_f32_32x32x16_bf16 v[0:15], a[108:111], v[60:63], v[0:15]
    ds_read_b128 v[60:63], v116 offset:3072
    s_waitcnt lgkmcnt(6)
    v_mfma_f32_32x32x16_bf16 v[0:15], a[112:115], v[64:67], v[0:15]
    ds_read_b128 v[64:67], v116 offset:4096
    v_mfma_f32_32x32x16_bf16 v[0:15], a[116:119], v[68:71], v[0:15]
    ds_read_b128 v[68:71], v116 offset:5120
    s_waitcnt lgkmcnt(6)
    v_mfma_f32_32x32x16_bf16 v[0:15], a[120:123], v[72:75], v[0:15]
    ds_read_b128 v[72:75], v116 offset:6144
    v_mfma_f32_32x32x16_bf16 v[0:15], a[124:127], v[76:79], v[0:15]
    ds_read_b128 v[76:79], v116 offset:7168
    s_waitcnt lgkmcnt(6)
    v_mfma_f32_32x32x16_bf16 v[16:31], a[0:3], v[48:51], 0
    ds_read_b128 v[48:51], v116 offset:8192
    global_load_dword v114, v111, s[40:41] sc1
    v_mfma_f32_32x32x16_bf16 v[16:31], a[4:7], v[52:55], v[16:31]
    ds_read_b128 v[52:55], v116 offset:9216
    s_waitcnt lgkmcnt(6)
    v_mfma_f32_32x32x16_bf16 v[16:31], a[8:11], v[56:59], v[16:31]
    ds_read_b128 v[56:59], v116 offset:10240
    v_mfma_f32_32x32x16_bf16 v[16:31], a[12:15], v[60:63], v[16:31]
    ds_read_b128 v[60:63], v116 offset:11264
    v_cvt_pk_bf16_f32 v80, v0, v1
    v_cvt_pk_bf16_f32 v81, v2, v3
    v_cvt_pk_bf16_f32 v82, v4, v5
    v_cvt_pk_bf16_f32 v83, v6, v7
    s_waitcnt lgkmcnt(6)
    v_mfma_f32_32x32x16_bf16 v[16:31], a[16:19], v[64:67], v[16:31]
    ds_read_b128 v[64:67], v116 offset:12288
    v_cvt_pk_bf16_f32 v84, v8, v9
    v_cvt_pk_bf16_f32 v85, v10, v11
    v_cvt_pk_bf16_f32 v86, v12, v13
    v_cvt_pk_bf16_f32 v87, v14, v15
    v_mfma_f32_32x32x16_bf16 v[16:31], a[20:23], v[68:71], v[16:31]
    ds_read_b128 v[68:71], v116 offset:13312
    v_min_u32 v80, -2, v80
    v_min_u32 v81, -2, v81
    v_min_u32 v82, -2, v82
    v_min_u32 v83, -2, v83
    s_waitcnt lgkmcnt(6)
    v_mfma_f32_32x32x16_bf16 v[16:31], a[24:27], v[72:75], v[16:31]
    ds_read_b128 v[72:75], v116 offset:14336
    v_min_u32 v84, -2, v84
    v_min_u32 v85, -2, v85
    v_min_u32 v86, -2, v86
    v_min_u32 v87, -2, v87
    v_mfma_f32_32x32x16_bf16 v[16:31], a[28:31], v[76:79], v[16:31]
    ds_read_b128 v[76:79], v116 offset:15360
    global_store_dwordx4 v110, v[80:83], s[44:45] offset:0 sc1
    global_store_dwordx4 v110, v[84:87], s[44:45] offset:1024 sc1
    s_add_u32 s44, s44, 0x80000
    s_addc_u32 s45, s45, 0
    s_waitcnt lgkmcnt(6)
    v_mfma_f32_32x32x16_bf16 v[16:31], a[32:35], v[48:51], v[16:31]
    ds_read_b128 v[48:51], v116 offset:16384
    v_mfma_f32_32x32x16_bf16 v[16:31], a[36:39], v[52:55], v[16:31]
    ds_read_b128 v[52:55], v116 offset:17408
    s_waitcnt lgkmcnt(6)
    v_mfma_f32_32x32x16_bf16 v[16:31], a[40:43], v[56:59], v[16:31]
    ds_read_b128 v[56:59], v116 offset:18432
    v_mfma_f32_32x32x16_bf16 v[16:31], a[44:47], v[60:63], v[16:31]
    ds_read_b128 v[60:63], v116 offset:19456
    s_waitcnt lgkmcnt(6)
    v_mfma_f32_32x32x16_bf16 v[16:31], a[48:51], v[64:67], v[16:31]
    ds_read_b128 v[64:67], v116 offset:20480
    v_mfma_f32_32x32x16_bf16 v[16:31], a[52:55], v[68:71], v[16:31]
    ds_read_b128 v[68:71], v116 offset:21504
    s_waitcnt lgkmcnt(6)
    v_mfma_f32_32x32x16_bf16 v[16:31], a[56:59], v[72:75], v[16:31]
    ds_read_b128 v[72:75], v116 offset:22528
    v_mfma_f32_32x32x16_bf16 v[16:31], a[60:63], v[76:79], v[16:31]
    ds_read_b128 v[76:79], v116 offset:23552
    s_waitcnt lgkmcnt(6)
    v_mfma_f32_32x32x16_bf16 v[16:31], a[64:67], v[48:51], v[16:31]
    ds_read_b128 v[48:51], v116 offset:24576
    v_mfma_f32_32x32x16_bf16 v[16:31], a[68:71], v[52:55], v[16:31]
    ds_read_b128 v[52:55], v116 offset:25600
    s_waitcnt lgkmcnt(6)
    v_mfma_f32_32x32x16_bf16 v[16:31], a[72:75], v[56:59], v[16:31]
    ds_read_b128 v[56:59], v116 offset:26624
    v_mfma_f32_32x32x16_bf16 v[16:31], a[76:79], v[60:63], v[16:31]
    ds_read_b128 v[60:63], v116 offset:27648
    s_waitcnt lgkmcnt(6)
    v_mfma_f32_32x32x16_bf16 v[16:31], a[80:83], v[64:67], v[16:31]
    ds_read_b128 v[64:67], v116 offset:28672
    v_mfma_f32_32x32x16_bf16 v[16:31], a[84:87], v[68:71], v[16:31]
    ds_read_b128 v[68:71], v116 offset:29696
    s_waitcnt lgkmcnt(6)
    v_mfma_f32_32x32x16_bf16 v[16:31], a[88:91], v[72:75], v[16:31]
    ds_read_b128 v[72:75], v116 offset:30720
    v_mfma_f32_32x32x16_bf16 v[16:31], a[92:95], v[76:79], v[16:31]
    ds_read_b128 v[76:79], v116 offset:31744
    s_waitcnt lgkmcnt(6)
    v_mfma_f32_32x32x16_bf16 v[16:31], a[96:99], v[48:51], v[16:31]
    ds_read_b128 v[48:51], v117 offset:0
    v_mfma_f32_32x32x16_bf16 v[16:31], a[100:103], v[52:55], v[16:31]
    ds_read_b128 v[52:55], v117 offset:1024
    s_waitcnt lgkmcnt(6)
    v_mfma_f32_32x32x16_bf16 v[16:31], a[104:107], v[56:59], v[16:31]
    ds_read_b128 v[56:59], v117 offset:2048
    v_mfma_f32_32x32x16_bf16 v[16:31], a[108:111], v[60:63], v[16:31]
    ds_read_b128 v[60:63], v117 offset:3072
    s_waitcnt vmcnt(2)
    s_cmp_lg_u32 s52, 1
    s_cbranch_scc1 L_qb_k_q
    s_mov_b64 exec, 1
    global_store_byte v110, v113, s[50:51] offset:8 sc1
    s_mov_b64 exec, -1
    s_add_u32 s50, s50, 0x20
    s_addc_u32 s51, s51, 0
L_qb_k_q:
    s_mov_b32 s52, 0
    v_cmp_gt_u32 vcc, s55, v114
    s_cmp_eq_u64 vcc, 0
    s_cselect_b32 s35, 1, 0
    s_cmp_ge_u32 s33, 62
    s_cselect_b32 s35, 0, s35
    s_cmp_eq_u32 s33, 0
    s_cbranch_scc1 L_qb_k_1st
    s_cmp_eq_u32 s35, 0
    s_cbranch_scc1 L_qb_k_st
    v_xor_b32 v111, 512, v111
    s_add_u32 s54, s54, 1
    s_lshr_b32 s55, s54, 1
    s_cmp_ge_u32 s33, 8
    s_cbranch_scc1 L_qb_k_lz0
    s_waitcnt vmcnt(0)
    s_mov_b64 exec, 1
    global_store_byte v110, v113, s[46:47] offset:0 sc1
    s_mov_b64 exec, -1
L_qb_k_lz0:
    s_waitcnt lgkmcnt(6)
    v_mfma_f32_32x32x16_bf16 v[16:31], a[112:115], v[64:67], v[16:31]
    ds_read_b128 v[64:67], v117 offset:4096
    s_add_u32 m0, s59, s36
    v_mfma_f32_32x32x16_bf16 v[16:31], a[116:119], v[68:71], v[16:31]
    ds_read_b128 v[68:71], v117 offset:5120
    global_load_lds_dwordx4 v110, s[38:39] offset:0 sc1
    s_waitcnt lgkmcnt(6)
    v_mfma_f32_32x32x16_bf16 v[16:31], a[120:123], v[72:75], v[16:31]
    ds_read_b128 v[72:75], v117 offset:6144
    global_load_lds_dwordx4 v110, s[38:39] offset:1024 sc1
    v_mfma_f32_32x32x16_bf16 v[16:31], a[124:127], v[76:79], v[16:31]
    ds_read_b128 v[76:79], v117 offset:7168
    global_load_lds_dwordx4 v110, s[38:39] offset:2048 sc1
    s_waitcnt lgkmcnt(6)
    v_mfma_f32_32x32x16_bf16 v[32:47], a[128:131], v[48:51], 0
    ds_read_b128 v[48:51], v117 offset:8192
    global_load_lds_dwordx4 v110, s[38:39] offset:3072 sc1
    s_add_u32 s38, s38, 0x1000
    s_addc_u32 s39, s39, 0
    v_mfma_f32_32x32x16_bf16 v[32:47], a[132:135], v[52:55], v[32:47]
    ds_read_b128 v[52:55], v117 offset:9216
    s_add_u32 m0, m0, 4096
    s_waitcnt lgkmcnt(6)
    v_mfma_f32_32x32x16_bf16 v[32:47], a[136:139], v[56:59], v[32:47]
    ds_read_b128 v[56:59], v117 offset:10240
    global_load_lds_dwordx4 v110, s[38:39] offset:0 sc1
    v_mfma_f32_32x32x16_bf16 v[32:47], a[140:143], v[60:63], v[32:47]
    ds_read_b128 v[60:63], v117 offset:11264
    v_cvt_pk_bf16_f32 v88, v16, v17
    v_cvt_pk_bf16_f32 v89, v18, v19
    v_cvt_pk_bf16_f32 v90, v20, v21
    v_cvt_pk_bf16_f32 v91, v22, v23
    s_waitcnt lgkmcnt(6)
    v_mfma_f32_32x32x16_bf16 v[32:47], a[144:147], v[64:67], v[32:47]
    ds_read_b128 v[64:67], v117 offset:12288
    v_cvt_pk_bf16_f32 v92, v24, v25
    v_cvt_pk_bf16_f32 v93, v26, v27
    v_cvt_pk_bf16_f32 v94, v28, v29
    v_cvt_pk_bf16_f32 v95, v30, v31
    v_mfma_f32_32x32x16_bf16 v[32:47], a[148:151], v[68:71], v[32:47]
    ds_read_b128 v[68:71], v117 offset:13312
    v_min_u32 v88, -2, v88
    v_min_u32 v89, -2, v89
    v_min_u32 v90, -2, v90
    v_min_u32 v91, -2, v91
    s_waitcnt lgkmcnt(6)
    v_mfma_f32_32x32x16_bf16 v[32:47], a[152:155], v[72:75], v[32:47]
    ds_read_b128 v[72:75], v117 offset:14336
    v_min_u32 v92, -2, v92
    v_min_u32 v93, -2, v93
    v_min_u32 v94, -2, v94
    v_min_u32 v95, -2, v95
    v_mfma_f32_32x32x16_bf16 v[32:47], a[156:159], v[76:79], v[32:47]
    ds_read_b128 v[76:79], v117 offset:15360
    global_store_dwordx4 v110, v[88:91], s[44:45] offset:0 sc1
    global_store_dwordx4 v110, v[92:95], s[44:45] offset:1024 sc1
    s_add_u32 s44, s44, 0x80000
    s_addc_u32 s45, s45, 0
    s_waitcnt lgkmcnt(6)
    v_mfma_f32_32x32x16_bf16 v[32:47], a[160:163], v[48:51], v[32:47]
    ds_read_b128 v[48:51], v117 offset:16384
    global_load_lds_dwordx4 v110, s[38:39] offset:1024 sc1
    v_mfma_f32_32x32x16_bf16 v[32:47], a[164:167], v[52:55], v[32:47]
    ds_read_b128 v[52:55], v117 offset:17408
    global_load_lds_dwordx4 v110, s[38:39] offset:2048 sc1
    s_waitcnt lgkmcnt(6)
    v_mfma_f32_32x32x16_bf16 v[32:47], a[168:171], v[56:59], v[32:47]
    ds_read_b128 v[56:59], v117 offset:18432
    global_load_lds_dwordx4 v110, s[38:39] offset:3072 sc1
    s_add_u32 s38, s38, 0x7000
    s_addc_u32 s39, s39, 0
    v_mfma_f32_32x32x16_bf16 v[32:47], a[172:175], v[60:63], v[32:47]
    ds_read_b128 v[60:63], v117 offset:19456
    s_add_u32 m0, s60, s36
    s_waitcnt lgkmcnt(6)
    v_mfma_f32_32x32x16_bf16 v[32:47], a[176:179], v[64:67], v[32:47]
    ds_read_b128 v[64:67], v117 offset:20480
    global_load_lds_dwordx4 v110, s[38:39] offset:0 sc1
    v_mfma_f32_32x32x16_bf16 v[32:47], a[180:183], v[68:71], v[32:47]
    ds_read_b128 v[68:71], v117 offset:21504
    global_load_lds_dwordx4 v110, s[38:39] offset:1024 sc1
    s_waitcnt lgkmcnt(6)
    v_mfma_f32_32x32x16_bf16 v[32:47], a[184:187], v[72:75], v[32:47]
    ds_read_b128 v[72:75], v117 offset:22528
    global_load_lds_dwordx4 v110, s[38:39] offset:2048 sc1
    v_mfma_f32_32x32x16_bf16 v[32:47], a[188:191], v[76:79], v[32:47]
    ds_read_b128 v[76:79], v117 offset:23552
    global_load_lds_dwordx4 v110, s[38:39] offset:3072 sc1
    s_add_u32 s38, s38, 0x1000
    s_addc_u32 s39, s39, 0
    s_waitcnt lgkmcnt(6)
    v_mfma_f32_32x32x16_bf16 v[32:47], a[192:195], v[48:51], v[32:47]
    ds_read_b128 v[48:51], v117 offset:24576
    s_add_u32 m0, m0, 4096
    v_mfma_f32_32x32x16_bf16 v[32:47], a[196:199], v[52:55], v[32:47]
    ds_read_b128 v[52:55], v117 offset:25600
    global_load_lds_dwordx4 v110, s[38:39] offset:0 sc1
    s_waitcnt lgkmcnt(6)
    v_mfma_f32_32x32x16_bf16 v[32:47], a[200:203], v[56:59], v[32:47]
    ds_read_b128 v[56:59], v117 offset:26624
    global_load_lds_dwordx4 v110, s[38:39] offset:1024 sc1
    v_mfma_f32_32x32x16_bf16 v[32:47], a[204:207], v[60:63], v[32:47]
    ds_read_b128 v[60:63], v117 offset:27648
    global_load_lds_dwordx4 v110, s[38:39] offset:2048 sc1
    s_waitcnt lgkmcnt(6)
    v_mfma_f32_32x32x16_bf16 v[32:47], a[208:211], v[64:67], v[32:47]
    ds_read_b128 v[64:67], v117 offset:28672
    global_load_lds_dwordx4 v110, s[38:39] offset:3072 sc1
    s_add_u32 s38, s38, 0x7000
    s_addc_u32 s39, s39, 0
    v_mfma_f32_32x32x16_bf16 v[32:47], a[212:215], v[68:71], v[32:47]
    ds_read_b128 v[68:71], v117 offset:29696
    s_waitcnt lgkmcnt(6)
    v_mfma_f32_32x32x16_bf16 v[32:47], a[216:219], v[72:75], v[32:47]
    ds_read_b128 v[72:75], v117 offset:30720
    v_mfma_f32_32x32x16_bf16 v[32:47], a[220:223], v[76:79], v[32:47]
    ds_read_b128 v[76:79], v117 offset:31744
    s_waitcnt lgkmcnt(6)
    v_mfma_f32_32x32x16_bf16 v[32:47], a[224:227], v[48:51], v[32:47]
    v_mfma_f32_32x32x16_bf16 v[32:47], a[228:231], v[52:55], v[32:47]
    s_waitcnt lgkmcnt(4)
    v_mfma_f32_32x32x16_bf16 v[32:47], a[232:235], v[56:59], v[32:47]
    v_mfma_f32_32x32x16_bf16 v[32:47], a[236:239], v[60:63], v[32:47]
    s_cmp_ge_u32 s33, 8
    s_cbranch_scc1 L_qb_k_lz
    s_waitcnt vmcnt(11)
    s_mov_b64 exec, 1
    global_store_byte v110, v113, s[46:47] offset:16 sc1
    s_mov_b64 exec, -1
    s_branch L_qb_k_lz2
L_qb_k_lz:
    s_waitcnt vmcnt(18)
    s_mov_b64 exec, 1
    global_store_byte v110, v113, s[46:47] offset:0 sc1
    s_mov_b64 exec, -1
L_qb_k_lz2:
    s_waitcnt lgkmcnt(2)
    v_mfma_f32_32x32x16_bf16 v[32:47], a[240:243], v[64:67], v[32:47]
    v_mfma_f32_32x32x16_bf16 v[32:47], a[244:247], v[68:71], v[32:47]
    s_waitcnt lgkmcnt(0)
    v_mfma_f32_32x32x16_bf16 v[32:47], a[248:251], v[72:75], v[32:47]
    v_mfma_f32_32x32x16_bf16 v[32:47], a[252:255], v[76:79], v[32:47]
    s_branch L_qb_g1
L_qb_k_st:
    s_waitcnt vmcnt(0)
    s_mov_b64 exec, 1
    global_store_byte v110, v113, s[46:47] offset:0 sc1
    s_mov_b64 exec, -1
    s_waitcnt lgkmcnt(6)
    v_mfma_f32_32x32x16_bf16 v[16:31], a[112:115], v[64:67], v[16:31]
    ds_read_b128 v[64:67], v117 offset:4096
    v_mfma_f32_32x32x16_bf16 v[16:31], a[116:119], v[68:71], v[16:31]
    ds_read_b128 v[68:71], v117 offset:5120
    s_waitcnt lgkmcnt(6)
    v_mfma_f32_32x32x16_bf16 v[16:31], a[120:123], v[72:75], v[16:31]
    ds_read_b128 v[72:75], v117 offset:6144
    v_mfma_f32_32x32x16_bf16 v[16:31], a[124:127], v[76:79], v[16:31]
    ds_read_b128 v[76:79], v117 offset:7168
    s_waitcnt lgkmcnt(6)
    v_mfma_f32_32x32x16_bf16 v[32:47], a[128:131], v[48:51], 0
    ds_read_b128 v[48:51], v117 offset:8192
    v_mfma_f32_32x32x16_bf16 v[32:47], a[132:135], v[52:55], v[32:47]
    ds_read_b128 v[52:55], v117 offset:9216
    s_waitcnt lgkmcnt(6)
    v_mfma_f32_32x32x16_bf16 v[32:47], a[136:139], v[56:59], v[32:47]
    ds_read_b128 v[56:59], v117 offset:10240
    v_mfma_f32_32x32x16_bf16 v[32:47], a[140:143], v[60:63], v[32:47]
    ds_read_b128 v[60:63], v117 offset:11264
    s_nop 0
    v_cvt_pk_bf16_f32 v88, v16, v17
    v_cvt_pk_bf16_f32 v89, v18, v19
    v_cvt_pk_bf16_f32 v90, v20, v21
    v_cvt_pk_bf16_f32 v91, v22, v23
    s_waitcnt lgkmcnt(6)
    v_mfma_f32_32x32x16_bf16 v[32:47], a[144:147], v[64:67], v[32:47]
    ds_read_b128 v[64:67], v117 offset:12288
    v_cvt_pk_bf16_f32 v92, v24, v25
    v_cvt_pk_bf16_f32 v93, v26, v27
    v_cvt_pk_bf16_f32 v94, v28, v29
    v_cvt_pk_bf16_f32 v95, v30, v31
    v_mfma_f32_32x32x16_bf16 v[32:47], a[148:151], v[68:71], v[32:47]
    ds_read_b128 v[68:71], v117 offset:13312
    v_min_u32 v88, -2, v88
    v_min_u32 v89, -2, v89
    v_min_u32 v90, -2, v90
    v_min_u32 v91, -2, v91
    s_waitcnt lgkmcnt(6)
    v_mfma_f32_32x32x16_bf16 v[32:47], a[152:155], v[72:75], v[32:47]
    ds_read_b128 v[72:75], v117 offset:14336
    v_min_u32 v92, -2, v92
    v_min_u32 v93, -2, v93
    v_min_u32 v94, -2, v94
    v_min_u32 v95, -2, v95
    v_mfma_f32_32x32x16_bf16 v[32:47], a[156:159], v[76:79], v[32:47]
    ds_read_b128 v[76:79], v117 offset:15360
    global_store_dwordx4 v110, v[88:91], s[44:45] offset:0 sc1
    global_store_dwordx4 v110, v[92:95], s[44:45] offset:1024 sc1
    s_add_u32 s44, s44, 0x80000
    s_addc_u32 s45, s45, 0
    s_waitcnt lgkmcnt(6)
    v_mfma_f32_32x32x16_bf16 v[32:47], a[160:163], v[48:51], v[32:47]
    ds_read_b128 v[48:51], v117 offset:16384
    v_mfma_f32_32x32x16_bf16 v[32:47], a[164:167], v[52:55], v[32:47]
    ds_read_b128 v[52:55], v117 offset:17408
    s_waitcnt lgkmcnt(6)
    v_mfma_f32_32x32x16_bf16 v[32:47], a[168:171], v[56:59], v[32:47]
    ds_read_b128 v[56:59], v117 offset:18432
    v_mfma_f32_32x32x16_bf16 v[32:47], a[172:175], v[60:63], v[32:47]
    ds_read_b128 v[60:63], v117 offset:19456
    s_waitcnt lgkmcnt(6)
    v_mfma_f32_32x32x16_bf16 v[32:47], a[176:179], v[64:67], v[32:47]
    ds_read_b128 v[64:67], v117 offset:20480
    v_mfma_f32_32x32x16_bf16 v[32:47], a[180:183], v[68:71], v[32:47]
    ds_read_b128 v[68:71], v117 offset:21504
    global_load_dword v114, v111, s[40:41] sc1
    s_waitcnt lgkmcnt(6)
    v_mfma_f32_32x32x16_bf16 v[32:47], a[184:187], v[72:75], v[32:47]
    ds_read_b128 v[72:75], v117 offset:22528
    v_mfma_f32_32x32x16_bf16 v[32:47], a[188:191], v[76:79], v[32:47]
    ds_read_b128 v[76:79], v117 offset:23552
    s_waitcnt lgkmcnt(6)
    v_mfma_f32_32x32x16_bf16 v[32:47], a[192:195], v[48:51], v[32:47]
    ds_read_b128 v[48:51], v117 offset:24576
    v_mfma_f32_32x32x16_bf16 v[32:47], a[196:199], v[52:55], v[32:47]
    ds_read_b128 v[52:55], v117 offset:25600
    s_waitcnt lgkmcnt(6)
    v_mfma_f32_32x32x16_bf16 v[32:47], a[200:203], v[56:59], v[32:47]
    ds_read_b128 v[56:59], v117 offset:26624
    v_mfma_f32_32x32x16_bf16 v[32:47], a[204:207], v[60:63], v[32:47]
    ds_read_b128 v[60:63], v117 offset:27648
    s_waitcnt lgkmcnt(6)
    v_mfma_f32_32x32x16_bf16 v[32:47], a[208:211], v[64:67], v[32:47]
    ds_read_b128 v[64:67], v117 offset:28672
    v_mfma_f32_32x32x16_bf16 v[32:47], a[212:215], v[68:71], v[32:47]
    ds_read_b128 v[68:71], v117 offset:29696
    s_waitcnt lgkmcnt(6)
    v_mfma_f32_32x32x16_bf16 v[32:47], a[216:219], v[72:75], v[32:47]
    ds_read_b128 v[72:75], v117 offset:30720
    v_mfma_f32_32x32x16_bf16 v[32:47], a[220:223], v[76:79], v[32:47]
    ds_read_b128 v[76:79], v117 offset:31744
    s_waitcnt lgkmcnt(6)
    v_mfma_f32_32x32x16_bf16 v[32:47], a[224:227], v[48:51], v[32:47]
    v_mfma_f32_32x32x16_bf16 v[32:47], a[228:231], v[52:55], v[32:47]
    s_waitcnt lgkmcnt(4)
    v_mfma_f32_32x32x16_bf16 v[32:47], a[232:235], v[56:59], v[32:47]
    v_mfma_f32_32x32x16_bf16 v[32:47], a[236:239], v[60:63], v[32:47]
    s_waitcnt vmcnt(0)
    s_cmp_ge_u32 s33, 62
    s_cbranch_scc1 L_qb_k_n2
    v_cmp_gt_u32 vcc, s55, v114
    s_cbranch_vccnz L_qb_k_n2
    s_mov_b64 exec, 1
    global_store_byte v110, v113, s[46:47] offset:16 sc1
    s_mov_b64 exec, -1
    s_add_u32 m0, s59, s36
    s_nop 0
    global_load_lds_dwordx4 v110, s[38:39] offset:0 sc1
    global_load_lds_dwordx4 v110, s[38:39] offset:1024 sc1
    global_load_lds_dwordx4 v110, s[38:39] offset:2048 sc1
    global_load_lds_dwordx4 v110, s[38:39] offset:3072 sc1
    s_add_u32 s38, s38, 0x1000
    s_addc_u32 s39, s39, 0
    s_add_u32 m0, m0, 4096
    s_nop 0
    global_load_lds_dwordx4 v110, s[38:39] offset:0 sc1
    global_load_lds_dwordx4 v110, s[38:39] offset:1024 sc1
    global_load_lds_dwordx4 v110, s[38:39] offset:2048 sc1
    global_load_lds_dwordx4 v110, s[38:39] offset:3072 sc1
    s_add_u32 s38, s38, 0x7000
    s_addc_u32 s39, s39, 0
    s_add_u32 m0, s60, s36
    s_nop 0
    global_load_lds_dwordx4 v110, s[38:39] offset:0 sc1
    global_load_lds_dwordx4 v110, s[38:39] offset:1024 sc1
    global_load_lds_dwordx4 v110, s[38:39] offset:2048 sc1
    global_load_lds_dwordx4 v110, s[38:39] offset:3072 sc1
    s_add_u32 s38, s38, 0x1000
    s_addc_u32 s39, s39, 0
    s_add_u32 m0, m0, 4096
    s_nop 0
    global_load_lds_dwordx4 v110, s[38:39] offset:0 sc1
    global_load_lds_dwordx4 v110, s[38:39] offset:1024 sc1
    global_load_lds_dwordx4 v110, s[38:39] offset:2048 sc1
    global_load_lds_dwordx4 v110, s[38:39] offset:3072 sc1
    s_add_u32 s38, s38, 0x7000
    s_addc_u32 s39, s39, 0
    v_xor_b32 v111, 512, v111
    s_add_u32 s54, s54, 1
    s_lshr_b32 s55, s54, 1
    s_mov_b32 s35, 1
L_qb_k_n2:
    s_mov_b64 exec, 1
    global_store_byte v110, v113, s[46:47] offset:16 sc1
    s_mov_b64 exec, -1
    s_waitcnt lgkmcnt(2)
    v_mfma_f32_32x32x16_bf16 v[32:47], a[240:243], v[64:67], v[32:47]
    v_mfma_f32_32x32x16_bf16 v[32:47], a[244:247], v[68:71], v[32:47]
    s_waitcnt lgkmcnt(0)
    v_mfma_f32_32x32x16_bf16 v[32:47], a[248:251], v[72:75], v[32:47]
    v_mfma_f32_32x32x16_bf16 v[32:47], a[252:255], v[76:79], v[32:47]
    s_branch L_qb_g1
L_qb_k_1st:
    s_waitcnt lgkmcnt(6)
    v_mfma_f32_32x32x16_bf16 v[16:31], a[112:115], v[64:67], v[16:31]
    ds_read_b128 v[64:67], v117 offset:4096
    v_mfma_f32_32x32x16_bf16 v[16:31], a[116:119], v[68:71], v[16:31]
    ds_read_b128 v[68:71], v117 offset:5120
    s_waitcnt lgkmcnt(6)
    v_mfma_f32_32x32x16_bf16 v[16:31], a[120:123], v[72:75], v[16:31]
    ds_read_b128 v[72:75], v117 offset:6144
    v_mfma_f32_32x32x16_bf16 v[16:31], a[124:127], v[76:79], v[16:31]
    ds_read_b128 v[76:79], v117 offset:7168
    s_nop 10
    v_cvt_pk_bf16_f32 v88, v16, v17
    v_cvt_pk_bf16_f32 v89, v18, v19
    v_cvt_pk_bf16_f32 v90, v20, v21
    v_cvt_pk_bf16_f32 v91, v22, v23
    v_cvt_pk_bf16_f32 v92, v24, v25
    v_cvt_pk_bf16_f32 v93, v26, v27
    v_cvt_pk_bf16_f32 v94, v28, v29
    v_cvt_pk_bf16_f32 v95, v30, v31
    v_min_u32 v88, -2, v88
    v_min_u32 v89, -2, v89
    v_min_u32 v90, -2, v90
    v_min_u32 v91, -2, v91
    v_min_u32 v92, -2, v92
    v_min_u32 v93, -2, v93
    v_min_u32 v94, -2, v94
    v_min_u32 v95, -2, v95
    global_store_dwordx4 v110, v[88:91], s[44:45] offset:0 sc1
    global_store_dwordx4 v110, v[92:95], s[44:45] offset:1024 sc1
    s_add_u32 s44, s44, 0x80000
    s_addc_u32 s45, s45, 0
    s_cmp_eq_u32 s35, 0
    s_cbranch_scc1 L_qb_k_1n
    s_add_u32 m0, s59, s36
    s_nop 0
    global_load_lds_dwordx4 v110, s[38:39] offset:0 sc1
    global_load_lds_dwordx4 v110, s[38:39] offset:1024 sc1
    global_load_lds_dwordx4 v110, s[38:39] offset:2048 sc1
    global_load_lds_dwordx4 v110, s[38:39] offset:3072 sc1
    s_add_u32 s38, s38, 0x1000
    s_addc_u32 s39, s39, 0
    s_add_u32 m0, m0, 4096
    s_nop 0
    global_load_lds_dwordx4 v110, s[38:39] offset:0 sc1
    global_load_lds_dwordx4 v110, s[38:39] offset:1024 sc1
    global_load_lds_dwordx4 v110, s[38:39] offset:2048 sc1
    global_load_lds_dwordx4 v110, s[38:39] offset:3072 sc1
    s_add_u32 s38, s38, 0x7000
    s_addc_u32 s39, s39, 0
    s_add_u32 m0, s60, s36
    s_nop 0
    global_load_lds_dwordx4 v110, s[38:39] offset:0 sc1
    global_load_lds_dwordx4 v110, s[38:39] offset:1024 sc1
    global_load_lds_dwordx4 v110, s[38:39] offset:2048 sc1
    global_load_lds_dwordx4 v110, s[38:39] offset:3072 sc1
    s_add_u32 s38, s38, 0x1000
    s_addc_u32 s39, s39, 0
    s_add_u32 m0, m0, 4096
    s_nop 0
    global_load_lds_dwordx4 v110, s[38:39] offset:0 sc1
    global_load_lds_dwordx4 v110, s[38:39] offset:1024 sc1
    global_load_lds_dwordx4 v110, s[38:39] offset:2048 sc1
    global_load_lds_dwordx4 v110, s[38:39] offset:3072 sc1
    s_add_u32 s38, s38, 0x7000
    s_addc_u32 s39, s39, 0
    v_xor_b32 v111, 512, v111
    s_add_u32 s54, s54, 1
    s_lshr_b32 s55, s54, 1
    s_waitcnt vmcnt(8)
L_qb_k_1n:
    s_mov_b32 s52, 2
    s_waitcnt lgkmcnt(0)
    s_branch L_qb_g2
L_qb_gv:
    s_waitcnt lgkmcnt(6)
    v_mfma_f32_32x32x16_bf16 v[0:15], v[48:51], a[0:3], 0
    ds_read_b128 v[48:51], v115 offset:8192
    v_mfma_f32_32x32x16_bf16 v[0:15], v[52:55], a[4:7], v[0:15]
    ds_read_b128 v[52:55], v115 offset:9216
    s_waitcnt lgkmcnt(6)
    v_mfma_f32_32x32x16_bf16 v[0:15], v[56:59], a[8:11], v[0:15]
    ds_read_b128 v[56:59], v115 offset:10240
    v_mfma_f32_32x32x16_bf16 v[0:15], v[60:63], a[12:15], v[0:15]
    ds_read_b128 v[60:63], v115 offset:11264
    s_waitcnt lgkmcnt(6)
    v_mfma_f32_32x32x16_bf16 v[0:15], v[64:67], a[16:19], v[0:15]
    ds_read_b128 v[64:67], v115 offset:12288
    v_mfma_f32_32x32x16_bf16 v[0:15], v[68:71], a[20:23], v[0:15]
    ds_read_b128 v[68:71], v115 offset:13312
    s_waitcnt lgkmcnt(6)
    v_mfma_f32_32x32x16_bf16 v[0:15], v[72:75], a[24:27], v[0:15]
    ds_read_b128 v[72:75], v115 offset:14336
    v_mfma_f32_32x32x16_bf16 v[0:15], v[76:79], a[28:31], v[0:15]
    ds_read_b128 v[76:79], v115 offset:15360
    s_waitcnt lgkmcnt(6)
    v_mfma_f32_32x32x16_bf16 v[0:15], v[48:51], a[32:35], v[0:15]
    ds_read_b128 v[48:51], v115 offset:16384
    v_mfma_f32_32x32x16_bf16 v[0:15], v[52:55], a[36:39], v[0:15]
    ds_read_b128 v[52:55], v115 offset:17408
    s_waitcnt lgkmcnt(6)
    v_mfma_f32_32x32x16_bf16 v[0:15], v[56:59], a[40:43], v[0:15]
    ds_read_b128 v[56:59], v115 offset:18432
    v_mfma_f32_32x32x16_bf16 v[0:15], v[60:63], a[44:47], v[0:15]
    ds_read_b128 v[60:63], v115 offset:19456
    s_waitcnt lgkmcnt(6)
    v_mfma_f32_32x32x16_bf16 v[0:15], v[64:67], a[48:51], v[0:15]
    ds_read_b128 v[64:67], v115 offset:20480
    v_mfma_f32_32x32x16_bf16 v[0:15], v[68:71], a[52:55], v[0:15]
    ds_read_b128 v[68:71], v115 offset:21504
    s_waitcnt lgkmcnt(6)
    v_mfma_f32_32x32x16_bf16 v[0:15], v[72:75], a[56:59], v[0:15]
    ds_read_b128 v[72:75], v115 offset:22528
    v_mfma_f32_32x32x16_bf16 v[0:15], v[76:79], a[60:63], v[0:15]
    ds_read_b128 v[76:79], v115 offset:23552
    s_waitcnt lgkmcnt(6)
    v_mfma_f32_32x32x16_bf16 v[0:15], v[48:51], a[64:67], v[0:15]
    ds_read_b128 v[48:51], v115 offset:24576
    v_mfma_f32_32x32x16_bf16 v[0:15], v[52:55], a[68:71], v[0:15]
    ds_read_b128 v[52:55], v115 offset:25600
    s_waitcnt lgkmcnt(6)
    v_mfma_f32_32x32x16_bf16 v[0:15], v[56:59], a[72:75], v[0:15]
    ds_read_b128 v[56:59], v115 offset:26624
    v_mfma_f32_32x32x16_bf16 v[0:15], v[60:63], a[76:79], v[0:15]
    ds_read_b128 v[60:63], v115 offset:27648
    s_waitcnt lgkmcnt(6)
    v_mfma_f32_32x32x16_bf16 v[0:15], v[64:67], a[80:83], v[0:15]
    ds_read_b128 v[64:67], v115 offset:28672
    v_mfma_f32_32x32x16_bf16 v[0:15], v[68:71], a[84:87], v[0:15]
    ds_read_b128 v[68:71], v115 offset:29696
    s_cmp_eq_u32 s52, 1
    s_cbranch_scc1 L_qb_v_a
    s_waitcnt vmcnt(0)
L_qb_v_a:
    s_waitcnt vmcnt(3)
    s_cmp_eq_u32 s52, 0
    s_cbranch_scc1 L_qb_v_b
    s_mov_b64 exec, 3
    global_store_byte v110, v113, s[46:47] offset:-32 sc1
    s_mov_b64 exec, -1
L_qb_v_b:
    s_barrier
    s_waitcnt lgkmcnt(6)
    v_mfma_f32_32x32x16_bf16 v[0:15], v[72:75], a[88:91], v[0:15]
    ds_read_b128 v[72:75], v115 offset:30720
    v_mfma_f32_32x32x16_bf16 v[0:15], v[76:79], a[92:95], v[0:15]
    ds_read_b128 v[76:79], v115 offset:31744
    s_waitcnt lgkmcnt(6)
    v_mfma_f32_32x32x16_bf16 v[0:15], v[48:51], a[96:99], v[0:15]
    ds_read_b128 v[48:51], v116 offset:0
    v_mfma_f32_32x32x16_bf16 v[0:15], v[52:55], a[100:103], v[0:15]
    ds_read_b128 v[52:55], v116 offset:1024
    s_waitcnt lgkmcnt(6)
    v_mfma_f32_32x32x16_bf16 v[0:15], v[56:59], a[104:107], v[0:15]
    ds_read_b128 v[56:59], v116 offset:2048
    v_mfma_f32_32x32x16_bf16 v[0:15], v[60:63], a[108:111], v[0:15]
    ds_read_b128 v[60:63], v116 offset:3072
    s_waitcnt lgkmcnt(6)
    v_mfma_f32_32x32x16_bf16 v[0:15], v[64:67], a[112:115], v[0:15]
    ds_read_b128 v[64:67], v116 offset:4096
    v_mfma_f32_32x32x16_bf16 v[0:15], v[68:71], a[116:119], v[0:15]
    ds_read_b128 v[68:71], v116 offset:5120
    s_waitcnt lgkmcnt(6)
    v_mfma_f32_32x32x16_bf16 v[0:15], v[72:75], a[120:123], v[0:15]
    ds_read_b128 v[72:75], v116 offset:6144
    v_mfma_f32_32x32x16_bf16 v[0:15], v[76:79], a[124:127], v[0:15]
    ds_read_b128 v[76:79], v116 offset:7168
    s_waitcnt lgkmcnt(6)
    v_mfma_f32_32x32x16_bf16 v[16:31], v[48:51], a[0:3], 0
    ds_read_b128 v[48:51], v116 offset:8192
    global_load_dword v114, v111, s[40:41] sc1
    v_mfma_f32_32x32x16_bf16 v[16:31], v[52:55], a[4:7], v[16:31]
    ds_read_b128 v[52:55], v116 offset:9216
    s_waitcnt lgkmcnt(6)
    v_mfma_f32_32x32x16_bf16 v[16:31], v[56:59], a[8:11], v[16:31]
    ds_read_b128 v[56:59], v116 offset:10240
    v_mfma_f32_32x32x16_bf16 v[16:31], v[60:63], a[12:15], v[16:31]
    ds_read_b128 v[60:63], v116 offset:11264
    v_cvt_pk_bf16_f32 v80, v0, v1
    v_cvt_pk_bf16_f32 v81, v2, v3
    v_cvt_pk_bf16_f32 v82, v4, v5
    v_cvt_pk_bf16_f32 v83, v6, v7
    s_waitcnt lgkmcnt(6)
    v_mfma_f32_32x32x16_bf16 v[16:31], v[64:67], a[16:19], v[16:31]
    ds_read_b128 v[64:67], v116 offset:12288
    v_cvt_pk_bf16_f32 v84, v8, v9
    v_cvt_pk_bf16_f32 v85, v10, v11
    v_cvt_pk_bf16_f32 v86, v12, v13
    v_cvt_pk_bf16_f32 v87, v14, v15
    v_mfma_f32_32x32x16_bf16 v[16:31], v[68:71], a[20:23], v[16:31]
    ds_read_b128 v[68:71], v116 offset:13312
    v_min_u32 v80, -2, v80
    v_min_u32 v81, -2, v81
    v_min_u32 v82, -2, v82
    v_min_u32 v83, -2, v83
    s_waitcnt lgkmcnt(6)
    v_mfma_f32_32x32x16_bf16 v[16:31], v[72:75], a[24:27], v[16:31]
    ds_read_b128 v[72:75], v116 offset:14336
    v_min_u32 v84, -2, v84
    v_min_u32 v85, -2, v85
    v_min_u32 v86, -2, v86
    v_min_u32 v87, -2, v87
    v_mfma_f32_32x32x16_bf16 v[16:31], v[76:79], a[28:31], v[16:31]
    ds_read_b128 v[76:79], v116 offset:15360
    global_store_dwordx4 v110, v[80:83], s[44:45] offset:0 sc1
    global_store_dwordx4 v110, v[84:87], s[44:45] offset:1024 sc1
    s_add_u32 s44, s44, 0x80000
    s_addc_u32 s45, s45, 0
    s_waitcnt lgkmcnt(6)
    v_mfma_f32_32x32x16_bf16 v[16:31], v[48:51], a[32:35], v[16:31]
    ds_read_b128 v[48:51], v116 offset:16384
    v_mfma_f32_32x32x16_bf16 v[16:31], v[52:55], a[36:39], v[16:31]
    ds_read_b128 v[52:55], v116 offset:17408
    s_waitcnt lgkmcnt(6)
    v_mfma_f32_32x32x16_bf16 v[16:31], v[56:59], a[40:43], v[16:31]
    ds_read_b128 v[56:59], v116 offset:18432
    v_mfma_f32_32x32x16_bf16 v[16:31], v[60:63], a[44:47], v[16:31]
    ds_read_b128 v[60:63], v116 offset:19456
    s_waitcnt lgkmcnt(6)
    v_mfma_f32_32x32x16_bf16 v[16:31], v[64:67], a[48:51], v[16:31]
    ds_read_b128 v[64:67], v116 offset:20480
    v_mfma_f32_32x32x16_bf16 v[16:31], v[68:71], a[52:55], v[16:31]
    ds_read_b128 v[68:71], v116 offset:21504
    s_waitcnt lgkmcnt(6)
    v_mfma_f32_32x32x16_bf16 v[16:31], v[72:75], a[56:59], v[16:31]
    ds_read_b128 v[72:75], v116 offset:22528
    v_mfma_f32_32x32x16_bf16 v[16:31], v[76:79], a[60:63], v[16:31]
    ds_read_b128 v[76:79], v116 offset:23552
    s_waitcnt lgkmcnt(6)
    v_mfma_f32_32x32x16_bf16 v[16:31], v[48:51], a[64:67], v[16:31]
    ds_read_b128 v[48:51], v116 offset:24576
    v_mfma_f32_32x32x16_bf16 v[16:31], v[52:55], a[68:71], v[16:31]
    ds_read_b128 v[52:55], v116 offset:25600
    s_waitcnt lgkmcnt(6)
    v_mfma_f32_32x32x16_bf16 v[16:31], v[56:59], a[72:75], v[16:31]
    ds_read_b128 v[56:59], v116 offset:26624
    v_mfma_f32_32x32x16_bf16 v[16:31], v[60:63], a[76:79], v[16:31]
    ds_read_b128 v[60:63], v116 offset:27648
    s_waitcnt lgkmcnt(6)
    v_mfma_f32_32x32x16_bf16 v[16:31], v[64:67], a[80:83], v[16:31]
    ds_read_b128 v[64:67], v116 offset:28672
    v_mfma_f32_32x32x16_bf16 v[16:31], v[68:71], a[84:87], v[16:31]
    ds_read_b128 v[68:71], v116 offset:29696
    s_waitcnt lgkmcnt(6)
    v_mfma_f32_32x32x16_bf16 v[16:31], v[72:75], a[88:91], v[16:31]
    ds_read_b128 v[72:75], v116 offset:30720
    v_mfma_f32_32x32x16_bf16 v[16:31], v[76:79], a[92:95], v[16:31]
    ds_read_b128 v[76:79], v116 offset:31744
    s_waitcnt lgkmcnt(6)
    v_mfma_f32_32x32x16_bf16 v[16:31], v[48:51], a[96:99], v[16:31]
    ds_read_b128 v[48:51], v117 offset:0
    v_mfma_f32_32x32x16_bf16 v[16:31], v[52:55], a[100:103], v[16:31]
    ds_read_b128 v[52:55], v117 offset:1024
    s_waitcnt lgkmcnt(6)
    v_mfma_f32_32x32x16_bf16 v[16:31], v[56:59], a[104:107], v[16:31]
    ds_read_b128 v[56:59], v117 offset:2048
    v_mfma_f32_32x32x16_bf16 v[16:31], v[60:63], a[108:111], v[16:31]
    ds_read_b128 v[60:63], v117 offset:3072
    s_waitcnt vmcnt(2)
    s_cmp_lg_u32 s52, 1
    s_cbranch_scc1 L_qb_v_q
    s_mov_b64 exec, 1
    global_store_byte v110, v113, s[50:51] offset:8 sc1
    s_mov_b64 exec, -1
    s_add_u32 s50, s50, 0x20
    s_addc_u32 s51, s51, 0
L_qb_v_q:
    s_mov_b32 s52, 0
    v_cmp_gt_u32 vcc, s55, v114
    s_cmp_eq_u64 vcc, 0
    s_cselect_b32 s35, 1, 0
    s_cmp_ge_u32 s33, 62
    s_cselect_b32 s35, 0, s35
    s_cmp_eq_u32 s33, 0
    s_cbranch_scc1 L_qb_v_1st
    s_cmp_eq_u32 s35, 0
    s_cbranch_scc1 L_qb_v_st
    v_xor_b32 v111, 512, v111
    s_add_u32 s54, s54, 1
    s_lshr_b32 s55, s54, 1
    s_cmp_ge_u32 s33, 8
    s_cbranch_scc1 L_qb_v_lz0
    s_waitcnt vmcnt(0)
    s_mov_b64 exec, 1
    global_store_byte v110, v113, s[46:47] offset:0 sc1
    s_mov_b64 exec, -1
L_qb_v_lz0:
    s_waitcnt lgkmcnt(6)
    v_mfma_f32_32x32x16_bf16 v[16:31], v[64:67], a[112:115], v[16:31]
    ds_read_b128 v[64:67], v117 offset:4096
    s_add_u32 m0, s59, s36
    v_mfma_f32_32x32x16_bf16 v[16:31], v[68:71], a[116:119], v[16:31]
    ds_read_b128 v[68:71], v117 offset:5120
    global_load_lds_dwordx4 v110, s[38:39] offset:0 sc1
    s_waitcnt lgkmcnt(6)
    v_mfma_f32_32x32x16_bf16 v[16:31], v[72:75], a[120:123], v[16:31]
    ds_read_b128 v[72:75], v117 offset:6144
    global_load_lds_dwordx4 v110, s[38:39] offset:1024 sc1
    v_mfma_f32_32x32x16_bf16 v[16:31], v[76:79], a[124:127], v[16:31]
    ds_read_b128 v[76:79], v117 offset:7168
    global_load_lds_dwordx4 v110, s[38:39] offset:2048 sc1
    s_waitcnt lgkmcnt(6)
    v_mfma_f32_32x32x16_bf16 v[32:47], a[128:131], v[48:51], 0
    ds_read_b128 v[48:51], v117 offset:8192
    global_load_lds_dwordx4 v110, s[38:39] offset:3072 sc1
    s_add_u32 s38, s38, 0x1000
    s_addc_u32 s39, s39, 0
    v_mfma_f32_32x32x16_bf16 v[32:47], a[132:135], v[52:55], v[32:47]
    ds_read_b128 v[52:55], v117 offset:9216
    s_add_u32 m0, m0, 4096
    s_waitcnt lgkmcnt(6)
    v_mfma_f32_32x32x16_bf16 v[32:47], a[136:139], v[56:59], v[32:47]
    ds_read_b128 v[56:59], v117 offset:10240
    global_load_lds_dwordx4 v110, s[38:39] offset:0 sc1
    v_mfma_f32_32x32x16_bf16 v[32:47], a[140:143], v[60:63], v[32:47]
    ds_read_b128 v[60:63], v117 offset:11264
    v_cvt_pk_bf16_f32 v88, v16, v17
    v_cvt_pk_bf16_f32 v89, v18, v19
    v_cvt_pk_bf16_f32 v90, v20, v21
    v_cvt_pk_bf16_f32 v91, v22, v23
    s_waitcnt lgkmcnt(6)
    v_mfma_f32_32x32x16_bf16 v[32:47], a[144:147], v[64:67], v[32:47]
    ds_read_b128 v[64:67], v117 offset:12288
    v_cvt_pk_bf16_f32 v92, v24, v25
    v_cvt_pk_bf16_f32 v93, v26, v27
    v_cvt_pk_bf16_f32 v94, v28, v29
    v_cvt_pk_bf16_f32 v95, v30, v31
    v_mfma_f32_32x32x16_bf16 v[32:47], a[148:151], v[68:71], v[32:47]
    ds_read_b128 v[68:71], v117 offset:13312
    v_min_u32 v88, -2, v88
    v_min_u32 v89, -2, v89
    v_min_u32 v90, -2, v90
    v_min_u32 v91, -2, v91
    s_waitcnt lgkmcnt(6)
    v_mfma_f32_32x32x16_bf16 v[32:47], a[152:155], v[72:75], v[32:47]
    ds_read_b128 v[72:75], v117 offset:14336
    v_min_u32 v92, -2, v92
    v_min_u32 v93, -2, v93
    v_min_u32 v94, -2, v94
    v_min_u32 v95, -2, v95
    v_mfma_f32_32x32x16_bf16 v[32:47], a[156:159], v[76:79], v[32:47]
    ds_read_b128 v[76:79], v117 offset:15360
    global_store_dwordx4 v110, v[88:91], s[44:45] offset:0 sc1
    global_store_dwordx4 v110, v[92:95], s[44:45] offset:1024 sc1
    s_add_u32 s44, s44, 0x80000
    s_addc_u32 s45, s45, 0
    s_waitcnt lgkmcnt(6)
    v_mfma_f32_32x32x16_bf16 v[32:47], a[160:163], v[48:51], v[32:47]
    ds_read_b128 v[48:51], v117 offset:16384
    global_load_lds_dwordx4 v110, s[38:39] offset:1024 sc1
    v_mfma_f32_32x32x16_bf16 v[32:47], a[164:167], v[52:55], v[32:47]
    ds_read_b128 v[52:55], v117 offset:17408
    global_load_lds_dwordx4 v110, s[38:39] offset:2048 sc1
    s_waitcnt lgkmcnt(6)
    v_mfma_f32_32x32x16_bf16 v[32:47], a[168:171], v[56:59], v[32:47]
    ds_read_b128 v[56:59], v117 offset:18432
    global_load_lds_dwordx4 v110, s[38:39] offset:3072 sc1
    s_add_u32 s38, s38, 0x7000
    s_addc_u32 s39, s39, 0
    v_mfma_f32_32x32x16_bf16 v[32:47], a[172:175], v[60:63], v[32:47]
    ds_read_b128 v[60:63], v117 offset:19456
    s_add_u32 m0, s60, s36
    s_waitcnt lgkmcnt(6)
    v_mfma_f32_32x32x16_bf16 v[32:47], a[176:179], v[64:67], v[32:47]
    ds_read_b128 v[64:67], v117 offset:20480
    global_load_lds_dwordx4 v110, s[38:39] offset:0 sc1
    v_mfma_f32_32x32x16_bf16 v[32:47], a[180:183], v[68:71], v[32:47]
    ds_read_b128 v[68:71], v117 offset:21504
    global_load_lds_dwordx4 v110, s[38:39] offset:1024 sc1
    s_waitcnt lgkmcnt(6)
    v_mfma_f32_32x32x16_bf16 v[32:47], a[184:187], v[72:75], v[32:47]
    ds_read_b128 v[72:75], v117 offset:22528
    global_load_lds_dwordx4 v110, s[38:39] offset:2048 sc1
    v_mfma_f32_32x32x16_bf16 v[32:47], a[188:191], v[76:79], v[32:47]
    ds_read_b128 v[76:79], v117 offset:23552
    global_load_lds_dwordx4 v110, s[38:39] offset:3072 sc1
    s_add_u32 s38, s38, 0x1000
    s_addc_u32 s39, s39, 0
    s_waitcnt lgkmcnt(6)
    v_mfma_f32_32x32x16_bf16 v[32:47], a[192:195], v[48:51], v[32:47]
    ds_read_b128 v[48:51], v117 offset:24576
    s_add_u32 m0, m0, 4096
    v_mfma_f32_32x32x16_bf16 v[32:47], a[196:199], v[52:55], v[32:47]
    ds_read_b128 v[52:55], v117 offset:25600
    global_load_lds_dwordx4 v110, s[38:39] offset:0 sc1
    s_waitcnt lgkmcnt(6)
    v_mfma_f32_32x32x16_bf16 v[32:47], a[200:203], v[56:59], v[32:47]
    ds_read_b128 v[56:59], v117 offset:26624
    global_load_lds_dwordx4 v110, s[38:39] offset:1024 sc1
    v_mfma_f32_32x32x16_bf16 v[32:47], a[204:207], v[60:63], v[32:47]
    ds_read_b128 v[60:63], v117 offset:27648
    global_load_lds_dwordx4 v110, s[38:39] offset:2048 sc1
    s_waitcnt lgkmcnt(6)
    v_mfma_f32_32x32x16_bf16 v[32:47], a[208:211], v[64:67], v[32:47]
    ds_read_b128 v[64:67], v117 offset:28672
    global_load_lds_dwordx4 v110, s[38:39] offset:3072 sc1
    s_add_u32 s38, s38, 0x7000
    s_addc_u32 s39, s39, 0
    v_mfma_f32_32x32x16_bf16 v[32:47], a[212:215], v[68:71], v[32:47]
    ds_read_b128 v[68:71], v117 offset:29696
    s_waitcnt lgkmcnt(6)
    v_mfma_f32_32x32x16_bf16 v[32:47], a[216:219], v[72:75], v[32:47]
    ds_read_b128 v[72:75], v117 offset:30720
    v_mfma_f32_32x32x16_bf16 v[32:47], a[220:223], v[76:79], v[32:47]
    ds_read_b128 v[76:79], v117 offset:31744
    s_waitcnt lgkmcnt(6)
    v_mfma_f32_32x32x16_bf16 v[32:47], a[224:227], v[48:51], v[32:47]
    v_mfma_f32_32x32x16_bf16 v[32:47], a[228:231], v[52:55], v[32:47]
    s_waitcnt lgkmcnt(4)
    v_mfma_f32_32x32x16_bf16 v[32:47], a[232:235], v[56:59], v[32:47]
    v_mfma_f32_32x32x16_bf16 v[32:47], a[236:239], v[60:63], v[32:47]
    s_cmp_ge_u32 s33, 8
    s_cbranch_scc1 L_qb_v_lz
    s_waitcnt vmcnt(11)
    s_mov_b64 exec, 1
    global_store_byte v110, v113, s[46:47] offset:16 sc1
    s_mov_b64 exec, -1
    s_branch L_qb_v_lz2
L_qb_v_lz:
    s_waitcnt vmcnt(18)
    s_mov_b64 exec, 1
    global_store_byte v110, v113, s[46:47] offset:0 sc1
    s_mov_b64 exec, -1
L_qb_v_lz2:
    s_waitcnt lgkmcnt(2)
    v_mfma_f32_32x32x16_bf16 v[32:47], a[240:243], v[64:67], v[32:47]
    v_mfma_f32_32x32x16_bf16 v[32:47], a[244:247], v[68:71], v[32:47]
    s_waitcnt lgkmcnt(0)
    v_mfma_f32_32x32x16_bf16 v[32:47], a[248:251], v[72:75], v[32:47]
    v_mfma_f32_32x32x16_bf16 v[32:47], a[252:255], v[76:79], v[32:47]
    s_branch L_qb_g1
L_qb_v_st:
    s_waitcnt vmcnt(0)
    s_mov_b64 exec, 1
    global_store_byte v110, v113, s[46:47] offset:0 sc1
    s_mov_b64 exec, -1
    s_waitcnt lgkmcnt(6)
    v_mfma_f32_32x32x16_bf16 v[16:31], v[64:67], a[112:115], v[16:31]
    ds_read_b128 v[64:67], v117 offset:4096
    v_mfma_f32_32x32x16_bf16 v[16:31], v[68:71], a[116:119], v[16:31]
    ds_read_b128 v[68:71], v117 offset:5120
    s_waitcnt lgkmcnt(6)
    v_mfma_f32_32x32x16_bf16 v[16:31], v[72:75], a[120:123], v[16:31]
    ds_read_b128 v[72:75], v117 offset:6144
    v_mfma_f32_32x32x16_bf16 v[16:31], v[76:79], a[124:127], v[16:31]
    ds_read_b128 v[76:79], v117 offset:7168
    s_waitcnt lgkmcnt(6)
    v_mfma_f32_32x32x16_bf16 v[32:47], a[128:131], v[48:51], 0
    ds_read_b128 v[48:51], v117 offset:8192
    v_mfma_f32_32x32x16_bf16 v[32:47], a[132:135], v[52:55], v[32:47]
    ds_read_b128 v[52:55], v117 offset:9216
    s_waitcnt lgkmcnt(6)
    v_mfma_f32_32x32x16_bf16 v[32:47], a[136:139], v[56:59], v[32:47]
    ds_read_b128 v[56:59], v117 offset:10240
    v_mfma_f32_32x32x16_bf16 v[32:47], a[140:143], v[60:63], v[32:47]
    ds_read_b128 v[60:63], v117 offset:11264
    s_nop 0
    v_cvt_pk_bf16_f32 v88, v16, v17
    v_cvt_pk_bf16_f32 v89, v18, v19
    v_cvt_pk_bf16_f32 v90, v20, v21
    v_cvt_pk_bf16_f32 v91, v22, v23
    s_waitcnt lgkmcnt(6)
    v_mfma_f32_32x32x16_bf16 v[32:47], a[144:147], v[64:67], v[32:47]
    ds_read_b128 v[64:67], v117 offset:12288
    v_cvt_pk_bf16_f32 v92, v24, v25
    v_cvt_pk_bf16_f32 v93, v26, v27
    v_cvt_pk_bf16_f32 v94, v28, v29
    v_cvt_pk_bf16_f32 v95, v30, v31
    v_mfma_f32_32x32x16_bf16 v[32:47], a[148:151], v[68:71], v[32:47]
    ds_read_b128 v[68:71], v117 offset:13312
    v_min_u32 v88, -2, v88
    v_min_u32 v89, -2, v89
    v_min_u32 v90, -2, v90
    v_min_u32 v91, -2, v91
    s_waitcnt lgkmcnt(6)
    v_mfma_f32_32x32x16_bf16 v[32:47], a[152:155], v[72:75], v[32:47]
    ds_read_b128 v[72:75], v117 offset:14336
    v_min_u32 v92, -2, v92
    v_min_u32 v93, -2, v93
    v_min_u32 v94, -2, v94
    v_min_u32 v95, -2, v95
    v_mfma_f32_32x32x16_bf16 v[32:47], a[156:159], v[76:79], v[32:47]
    ds_read_b128 v[76:79], v117 offset:15360
    global_store_dwordx4 v110, v[88:91], s[44:45] offset:0 sc1
    global_store_dwordx4 v110, v[92:95], s[44:45] offset:1024 sc1
    s_add_u32 s44, s44, 0x80000
    s_addc_u32 s45, s45, 0
    s_waitcnt lgkmcnt(6)
    v_mfma_f32_32x32x16_bf16 v[32:47], a[160:163], v[48:51], v[32:47]
    ds_read_b128 v[48:51], v117 offset:16384
    v_mfma_f32_32x32x16_bf16 v[32:47], a[164:167], v[52:55], v[32:47]
    ds_read_b128 v[52:55], v117 offset:17408
    s_waitcnt lgkmcnt(6)
    v_mfma_f32_32x32x16_bf16 v[32:47], a[168:171], v[56:59], v[32:47]
    ds_read_b128 v[56:59], v117 offset:18432
    v_mfma_f32_32x32x16_bf16 v[32:47], a[172:175], v[60:63], v[32:47]
    ds_read_b128 v[60:63], v117 offset:19456
    s_waitcnt lgkmcnt(6)
    v_mfma_f32_32x32x16_bf16 v[32:47], a[176:179], v[64:67], v[32:47]
    ds_read_b128 v[64:67], v117 offset:20480
    v_mfma_f32_32x32x16_bf16 v[32:47], a[180:183], v[68:71], v[32:47]
    ds_read_b128 v[68:71], v117 offset:21504
    global_load_dword v114, v111, s[40:41] sc1
    s_waitcnt lgkmcnt(6)
    v_mfma_f32_32x32x16_bf16 v[32:47], a[184:187], v[72:75], v[32:47]
    ds_read_b128 v[72:75], v117 offset:22528
    v_mfma_f32_32x32x16_bf16 v[32:47], a[188:191], v[76:79], v[32:47]
    ds_read_b128 v[76:79], v117 offset:23552
    s_waitcnt lgkmcnt(6)
    v_mfma_f32_32x32x16_bf16 v[32:47], a[192:195], v[48:51], v[32:47]
    ds_read_b128 v[48:51], v117 offset:24576
    v_mfma_f32_32x32x16_bf16 v[32:47], a[196:199], v[52:55], v[32:47]
    ds_read_b128 v[52:55], v117 offset:25600
    s_waitcnt lgkmcnt(6)
    v_mfma_f32_32x32x16_bf16 v[32:47], a[200:203], v[56:59], v[32:47]
    ds_read_b128 v[56:59], v117 offset:26624
    v_mfma_f32_32x32x16_bf16 v[32:47], a[204:207], v[60:63], v[32:47]
    ds_read_b128 v[60:63], v117 offset:27648
    s_waitcnt lgkmcnt(6)
    v_mfma_f32_32x32x16_bf16 v[32:47], a[208:211], v[64:67], v[32:47]
    ds_read_b128 v[64:67], v117 offset:28672
    v_mfma_f32_32x32x16_bf16 v[32:47], a[212:215], v[68:71], v[32:47]
    ds_read_b128 v[68:71], v117 offset:29696
    s_waitcnt lgkmcnt(6)
    v_mfma_f32_32x32x16_bf16 v[32:47], a[216:219], v[72:75], v[32:47]
    ds_read_b128 v[72:75], v117 offset:30720
    v_mfma_f32_32x32x16_bf16 v[32:47], a[220:223], v[76:79], v[32:47]
    ds_read_b128 v[76:79], v117 offset:31744
    s_waitcnt lgkmcnt(6)
    v_mfma_f32_32x32x16_bf16 v[32:47], a[224:227], v[48:51], v[32:47]
    v_mfma_f32_32x32x16_bf16 v[32:47], a[228:231], v[52:55], v[32:47]
    s_waitcnt lgkmcnt(4)
    v_mfma_f32_32x32x16_bf16 v[32:47], a[232:235], v[56:59], v[32:47]
    v_mfma_f32_32x32x16_bf16 v[32:47], a[236:239], v[60:63], v[32:47]
    s_waitcnt vmcnt(0)
    s_cmp_ge_u32 s33, 62
    s_cbranch_scc1 L_qb_v_n2
    v_cmp_gt_u32 vcc, s55, v114
    s_cbranch_vccnz L_qb_v_n2
    s_mov_b64 exec, 1
    global_store_byte v110, v113, s[46:47] offset:16 sc1
    s_mov_b64 exec, -1
    s_add_u32 m0, s59, s36
    s_nop 0
    global_load_lds_dwordx4 v110, s[38:39] offset:0 sc1
    global_load_lds_dwordx4 v110, s[38:39] offset:1024 sc1
    global_load_lds_dwordx4 v110, s[38:39] offset:2048 sc1
    global_load_lds_dwordx4 v110, s[38:39] offset:3072 sc1
    s_add_u32 s38, s38, 0x1000
    s_addc_u32 s39, s39, 0
    s_add_u32 m0, m0, 4096
    s_nop 0
    global_load_lds_dwordx4 v110, s[38:39] offset:0 sc1
    global_load_lds_dwordx4 v110, s[38:39] offset:1024 sc1
    global_load_lds_dwordx4 v110, s[38:39] offset:2048 sc1
    global_load_lds_dwordx4 v110, s[38:39] offset:3072 sc1
    s_add_u32 s38, s38, 0x7000
    s_addc_u32 s39, s39, 0
    s_add_u32 m0, s60, s36
    s_nop 0
    global_load_lds_dwordx4 v110, s[38:39] offset:0 sc1
    global_load_lds_dwordx4 v110, s[38:39] offset:1024 sc1
    global_load_lds_dwordx4 v110, s[38:39] offset:2048 sc1
    global_load_lds_dwordx4 v110, s[38:39] offset:3072 sc1
    s_add_u32 s38, s38, 0x1000
    s_addc_u32 s39, s39, 0
    s_add_u32 m0, m0, 4096
    s_nop 0
    global_load_lds_dwordx4 v110, s[38:39] offset:0 sc1
    global_load_lds_dwordx4 v110, s[38:39] offset:1024 sc1
    global_load_lds_dwordx4 v110, s[38:39] offset:2048 sc1
    global_load_lds_dwordx4 v110, s[38:39] offset:3072 sc1
    s_add_u32 s38, s38, 0x7000
    s_addc_u32 s39, s39, 0
    v_xor_b32 v111, 512, v111
    s_add_u32 s54, s54, 1
    s_lshr_b32 s55, s54, 1
    s_mov_b32 s35, 1
L_qb_v_n2:
    s_mov_b64 exec, 1
    global_store_byte v110, v113, s[46:47] offset:16 sc1
    s_mov_b64 exec, -1
    s_waitcnt lgkmcnt(2)
    v_mfma_f32_32x32x16_bf16 v[32:47], a[240:243], v[64:67], v[32:47]
    v_mfma_f32_32x32x16_bf16 v[32:47], a[244:247], v[68:71], v[32:47]
    s_waitcnt lgkmcnt(0)
    v_mfma_f32_32x32x16_bf16 v[32:47], a[248:251], v[72:75], v[32:47]
    v_mfma_f32_32x32x16_bf16 v[32:47], a[252:255], v[76:79], v[32:47]
    s_branch L_qb_g1
L_qb_v_1st:
    s_waitcnt lgkmcnt(6)
    v_mfma_f32_32x32x16_bf16 v[16:31], v[64:67], a[112:115], v[16:31]
    ds_read_b128 v[64:67], v117 offset:4096
    v_mfma_f32_32x32x16_bf16 v[16:31], v[68:71], a[116:119], v[16:31]
    ds_read_b128 v[68:71], v117 offset:5120
    s_waitcnt lgkmcnt(6)
    v_mfma_f32_32x32x16_bf16 v[16:31], v[72:75], a[120:123], v[16:31]
    ds_read_b128 v[72:75], v117 offset:6144
    v_mfma_f32_32x32x16_bf16 v[16:31], v[76:79], a[124:127], v[16:31]
    ds_read_b128 v[76:79], v117 offset:7168
    s_nop 10
    v_cvt_pk_bf16_f32 v88, v16, v17
    v_cvt_pk_bf16_f32 v89, v18, v19
    v_cvt_pk_bf16_f32 v90, v20, v21
    v_cvt_pk_bf16_f32 v91, v22, v23
    v_cvt_pk_bf16_f32 v92, v24, v25
    v_cvt_pk_bf16_f32 v93, v26, v27
    v_cvt_pk_bf16_f32 v94, v28, v29
    v_cvt_pk_bf16_f32 v95, v30, v31
    v_min_u32 v88, -2, v88
    v_min_u32 v89, -2, v89
    v_min_u32 v90, -2, v90
    v_min_u32 v91, -2, v91
    v_min_u32 v92, -2, v92
    v_min_u32 v93, -2, v93
    v_min_u32 v94, -2, v94
    v_min_u32 v95, -2, v95
    global_store_dwordx4 v110, v[88:91], s[44:45] offset:0 sc1
    global_store_dwordx4 v110, v[92:95], s[44:45] offset:1024 sc1
    s_add_u32 s44, s44, 0x80000
    s_addc_u32 s45, s45, 0
    s_cmp_eq_u32 s35, 0
    s_cbranch_scc1 L_qb_v_1n
    s_add_u32 m0, s59, s36
    s_nop 0
    global_load_lds_dwordx4 v110, s[38:39] offset:0 sc1
    global_load_lds_dwordx4 v110, s[38:39] offset:1024 sc1
    global_load_lds_dwordx4 v110, s[38:39] offset:2048 sc1
    global_load_lds_dwordx4 v110, s[38:39] offset:3072 sc1
    s_add_u32 s38, s38, 0x1000
    s_addc_u32 s39, s39, 0
    s_add_u32 m0, m0, 4096
    s_nop 0
    global_load_lds_dwordx4 v110, s[38:39] offset:0 sc1
    global_load_lds_dwordx4 v110, s[38:39] offset:1024 sc1
    global_load_lds_dwordx4 v110, s[38:39] offset:2048 sc1
    global_load_lds_dwordx4 v110, s[38:39] offset:3072 sc1
    s_add_u32 s38, s38, 0x7000
    s_addc_u32 s39, s39, 0
    s_add_u32 m0, s60, s36
    s_nop 0
    global_load_lds_dwordx4 v110, s[38:39] offset:0 sc1
    global_load_lds_dwordx4 v110, s[38:39] offset:1024 sc1
    global_load_lds_dwordx4 v110, s[38:39] offset:2048 sc1
    global_load_lds_dwordx4 v110, s[38:39] offset:3072 sc1
    s_add_u32 s38, s38, 0x1000
    s_addc_u32 s39, s39, 0
    s_add_u32 m0, m0, 4096
    s_nop 0
    global_load_lds_dwordx4 v110, s[38:39] offset:0 sc1
    global_load_lds_dwordx4 v110, s[38:39] offset:1024 sc1
    global_load_lds_dwordx4 v110, s[38:39] offset:2048 sc1
    global_load_lds_dwordx4 v110, s[38:39] offset:3072 sc1
    s_add_u32 s38, s38, 0x7000
    s_addc_u32 s39, s39, 0
    v_xor_b32 v111, 512, v111
    s_add_u32 s54, s54, 1
    s_lshr_b32 s55, s54, 1
    s_waitcnt vmcnt(8)
L_qb_v_1n:
    s_mov_b32 s52, 2
    s_waitcnt lgkmcnt(0)
    s_branch L_qb_g2
L_qb_g1:
    s_nop 10
    v_pk_mul_f32 v[32:33], v[32:33], s[48:49]
    v_pk_mul_f32 v[34:35], v[34:35], s[48:49]
    v_pk_mul_f32 v[36:37], v[36:37], s[48:49]
    v_pk_mul_f32 v[38:39], v[38:39], s[48:49]
    v_pk_mul_f32 v[40:41], v[40:41], s[48:49]
    v_pk_mul_f32 v[42:43], v[42:43], s[48:49]
    v_pk_mul_f32 v[44:45], v[44:45], s[48:49]
    v_pk_mul_f32 v[46:47], v[46:47], s[48:49]
    v_cvt_pk_bf16_f32 v96, v32, v33
    v_cvt_pk_bf16_f32 v97, v34, v35
    v_cvt_pk_bf16_f32 v98, v36, v37
    v_cvt_pk_bf16_f32 v99, v38, v39
    v_cvt_pk_bf16_f32 v100, v40, v41
    v_cvt_pk_bf16_f32 v101, v42, v43
    v_cvt_pk_bf16_f32 v102, v44, v45
    v_cvt_pk_bf16_f32 v103, v46, v47
    global_store_dwordx4 v110, v[96:99], s[42:43] offset:0 sc1
    global_store_dwordx4 v110, v[100:103], s[42:43] offset:1024 sc1
    s_mov_b32 s52, 1
    s_add_u32 s42, s42, 0x80000
    s_addc_u32 s43, s43, 0
L_qb_g2:
    s_cmp_eq_u32 s32, 0
    s_cselect_b32 s80, s56, s57
    s_cselect_b32 s81, s57, s56
    s_mov_b32 s56, s59
    s_mov_b32 s57, s60
    s_mov_b32 s59, s81
    s_mov_b32 s60, s58
    s_mov_b32 s58, s80
    s_add_u32 s46, s46, 0x20
    s_addc_u32 s47, s47, 0
    s_add_u32 s33, s33, 2
    s_cmp_lt_u32 s33, 64
    s_cbranch_scc1 L_qb_loop
    v_add_u32 v115, s56, v110
    v_add_u32 v116, s57, v110
    v_add_u32 v117, s58, v110
    ds_read_b128 v[48:51], v117 offset:0
    ds_read_b128 v[52:55], v117 offset:1024
    ds_read_b128 v[56:59], v117 offset:2048
    ds_read_b128 v[60:63], v117 offset:3072
    ds_read_b128 v[64:67], v117 offset:4096
    ds_read_b128 v[68:71], v117 offset:5120
    ds_read_b128 v[72:75], v117 offset:6144
    ds_read_b128 v[76:79], v117 offset:7168
    s_waitcnt lgkmcnt(6)
    v_mfma_f32_32x32x16_bf16 v[32:47], a[128:131], v[48:51], 0
    ds_read_b128 v[48:51], v117 offset:8192
    v_mfma_f32_32x32x16_bf16 v[32:47], a[132:135], v[52:55], v[32:47]
    ds_read_b128 v[52:55], v117 offset:9216
    s_waitcnt lgkmcnt(6)
    v_mfma_f32_32x32x16_bf16 v[32:47], a[136:139], v[56:59], v[32:47]
    ds_read_b128 v[56:59], v117 offset:10240
    v_mfma_f32_32x32x16_bf16 v[32:47], a[140:143], v[60:63], v[32:47]
    ds_read_b128 v[60:63], v117 offset:11264
    s_waitcnt lgkmcnt(6)
    v_mfma_f32_32x32x16_bf16 v[32:47], a[144:147], v[64:67], v[32:47]
    ds_read_b128 v[64:67], v117 offset:12288
    v_mfma_f32_32x32x16_bf16 v[32:47], a[148:151], v[68:71], v[32:47]
    ds_read_b128 v[68:71], v117 offset:13312
    s_waitcnt lgkmcnt(6)
    v_mfma_f32_32x32x16_bf16 v[32:47], a[152:155], v[72:75], v[32:47]
    ds_read_b128 v[72:75], v117 offset:14336
    v_mfma_f32_32x32x16_bf16 v[32:47], a[156:159], v[76:79], v[32:47]
    ds_read_b128 v[76:79], v117 offset:15360
    s_waitcnt lgkmcnt(6)
    v_mfma_f32_32x32x16_bf16 v[32:47], a[160:163], v[48:51], v[32:47]
    ds_read_b128 v[48:51], v117 offset:16384
    v_mfma_f32_32x32x16_bf16 v[32:47], a[164:167], v[52:55], v[32:47]
    ds_read_b128 v[52:55], v117 offset:17408
    s_waitcnt lgkmcnt(6)
    v_mfma_f32_32x32x16_bf16 v[32:47], a[168:171], v[56:59], v[32:47]
    ds_read_b128 v[56:59], v117 offset:18432
    v_mfma_f32_32x32x16_bf16 v[32:47], a[172:175], v[60:63], v[32:47]
    ds_read_b128 v[60:63], v117 offset:19456
    s_waitcnt lgkmcnt(6)
    v_mfma_f32_32x32x16_bf16 v[32:47], a[176:179], v[64:67], v[32:47]
    ds_read_b128 v[64:67], v117 offset:20480
    v_mfma_f32_32x32x16_bf16 v[32:47], a[180:183], v[68:71], v[32:47]
    ds_read_b128 v[68:71], v117 offset:21504
    s_waitcnt lgkmcnt(6)
    v_mfma_f32_32x32x16_bf16 v[32:47], a[184:187], v[72:75], v[32:47]
    ds_read_b128 v[72:75], v117 offset:22528
    v_mfma_f32_32x32x16_bf16 v[32:47], a[188:191], v[76:79], v[32:47]
    ds_read_b128 v[76:79], v117 offset:23552
    s_waitcnt lgkmcnt(6)
    v_mfma_f32_32x32x16_bf16 v[32:47], a[192:195], v[48:51], v[32:47]
    ds_read_b128 v[48:51], v117 offset:24576
    v_mfma_f32_32x32x16_bf16 v[32:47], a[196:199], v[52:55], v[32:47]
    ds_read_b128 v[52:55], v117 offset:25600
    s_waitcnt lgkmcnt(6)
    v_mfma_f32_32x32x16_bf16 v[32:47], a[200:203], v[56:59], v[32:47]
    ds_read_b128 v[56:59], v117 offset:26624
    v_mfma_f32_32x32x16_bf16 v[32:47], a[204:207], v[60:63], v[32:47]
    ds_read_b128 v[60:63], v117 offset:27648
    s_waitcnt lgkmcnt(6)
    v_mfma_f32_32x32x16_bf16 v[32:47], a[208:211], v[64:67], v[32:47]
    ds_read_b128 v[64:67], v117 offset:28672
    v_mfma_f32_32x32x16_bf16 v[32:47], a[212:215], v[68:71], v[32:47]
    ds_read_b128 v[68:71], v117 offset:29696
    s_waitcnt lgkmcnt(6)
    v_mfma_f32_32x32x16_bf16 v[32:47], a[216:219], v[72:75], v[32:47]
    ds_read_b128 v[72:75], v117 offset:30720
    v_mfma_f32_32x32x16_bf16 v[32:47], a[220:223], v[76:79], v[32:47]
    ds_read_b128 v[76:79], v117 offset:31744
    s_waitcnt lgkmcnt(6)
    v_mfma_f32_32x32x16_bf16 v[32:47], a[224:227], v[48:51], v[32:47]
    v_mfma_f32_32x32x16_bf16 v[32:47], a[228:231], v[52:55], v[32:47]
    s_waitcnt lgkmcnt(4)
    v_mfma_f32_32x32x16_bf16 v[32:47], a[232:235], v[56:59], v[32:47]
    v_mfma_f32_32x32x16_bf16 v[32:47], a[236:239], v[60:63], v[32:47]
    s_waitcnt lgkmcnt(2)
    v_mfma_f32_32x32x16_bf16 v[32:47], a[240:243], v[64:67], v[32:47]
    v_mfma_f32_32x32x16_bf16 v[32:47], a[244:247], v[68:71], v[32:47]
    s_waitcnt lgkmcnt(0)
    v_mfma_f32_32x32x16_bf16 v[32:47], a[248:251], v[72:75], v[32:47]
    v_mfma_f32_32x32x16_bf16 v[32:47], a[252:255], v[76:79], v[32:47]
    s_waitcnt vmcnt(0)
    s_cmp_lg_u32 s52, 1
    s_cbranch_scc1 L_qb_q1
    s_mov_b64 exec, 1
    global_store_byte v110, v113, s[50:51] offset:8 sc1
    s_mov_b64 exec, -1
    s_add_u32 s50, s50, 0x20
    s_addc_u32 s51, s51, 0
L_qb_q1:
    s_mov_b32 s52, 0
    s_nop 7
    v_pk_mul_f32 v[32:33], v[32:33], s[48:49]
    v_pk_mul_f32 v[34:35], v[34:35], s[48:49]
    v_pk_mul_f32 v[36:37], v[36:37], s[48:49]
    v_pk_mul_f32 v[38:39], v[38:39], s[48:49]
    v_pk_mul_f32 v[40:41], v[40:41], s[48:49]
    v_pk_mul_f32 v[42:43], v[42:43], s[48:49]
    v_pk_mul_f32 v[44:45], v[44:45], s[48:49]
    v_pk_mul_f32 v[46:47], v[46:47], s[48:49]
    v_cvt_pk_bf16_f32 v96, v32, v33
    v_cvt_pk_bf16_f32 v97, v34, v35
    v_cvt_pk_bf16_f32 v98, v36, v37
    v_cvt_pk_bf16_f32 v99, v38, v39
    v_cvt_pk_bf16_f32 v100, v40, v41
    v_cvt_pk_bf16_f32 v101, v42, v43
    v_cvt_pk_bf16_f32 v102, v44, v45
    v_cvt_pk_bf16_f32 v103, v46, v47
    global_store_dwordx4 v110, v[96:99], s[42:43] offset:0 sc1
    global_store_dwordx4 v110, v[100:103], s[42:43] offset:1024 sc1
    s_mov_b32 s52, 1
    s_add_u32 s42, s42, 0x80000
    s_addc_u32 s43, s43, 0
    s_waitcnt vmcnt(0)
    s_cmp_lg_u32 s52, 1
    s_cbranch_scc1 L_qb_q2
    s_mov_b64 exec, 1
    global_store_byte v110, v113, s[50:51] offset:8 sc1
    s_mov_b64 exec, -1
    s_add_u32 s50, s50, 0x20
    s_addc_u32 s51, s51, 0
L_qb_q2:
    s_mov_b32 s52, 0
    s_add_u32 s34, s34, 1
    s_cmp_lt_u32 s34, 2
    s_cbranch_scc1 L_qb_layer
    s_endpgm
L_proja:
    v_mov_b32 v127, v0
    v_mov_b32 v65, 0x0
    v_bfe_u32 v64, v127, 6, 2
    v_lshl_add_u32 v65, v64, 13, v65
    v_mov_b32 v66, 0x0
    v_bfe_u32 v64, v127, 0, 6
    v_lshl_add_u32 v66, v64, 4, v66
    v_add_u32 v65, v65, v66
    v_mov_b32 v66, 0x400
    v_bfe_u32 v64, v127, 6, 2
    v_lshl_add_u32 v66, v64, 13, v66
    v_mov_b32 v67, 0x40
    v_bfe_i32 v64, v127, 0, 1
    v_and_b32 v64, 0x10, v64
    v_xor_b32 v67, v67, v64
    v_bfe_i32 v64, v127, 1, 1
    v_and_b32 v64, 0x20, v64
    v_xor_b32 v67, v67, v64
    v_bfe_i32 v64, v127, 2, 1
    v_and_b32 v64, 0x40, v64
    v_xor_b32 v67, v67, v64
    v_bfe_i32 v64, v127, 3, 1
    v_and_b32 v64, 0x80, v64
    v_xor_b32 v67, v67, v64
    v_bfe_i32 v64, v127, 4, 1
    v_and_b32 v64, 0x100, v64
    v_xor_b32 v67, v67, v64
    v_bfe_i32 v64, v127, 5, 1
    v_and_b32 v64, 0x200, v64
    v_xor_b32 v67, v67, v64
    v_add_u32 v66, v66, v67
    v_mov_b32 v67, 0x800
    v_bfe_u32 v64, v127, 6, 2
    v_lshl_add_u32 v67, v64, 13, v67
    v_mov_b32 v68, 0x80
    v_bfe_i32 v64, v127, 0, 1
    v_and_b32 v64, 0x10, v64
    v_xor_b32 v68, v68, v64
    v_bfe_i32 v64, v127, 1, 1
    v_and_b32 v64, 0x20, v64
    v_xor_b32 v68, v68, v64
    v_bfe_i32 v64, v127, 2, 1
    v_and_b32 v64, 0x40, v64
    v_xor_b32 v68, v68, v64
    v_bfe_i32 v64, v127, 3, 1
    v_and_b32 v64, 0x80, v64
    v_xor_b32 v68, v68, v64
    v_bfe_i32 v64, v127, 4, 1
    v_and_b32 v64, 0x100, v64
    v_xor_b32 v68, v68, v64
    v_bfe_i32 v64, v127, 5, 1
    v_and_b32 v64, 0x200, v64
    v_xor_b32 v68, v68, v64
    v_add_u32 v67, v67, v68
    v_mov_b32 v68, 0xc00
    v_bfe_u32 v64, v127, 6, 2
    v_lshl_add_u32 v68, v64, 13, v68
    v_mov_b32 v69, 0xc0
    v_bfe_i32 v64, v127, 0, 1
    v_and_b32 v64, 0x10, v64
    v_xor_b32 v69, v69, v64
    v_bfe_i32 v64, v127, 1, 1
    v_and_b32 v64, 0x20, v64
    v_xor_b32 v69, v69, v64
    v_bfe_i32 v64, v127, 2, 1
    v_and_b32 v64, 0x40, v64
    v_xor_b32 v69, v69, v64
    v_bfe_i32 v64, v127, 3, 1
    v_and_b32 v64, 0x80, v64
    v_xor_b32 v69, v69, v64
    v_bfe_i32 v64, v127, 4, 1
    v_and_b32 v64, 0x100, v64
    v_xor_b32 v69, v69, v64
    v_bfe_i32 v64, v127, 5, 1
    v_and_b32 v64, 0x200, v64
    v_xor_b32 v69, v69, v64
    v_add_u32 v68, v68, v69
    v_mov_b32 v69, 0x1000
    v_bfe_u32 v64, v127, 6, 2
    v_lshl_add_u32 v69, v64, 13, v69
    v_mov_b32 v70, 0x0
    v_bfe_u32 v64, v127, 0, 6
    v_lshl_add_u32 v70, v64, 4, v70
    v_add_u32 v69, v69, v70
    v_mov_b32 v70, 0x1400
    v_bfe_u32 v64, v127, 6, 2
    v_lshl_add_u32 v70, v64, 13, v70
    v_mov_b32 v71, 0x40
    v_bfe_i32 v64, v127, 0, 1
    v_and_b32 v64, 0x10, v64
    v_xor_b32 v71, v71, v64
    v_bfe_i32 v64, v127, 1, 1
    v_and_b32 v64, 0x20, v64
    v_xor_b32 v71, v71, v64
    v_bfe_i32 v64, v127, 2, 1
    v_and_b32 v64, 0x40, v64
    v_xor_b32 v71, v71, v64
    v_bfe_i32 v64, v127, 3, 1
    v_and_b32 v64, 0x80, v64
    v_xor_b32 v71, v71, v64
    v_bfe_i32 v64, v127, 4, 1
    v_and_b32 v64, 0x100, v64
    v_xor_b32 v71, v71, v64
    v_bfe_i32 v64, v127, 5, 1
    v_and_b32 v64, 0x200, v64
    v_xor_b32 v71, v71, v64
    v_add_u32 v70, v70, v71
    v_mov_b32 v71, 0x1800
    v_bfe_u32 v64, v127, 6, 2
    v_lshl_add_u32 v71, v64, 13, v71
    v_mov_b32 v72, 0x80
    v_bfe_i32 v64, v127, 0, 1
    v_and_b32 v64, 0x10, v64
    v_xor_b32 v72, v72, v64
    v_bfe_i32 v64, v127, 1, 1
    v_and_b32 v64, 0x20, v64
    v_xor_b32 v72, v72, v64
    v_bfe_i32 v64, v127, 2, 1
    v_and_b32 v64, 0x40, v64
    v_xor_b32 v72, v72, v64
    v_bfe_i32 v64, v127, 3, 1
    v_and_b32 v64, 0x80, v64
    v_xor_b32 v72, v72, v64
    v_bfe_i32 v64, v127, 4, 1
    v_and_b32 v64, 0x100, v64
    v_xor_b32 v72, v72, v64
    v_bfe_i32 v64, v127, 5, 1
    v_and_b32 v64, 0x200, v64
    v_xor_b32 v72, v72, v64
    v_add_u32 v71, v71, v72
    v_mov_b32 v72, 0x1c00
    v_bfe_u32 v64, v127, 6, 2
    v_lshl_add_u32 v72, v64, 13, v72
    v_mov_b32 v73, 0xc0
    v_bfe_i32 v64, v127, 0, 1
    v_and_b32 v64, 0x10, v64
    v_xor_b32 v73, v73, v64
    v_bfe_i32 v64, v127, 1, 1
    v_and_b32 v64, 0x20, v64
    v_xor_b32 v73, v73, v64
    v_bfe_i32 v64, v127, 2, 1
    v_and_b32 v64, 0x40, v64
    v_xor_b32 v73, v73, v64
    v_bfe_i32 v64, v127, 3, 1
    v_and_b32 v64, 0x80, v64
    v_xor_b32 v73, v73, v64
    v_bfe_i32 v64, v127, 4, 1
    v_and_b32 v64, 0x100, v64
    v_xor_b32 v73, v73, v64
    v_bfe_i32 v64, v127, 5, 1
    v_and_b32 v64, 0x200, v64
    v_xor_b32 v73, v73, v64
    v_add_u32 v72, v72, v73
    v_mov_b32 v74, 0x0
    v_bfe_u32 v64, v127, 0, 2
    v_lshl_add_u32 v74, v64, 4, v74
    v_bfe_u32 v64, v127, 2, 2
    v_mul_u32_u24 v64, 0x440, v64
    v_add_u32 v74, v74, v64
    v_bfe_u32 v64, v127, 4, 2
    v_lshl_add_u32 v74, v64, 13, v74
    v_bfe_u32 v64, v127, 6, 2
    v_lshl_add_u32 v74, v64, 8, v74
    v_mov_b32 v75, 0x40
    v_bfe_u32 v64, v127, 0, 2
    v_lshl_add_u32 v75, v64, 4, v75
    v_bfe_u32 v64, v127, 2, 1
    v_mul_u32_u24 v64, 0x3c0, v64
    v_add_u32 v75, v75, v64
    v_bfe_u32 v64, v127, 3, 1
    v_mul_u32_u24 v64, 0x880, v64
    v_add_u32 v75, v75, v64
    v_bfe_u32 v64, v127, 4, 2
    v_lshl_add_u32 v75, v64, 13, v75
    v_bfe_u32 v64, v127, 6, 2
    v_lshl_add_u32 v75, v64, 8, v75
    v_mov_b32 v76, 0x80
    v_bfe_u32 v64, v127, 0, 2
    v_lshl_add_u32 v76, v64, 4, v76
    v_bfe_u32 v64, v127, 2, 1
    v_mul_u32_u24 v64, 0x440, v64
    v_add_u32 v76, v76, v64
    v_bfe_u32 v64, v127, 3, 1
    v_mul_u32_u24 v64, 0x780, v64
    v_add_u32 v76, v76, v64
    v_bfe_u32 v64, v127, 4, 2
    v_lshl_add_u32 v76, v64, 13, v76
    v_bfe_u32 v64, v127, 6, 2
    v_lshl_add_u32 v76, v64, 8, v76
    v_mov_b32 v77, 0xc0
    v_bfe_u32 v64, v127, 0, 2
    v_lshl_add_u32 v77, v64, 4, v77
    v_bfe_u32 v64, v127, 2, 2
    v_mul_u32_u24 v64, 0x3c0, v64
    v_add_u32 v77, v77, v64
    v_bfe_u32 v64, v127, 4, 2
    v_lshl_add_u32 v77, v64, 13, v77
    v_bfe_u32 v64, v127, 6, 2
    v_lshl_add_u32 v77, v64, 8, v77
    s_lshl_b32 s64, s31, 13
    s_add_u32 s66, s8, 0x0
    s_addc_u32 s67, s9, 0
    s_add_u32 m0, s64, 0x20000
    s_nop 0
    global_load_lds_dwordx4 v65, s[66:67]
    s_add_u32 m0, s64, 0x20400
    s_nop 0
    global_load_lds_dwordx4 v66, s[66:67]
    s_add_u32 m0, s64, 0x20800
    s_nop 0
    global_load_lds_dwordx4 v67, s[66:67]
    s_add_u32 m0, s64, 0x20c00
    s_nop 0
    global_load_lds_dwordx4 v68, s[66:67]
    s_add_u32 m0, s64, 0x21000
    s_nop 0
    global_load_lds_dwordx4 v69, s[66:67]
    s_add_u32 m0, s64, 0x21400
    s_nop 0
    global_load_lds_dwordx4 v70, s[66:67]
    s_add_u32 m0, s64, 0x21800
    s_nop 0
    global_load_lds_dwordx4 v71, s[66:67]
    s_add_u32 m0, s64, 0x21c00
    s_nop 0
    global_load_lds_dwordx4 v72, s[66:67]
    s_add_u32 s66, s8, 0x8000
    s_addc_u32 s67, s9, 0
    s_add_u32 m0, s64, 0x0
    s_nop 0
    global_load_lds_dwordx4 v65, s[66:67]
    s_add_u32 m0, s64, 0x400
    s_nop 0
    global_load_lds_dwordx4 v66, s[66:67]
    s_add_u32 m0, s64, 0x800
    s_nop 0
    global_load_lds_dwordx4 v67, s[66:67]
    s_add_u32 m0, s64, 0xc00
    s_nop 0
    global_load_lds_dwordx4 v68, s[66:67]
    s_add_u32 m0, s64, 0x1000
    s_nop 0
    global_load_lds_dwordx4 v69, s[66:67]
    s_add_u32 m0, s64, 0x1400
    s_nop 0
    global_load_lds_dwordx4 v70, s[66:67]
    s_add_u32 m0, s64, 0x1800
    s_nop 0
    global_load_lds_dwordx4 v71, s[66:67]
    s_add_u32 m0, s64, 0x1c00
    s_nop 0
    global_load_lds_dwordx4 v72, s[66:67]
    s_add_u32 s66, s8, 0x10000
    s_addc_u32 s67, s9, 0
    s_add_u32 m0, s64, 0x8000
    s_nop 0
    global_load_lds_dwordx4 v65, s[66:67]
    s_add_u32 m0, s64, 0x8400
    s_nop 0
    global_load_lds_dwordx4 v66, s[66:67]
    s_add_u32 m0, s64, 0x8800
    s_nop 0
    global_load_lds_dwordx4 v67, s[66:67]
    s_add_u32 m0, s64, 0x8c00
    s_nop 0
    global_load_lds_dwordx4 v68, s[66:67]
    s_add_u32 m0, s64, 0x9000
    s_nop 0
    global_load_lds_dwordx4 v69, s[66:67]
    s_add_u32 m0, s64, 0x9400
    s_nop 0
    global_load_lds_dwordx4 v70, s[66:67]
    s_add_u32 m0, s64, 0x9800
    s_nop 0
    global_load_lds_dwordx4 v71, s[66:67]
    s_add_u32 m0, s64, 0x9c00
    s_nop 0
    global_load_lds_dwordx4 v72, s[66:67]
    s_add_u32 s66, s8, 0x18000
    s_addc_u32 s67, s9, 0
    s_add_u32 m0, s64, 0x10000
    s_nop 0
    global_load_lds_dwordx4 v65, s[66:67]
    s_add_u32 m0, s64, 0x10400
    s_nop 0
    global_load_lds_dwordx4 v66, s[66:67]
    s_add_u32 m0, s64, 0x10800
    s_nop 0
    global_load_lds_dwordx4 v67, s[66:67]
    s_add_u32 m0, s64, 0x10c00
    s_nop 0
    global_load_lds_dwordx4 v68, s[66:67]
    s_add_u32 m0, s64, 0x11000
    s_nop 0
    global_load_lds_dwordx4 v69, s[66:67]
    s_add_u32 m0, s64, 0x11400
    s_nop 0
    global_load_lds_dwordx4 v70, s[66:67]
    s_add_u32 m0, s64, 0x11800
    s_nop 0
    global_load_lds_dwordx4 v71, s[66:67]
    s_add_u32 m0, s64, 0x11c00
    s_nop 0
    global_load_lds_dwordx4 v72, s[66:67]
    s_waitcnt vmcnt(24)
    s_barrier
    s_add_u32 s66, s8, 0x20000
    s_addc_u32 s67, s9, 0
    s_add_u32 m0, s64, 0x18000
    s_nop 0
    global_load_lds_dwordx4 v65, s[66:67]
    s_add_u32 m0, s64, 0x18400
    s_nop 0
    global_load_lds_dwordx4 v66, s[66:67]
    s_add_u32 m0, s64, 0x18800
    s_nop 0
    global_load_lds_dwordx4 v67, s[66:67]
    s_add_u32 m0, s64, 0x18c00
    s_nop 0
    global_load_lds_dwordx4 v68, s[66:67]
    s_add_u32 m0, s64, 0x19000
    s_nop 0
    global_load_lds_dwordx4 v69, s[66:67]
    s_add_u32 m0, s64, 0x19400
    s_nop 0
    global_load_lds_dwordx4 v70, s[66:67]
    s_add_u32 m0, s64, 0x19800
    s_nop 0
    global_load_lds_dwordx4 v71, s[66:67]
    s_add_u32 m0, s64, 0x19c00
    s_nop 0
    global_load_lds_dwordx4 v72, s[66:67]
    v_add_u32 v90, 0x20000, v74
    v_add_u32 v91, 0x20000, v75
    v_add_u32 v92, 0x20000, v76
    v_add_u32 v93, 0x20000, v77
    ds_read_b64_tr_b16 a[0:1], v90 offset:0
    ds_read_b64_tr_b16 a[2:3], v90 offset:4096
    ds_read_b64_tr_b16 a[4:5], v90 offset:8
    ds_read_b64_tr_b16 a[6:7], v90 offset:4104
    ds_read_b64_tr_b16 a[8:9], v91 offset:0
    ds_read_b64_tr_b16 a[10:11], v91 offset:4096
    ds_read_b64_tr_b16 a[12:13], v91 offset:8
    ds_read_b64_tr_b16 a[14:15], v91 offset:4104
    ds_read_b64_tr_b16 a[16:17], v92 offset:0
    ds_read_b64_tr_b16 a[18:19], v92 offset:4096
    ds_read_b64_tr_b16 a[20:21], v92 offset:8
    ds_read_b64_tr_b16 a[22:23], v92 offset:4104
    ds_read_b64_tr_b16 a[24:25], v93 offset:0
    ds_read_b64_tr_b16 a[26:27], v93 offset:4096
    ds_read_b64_tr_b16 a[28:29], v93 offset:8
    ds_read_b64_tr_b16 a[30:31], v93 offset:4104
L_lw_80:
    s_waitcnt lgkmcnt(0)
    s_waitcnt vmcnt(24)
    s_barrier
    s_add_u32 s66, s8, 0x28000
    s_addc_u32 s67, s9, 0
    s_add_u32 m0, s64, 0x20000
    s_nop 0
    global_load_lds_dwordx4 v65, s[66:67]
    s_add_u32 m0, s64, 0x20400
    s_nop 0
    global_load_lds_dwordx4 v66, s[66:67]
    s_add_u32 m0, s64, 0x20800
    s_nop 0
    global_load_lds_dwordx4 v67, s[66:67]
    s_add_u32 m0, s64, 0x20c00
    s_nop 0
    global_load_lds_dwordx4 v68, s[66:67]
    s_add_u32 m0, s64, 0x21000
    s_nop 0
    global_load_lds_dwordx4 v69, s[66:67]
    s_add_u32 m0, s64, 0x21400
    s_nop 0
    global_load_lds_dwordx4 v70, s[66:67]
    s_add_u32 m0, s64, 0x21800
    s_nop 0
    global_load_lds_dwordx4 v71, s[66:67]
    s_add_u32 m0, s64, 0x21c00
    s_nop 0
    global_load_lds_dwordx4 v72, s[66:67]
    v_add_u32 v90, 0x0, v74
    v_add_u32 v91, 0x0, v75
    v_add_u32 v92, 0x0, v76
    v_add_u32 v93, 0x0, v77
    ds_read_b64_tr_b16 a[32:33], v90 offset:0
    ds_read_b64_tr_b16 a[34:35], v90 offset:4096
    ds_read_b64_tr_b16 a[36:37], v90 offset:8
    ds_read_b64_tr_b16 a[38:39], v90 offset:4104
    ds_read_b64_tr_b16 a[40:41], v91 offset:0
    ds_read_b64_tr_b16 a[42:43], v91 offset:4096
    ds_read_b64_tr_b16 a[44:45], v91 offset:8
    ds_read_b64_tr_b16 a[46:47], v91 offset:4104
    ds_read_b64_tr_b16 a[48:49], v92 offset:0
    ds_read_b64_tr_b16 a[50:51], v92 offset:4096
    ds_read_b64_tr_b16 a[52:53], v92 offset:8
    ds_read_b64_tr_b16 a[54:55], v92 offset:4104
    ds_read_b64_tr_b16 a[56:57], v93 offset:0
    ds_read_b64_tr_b16 a[58:59], v93 offset:4096
    ds_read_b64_tr_b16 a[60:61], v93 offset:8
    ds_read_b64_tr_b16 a[62:63], v93 offset:4104
L_lw_81:
    s_waitcnt lgkmcnt(0)
    s_waitcnt vmcnt(24)
    s_barrier
    s_add_u32 s66, s8, 0x30000
    s_addc_u32 s67, s9, 0
    s_add_u32 m0, s64, 0x0
    s_nop 0
    global_load_lds_dwordx4 v65, s[66:67]
    s_add_u32 m0, s64, 0x400
    s_nop 0
    global_load_lds_dwordx4 v66, s[66:67]
    s_add_u32 m0, s64, 0x800
    s_nop 0
    global_load_lds_dwordx4 v67, s[66:67]
    s_add_u32 m0, s64, 0xc00
    s_nop 0
    global_load_lds_dwordx4 v68, s[66:67]
    s_add_u32 m0, s64, 0x1000
    s_nop 0
    global_load_lds_dwordx4 v69, s[66:67]
    s_add_u32 m0, s64, 0x1400
    s_nop 0
    global_load_lds_dwordx4 v70, s[66:67]
    s_add_u32 m0, s64, 0x1800
    s_nop 0
    global_load_lds_dwordx4 v71, s[66:67]
    s_add_u32 m0, s64, 0x1c00
    s_nop 0
    global_load_lds_dwordx4 v72, s[66:67]
    v_add_u32 v90, 0x8000, v74
    v_add_u32 v91, 0x8000, v75
    v_add_u32 v92, 0x8000, v76
    v_add_u32 v93, 0x8000, v77
    ds_read_b64_tr_b16 a[64:65], v90 offset:0
    ds_read_b64_tr_b16 a[66:67], v90 offset:4096
    ds_read_b64_tr_b16 a[68:69], v90 offset:8
    ds_read_b64_tr_b16 a[70:71], v90 offset:4104
    ds_read_b64_tr_b16 a[72:73], v91 offset:0
    ds_read_b64_tr_b16 a[74:75], v91 offset:4096
    ds_read_b64_tr_b16 a[76:77], v91 offset:8
    ds_read_b64_tr_b16 a[78:79], v91 offset:4104
    ds_read_b64_tr_b16 a[80:81], v92 offset:0
    ds_read_b64_tr_b16 a[82:83], v92 offset:4096
    ds_read_b64_tr_b16 a[84:85], v92 offset:8
    ds_read_b64_tr_b16 a[86:87], v92 offset:4104
    ds_read_b64_tr_b16 a[88:89], v93 offset:0
    ds_read_b64_tr_b16 a[90:91], v93 offset:4096
    ds_read_b64_tr_b16 a[92:93], v93 offset:8
    ds_read_b64_tr_b16 a[94:95], v93 offset:4104
L_lw_82:
    s_waitcnt lgkmcnt(0)
    s_waitcnt vmcnt(24)
    s_barrier
    s_add_u32 s66, s8, 0x38000
    s_addc_u32 s67, s9, 0
    s_add_u32 m0, s64, 0x8000
    s_nop 0
    global_load_lds_dwordx4 v65, s[66:67]
    s_add_u32 m0, s64, 0x8400
    s_nop 0
    global_load_lds_dwordx4 v66, s[66:67]
    s_add_u32 m0, s64, 0x8800
    s_nop 0
    global_load_lds_dwordx4 v67, s[66:67]
    s_add_u32 m0, s64, 0x8c00
    s_nop 0
    global_load_lds_dwordx4 v68, s[66:67]
    s_add_u32 m0, s64, 0x9000
    s_nop 0
    global_load_lds_dwordx4 v69, s[66:67]
    s_add_u32 m0, s64, 0x9400
    s_nop 0
    global_load_lds_dwordx4 v70, s[66:67]
    s_add_u32 m0, s64, 0x9800
    s_nop 0
    global_load_lds_dwordx4 v71, s[66:67]
    s_add_u32 m0, s64, 0x9c00
    s_nop 0
    global_load_lds_dwordx4 v72, s[66:67]
    v_add_u32 v90, 0x10000, v74
    v_add_u32 v91, 0x10000, v75
    v_add_u32 v92, 0x10000, v76
    v_add_u32 v93, 0x10000, v77
    ds_read_b64_tr_b16 a[96:97], v90 offset:0
    ds_read_b64_tr_b16 a[98:99], v90 offset:4096
    ds_read_b64_tr_b16 a[100:101], v90 offset:8
    ds_read_b64_tr_b16 a[102:103], v90 offset:4104
    ds_read_b64_tr_b16 a[104:105], v91 offset:0
    ds_read_b64_tr_b16 a[106:107], v91 offset:4096
    ds_read_b64_tr_b16 a[108:109], v91 offset:8
    ds_read_b64_tr_b16 a[110:111], v91 offset:4104
    ds_read_b64_tr_b16 a[112:113], v92 offset:0
    ds_read_b64_tr_b16 a[114:115], v92 offset:4096
    ds_read_b64_tr_b16 a[116:117], v92 offset:8
    ds_read_b64_tr_b16 a[118:119], v92 offset:4104
    ds_read_b64_tr_b16 a[120:121], v93 offset:0
    ds_read_b64_tr_b16 a[122:123], v93 offset:4096
    ds_read_b64_tr_b16 a[124:125], v93 offset:8
    ds_read_b64_tr_b16 a[126:127], v93 offset:4104
L_lw_83:
    s_waitcnt lgkmcnt(0)
    s_waitcnt vmcnt(24)
    s_barrier
    s_add_u32 s66, s8, 0x40000
    s_addc_u32 s67, s9, 0
    s_add_u32 m0, s64, 0x10000
    s_nop 0
    global_load_lds_dwordx4 v65, s[66:67]
    s_add_u32 m0, s64, 0x10400
    s_nop 0
    global_load_lds_dwordx4 v66, s[66:67]
    s_add_u32 m0, s64, 0x10800
    s_nop 0
    global_load_lds_dwordx4 v67, s[66:67]
    s_add_u32 m0, s64, 0x10c00
    s_nop 0
    global_load_lds_dwordx4 v68, s[66:67]
    s_add_u32 m0, s64, 0x11000
    s_nop 0
    global_load_lds_dwordx4 v69, s[66:67]
    s_add_u32 m0, s64, 0x11400
    s_nop 0
    global_load_lds_dwordx4 v70, s[66:67]
    s_add_u32 m0, s64, 0x11800
    s_nop 0
    global_load_lds_dwordx4 v71, s[66:67]
    s_add_u32 m0, s64, 0x11c00
    s_nop 0
    global_load_lds_dwordx4 v72, s[66:67]
    v_add_u32 v90, 0x18000, v74
    v_add_u32 v91, 0x18000, v75
    v_add_u32 v92, 0x18000, v76
    v_add_u32 v93, 0x18000, v77
    ds_read_b64_tr_b16 a[128:129], v90 offset:0
    ds_read_b64_tr_b16 a[130:131], v90 offset:4096
    ds_read_b64_tr_b16 a[132:133], v90 offset:8
    ds_read_b64_tr_b16 a[134:135], v90 offset:4104
    ds_read_b64_tr_b16 a[136:137], v91 offset:0
    ds_read_b64_tr_b16 a[138:139], v91 offset:4096
    ds_read_b64_tr_b16 a[140:141], v91 offset:8
    ds_read_b64_tr_b16 a[142:143], v91 offset:4104
    ds_read_b64_tr_b16 a[144:145], v92 offset:0
    ds_read_b64_tr_b16 a[146:147], v92 offset:4096
    ds_read_b64_tr_b16 a[148:149], v92 offset:8
    ds_read_b64_tr_b16 a[150:151], v92 offset:4104
    ds_read_b64_tr_b16 a[152:153], v93 offset:0
    ds_read_b64_tr_b16 a[154:155], v93 offset:4096
    ds_read_b64_tr_b16 a[156:157], v93 offset:8
    ds_read_b64_tr_b16 a[158:159], v93 offset:4104
L_lw_84:
    s_waitcnt lgkmcnt(0)
    s_waitcnt vmcnt(24)
    s_barrier
    s_add_u32 s66, s8, 0x48000
    s_addc_u32 s67, s9, 0
    s_add_u32 m0, s64, 0x18000
    s_nop 0
    global_load_lds_dwordx4 v65, s[66:67]
    s_add_u32 m0, s64, 0x18400
    s_nop 0
    global_load_lds_dwordx4 v66, s[66:67]
    s_add_u32 m0, s64, 0x18800
    s_nop 0
    global_load_lds_dwordx4 v67, s[66:67]
    s_add_u32 m0, s64, 0x18c00
    s_nop 0
    global_load_lds_dwordx4 v68, s[66:67]
    s_add_u32 m0, s64, 0x19000
    s_nop 0
    global_load_lds_dwordx4 v69, s[66:67]
    s_add_u32 m0, s64, 0x19400
    s_nop 0
    global_load_lds_dwordx4 v70, s[66:67]
    s_add_u32 m0, s64, 0x19800
    s_nop 0
    global_load_lds_dwordx4 v71, s[66:67]
    s_add_u32 m0, s64, 0x19c00
    s_nop 0
    global_load_lds_dwordx4 v72, s[66:67]
    v_add_u32 v90, 0x20000, v74
    v_add_u32 v91, 0x20000, v75
    v_add_u32 v92, 0x20000, v76
    v_add_u32 v93, 0x20000, v77
    ds_read_b64_tr_b16 a[160:161], v90 offset:0
    ds_read_b64_tr_b16 a[162:163], v90 offset:4096
    ds_read_b64_tr_b16 a[164:165], v90 offset:8
    ds_read_b64_tr_b16 a[166:167], v90 offset:4104
    ds_read_b64_tr_b16 a[168:169], v91 offset:0
    ds_read_b64_tr_b16 a[170:171], v91 offset:4096
    ds_read_b64_tr_b16 a[172:173], v91 offset:8
    ds_read_b64_tr_b16 a[174:175], v91 offset:4104
    ds_read_b64_tr_b16 a[176:177], v92 offset:0
    ds_read_b64_tr_b16 a[178:179], v92 offset:4096
    ds_read_b64_tr_b16 a[180:181], v92 offset:8
    ds_read_b64_tr_b16 a[182:183], v92 offset:4104
    ds_read_b64_tr_b16 a[184:185], v93 offset:0
    ds_read_b64_tr_b16 a[186:187], v93 offset:4096
    ds_read_b64_tr_b16 a[188:189], v93 offset:8
    ds_read_b64_tr_b16 a[190:191], v93 offset:4104
L_lw_85:
    s_waitcnt lgkmcnt(0)
    s_waitcnt vmcnt(24)
    s_barrier
    s_add_u32 s66, s8, 0x50000
    s_addc_u32 s67, s9, 0
    s_add_u32 m0, s64, 0x20000
    s_nop 0
    global_load_lds_dwordx4 v65, s[66:67]
    s_add_u32 m0, s64, 0x20400
    s_nop 0
    global_load_lds_dwordx4 v66, s[66:67]
    s_add_u32 m0, s64, 0x20800
    s_nop 0
    global_load_lds_dwordx4 v67, s[66:67]
    s_add_u32 m0, s64, 0x20c00
    s_nop 0
    global_load_lds_dwordx4 v68, s[66:67]
    s_add_u32 m0, s64, 0x21000
    s_nop 0
    global_load_lds_dwordx4 v69, s[66:67]
    s_add_u32 m0, s64, 0x21400
    s_nop 0
    global_load_lds_dwordx4 v70, s[66:67]
    s_add_u32 m0, s64, 0x21800
    s_nop 0
    global_load_lds_dwordx4 v71, s[66:67]
    s_add_u32 m0, s64, 0x21c00
    s_nop 0
    global_load_lds_dwordx4 v72, s[66:67]
    v_add_u32 v90, 0x0, v74
    v_add_u32 v91, 0x0, v75
    v_add_u32 v92, 0x0, v76
    v_add_u32 v93, 0x0, v77
    ds_read_b64_tr_b16 a[192:193], v90 offset:0
    ds_read_b64_tr_b16 a[194:195], v90 offset:4096
    ds_read_b64_tr_b16 a[196:197], v90 offset:8
    ds_read_b64_tr_b16 a[198:199], v90 offset:4104
    ds_read_b64_tr_b16 a[200:201], v91 offset:0
    ds_read_b64_tr_b16 a[202:203], v91 offset:4096
    ds_read_b64_tr_b16 a[204:205], v91 offset:8
    ds_read_b64_tr_b16 a[206:207], v91 offset:4104
    ds_read_b64_tr_b16 a[208:209], v92 offset:0
    ds_read_b64_tr_b16 a[210:211], v92 offset:4096
    ds_read_b64_tr_b16 a[212:213], v92 offset:8
    ds_read_b64_tr_b16 a[214:215], v92 offset:4104
    ds_read_b64_tr_b16 a[216:217], v93 offset:0
    ds_read_b64_tr_b16 a[218:219], v93 offset:4096
    ds_read_b64_tr_b16 a[220:221], v93 offset:8
    ds_read_b64_tr_b16 a[222:223], v93 offset:4104
L_lw_86:
    s_waitcnt lgkmcnt(0)
    s_waitcnt vmcnt(24)
    s_barrier
    s_add_u32 s66, s8, 0x58000
    s_addc_u32 s67, s9, 0
    s_add_u32 m0, s64, 0x0
    s_nop 0
    global_load_lds_dwordx4 v65, s[66:67]
    s_add_u32 m0, s64, 0x400
    s_nop 0
    global_load_lds_dwordx4 v66, s[66:67]
    s_add_u32 m0, s64, 0x800
    s_nop 0
    global_load_lds_dwordx4 v67, s[66:67]
    s_add_u32 m0, s64, 0xc00
    s_nop 0
    global_load_lds_dwordx4 v68, s[66:67]
    s_add_u32 m0, s64, 0x1000
    s_nop 0
    global_load_lds_dwordx4 v69, s[66:67]
    s_add_u32 m0, s64, 0x1400
    s_nop 0
    global_load_lds_dwordx4 v70, s[66:67]
    s_add_u32 m0, s64, 0x1800
    s_nop 0
    global_load_lds_dwordx4 v71, s[66:67]
    s_add_u32 m0, s64, 0x1c00
    s_nop 0
    global_load_lds_dwordx4 v72, s[66:67]
    v_add_u32 v90, 0x8000, v74
    v_add_u32 v91, 0x8000, v75
    v_add_u32 v92, 0x8000, v76
    v_add_u32 v93, 0x8000, v77
    ds_read_b64_tr_b16 a[224:225], v90 offset:0
    ds_read_b64_tr_b16 a[226:227], v90 offset:4096
    ds_read_b64_tr_b16 a[228:229], v90 offset:8
    ds_read_b64_tr_b16 a[230:231], v90 offset:4104
    ds_read_b64_tr_b16 a[232:233], v91 offset:0
    ds_read_b64_tr_b16 a[234:235], v91 offset:4096
    ds_read_b64_tr_b16 a[236:237], v91 offset:8
    ds_read_b64_tr_b16 a[238:239], v91 offset:4104
    ds_read_b64_tr_b16 a[240:241], v92 offset:0
    ds_read_b64_tr_b16 a[242:243], v92 offset:4096
    ds_read_b64_tr_b16 a[244:245], v92 offset:8
    ds_read_b64_tr_b16 a[246:247], v92 offset:4104
    ds_read_b64_tr_b16 a[248:249], v93 offset:0
    ds_read_b64_tr_b16 a[250:251], v93 offset:4096
    ds_read_b64_tr_b16 a[252:253], v93 offset:8
    ds_read_b64_tr_b16 a[254:255], v93 offset:4104
L_lw_87:
    s_waitcnt lgkmcnt(0)
    s_waitcnt vmcnt(24)
    s_barrier
    s_add_u32 s66, s8, 0x60000
    s_addc_u32 s67, s9, 0
    s_add_u32 m0, s64, 0x8000
    s_nop 0
    global_load_lds_dwordx4 v65, s[66:67]
    s_add_u32 m0, s64, 0x8400
    s_nop 0
    global_load_lds_dwordx4 v66, s[66:67]
    s_add_u32 m0, s64, 0x8800
    s_nop 0
    global_load_lds_dwordx4 v67, s[66:67]
    s_add_u32 m0, s64, 0x8c00
    s_nop 0
    global_load_lds_dwordx4 v68, s[66:67]
    s_add_u32 m0, s64, 0x9000
    s_nop 0
    global_load_lds_dwordx4 v69, s[66:67]
    s_add_u32 m0, s64, 0x9400
    s_nop 0
    global_load_lds_dwordx4 v70, s[66:67]
    s_add_u32 m0, s64, 0x9800
    s_nop 0
    global_load_lds_dwordx4 v71, s[66:67]
    s_add_u32 m0, s64, 0x9c00
    s_nop 0
    global_load_lds_dwordx4 v72, s[66:67]
    v_add_u32 v90, 0x10000, v74
    v_add_u32 v91, 0x10000, v75
    v_add_u32 v92, 0x10000, v76
    v_add_u32 v93, 0x10000, v77
    ds_read_b64_tr_b16 v[128:129], v90 offset:0
    ds_read_b64_tr_b16 v[130:131], v90 offset:4096
    ds_read_b64_tr_b16 v[132:133], v90 offset:8
    ds_read_b64_tr_b16 v[134:135], v90 offset:4104
    ds_read_b64_tr_b16 v[136:137], v91 offset:0
    ds_read_b64_tr_b16 v[138:139], v91 offset:4096
    ds_read_b64_tr_b16 v[140:141], v91 offset:8
    ds_read_b64_tr_b16 v[142:143], v91 offset:4104
    ds_read_b64_tr_b16 v[144:145], v92 offset:0
    ds_read_b64_tr_b16 v[146:147], v92 offset:4096
    ds_read_b64_tr_b16 v[148:149], v92 offset:8
    ds_read_b64_tr_b16 v[150:151], v92 offset:4104
    ds_read_b64_tr_b16 v[152:153], v93 offset:0
    ds_read_b64_tr_b16 v[154:155], v93 offset:4096
    ds_read_b64_tr_b16 v[156:157], v93 offset:8
    ds_read_b64_tr_b16 v[158:159], v93 offset:4104
L_lw_88:
    s_waitcnt lgkmcnt(0)
    s_waitcnt vmcnt(24)
    s_barrier
    s_add_u32 s66, s8, 0x68000
    s_addc_u32 s67, s9, 0
    s_add_u32 m0, s64, 0x10000
    s_nop 0
    global_load_lds_dwordx4 v65, s[66:67]
    s_add_u32 m0, s64, 0x10400
    s_nop 0
    global_load_lds_dwordx4 v66, s[66:67]
    s_add_u32 m0, s64, 0x10800
    s_nop 0
    global_load_lds_dwordx4 v67, s[66:67]
    s_add_u32 m0, s64, 0x10c00
    s_nop 0
    global_load_lds_dwordx4 v68, s[66:67]
    s_add_u32 m0, s64, 0x11000
    s_nop 0
    global_load_lds_dwordx4 v69, s[66:67]
    s_add_u32 m0, s64, 0x11400
    s_nop 0
    global_load_lds_dwordx4 v70, s[66:67]
    s_add_u32 m0, s64, 0x11800
    s_nop 0
    global_load_lds_dwordx4 v71, s[66:67]
    s_add_u32 m0, s64, 0x11c00
    s_nop 0
    global_load_lds_dwordx4 v72, s[66:67]
    v_add_u32 v90, 0x18000, v74
    v_add_u32 v91, 0x18000, v75
    v_add_u32 v92, 0x18000, v76
    v_add_u32 v93, 0x18000, v77
    ds_read_b64_tr_b16 v[160:161], v90 offset:0
    ds_read_b64_tr_b16 v[162:163], v90 offset:4096
    ds_read_b64_tr_b16 v[164:165], v90 offset:8
    ds_read_b64_tr_b16 v[166:167], v90 offset:4104
    ds_read_b64_tr_b16 v[168:169], v91 offset:0
    ds_read_b64_tr_b16 v[170:171], v91 offset:4096
    ds_read_b64_tr_b16 v[172:173], v91 offset:8
    ds_read_b64_tr_b16 v[174:175], v91 offset:4104
    ds_read_b64_tr_b16 v[176:177], v92 offset:0
    ds_read_b64_tr_b16 v[178:179], v92 offset:4096
    ds_read_b64_tr_b16 v[180:181], v92 offset:8
    ds_read_b64_tr_b16 v[182:183], v92 offset:4104
    ds_read_b64_tr_b16 v[184:185], v93 offset:0
    ds_read_b64_tr_b16 v[186:187], v93 offset:4096
    ds_read_b64_tr_b16 v[188:189], v93 offset:8
    ds_read_b64_tr_b16 v[190:191], v93 offset:4104
L_lw_89:
    s_waitcnt lgkmcnt(0)
    s_waitcnt vmcnt(24)
    s_barrier
    s_add_u32 s66, s8, 0x70000
    s_addc_u32 s67, s9, 0
    s_add_u32 m0, s64, 0x18000
    s_nop 0
    global_load_lds_dwordx4 v65, s[66:67]
    s_add_u32 m0, s64, 0x18400
    s_nop 0
    global_load_lds_dwordx4 v66, s[66:67]
    s_add_u32 m0, s64, 0x18800
    s_nop 0
    global_load_lds_dwordx4 v67, s[66:67]
    s_add_u32 m0, s64, 0x18c00
    s_nop 0
    global_load_lds_dwordx4 v68, s[66:67]
    s_add_u32 m0, s64, 0x19000
    s_nop 0
    global_load_lds_dwordx4 v69, s[66:67]
    s_add_u32 m0, s64, 0x19400
    s_nop 0
    global_load_lds_dwordx4 v70, s[66:67]
    s_add_u32 m0, s64, 0x19800
    s_nop 0
    global_load_lds_dwordx4 v71, s[66:67]
    s_add_u32 m0, s64, 0x19c00
    s_nop 0
    global_load_lds_dwordx4 v72, s[66:67]
    v_add_u32 v90, 0x20000, v74
    v_add_u32 v91, 0x20000, v75
    v_add_u32 v92, 0x20000, v76
    v_add_u32 v93, 0x20000, v77
    ds_read_b64_tr_b16 v[192:193], v90 offset:0
    ds_read_b64_tr_b16 v[194:195], v90 offset:4096
    ds_read_b64_tr_b16 v[196:197], v90 offset:8
    ds_read_b64_tr_b16 v[198:199], v90 offset:4104
    ds_read_b64_tr_b16 v[200:201], v91 offset:0
    ds_read_b64_tr_b16 v[202:203], v91 offset:4096
    ds_read_b64_tr_b16 v[204:205], v91 offset:8
    ds_read_b64_tr_b16 v[206:207], v91 offset:4104
    ds_read_b64_tr_b16 v[208:209], v92 offset:0
    ds_read_b64_tr_b16 v[210:211], v92 offset:4096
    ds_read_b64_tr_b16 v[212:213], v92 offset:8
    ds_read_b64_tr_b16 v[214:215], v92 offset:4104
    ds_read_b64_tr_b16 v[216:217], v93 offset:0
    ds_read_b64_tr_b16 v[218:219], v93 offset:4096
    ds_read_b64_tr_b16 v[220:221], v93 offset:8
    ds_read_b64_tr_b16 v[222:223], v93 offset:4104
L_lw_90:
    s_waitcnt lgkmcnt(0)
    s_waitcnt vmcnt(24)
    s_barrier
    s_add_u32 s66, s8, 0x78000
    s_addc_u32 s67, s9, 0
    s_add_u32 m0, s64, 0x20000
    s_nop 0
    global_load_lds_dwordx4 v65, s[66:67]
    s_add_u32 m0, s64, 0x20400
    s_nop 0
    global_load_lds_dwordx4 v66, s[66:67]
    s_add_u32 m0, s64, 0x20800
    s_nop 0
    global_load_lds_dwordx4 v67, s[66:67]
    s_add_u32 m0, s64, 0x20c00
    s_nop 0
    global_load_lds_dwordx4 v68, s[66:67]
    s_add_u32 m0, s64, 0x21000
    s_nop 0
    global_load_lds_dwordx4 v69, s[66:67]
    s_add_u32 m0, s64, 0x21400
    s_nop 0
    global_load_lds_dwordx4 v70, s[66:67]
    s_add_u32 m0, s64, 0x21800
    s_nop 0
    global_load_lds_dwordx4 v71, s[66:67]
    s_add_u32 m0, s64, 0x21c00
    s_nop 0
    global_load_lds_dwordx4 v72, s[66:67]
    v_add_u32 v90, 0x0, v74
    v_add_u32 v91, 0x0, v75
    v_add_u32 v92, 0x0, v76
    v_add_u32 v93, 0x0, v77
    ds_read_b64_tr_b16 v[224:225], v90 offset:0
    ds_read_b64_tr_b16 v[226:227], v90 offset:4096
    ds_read_b64_tr_b16 v[228:229], v90 offset:8
    ds_read_b64_tr_b16 v[230:231], v90 offset:4104
    ds_read_b64_tr_b16 v[232:233], v91 offset:0
    ds_read_b64_tr_b16 v[234:235], v91 offset:4096
    ds_read_b64_tr_b16 v[236:237], v91 offset:8
    ds_read_b64_tr_b16 v[238:239], v91 offset:4104
    ds_read_b64_tr_b16 v[240:241], v92 offset:0
    ds_read_b64_tr_b16 v[242:243], v92 offset:4096
    ds_read_b64_tr_b16 v[244:245], v92 offset:8
    ds_read_b64_tr_b16 v[246:247], v92 offset:4104
    ds_read_b64_tr_b16 v[248:249], v93 offset:0
    ds_read_b64_tr_b16 v[250:251], v93 offset:4096
    ds_read_b64_tr_b16 v[252:253], v93 offset:8
    ds_read_b64_tr_b16 v[254:255], v93 offset:4104
L_lw_91:
    s_waitcnt lgkmcnt(0)
    s_waitcnt vmcnt(24)
    s_barrier
    v_add_u32 v90, 0x8000, v74
    v_add_u32 v91, 0x8000, v75
    v_add_u32 v92, 0x8000, v76
    v_add_u32 v93, 0x8000, v77
    ds_read_b64_tr_b16 v[0:1], v90 offset:0
    ds_read_b64_tr_b16 v[2:3], v90 offset:4096
    ds_read_b64_tr_b16 v[4:5], v90 offset:8
    ds_read_b64_tr_b16 v[6:7], v90 offset:4104
    ds_read_b64_tr_b16 v[8:9], v91 offset:0
    ds_read_b64_tr_b16 v[10:11], v91 offset:4096
    ds_read_b64_tr_b16 v[12:13], v91 offset:8
    ds_read_b64_tr_b16 v[14:15], v91 offset:4104
    ds_read_b64_tr_b16 v[16:17], v92 offset:0
    ds_read_b64_tr_b16 v[18:19], v92 offset:4096
    ds_read_b64_tr_b16 v[20:21], v92 offset:8
    ds_read_b64_tr_b16 v[22:23], v92 offset:4104
    ds_read_b64_tr_b16 v[24:25], v93 offset:0
    ds_read_b64_tr_b16 v[26:27], v93 offset:4096
    ds_read_b64_tr_b16 v[28:29], v93 offset:8
    ds_read_b64_tr_b16 v[30:31], v93 offset:4104
L_lw_92:
    s_waitcnt lgkmcnt(0)
    s_barrier
    v_mov_b32 v125, 0x8000
    v_bfe_u32 v126, v127, 0, 6
    v_lshl_add_u32 v125, v126, 4, v125
    v_bfe_u32 v126, v127, 6, 2
    v_lshl_add_u32 v125, v126, 13, v125
    ds_write_b128 v125, v[0:3] offset:0
    ds_write_b128 v125, v[4:7] offset:1024
    ds_write_b128 v125, v[8:11] offset:2048
    ds_write_b128 v125, v[12:15] offset:3072
    ds_write_b128 v125, v[16:19] offset:4096
    ds_write_b128 v125, v[20:23] offset:5120
    ds_write_b128 v125, v[24:27] offset:6144
    ds_write_b128 v125, v[28:31] offset:7168
    s_waitcnt lgkmcnt(0)
    s_waitcnt vmcnt(16)
    s_barrier
    v_add_u32 v90, 0x10000, v74
    v_add_u32 v91, 0x10000, v75
    v_add_u32 v92, 0x10000, v76
    v_add_u32 v93, 0x10000, v77
    ds_read_b64_tr_b16 v[0:1], v90 offset:0
    ds_read_b64_tr_b16 v[2:3], v90 offset:4096
    ds_read_b64_tr_b16 v[4:5], v90 offset:8
    ds_read_b64_tr_b16 v[6:7], v90 offset:4104
    ds_read_b64_tr_b16 v[8:9], v91 offset:0
    ds_read_b64_tr_b16 v[10:11], v91 offset:4096
    ds_read_b64_tr_b16 v[12:13], v91 offset:8
    ds_read_b64_tr_b16 v[14:15], v91 offset:4104
    ds_read_b64_tr_b16 v[16:17], v92 offset:0
    ds_read_b64_tr_b16 v[18:19], v92 offset:4096
    ds_read_b64_tr_b16 v[20:21], v92 offset:8
    ds_read_b64_tr_b16 v[22:23], v92 offset:4104
    ds_read_b64_tr_b16 v[24:25], v93 offset:0
    ds_read_b64_tr_b16 v[26:27], v93 offset:4096
    ds_read_b64_tr_b16 v[28:29], v93 offset:8
    ds_read_b64_tr_b16 v[30:31], v93 offset:4104
L_lw_93:
    s_waitcnt lgkmcnt(0)
    s_barrier
    v_mov_b32 v125, 0x10000
    v_bfe_u32 v126, v127, 0, 6
    v_lshl_add_u32 v125, v126, 4, v125
    v_bfe_u32 v126, v127, 6, 2
    v_lshl_add_u32 v125, v126, 13, v125
    ds_write_b128 v125, v[0:3] offset:0
    ds_write_b128 v125, v[4:7] offset:1024
    ds_write_b128 v125, v[8:11] offset:2048
    ds_write_b128 v125, v[12:15] offset:3072
    ds_write_b128 v125, v[16:19] offset:4096
    ds_write_b128 v125, v[20:23] offset:5120
    ds_write_b128 v125, v[24:27] offset:6144
    ds_write_b128 v125, v[28:31] offset:7168
    s_waitcnt lgkmcnt(0)
    s_waitcnt vmcnt(8)
    s_barrier
    v_add_u32 v90, 0x18000, v74
    v_add_u32 v91, 0x18000, v75
    v_add_u32 v92, 0x18000, v76
    v_add_u32 v93, 0x18000, v77
    ds_read_b64_tr_b16 v[0:1], v90 offset:0
    ds_read_b64_tr_b16 v[2:3], v90 offset:4096
    ds_read_b64_tr_b16 v[4:5], v90 offset:8
    ds_read_b64_tr_b16 v[6:7], v90 offset:4104
    ds_read_b64_tr_b16 v[8:9], v91 offset:0
    ds_read_b64_tr_b16 v[10:11], v91 offset:4096
    ds_read_b64_tr_b16 v[12:13], v91 offset:8
    ds_read_b64_tr_b16 v[14:15], v91 offset:4104
    ds_read_b64_tr_b16 v[16:17], v92 offset:0
    ds_read_b64_tr_b16 v[18:19], v92 offset:4096
    ds_read_b64_tr_b16 v[20:21], v92 offset:8
    ds_read_b64_tr_b16 v[22:23], v92 offset:4104
    ds_read_b64_tr_b16 v[24:25], v93 offset:0
    ds_read_b64_tr_b16 v[26:27], v93 offset:4096
    ds_read_b64_tr_b16 v[28:29], v93 offset:8
    ds_read_b64_tr_b16 v[30:31], v93 offset:4104
L_lw_94:
    s_waitcnt lgkmcnt(0)
    s_barrier
    v_mov_b32 v125, 0x18000
    v_bfe_u32 v126, v127, 0, 6
    v_lshl_add_u32 v125, v126, 4, v125
    v_bfe_u32 v126, v127, 6, 2
    v_lshl_add_u32 v125, v126, 13, v125
    ds_write_b128 v125, v[0:3] offset:0
    ds_write_b128 v125, v[4:7] offset:1024
    ds_write_b128 v125, v[8:11] offset:2048
    ds_write_b128 v125, v[12:15] offset:3072
    ds_write_b128 v125, v[16:19] offset:4096
    ds_write_b128 v125, v[20:23] offset:5120
    ds_write_b128 v125, v[24:27] offset:6144
    ds_write_b128 v125, v[28:31] offset:7168
    s_waitcnt lgkmcnt(0)
    s_waitcnt vmcnt(0)
    s_barrier
    v_add_u32 v90, 0x20000, v74
    v_add_u32 v91, 0x20000, v75
    v_add_u32 v92, 0x20000, v76
    v_add_u32 v93, 0x20000, v77
    ds_read_b64_tr_b16 v[0:1], v90 offset:0
    ds_read_b64_tr_b16 v[2:3], v90 offset:4096
    ds_read_b64_tr_b16 v[4:5], v90 offset:8
    ds_read_b64_tr_b16 v[6:7], v90 offset:4104
    ds_read_b64_tr_b16 v[8:9], v91 offset:0
    ds_read_b64_tr_b16 v[10:11], v91 offset:4096
    ds_read_b64_tr_b16 v[12:13], v91 offset:8
    ds_read_b64_tr_b16 v[14:15], v91 offset:4104
    ds_read_b64_tr_b16 v[16:17], v92 offset:0
    ds_read_b64_tr_b16 v[18:19], v92 offset:4096
    ds_read_b64_tr_b16 v[20:21], v92 offset:8
    ds_read_b64_tr_b16 v[22:23], v92 offset:4104
    ds_read_b64_tr_b16 v[24:25], v93 offset:0
    ds_read_b64_tr_b16 v[26:27], v93 offset:4096
    ds_read_b64_tr_b16 v[28:29], v93 offset:8
    ds_read_b64_tr_b16 v[30:31], v93 offset:4104
L_lw_95:
    s_waitcnt lgkmcnt(0)
    s_barrier
    v_mov_b32 v125, 0x20000
    v_bfe_u32 v126, v127, 0, 6
    v_lshl_add_u32 v125, v126, 4, v125
    v_bfe_u32 v126, v127, 6, 2
    v_lshl_add_u32 v125, v126, 13, v125
    ds_write_b128 v125, v[0:3] offset:0
    ds_write_b128 v125, v[4:7] offset:1024
    ds_write_b128 v125, v[8:11] offset:2048
    ds_write_b128 v125, v[12:15] offset:3072
    ds_write_b128 v125, v[16:19] offset:4096
    ds_write_b128 v125, v[20:23] offset:5120
    ds_write_b128 v125, v[24:27] offset:6144
    ds_write_b128 v125, v[28:31] offset:7168
    s_waitcnt lgkmcnt(0)
    v_mov_b32 v104, 0x0
    v_bfe_u32 v64, v127, 0, 6
    v_lshl_add_u32 v104, v64, 4, v104
    v_mov_b32 v105, 0x0
    v_bfe_u32 v64, v127, 0, 5
    v_lshl_add_u32 v105, v64, 7, v105
    v_mov_b32 v106, 0x0
    v_bfe_u32 v64, v127, 0, 4
    v_lshl_add_u32 v106, v64, 4, v106
    v_bfe_u32 v64, v127, 4, 2
    v_lshl_add_u32 v106, v64, 9, v106
    v_mov_b32 v107, 0x8000
    v_bfe_u32 v64, v127, 0, 6
    v_lshl_add_u32 v107, v64, 4, v107
    v_bfe_u32 v64, v127, 6, 2
    v_lshl_add_u32 v107, v64, 13, v107
    v_mov_b32 v108, 0x4000
    v_bfe_u32 v64, v127, 0, 4
    v_lshl_add_u32 v108, v64, 4, v108
    v_bfe_u32 v64, v127, 5, 1
    v_lshl_add_u32 v108, v64, 8, v108
    v_bfe_u32 v64, v127, 6, 2
    v_lshl_add_u32 v108, v64, 2, v108
    v_mov_b32 v109, 0x4000
    v_bfe_u32 v64, v127, 0, 4
    v_lshl_add_u32 v109, v64, 4, v109
    v_add_u32 v113, 0x10000, v107
    v_mov_b32 v114, 0x0
    v_bfe_u32 v64, v127, 0, 4
    v_lshl_add_u32 v114, v64, 10, v114
    v_bfe_u32 v64, v127, 4, 2
    v_lshl_add_u32 v114, v64, 4, v114
    v_bfe_u32 v64, v127, 6, 2
    v_lshl_add_u32 v114, v64, 8, v114
    s_mov_b32 s90, 0x00003f80
    s_mov_b32 s91, 0x3f800000
    s_mov_b32 s92, 0x3f803f80
    v_mov_b32 v110, 0
    v_mov_b32 v111, 1
    s_mov_b32 s34, 0
    s_lshl_b32 s80, s30, 7
    s_add_u32 s80, s80, 0x9400
    s_add_u32 s50, s28, s80
    s_addc_u32 s51, s29, 0
    s_mov_b32 s36, 0
    s_cmp_lg_u32 s31, 0
    s_cbranch_scc1 L_pa_init_ok
    v_mov_b32 v64, 12
L_pa_init:
    global_load_dword v65, v64, s[26:27] sc1
    s_waitcnt vmcnt(0)
    v_readfirstlane_b32 s80, v65
    s_cmp_ge_u32 s80, 32
    s_cbranch_scc1 L_pa_init_ok
    s_sleep 4
    s_sub_u32 s62, s62, 1
    s_cbranch_scc0 L_pa_init
    s_movk_i32 s63, 10
    s_branch L_fail_far
L_pa_init_ok:
    s_cmp_lg_u32 s31, 0
    s_cbranch_scc1 L_pa_init2_ok
    v_mov_b32 v64, 64
L_pa_init2:
    global_load_dword v65, v64, s[26:27] sc1
    s_waitcnt vmcnt(0)
    v_readfirstlane_b32 s80, v65
    s_cmp_ge_u32 s80, 32
    s_cbranch_scc1 L_pa_init2_ok
    s_sleep 4
    s_sub_u32 s62, s62, 1
    s_cbranch_scc0 L_pa_init2
    s_movk_i32 s63, 10
    s_branch L_fail_far
L_pa_init2_ok:
    s_barrier
L_pa_layer:
    s_sub_u32 s33, s30, 24
L_pa_loop:
    s_mul_i32 s80, s34, 0x5200000
    s_lshr_b32 s81, s33, 1
    s_and_b32 s82, s33, 1
    s_lshl_b32 s83, s81, 15
    s_lshl_b32 s84, s82, 8
    s_add_u32 s83, s83, s84
    s_lshl_b32 s84, s31, 13
    s_add_u32 s83, s83, s84
    s_add_u32 s83, s83, s80
    s_add_u32 s85, s83, 0x900000
    s_add_u32 s38, s28, s85
    s_addc_u32 s39, s29, 0
    s_add_u32 s85, s83, 0x101000
    s_add_u32 s40, s28, s85
    s_addc_u32 s41, s29, 0
    s_add_u32 s85, s83, 0xb01000
    s_add_u32 s42, s28, s85
    s_addc_u32 s43, s29, 0
    s_add_u32 s85, s83, 0xd01000
    s_add_u32 s44, s28, s85
    s_addc_u32 s45, s29, 0
    s_lshl_b32 s85, s33, 15
    s_add_u32 s85, s85, s84
    s_add_u32 s85, s85, s80
    s_add_u32 s85, s85, 0xf01000
    s_add_u32 s46, s28, s85
    s_addc_u32 s47, s29, 0
    s_and_b32 s85, s81, 1
    s_lshl_b32 s85, s85, 12
    s_add_u32 s85, s85, 0x8000
    s_add_u32 s48, s28, s85
    s_addc_u32 s49, s29, 0
    s_lshr_b32 s35, s81, 1
    s_lshl_b32 s85, s34, 5
    s_add_u32 s35, s35, s85
    s_add_u32 s35, s35, 1
    s_add_u32 s36, s36, 1
    v_mov_b64 v[32:33], 0
    v_mov_b64 v[34:35], 0
    global_store_dwordx4 v104, v[32:35], s[46:47] offset:-4096 sc1
    global_store_dwordx4 v104, v[32:35], s[46:47] offset:-3072 sc1
    global_store_dwordx4 v104, v[32:35], s[46:47] offset:-2048 sc1
    global_store_dwordx4 v104, v[32:35], s[46:47] offset:-1024 sc1
    global_store_dwordx4 v104, v[32:35], s[46:47] offset:0 sc1
    global_store_dwordx4 v104, v[32:35], s[46:47] offset:1024 sc1
    global_store_dwordx4 v104, v[32:35], s[46:47] offset:2048 sc1
    global_store_dwordx4 v104, v[32:35], s[46:47] offset:3072 sc1
    ds_read_b128 v[48:51], v107 offset:0
    ds_read_b128 v[52:55], v107 offset:1024
    ds_read_b128 v[56:59], v107 offset:2048
    ds_read_b128 v[60:63], v107 offset:3072
    ds_read_b128 v[64:67], v107 offset:4096
    ds_read_b128 v[68:71], v107 offset:5120
    ds_read_b128 v[72:75], v107 offset:6144
    ds_read_b128 v[76:79], v107 offset:7168
    s_lshl_b32 s80, s31, 12
    s_cmp_lt_u32 s33, 8
    s_cbranch_scc1 L_pa_dp
    s_cmp_lg_u32 s31, 0
    s_cbranch_scc1 L_pa_wo_ok
L_pa_wo:
    global_load_dword v112, v105, s[48:49] sc1
    s_waitcnt vmcnt(0)
    v_cmp_gt_u32 vcc, s35, v112
    s_cbranch_vccz L_pa_wo_ok
    s_sub_u32 s62, s62, 1
    s_cbranch_scc0 L_pa_wo
    s_movk_i32 s63, 15
    s_branch L_fail_far
L_pa_wo_ok:
    s_barrier
    s_add_u32 m0, s80, 0
    s_nop 0
    global_load_lds_dwordx4 v106, s[38:39] sc1
    s_add_u32 s38, s38, 0x800
    s_addc_u32 s39, s39, 0
    s_add_u32 m0, s80, 1024
    s_nop 0
    global_load_lds_dwordx4 v106, s[38:39] sc1
    s_add_u32 s38, s38, 0x800
    s_addc_u32 s39, s39, 0
    s_add_u32 m0, s80, 2048
    s_nop 0
    global_load_lds_dwordx4 v106, s[38:39] sc1
    s_add_u32 s38, s38, 0x800
    s_addc_u32 s39, s39, 0
    s_add_u32 m0, s80, 3072
    s_nop 0
    global_load_lds_dwordx4 v106, s[38:39] sc1
    s_waitcnt vmcnt(0)
L_pa_dp_ok:
    s_barrier
    s_cmp_eq_u32 s34, 0
    s_cbranch_scc1 L_pa_r0
    global_load_dwordx4 v[80:83], v106, s[40:41] offset:-4096 sc1
    global_load_dwordx4 v[84:87], v106, s[40:41] offset:-2048 sc1
    global_load_dwordx4 v[88:91], v106, s[40:41] offset:0 sc1
    global_load_dwordx4 v[92:95], v106, s[40:41] offset:2048 sc1
    s_branch L_pa_r1
L_pa_r0:
    s_lshl_b32 s80, s33, 14
    s_add_u32 s40, s4, s80
    s_addc_u32 s41, s5, 0
    global_load_dwordx4 v[80:83], v114, s[40:41] offset:0
    global_load_dwordx4 v[84:87], v114, s[40:41] offset:64
    global_load_dwordx4 v[88:91], v114, s[40:41] offset:128
    global_load_dwordx4 v[92:95], v114, s[40:41] offset:192
L_pa_r1:
    ds_read_b128 v[32:35], v104 offset:12288
    ds_read_b128 v[36:39], v104 offset:0
    ds_read_b128 v[40:43], v104 offset:1024
    s_waitcnt lgkmcnt(2)
    ds_read_b128 v[44:47], v104 offset:2048
    v_mfma_f32_16x16x32_bf16 v[0:3], v[48:51], v[32:35], 0
    ds_read_b128 v[48:51], v107 offset:32768
    v_mfma_f32_16x16x32_bf16 v[4:7], v[52:55], v[32:35], 0
    ds_read_b128 v[52:55], v107 offset:33792
    v_mfma_f32_16x16x32_bf16 v[8:11], v[56:59], v[32:35], 0
    ds_read_b128 v[56:59], v107 offset:34816
    v_mfma_f32_16x16x32_bf16 v[12:15], v[60:63], v[32:35], 0
    ds_read_b128 v[60:63], v107 offset:35840
    v_mfma_f32_16x16x32_bf16 v[16:19], v[64:67], v[32:35], 0
    ds_read_b128 v[64:67], v107 offset:36864
    v_mfma_f32_16x16x32_bf16 v[20:23], v[68:71], v[32:35], 0
    ds_read_b128 v[68:71], v107 offset:37888
    v_mfma_f32_16x16x32_bf16 v[24:27], v[72:75], v[32:35], 0
    ds_read_b128 v[72:75], v107 offset:38912
    v_mfma_f32_16x16x32_bf16 v[28:31], v[76:79], v[32:35], 0
    ds_read_b128 v[76:79], v107 offset:39936
    s_waitcnt lgkmcnt(10)
    ds_read_b128 v[32:35], v104 offset:13312
    v_mfma_f32_16x16x32_bf16 v[0:3], a[0:3], v[36:39], v[0:3]
    v_mfma_f32_16x16x32_bf16 v[4:7], a[4:7], v[36:39], v[4:7]
    v_mfma_f32_16x16x32_bf16 v[8:11], a[8:11], v[36:39], v[8:11]
    v_mfma_f32_16x16x32_bf16 v[12:15], a[12:15], v[36:39], v[12:15]
    v_mfma_f32_16x16x32_bf16 v[16:19], a[16:19], v[36:39], v[16:19]
    v_mfma_f32_16x16x32_bf16 v[20:23], a[20:23], v[36:39], v[20:23]
    v_mfma_f32_16x16x32_bf16 v[24:27], a[24:27], v[36:39], v[24:27]
    v_mfma_f32_16x16x32_bf16 v[28:31], a[28:31], v[36:39], v[28:31]
    s_waitcnt lgkmcnt(10)
    ds_read_b128 v[36:39], v104 offset:3072
    v_mfma_f32_16x16x32_bf16 v[0:3], a[32:35], v[40:43], v[0:3]
    v_mfma_f32_16x16x32_bf16 v[4:7], a[36:39], v[40:43], v[4:7]
    v_mfma_f32_16x16x32_bf16 v[8:11], a[40:43], v[40:43], v[8:11]
    v_mfma_f32_16x16x32_bf16 v[12:15], a[44:47], v[40:43], v[12:15]
    v_mfma_f32_16x16x32_bf16 v[16:19], a[48:51], v[40:43], v[16:19]
    v_mfma_f32_16x16x32_bf16 v[20:23], a[52:55], v[40:43], v[20:23]
    v_mfma_f32_16x16x32_bf16 v[24:27], a[56:59], v[40:43], v[24:27]
    v_mfma_f32_16x16x32_bf16 v[28:31], a[60:63], v[40:43], v[28:31]
    s_waitcnt lgkmcnt(10)
    ds_read_b128 v[40:43], v104 offset:4096
    v_mfma_f32_16x16x32_bf16 v[0:3], a[64:67], v[44:47], v[0:3]
    v_mfma_f32_16x16x32_bf16 v[4:7], a[68:71], v[44:47], v[4:7]
    v_mfma_f32_16x16x32_bf16 v[8:11], a[72:75], v[44:47], v[8:11]
    v_mfma_f32_16x16x32_bf16 v[12:15], a[76:79], v[44:47], v[12:15]
    v_mfma_f32_16x16x32_bf16 v[16:19], a[80:83], v[44:47], v[16:19]
    v_mfma_f32_16x16x32_bf16 v[20:23], a[84:87], v[44:47], v[20:23]
    v_mfma_f32_16x16x32_bf16 v[24:27], a[88:91], v[44:47], v[24:27]
    v_mfma_f32_16x16x32_bf16 v[28:31], a[92:95], v[44:47], v[28:31]
    s_waitcnt lgkmcnt(2)
    ds_read_b128 v[44:47], v104 offset:5120
    v_mfma_f32_16x16x32_bf16 v[0:3], v[48:51], v[32:35], v[0:3]
    ds_read_b128 v[48:51], v113 offset:0
    v_mfma_f32_16x16x32_bf16 v[4:7], v[52:55], v[32:35], v[4:7]
    ds_read_b128 v[52:55], v113 offset:1024
    v_mfma_f32_16x16x32_bf16 v[8:11], v[56:59], v[32:35], v[8:11]
    ds_read_b128 v[56:59], v113 offset:2048
    v_mfma_f32_16x16x32_bf16 v[12:15], v[60:63], v[32:35], v[12:15]
    ds_read_b128 v[60:63], v113 offset:3072
    v_mfma_f32_16x16x32_bf16 v[16:19], v[64:67], v[32:35], v[16:19]
    ds_read_b128 v[64:67], v113 offset:4096
    v_mfma_f32_16x16x32_bf16 v[20:23], v[68:71], v[32:35], v[20:23]
    ds_read_b128 v[68:71], v113 offset:5120
    v_mfma_f32_16x16x32_bf16 v[24:27], v[72:75], v[32:35], v[24:27]
    ds_read_b128 v[72:75], v113 offset:6144
    v_mfma_f32_16x16x32_bf16 v[28:31], v[76:79], v[32:35], v[28:31]
    ds_read_b128 v[76:79], v113 offset:7168
    s_waitcnt lgkmcnt(10)
    ds_read_b128 v[32:35], v104 offset:14336
    v_mfma_f32_16x16x32_bf16 v[0:3], a[96:99], v[36:39], v[0:3]
    v_mfma_f32_16x16x32_bf16 v[4:7], a[100:103], v[36:39], v[4:7]
    v_mfma_f32_16x16x32_bf16 v[8:11], a[104:107], v[36:39], v[8:11]
    v_mfma_f32_16x16x32_bf16 v[12:15], a[108:111], v[36:39], v[12:15]
    v_mfma_f32_16x16x32_bf16 v[16:19], a[112:115], v[36:39], v[16:19]
    v_mfma_f32_16x16x32_bf16 v[20:23], a[116:119], v[36:39], v[20:23]
    v_mfma_f32_16x16x32_bf16 v[24:27], a[120:123], v[36:39], v[24:27]
    v_mfma_f32_16x16x32_bf16 v[28:31], a[124:127], v[36:39], v[28:31]
    s_waitcnt lgkmcnt(10)
    ds_read_b128 v[36:39], v104 offset:6144
    v_mfma_f32_16x16x32_bf16 v[0:3], a[128:131], v[40:43], v[0:3]
    v_mfma_f32_16x16x32_bf16 v[4:7], a[132:135], v[40:43], v[4:7]
    v_mfma_f32_16x16x32_bf16 v[8:11], a[136:139], v[40:43], v[8:11]
    v_mfma_f32_16x16x32_bf16 v[12:15], a[140:143], v[40:43], v[12:15]
    v_mfma_f32_16x16x32_bf16 v[16:19], a[144:147], v[40:43], v[16:19]
    v_mfma_f32_16x16x32_bf16 v[20:23], a[148:151], v[40:43], v[20:23]
    v_mfma_f32_16x16x32_bf16 v[24:27], a[152:155], v[40:43], v[24:27]
    v_mfma_f32_16x16x32_bf16 v[28:31], a[156:159], v[40:43], v[28:31]
    s_waitcnt lgkmcnt(10)
    ds_read_b128 v[40:43], v104 offset:7168
    v_mfma_f32_16x16x32_bf16 v[0:3], a[160:163], v[44:47], v[0:3]
    v_mfma_f32_16x16x32_bf16 v[4:7], a[164:167], v[44:47], v[4:7]
    v_mfma_f32_16x16x32_bf16 v[8:11], a[168:171], v[44:47], v[8:11]
    v_mfma_f32_16x16x32_bf16 v[12:15], a[172:175], v[44:47], v[12:15]
    v_mfma_f32_16x16x32_bf16 v[16:19], a[176:179], v[44:47], v[16:19]
    v_mfma_f32_16x16x32_bf16 v[20:23], a[180:183], v[44:47], v[20:23]
    v_mfma_f32_16x16x32_bf16 v[24:27], a[184:187], v[44:47], v[24:27]
    v_mfma_f32_16x16x32_bf16 v[28:31], a[188:191], v[44:47], v[28:31]
    s_waitcnt lgkmcnt(2)
    ds_read_b128 v[44:47], v104 offset:8192
    v_mfma_f32_16x16x32_bf16 v[0:3], v[48:51], v[32:35], v[0:3]
    ds_read_b128 v[48:51], v113 offset:32768
    v_mfma_f32_16x16x32_bf16 v[4:7], v[52:55], v[32:35], v[4:7]
    ds_read_b128 v[52:55], v113 offset:33792
    v_mfma_f32_16x16x32_bf16 v[8:11], v[56:59], v[32:35], v[8:11]
    ds_read_b128 v[56:59], v113 offset:34816
    v_mfma_f32_16x16x32_bf16 v[12:15], v[60:63], v[32:35], v[12:15]
    ds_read_b128 v[60:63], v113 offset:35840
    v_mfma_f32_16x16x32_bf16 v[16:19], v[64:67], v[32:35], v[16:19]
    ds_read_b128 v[64:67], v113 offset:36864
    v_mfma_f32_16x16x32_bf16 v[20:23], v[68:71], v[32:35], v[20:23]
    ds_read_b128 v[68:71], v113 offset:37888
    v_mfma_f32_16x16x32_bf16 v[24:27], v[72:75], v[32:35], v[24:27]
    ds_read_b128 v[72:75], v113 offset:38912
    v_mfma_f32_16x16x32_bf16 v[28:31], v[76:79], v[32:35], v[28:31]
    ds_read_b128 v[76:79], v113 offset:39936
    s_waitcnt lgkmcnt(10)
    ds_read_b128 v[32:35], v104 offset:15360
    v_mfma_f32_16x16x32_bf16 v[0:3], a[192:195], v[36:39], v[0:3]
    v_mfma_f32_16x16x32_bf16 v[4:7], a[196:199], v[36:39], v[4:7]
    v_mfma_f32_16x16x32_bf16 v[8:11], a[200:203], v[36:39], v[8:11]
    v_mfma_f32_16x16x32_bf16 v[12:15], a[204:207], v[36:39], v[12:15]
    v_mfma_f32_16x16x32_bf16 v[16:19], a[208:211], v[36:39], v[16:19]
    v_mfma_f32_16x16x32_bf16 v[20:23], a[212:215], v[36:39], v[20:23]
    v_mfma_f32_16x16x32_bf16 v[24:27], a[216:219], v[36:39], v[24:27]
    v_mfma_f32_16x16x32_bf16 v[28:31], a[220:223], v[36:39], v[28:31]
    s_waitcnt lgkmcnt(10)
    ds_read_b128 v[36:39], v104 offset:9216
    v_mfma_f32_16x16x32_bf16 v[0:3], a[224:227], v[40:43], v[0:3]
    v_mfma_f32_16x16x32_bf16 v[4:7], a[228:231], v[40:43], v[4:7]
    v_mfma_f32_16x16x32_bf16 v[8:11], a[232:235], v[40:43], v[8:11]
    v_mfma_f32_16x16x32_bf16 v[12:15], a[236:239], v[40:43], v[12:15]
    v_mfma_f32_16x16x32_bf16 v[16:19], a[240:243], v[40:43], v[16:19]
    v_mfma_f32_16x16x32_bf16 v[20:23], a[244:247], v[40:43], v[20:23]
    v_mfma_f32_16x16x32_bf16 v[24:27], a[248:251], v[40:43], v[24:27]
    v_mfma_f32_16x16x32_bf16 v[28:31], a[252:255], v[40:43], v[28:31]
    s_waitcnt lgkmcnt(10)
    ds_read_b128 v[40:43], v104 offset:10240
    v_mfma_f32_16x16x32_bf16 v[0:3], v[128:131], v[44:47], v[0:3]
    v_mfma_f32_16x16x32_bf16 v[4:7], v[132:135], v[44:47], v[4:7]
    v_mfma_f32_16x16x32_bf16 v[8:11], v[136:139], v[44:47], v[8:11]
    v_mfma_f32_16x16x32_bf16 v[12:15], v[140:143], v[44:47], v[12:15]
    v_mfma_f32_16x16x32_bf16 v[16:19], v[144:147], v[44:47], v[16:19]
    v_mfma_f32_16x16x32_bf16 v[20:23], v[148:151], v[44:47], v[20:23]
    v_mfma_f32_16x16x32_bf16 v[24:27], v[152:155], v[44:47], v[24:27]
    v_mfma_f32_16x16x32_bf16 v[28:31], v[156:159], v[44:47], v[28:31]
    s_waitcnt lgkmcnt(2)
    ds_read_b128 v[44:47], v104 offset:11264
    v_mfma_f32_16x16x32_bf16 v[0:3], v[48:51], v[32:35], v[0:3]
    v_mfma_f32_16x16x32_bf16 v[4:7], v[52:55], v[32:35], v[4:7]
    v_mfma_f32_16x16x32_bf16 v[8:11], v[56:59], v[32:35], v[8:11]
    v_mfma_f32_16x16x32_bf16 v[12:15], v[60:63], v[32:35], v[12:15]
    v_mfma_f32_16x16x32_bf16 v[16:19], v[64:67], v[32:35], v[16:19]
    v_mfma_f32_16x16x32_bf16 v[20:23], v[68:71], v[32:35], v[20:23]
    v_mfma_f32_16x16x32_bf16 v[24:27], v[72:75], v[32:35], v[24:27]
    v_mfma_f32_16x16x32_bf16 v[28:31], v[76:79], v[32:35], v[28:31]
    s_waitcnt lgkmcnt(2)
    v_mfma_f32_16x16x32_bf16 v[0:3], v[160:163], v[36:39], v[0:3]
    v_mfma_f32_16x16x32_bf16 v[4:7], v[164:167], v[36:39], v[4:7]
    v_mfma_f32_16x16x32_bf16 v[8:11], v[168:171], v[36:39], v[8:11]
    v_mfma_f32_16x16x32_bf16 v[12:15], v[172:175], v[36:39], v[12:15]
    v_mfma_f32_16x16x32_bf16 v[16:19], v[176:179], v[36:39], v[16:19]
    v_mfma_f32_16x16x32_bf16 v[20:23], v[180:183], v[36:39], v[20:23]
    v_mfma_f32_16x16x32_bf16 v[24:27], v[184:187], v[36:39], v[24:27]
    v_mfma_f32_16x16x32_bf16 v[28:31], v[188:191], v[36:39], v[28:31]
    s_waitcnt lgkmcnt(1)
    v_mfma_f32_16x16x32_bf16 v[0:3], v[192:195], v[40:43], v[0:3]
    v_mfma_f32_16x16x32_bf16 v[4:7], v[196:199], v[40:43], v[4:7]
    v_mfma_f32_16x16x32_bf16 v[8:11], v[200:203], v[40:43], v[8:11]
    v_mfma_f32_16x16x32_bf16 v[12:15], v[204:207], v[40:43], v[12:15]
    v_mfma_f32_16x16x32_bf16 v[16:19], v[208:211], v[40:43], v[16:19]
    v_mfma_f32_16x16x32_bf16 v[20:23], v[212:215], v[40:43], v[20:23]
    v_mfma_f32_16x16x32_bf16 v[24:27], v[216:219], v[40:43], v[24:27]
    v_mfma_f32_16x16x32_bf16 v[28:31], v[220:223], v[40:43], v[28:31]
    s_waitcnt lgkmcnt(0)
    v_mfma_f32_16x16x32_bf16 v[0:3], v[224:227], v[44:47], v[0:3]
    v_mfma_f32_16x16x32_bf16 v[4:7], v[228:231], v[44:47], v[4:7]
    v_mfma_f32_16x16x32_bf16 v[8:11], v[232:235], v[44:47], v[8:11]
    v_mfma_f32_16x16x32_bf16 v[12:15], v[236:239], v[44:47], v[12:15]
    v_mfma_f32_16x16x32_bf16 v[16:19], v[240:243], v[44:47], v[16:19]
    v_mfma_f32_16x16x32_bf16 v[20:23], v[244:247], v[44:47], v[20:23]
    v_mfma_f32_16x16x32_bf16 v[24:27], v[248:251], v[44:47], v[24:27]
    v_mfma_f32_16x16x32_bf16 v[28:31], v[252:255], v[44:47], v[28:31]
    s_waitcnt vmcnt(0)
    v_dot2_f32_bf16 v0, v80, s90, v0
    v_dot2_f32_bf16 v1, v80, s91, v1
    v_dot2_f32_bf16 v2, v81, s90, v2
    v_dot2_f32_bf16 v3, v81, s91, v3
    v_dot2_f32_bf16 v4, v82, s90, v4
    v_dot2_f32_bf16 v5, v82, s91, v5
    v_dot2_f32_bf16 v6, v83, s90, v6
    v_dot2_f32_bf16 v7, v83, s91, v7
    v_dot2_f32_bf16 v8, v84, s90, v8
    v_dot2_f32_bf16 v9, v84, s91, v9
    v_dot2_f32_bf16 v10, v85, s90, v10
    v_dot2_f32_bf16 v11, v85, s91, v11
    v_dot2_f32_bf16 v12, v86, s90, v12
    v_dot2_f32_bf16 v13, v86, s91, v13
    v_dot2_f32_bf16 v14, v87, s90, v14
    v_dot2_f32_bf16 v15, v87, s91, v15
    v_dot2_f32_bf16 v16, v88, s90, v16
    v_dot2_f32_bf16 v17, v88, s91, v17
    v_dot2_f32_bf16 v18, v89, s90, v18
    v_dot2_f32_bf16 v19, v89, s91, v19
    v_dot2_f32_bf16 v20, v90, s90, v20
    v_dot2_f32_bf16 v21, v90, s91, v21
    v_dot2_f32_bf16 v22, v91, s90, v22
    v_dot2_f32_bf16 v23, v91, s91, v23
    v_dot2_f32_bf16 v24, v92, s90, v24
    v_dot2_f32_bf16 v25, v92, s91, v25
    v_dot2_f32_bf16 v26, v93, s90, v26
    v_dot2_f32_bf16 v27, v93, s91, v27
    v_dot2_f32_bf16 v28, v94, s90, v28
    v_dot2_f32_bf16 v29, v94, s91, v29
    v_dot2_f32_bf16 v30, v95, s90, v30
    v_dot2_f32_bf16 v31, v95, s91, v31
    v_cvt_pk_bf16_f32 v80, v0, v1
    v_cvt_pk_bf16_f32 v81, v2, v3
    v_cvt_pk_bf16_f32 v82, v4, v5
    v_cvt_pk_bf16_f32 v83, v6, v7
    v_cvt_pk_bf16_f32 v84, v8, v9
    v_cvt_pk_bf16_f32 v85, v10, v11
    v_cvt_pk_bf16_f32 v86, v12, v13
    v_cvt_pk_bf16_f32 v87, v14, v15
    v_cvt_pk_bf16_f32 v88, v16, v17
    v_cvt_pk_bf16_f32 v89, v18, v19
    v_cvt_pk_bf16_f32 v90, v20, v21
    v_cvt_pk_bf16_f32 v91, v22, v23
    v_cvt_pk_bf16_f32 v92, v24, v25
    v_cvt_pk_bf16_f32 v93, v26, v27
    v_cvt_pk_bf16_f32 v94, v28, v29
    v_cvt_pk_bf16_f32 v95, v30, v31
    v_dot2_f32_bf16 v96, v80, s92, 0
    v_dot2_f32_bf16 v97, v80, v80, 0
    v_dot2_f32_bf16 v96, v81, s92, v96
    v_dot2_f32_bf16 v97, v81, v81, v97
    v_dot2_f32_bf16 v96, v82, s92, v96
    v_dot2_f32_bf16 v97, v82, v82, v97
    v_dot2_f32_bf16 v96, v83, s92, v96
    v_dot2_f32_bf16 v97, v83, v83, v97
    v_dot2_f32_bf16 v96, v84, s92, v96
    v_dot2_f32_bf16 v97, v84, v84, v97
    v_dot2_f32_bf16 v96, v85, s92, v96
    v_dot2_f32_bf16 v97, v85, v85, v97
    v_dot2_f32_bf16 v96, v86, s92, v96
    v_dot2_f32_bf16 v97, v86, v86, v97
    v_dot2_f32_bf16 v96, v87, s92, v96
    v_dot2_f32_bf16 v97, v87, v87, v97
    v_dot2_f32_bf16 v96, v88, s92, v96
    v_dot2_f32_bf16 v97, v88, v88, v97
    v_dot2_f32_bf16 v96, v89, s92, v96
    v_dot2_f32_bf16 v97, v89, v89, v97
    v_dot2_f32_bf16 v96, v90, s92, v96
    v_dot2_f32_bf16 v97, v90, v90, v97
    v_dot2_f32_bf16 v96, v91, s92, v96
    v_dot2_f32_bf16 v97, v91, v91, v97
    v_dot2_f32_bf16 v96, v92, s92, v96
    v_dot2_f32_bf16 v97, v92, v92, v97
    v_dot2_f32_bf16 v96, v93, s92, v96
    v_dot2_f32_bf16 v97, v93, v93, v97
    v_dot2_f32_bf16 v96, v94, s92, v96
    v_dot2_f32_bf16 v97, v94, v94, v97
    v_dot2_f32_bf16 v96, v95, s92, v96
    v_dot2_f32_bf16 v97, v95, v95, v97
    s_nop 2
    v_permlane32_swap_b32 v96, v97
    v_add_f32 v96, v96, v97
    v_mov_b32 v97, v96
    s_nop 1
    v_permlane16_swap_b32 v96, v97
    v_add_f32 v96, v96, v97
    ds_write_b32 v108, v96
    s_waitcnt lgkmcnt(0)
    s_barrier
    ds_read_b128 v[48:51], v109 offset:0
    ds_read_b128 v[52:55], v109 offset:256
    s_waitcnt lgkmcnt(0)
    v_pk_add_f32 v[48:49], v[48:49], v[50:51]
    v_pk_add_f32 v[52:53], v[52:53], v[54:55]
    v_add_f32 v96, v48, v49
    v_add_f32 v97, v52, v53
    v_mul_f32 v96, 0x3b000000, v96
    v_mul_f32 v97, 0x3b000000, v97
    v_fma_f32 v97, -v96, v96, v97
    v_max_f32 v97, 0, v97
    v_add_f32 v97, 0x3727c5ac, v97
    v_rsq_f32 v97, v97
    s_nop 0
    v_mul_f32 v96, v96, v97
    v_pk_fma_f32 v[0:1], v[0:1], v[96:97], v[96:97] op_sel:[0,1,0] op_sel_hi:[1,1,0] neg_lo:[0,0,1] neg_hi:[0,0,1]
    v_pk_fma_f32 v[2:3], v[2:3], v[96:97], v[96:97] op_sel:[0,1,0] op_sel_hi:[1,1,0] neg_lo:[0,0,1] neg_hi:[0,0,1]
    v_pk_fma_f32 v[4:5], v[4:5], v[96:97], v[96:97] op_sel:[0,1,0] op_sel_hi:[1,1,0] neg_lo:[0,0,1] neg_hi:[0,0,1]
    v_pk_fma_f32 v[6:7], v[6:7], v[96:97], v[96:97] op_sel:[0,1,0] op_sel_hi:[1,1,0] neg_lo:[0,0,1] neg_hi:[0,0,1]
    v_cvt_pk_bf16_f32 v32, v0, v1
    v_cvt_pk_bf16_f32 v33, v2, v3
    v_cvt_pk_bf16_f32 v34, v4, v5
    v_cvt_pk_bf16_f32 v35, v6, v7
    v_min_u32 v32, -2, v32
    v_min_u32 v33, -2, v33
    v_min_u32 v34, -2, v34
    v_min_u32 v35, -2, v35
    global_store_dwordx4 v106, v[32:35], s[44:45] offset:-4096 sc1
    v_pk_fma_f32 v[8:9], v[8:9], v[96:97], v[96:97] op_sel:[0,1,0] op_sel_hi:[1,1,0] neg_lo:[0,0,1] neg_hi:[0,0,1]
    v_pk_fma_f32 v[10:11], v[10:11], v[96:97], v[96:97] op_sel:[0,1,0] op_sel_hi:[1,1,0] neg_lo:[0,0,1] neg_hi:[0,0,1]
    v_pk_fma_f32 v[12:13], v[12:13], v[96:97], v[96:97] op_sel:[0,1,0] op_sel_hi:[1,1,0] neg_lo:[0,0,1] neg_hi:[0,0,1]
    v_pk_fma_f32 v[14:15], v[14:15], v[96:97], v[96:97] op_sel:[0,1,0] op_sel_hi:[1,1,0] neg_lo:[0,0,1] neg_hi:[0,0,1]
    v_cvt_pk_bf16_f32 v36, v8, v9
    v_cvt_pk_bf16_f32 v37, v10, v11
    v_cvt_pk_bf16_f32 v38, v12, v13
    v_cvt_pk_bf16_f32 v39, v14, v15
    v_min_u32 v36, -2, v36
    v_min_u32 v37, -2, v37
    v_min_u32 v38, -2, v38
    v_min_u32 v39, -2, v39
    global_store_dwordx4 v106, v[36:39], s[44:45] offset:-2048 sc1
    v_pk_fma_f32 v[16:17], v[16:17], v[96:97], v[96:97] op_sel:[0,1,0] op_sel_hi:[1,1,0] neg_lo:[0,0,1] neg_hi:[0,0,1]
    v_pk_fma_f32 v[18:19], v[18:19], v[96:97], v[96:97] op_sel:[0,1,0] op_sel_hi:[1,1,0] neg_lo:[0,0,1] neg_hi:[0,0,1]
    v_pk_fma_f32 v[20:21], v[20:21], v[96:97], v[96:97] op_sel:[0,1,0] op_sel_hi:[1,1,0] neg_lo:[0,0,1] neg_hi:[0,0,1]
    v_pk_fma_f32 v[22:23], v[22:23], v[96:97], v[96:97] op_sel:[0,1,0] op_sel_hi:[1,1,0] neg_lo:[0,0,1] neg_hi:[0,0,1]
    v_cvt_pk_bf16_f32 v40, v16, v17
    v_cvt_pk_bf16_f32 v41, v18, v19
    v_cvt_pk_bf16_f32 v42, v20, v21
    v_cvt_pk_bf16_f32 v43, v22, v23
    v_min_u32 v40, -2, v40
    v_min_u32 v41, -2, v41
    v_min_u32 v42, -2, v42
    v_min_u32 v43, -2, v43
    global_store_dwordx4 v106, v[40:43], s[44:45] offset:0 sc1
    v_pk_fma_f32 v[24:25], v[24:25], v[96:97], v[96:97] op_sel:[0,1,0] op_sel_hi:[1,1,0] neg_lo:[0,0,1] neg_hi:[0,0,1]
    v_pk_fma_f32 v[26:27], v[26:27], v[96:97], v[96:97] op_sel:[0,1,0] op_sel_hi:[1,1,0] neg_lo:[0,0,1] neg_hi:[0,0,1]
    v_pk_fma_f32 v[28:29], v[28:29], v[96:97], v[96:97] op_sel:[0,1,0] op_sel_hi:[1,1,0] neg_lo:[0,0,1] neg_hi:[0,0,1]
    v_pk_fma_f32 v[30:31], v[30:31], v[96:97], v[96:97] op_sel:[0,1,0] op_sel_hi:[1,1,0] neg_lo:[0,0,1] neg_hi:[0,0,1]
    v_cvt_pk_bf16_f32 v44, v24, v25
    v_cvt_pk_bf16_f32 v45, v26, v27
    v_cvt_pk_bf16_f32 v46, v28, v29
    v_cvt_pk_bf16_f32 v47, v30, v31
    v_min_u32 v44, -2, v44
    v_min_u32 v45, -2, v45
    v_min_u32 v46, -2, v46
    v_min_u32 v47, -2, v47
    global_store_dwordx4 v106, v[44:47], s[44:45] offset:2048 sc1
    global_store_dwordx4 v106, v[80:83], s[42:43] offset:-4096 sc1
    global_store_dwordx4 v106, v[84:87], s[42:43] offset:-2048 sc1
    global_store_dwordx4 v106, v[88:91], s[42:43] offset:0 sc1
    global_store_dwordx4 v106, v[92:95], s[42:43] offset:2048 sc1
    s_waitcnt vmcnt(0)
    s_barrier
    s_cmp_lg_u32 s31, 0
    s_cbranch_scc1 L_pa_pub
    v_mov_b32 v111, s36
    s_mov_b64 exec, 1
    global_store_dword v110, v111, s[50:51] sc1
    s_mov_b64 exec, -1
L_pa_pub:
    s_add_u32 s33, s33, 8
    s_cmp_lt_u32 s33, 128
    s_cbranch_scc1 L_pa_loop
    s_add_u32 s34, s34, 1
    s_cmp_lt_u32 s34, 2
    s_cbranch_scc1 L_pa_layer
    s_endpgm
L_pa_dp:
    s_add_u32 s38, s38, 0x1000
    s_addc_u32 s39, s39, 0
L_pa_dp1:
    global_load_dwordx4 v[80:83], v106, s[38:39] offset:-4096 sc1
    global_load_dwordx4 v[84:87], v106, s[38:39] offset:-2048 sc1
    global_load_dwordx4 v[88:91], v106, s[38:39] offset:0 sc1
    global_load_dwordx4 v[92:95], v106, s[38:39] offset:2048 sc1
    s_waitcnt vmcnt(0)
    v_max_u32 v112, v80, v81
    v_max3_u32 v112, v112, v82, v83
    v_max3_u32 v112, v112, v84, v85
    v_max3_u32 v112, v112, v86, v87
    v_max3_u32 v112, v112, v88, v89
    v_max3_u32 v112, v112, v90, v91
    v_max3_u32 v112, v112, v92, v93
    v_max3_u32 v112, v112, v94, v95
    v_cmp_eq_u32 vcc, -1, v112
    s_cbranch_vccz L_pa_dp2
    s_sub_u32 s62, s62, 1
    s_cbranch_scc0 L_pa_dp1
    s_movk_i32 s63, 23
    s_branch L_fail_far
L_pa_dp2:
    v_add_u32 v112, s80, v104
    ds_write_b128 v112, v[80:83] offset:0
    ds_write_b128 v112, v[84:87] offset:1024
    ds_write_b128 v112, v[88:91] offset:2048
    ds_write_b128 v112, v[92:95] offset:3072
    s_waitcnt lgkmcnt(0)
    s_branch L_pa_dp_ok
L_code_end:
    s_endpgm
.section .rodata,"a"
.p2align 6
.amdhsa_kernel interleave_layers__softmax_full_mha__memory_aug_recurrent_mem_tr__prompt_kernel
  .amdhsa_next_free_vgpr 512
  .amdhsa_next_free_sgpr 102
  .amdhsa_accum_offset 256
  .amdhsa_group_segment_fixed_size 0
  .amdhsa_kernarg_size 104
  .amdhsa_user_sgpr_count 2
  .amdhsa_user_sgpr_kernarg_segment_ptr 1
  .amdhsa_system_sgpr_workgroup_id_x 1
.end_amdhsa_kernel
```
